```python
import torch

def _softmax(x, axis=-1):
    return torch.softmax(x, dim=axis)
def _gelu(x):
    return torch.nn.functional.gelu(x, approximate="tanh")
def _silu(x):
    return torch.nn.functional.silu(x)
def _sigmoid(x):
    return torch.sigmoid(x)
def _layernorm(x, axis=-1, eps=1e-5):
    m = x.mean(dim=axis, keepdim=True)
    v = x.var(dim=axis, keepdim=True, unbiased=False)
    return (x - m) / torch.sqrt(v + eps)
def _scatter_add(tgt, idx, src, axis=0):
    return tgt.clone().index_add_(axis, idx, src)
def _segment_sum(src, seg, n):
    out = torch.zeros((n,) + src.shape[1:], dtype=src.dtype)
    return out.index_add_(0, seg, src)
def _pad(x, pw):
    flat = tuple(v for pair in reversed(pw) for v in pair)
    return torch.nn.functional.pad(x, flat)

kernel_name = 'standalone__modern_conv_block_slak__vision'

def setup_inputs():

    _w = (lambda a: (lambda t: t.to(torch.bfloat16) if t.is_floating_point() else t)(torch.as_tensor(a)))
    H = W = 384
    C = 384
    K = 1
    return {
        "x": _w((lambda *s: torch.randn(*s, dtype=torch.bfloat16) * 0.05)(1, H, W, C)),
        "dw": _w((lambda *s: torch.randn(*s, dtype=torch.bfloat16) * 0.05)(K, K, C)),
        "w1": _w((lambda *s: torch.randn(*s, dtype=torch.bfloat16) * 0.05)(C, 4 * C)),
        "w2": _w((lambda *s: torch.randn(*s, dtype=torch.bfloat16) * 0.05)(4 * C, C)),
        "grn_g": _w((lambda *s: torch.randn(*s, dtype=torch.bfloat16) * 0.05)(4 * C)),
        "grn_b": _w((lambda *s: torch.randn(*s, dtype=torch.bfloat16) * 0.05)(4 * C)),
    }

def reference(x, dw, w1, w2, grn_g, grn_b):
    B, H, W, C = x.shape
    K = dw.shape[0]
    pad = K // 2
    xp = _pad(x, ((0,0),(pad,pad),(pad,pad),(0,0)))
    out = torch.zeros_like(x)
    for i in range(K):
        for j in range(K):
            out = out + xp[:, i:i+H, j:j+W, :] * dw[i, j][None, None, None, :]
    h = _layernorm(out, axis=-1)
    h = _gelu(h @ w1)
    gx = torch.sqrt((h * h).sum(axis=(1, 2), keepdims=True) + 1e-6)
    nx = gx / (gx.mean(axis=-1, keepdims=True) + 1e-6)
    h = grn_g[None, None, None, :] * (h * nx) + grn_b[None, None, None, :] + h
    return x + h @ w2
```

```asm
; @launch kernel=gemm1_kernel grid=(256,1,1) block=(512,1,1) lds=151552
; @launch kernel=gemm2_kernel grid=(256,1,1) block=(512,1,1) lds=159744
.amdgcn_target "amdgcn-amd-amdhsa--gfx950"
.text
.globl gemm1_kernel
.p2align 8
.type gemm1_kernel,@function
gemm1_kernel:
    s_cmp_ge_u32 s2, 256
    s_cbranch_scc1 K1_end
    s_load_dwordx4 s[4:7], s[0:1], 0
    s_load_dwordx2 s[12:13], s[0:1], 16
    s_load_dwordx2 s[26:27], s[0:1], 48
    s_load_dwordx2 s[28:29], s[0:1], 56
    s_load_dwordx2 s[24:25], s[0:1], 64
    v_lshrrev_b32 v8, 6, v0
    v_and_b32 v9, 63, v0
    v_readfirstlane_b32 s30, v8
    v_lshrrev_b32 v12, 3, v9
    v_and_b32 v13, 7, v9
    v_lshrrev_b32 v14, 1, v12
    v_xor_b32 v14, v14, v13
    v_mul_u32_u24 v2, 768, v12
    v_lshl_add_u32 v2, v14, 4, v2
    s_lshr_b32 s36, s2, 4
    s_and_b32 s56, s36, 0
    s_lshl_b32 s36, s36, 4
    s_and_b32 s37, s2, 7
    s_lshl_b32 s37, s37, 1
    s_add_u32 s36, s36, s37
    s_bfe_u32 s37, s2, 0x10003
    s_add_u32 s41, s36, s37
    s_mul_i32 s52, s37, 12
    s_add_u32 s53, s52, 12
    s_lshr_b32 s31, s30, 2
    s_and_b32 s37, s30, 3
    s_add_u32 s36, s36, s31
    s_mul_i32 s40, s36, 442368
    s_mul_i32 s43, s37, 36864
    s_add_u32 s40, s40, s43
    s_add_u32 s40, s40, 294912
    s_mul_i32 s39, s36, 1744896
    s_add_u32 s39, s39, 1179648
    s_mul_i32 s59, s36, 442368
    s_mul_i32 s49, s41, 442368
    s_xor_b32 s43, s30, 4
    s_mul_i32 s43, s43, 36864
    s_add_u32 s49, s49, s43
    s_mul_i32 s82, s41, 1744896
    s_xor_b32 s43, s31, 1
    s_mul_i32 s43, s43, 589824
    s_add_u32 s82, s82, s43
    s_mov_b32 s83, 0
    s_mov_b32 s84, 24
    s_mov_b32 s85, 23
    s_mov_b32 s86, -1
    s_bitcmp1_b32 s2, 4
    s_cbranch_scc0 K1_noswap
    s_mov_b32 s43, s40
    s_mov_b32 s40, s49
    s_mov_b32 s49, s43
    s_mov_b32 s43, s39
    s_mov_b32 s39, s82
    s_mov_b32 s82, s43
    s_mov_b32 s43, s52
    s_mov_b32 s52, s83
    s_mov_b32 s83, s43
    s_mov_b32 s43, s53
    s_mov_b32 s53, s84
    s_mov_b32 s84, s43
    s_mov_b32 s43, s85
    s_mov_b32 s85, s86
    s_mov_b32 s86, s43
K1_noswap:
    s_mul_i32 s46, s30, 6144
    s_mov_b32 s57, s46
    s_add_u32 s3, s46, 49152
    s_waitcnt lgkmcnt(0)
    s_mov_b32 s8, s4
    s_mov_b32 s9, s5
    s_mov_b32 s10, 113246208
    s_mov_b32 s11, 0x00020000
    s_mov_b32 s16, s6
    s_mov_b32 s17, s7
    s_mov_b32 s18, 768
    s_mov_b32 s19, 0x00020000
    v_lshlrev_b32 v156, 2, v0
    buffer_load_dword v152, v156, s[16:19], 0 offen
    s_add_u32 m0, s57, 0
    s_add_u32 s58, s40, 384
    buffer_load_dwordx4 v2, s[8:11], s58 offen nt lds
    s_add_u32 m0, m0, 1024
    s_add_u32 s58, s58, 6144
    buffer_load_dwordx4 v2, s[8:11], s58 offen nt lds
    s_add_u32 m0, s57, 2048
    s_add_u32 s58, s40, 512
    buffer_load_dwordx4 v2, s[8:11], s58 offen nt lds
    s_add_u32 m0, m0, 1024
    s_add_u32 s58, s58, 6144
    buffer_load_dwordx4 v2, s[8:11], s58 offen nt lds
    s_add_u32 m0, s57, 4096
    s_add_u32 s58, s40, 640
    buffer_load_dwordx4 v2, s[8:11], s58 offen nt lds
    s_add_u32 m0, m0, 1024
    s_add_u32 s58, s58, 6144
    buffer_load_dwordx4 v2, s[8:11], s58 offen nt lds
    s_add_u32 m0, s3, 0
    s_add_u32 s58, s40, 256
    buffer_load_dwordx4 v2, s[8:11], s58 offen nt lds
    s_add_u32 m0, m0, 1024
    s_add_u32 s58, s58, 6144
    buffer_load_dwordx4 v2, s[8:11], s58 offen nt lds
    s_add_u32 m0, s3, 2048
    s_add_u32 s58, s40, 128
    buffer_load_dwordx4 v2, s[8:11], s58 offen nt lds
    s_add_u32 m0, m0, 1024
    s_add_u32 s58, s58, 6144
    buffer_load_dwordx4 v2, s[8:11], s58 offen nt lds
    s_add_u32 m0, s3, 4096
    s_add_u32 s58, s40, 0
    buffer_load_dwordx4 v2, s[8:11], s58 offen nt lds
    s_add_u32 m0, m0, 1024
    s_add_u32 s58, s58, 6144
    buffer_load_dwordx4 v2, s[8:11], s58 offen nt lds
    s_mov_b64 vcc, 0
    v_and_b32 v10, 15, v9
    v_lshrrev_b32 v11, 4, v9
    v_lshlrev_b32 v4, 2, v11
    v_xor_b32 v4, v4, v9
    v_lshlrev_b32 v4, 4, v4
    s_mul_i32 s43, s37, 3072
    v_add_u32 v4, s43, v4
    v_lshlrev_b32 v5, 5, v11
    v_add_u32 v5, 147456, v5
    v_and_b32 v14, 2, v12
    v_xor_b32 v13, v13, v14
    v_mul_u32_u24 v1, 3072, v12
    v_lshl_add_u32 v1, v13, 4, v1
    v_xor_b32 v6, 64, v1
    v_lshrrev_b32 v12, 2, v10
    v_lshl_add_u32 v13, v11, 3, v12
    v_lshlrev_b32 v7, 7, v13
    v_lshrrev_b32 v12, 1, v12
    v_and_b32_e64 v13, 1, v11
    v_lshl_add_u32 v12, v13, 1, v12
    v_lshl_add_u32 v7, v12, 5, v7
    v_and_b32_e64 v12, 3, v10
    v_lshl_add_u32 v7, v12, 3, v7
    s_mov_b32 s38, 0xc09d4000
    s_mov_b32 s44, 0xc4eac4ea
    s_mul_i32 s50, s30, 147456
    s_add_u32 s42, s52, s56
    s_lshl_b32 s54, s52, 7
    s_add_u32 s54, s54, s50
    s_lshl_b32 s55, s53, 7
    s_add_u32 s55, s55, s50
    s_lshl_b32 s45, s56, 7
    s_add_u32 s45, s45, s54
    s_mov_b32 s35, s46
    s_mov_b32 s51, 1
    s_mov_b32 s14, 1179648
    s_mov_b32 s15, 0x00020000
    s_mov_b32 s20, s28
    s_mov_b32 s21, s29
    s_mov_b32 s22, 256
    s_mov_b32 s23, 0x00020000
    v_lshlrev_b32 v156, 3, v0
    v_add_u32 v156, 147456, v156
    s_waitcnt vmcnt(12)
    s_nop 0
    v_and_b32 v154, 0xffff, v152
    v_and_b32 v155, 0xffff0000, v152
    ds_write_b64 v156, v[154:155]
    v_mov_b32 v208, 1
    s_cmp_lg_u32 s30, 0
    s_cbranch_scc1 K1_pj
    v_lshlrev_b32 v157, 8, v0
    s_and_b32 s36, s2, 7
    s_lshl_b32 s36, s36, 2
    buffer_atomic_add v208, v157, s[20:23], s36 offen sc0
K1_pj:
    v_mov_b32 v232, 0
    v_mov_b32 v233, 0
    v_mov_b32 v234, 0
    v_mov_b32 v235, 0
    v_mov_b32 v236, 0
    v_mov_b32 v237, 0
    v_mov_b32 v238, 0
    v_mov_b32 v239, 0
    v_mov_b32 v240, 0
    v_mov_b32 v241, 0
    v_mov_b32 v242, 0
    v_mov_b32 v243, 0
    v_mov_b32 v244, 0
    v_mov_b32 v245, 0
    v_mov_b32 v246, 0
    v_mov_b32 v247, 0
    v_mov_b32 v248, 0
    v_mov_b32 v249, 0
    v_mov_b32 v250, 0
    v_mov_b32 v251, 0
    v_mov_b32 v252, 0
    v_mov_b32 v253, 0
    v_mov_b32 v254, 0
    v_mov_b32 v255, 0
    s_mov_b32 s16, s24
    s_mov_b32 s17, s25
    s_mov_b32 s18, 446693376
    s_mov_b32 s19, 0x00020000
    s_mov_b32 s32, 0
    s_sub_u32 s33, s53, s52
    s_mov_b32 s34, 0
    s_mov_b32 s97, 0
    s_mov_b32 s87, s33
    s_sub_u32 s33, s33, 2
    s_waitcnt lgkmcnt(0)
    s_barrier
    v_and_b32 v213, 15, v0
    v_lshlrev_b32 v212, 7, v213
    v_bfe_u32 v213, v0, 1, 2
    v_bfe_u32 v214, v0, 4, 2
    v_xor_b32_e64 v213, v213, v214
    v_lshl_add_u32 v212, v213, 4, v212
    v_add_u32 v213, s3, v212
    v_add_u32 v212, s57, v212
K1_ln:
    s_cmp_eq_u32 s31, 0
    s_cbranch_scc1 K1_lp
    s_setprio 1
K1_lp:
    ds_read_b128 v[216:219], v5 offset:768
    ds_read_b128 v[220:223], v5 offset:784
    s_cbranch_vccnz K1_ta0
    s_waitcnt vmcnt(10)
    ds_read_b128 v[32:35], v212 offset:0
    ds_read_b128 v[36:39], v212 offset:64
K1_ta0:
    ds_read_b128 v[224:227], v5 offset:896
    ds_read_b128 v[228:231], v5 offset:912
    s_waitcnt lgkmcnt(2)
    s_cbranch_vccnz K1_tb0
    s_add_u32 m0, s57, 0
    s_add_u32 s58, s40, 12672
    buffer_load_dwordx4 v2, s[8:11], s58 offen nt lds
    s_add_u32 m0, m0, 1024
    s_add_u32 s58, s58, 6144
    buffer_load_dwordx4 v2, s[8:11], s58 offen nt lds
K1_tb0:
    v_dot2_f32_bf16 v159, v35, v223, 0
    v_dot2_f32_bf16 v158, v35, v222, 0
    v_dot2_f32_bf16 v157, v34, v221, 0
    v_dot2_f32_bf16 v156, v34, v220, 0
    v_dot2_f32_bf16 v155, v33, v219, 0
    v_dot2_f32_bf16 v154, v33, v218, 0
    v_dot2_f32_bf16 v153, v32, v217, 0
    v_dot2_f32_bf16 v152, v32, v216, 0
    v_pk_mul_f32 v[202:203], v[158:159], 1.0 op_sel_hi:[1,0]
    v_pk_mul_f32 v[206:207], v[158:159], v[158:159]
    v_pk_mul_f32 v[200:201], v[156:157], 1.0 op_sel_hi:[1,0]
    v_pk_mul_f32 v[204:205], v[156:157], v[156:157]
    v_pk_add_f32 v[202:203], v[202:203], v[154:155]
    v_pk_fma_f32 v[206:207], v[154:155], v[154:155], v[206:207]
    v_pk_add_f32 v[200:201], v[200:201], v[152:153]
    v_pk_fma_f32 v[204:205], v[152:153], v[152:153], v[204:205]
    ds_read_b128 v[216:219], v5 offset:1024
    ds_read_b128 v[220:223], v5 offset:1040
    s_waitcnt lgkmcnt(2)
    s_nop 0
    v_dot2_f32_bf16 v167, v39, v231, 0
    v_dot2_f32_bf16 v166, v39, v230, 0
    v_dot2_f32_bf16 v165, v38, v229, 0
    v_dot2_f32_bf16 v164, v38, v228, 0
    v_dot2_f32_bf16 v163, v37, v227, 0
    v_dot2_f32_bf16 v162, v37, v226, 0
    v_dot2_f32_bf16 v161, v36, v225, 0
    v_dot2_f32_bf16 v160, v36, v224, 0
    v_pk_add_f32 v[202:203], v[202:203], v[166:167]
    v_pk_fma_f32 v[206:207], v[166:167], v[166:167], v[206:207]
    v_pk_add_f32 v[200:201], v[200:201], v[164:165]
    v_pk_fma_f32 v[204:205], v[164:165], v[164:165], v[204:205]
    v_pk_add_f32 v[202:203], v[202:203], v[162:163]
    v_pk_fma_f32 v[206:207], v[162:163], v[162:163], v[206:207]
    v_pk_add_f32 v[200:201], v[200:201], v[160:161]
    v_pk_fma_f32 v[204:205], v[160:161], v[160:161], v[204:205]
    s_cbranch_vccnz K1_ta1
    s_waitcnt vmcnt(10)
    ds_read_b128 v[40:43], v212 offset:2048
    ds_read_b128 v[44:47], v212 offset:2112
K1_ta1:
    ds_read_b128 v[224:227], v5 offset:1152
    ds_read_b128 v[228:231], v5 offset:1168
    s_waitcnt lgkmcnt(2)
    s_cbranch_vccnz K1_tb1
    s_add_u32 m0, s57, 2048
    s_add_u32 s58, s40, 12800
    buffer_load_dwordx4 v2, s[8:11], s58 offen nt lds
    s_add_u32 m0, m0, 1024
    s_add_u32 s58, s58, 6144
    buffer_load_dwordx4 v2, s[8:11], s58 offen nt lds
K1_tb1:
    v_dot2_f32_bf16 v175, v43, v223, 0
    v_dot2_f32_bf16 v174, v43, v222, 0
    v_dot2_f32_bf16 v173, v42, v221, 0
    v_dot2_f32_bf16 v172, v42, v220, 0
    v_dot2_f32_bf16 v171, v41, v219, 0
    v_dot2_f32_bf16 v170, v41, v218, 0
    v_dot2_f32_bf16 v169, v40, v217, 0
    v_dot2_f32_bf16 v168, v40, v216, 0
    v_pk_add_f32 v[202:203], v[202:203], v[174:175]
    v_pk_fma_f32 v[206:207], v[174:175], v[174:175], v[206:207]
    v_pk_add_f32 v[200:201], v[200:201], v[172:173]
    v_pk_fma_f32 v[204:205], v[172:173], v[172:173], v[204:205]
    v_pk_add_f32 v[202:203], v[202:203], v[170:171]
    v_pk_fma_f32 v[206:207], v[170:171], v[170:171], v[206:207]
    v_pk_add_f32 v[200:201], v[200:201], v[168:169]
    v_pk_fma_f32 v[204:205], v[168:169], v[168:169], v[204:205]
    ds_read_b128 v[216:219], v5 offset:1280
    ds_read_b128 v[220:223], v5 offset:1296
    s_waitcnt lgkmcnt(2)
    s_nop 0
    v_dot2_f32_bf16 v183, v47, v231, 0
    v_dot2_f32_bf16 v182, v47, v230, 0
    v_dot2_f32_bf16 v181, v46, v229, 0
    v_dot2_f32_bf16 v180, v46, v228, 0
    v_dot2_f32_bf16 v179, v45, v227, 0
    v_dot2_f32_bf16 v178, v45, v226, 0
    v_dot2_f32_bf16 v177, v44, v225, 0
    v_dot2_f32_bf16 v176, v44, v224, 0
    v_pk_add_f32 v[202:203], v[202:203], v[182:183]
    v_pk_fma_f32 v[206:207], v[182:183], v[182:183], v[206:207]
    v_pk_add_f32 v[200:201], v[200:201], v[180:181]
    v_pk_fma_f32 v[204:205], v[180:181], v[180:181], v[204:205]
    v_pk_add_f32 v[202:203], v[202:203], v[178:179]
    v_pk_fma_f32 v[206:207], v[178:179], v[178:179], v[206:207]
    v_pk_add_f32 v[200:201], v[200:201], v[176:177]
    v_pk_fma_f32 v[204:205], v[176:177], v[176:177], v[204:205]
    s_cbranch_vccnz K1_ta2
    s_waitcnt vmcnt(10)
    ds_read_b128 v[48:51], v212 offset:4096
    ds_read_b128 v[52:55], v212 offset:4160
K1_ta2:
    ds_read_b128 v[224:227], v5 offset:1408
    ds_read_b128 v[228:231], v5 offset:1424
    s_waitcnt lgkmcnt(2)
    s_cbranch_vccnz K1_tb2
    s_add_u32 m0, s57, 4096
    s_add_u32 s58, s40, 12928
    buffer_load_dwordx4 v2, s[8:11], s58 offen nt lds
    s_add_u32 m0, m0, 1024
    s_add_u32 s58, s58, 6144
    buffer_load_dwordx4 v2, s[8:11], s58 offen nt lds
K1_tb2:
    v_dot2_f32_bf16 v191, v51, v223, 0
    v_dot2_f32_bf16 v190, v51, v222, 0
    v_dot2_f32_bf16 v189, v50, v221, 0
    v_dot2_f32_bf16 v188, v50, v220, 0
    v_dot2_f32_bf16 v187, v49, v219, 0
    v_dot2_f32_bf16 v186, v49, v218, 0
    v_dot2_f32_bf16 v185, v48, v217, 0
    v_dot2_f32_bf16 v184, v48, v216, 0
    v_pk_add_f32 v[202:203], v[202:203], v[190:191]
    v_pk_fma_f32 v[206:207], v[190:191], v[190:191], v[206:207]
    v_pk_add_f32 v[200:201], v[200:201], v[188:189]
    v_pk_fma_f32 v[204:205], v[188:189], v[188:189], v[204:205]
    v_pk_add_f32 v[202:203], v[202:203], v[186:187]
    v_pk_fma_f32 v[206:207], v[186:187], v[186:187], v[206:207]
    v_pk_add_f32 v[200:201], v[200:201], v[184:185]
    v_pk_fma_f32 v[204:205], v[184:185], v[184:185], v[204:205]
    ds_read_b128 v[216:219], v5 offset:640
    ds_read_b128 v[220:223], v5 offset:656
    s_waitcnt lgkmcnt(2)
    s_nop 0
    v_dot2_f32_bf16 v199, v55, v231, 0
    v_dot2_f32_bf16 v198, v55, v230, 0
    v_dot2_f32_bf16 v197, v54, v229, 0
    v_dot2_f32_bf16 v196, v54, v228, 0
    v_dot2_f32_bf16 v195, v53, v227, 0
    v_dot2_f32_bf16 v194, v53, v226, 0
    v_dot2_f32_bf16 v193, v52, v225, 0
    v_dot2_f32_bf16 v192, v52, v224, 0
    v_pk_add_f32 v[202:203], v[202:203], v[198:199]
    v_pk_fma_f32 v[206:207], v[198:199], v[198:199], v[206:207]
    v_pk_add_f32 v[200:201], v[200:201], v[196:197]
    v_pk_fma_f32 v[204:205], v[196:197], v[196:197], v[204:205]
    v_pk_add_f32 v[202:203], v[202:203], v[194:195]
    v_pk_fma_f32 v[206:207], v[194:195], v[194:195], v[206:207]
    v_pk_add_f32 v[200:201], v[200:201], v[192:193]
    v_pk_fma_f32 v[204:205], v[192:193], v[192:193], v[204:205]
    s_cbranch_vccnz K1_ta3
    s_waitcnt vmcnt(10)
    ds_read_b128 v[24:27], v213 offset:0
    ds_read_b128 v[28:31], v213 offset:64
K1_ta3:
    ds_read_b128 v[224:227], v5 offset:512
    ds_read_b128 v[228:231], v5 offset:528
    s_waitcnt lgkmcnt(2)
    s_cbranch_vccnz K1_tb3
    s_add_u32 m0, s3, 0
    s_add_u32 s58, s40, 12544
    buffer_load_dwordx4 v2, s[8:11], s58 offen nt lds
    s_add_u32 m0, m0, 1024
    s_add_u32 s58, s58, 6144
    buffer_load_dwordx4 v2, s[8:11], s58 offen nt lds
    s_nop 0
K1_tb3:
    v_dot2_f32_bf16 v55, v31, v223, 0
    v_dot2_f32_bf16 v54, v31, v222, 0
    v_dot2_f32_bf16 v53, v30, v221, 0
    v_dot2_f32_bf16 v52, v30, v220, 0
    v_dot2_f32_bf16 v51, v29, v219, 0
    v_dot2_f32_bf16 v50, v29, v218, 0
    v_dot2_f32_bf16 v49, v28, v217, 0
    v_dot2_f32_bf16 v48, v28, v216, 0
    v_pk_add_f32 v[202:203], v[202:203], v[54:55]
    v_pk_fma_f32 v[206:207], v[54:55], v[54:55], v[206:207]
    v_pk_add_f32 v[200:201], v[200:201], v[52:53]
    v_pk_fma_f32 v[204:205], v[52:53], v[52:53], v[204:205]
    v_pk_add_f32 v[202:203], v[202:203], v[50:51]
    v_pk_fma_f32 v[206:207], v[50:51], v[50:51], v[206:207]
    v_pk_add_f32 v[200:201], v[200:201], v[48:49]
    v_pk_fma_f32 v[204:205], v[48:49], v[48:49], v[204:205]
    ds_read_b128 v[216:219], v5 offset:384
    ds_read_b128 v[220:223], v5 offset:400
    s_waitcnt lgkmcnt(2)
    s_nop 0
    v_dot2_f32_bf16 v47, v27, v231, 0
    v_dot2_f32_bf16 v46, v27, v230, 0
    v_dot2_f32_bf16 v45, v26, v229, 0
    v_dot2_f32_bf16 v44, v26, v228, 0
    v_dot2_f32_bf16 v43, v25, v227, 0
    v_dot2_f32_bf16 v42, v25, v226, 0
    v_dot2_f32_bf16 v41, v24, v225, 0
    v_dot2_f32_bf16 v40, v24, v224, 0
    v_pk_add_f32 v[202:203], v[202:203], v[46:47]
    v_pk_fma_f32 v[206:207], v[46:47], v[46:47], v[206:207]
    v_pk_add_f32 v[200:201], v[200:201], v[44:45]
    v_pk_fma_f32 v[204:205], v[44:45], v[44:45], v[204:205]
    v_pk_add_f32 v[202:203], v[202:203], v[42:43]
    v_pk_fma_f32 v[206:207], v[42:43], v[42:43], v[206:207]
    v_pk_add_f32 v[200:201], v[200:201], v[40:41]
    v_pk_fma_f32 v[204:205], v[40:41], v[40:41], v[204:205]
    s_cbranch_vccnz K1_ta4
    s_waitcnt vmcnt(10)
    ds_read_b128 v[16:19], v213 offset:2048
    ds_read_b128 v[20:23], v213 offset:2112
K1_ta4:
    ds_read_b128 v[224:227], v5 offset:256
    ds_read_b128 v[228:231], v5 offset:272
    s_waitcnt lgkmcnt(2)
    s_cbranch_vccnz K1_tb4
    s_add_u32 m0, s3, 2048
    s_add_u32 s58, s40, 12416
    buffer_load_dwordx4 v2, s[8:11], s58 offen nt lds
    s_add_u32 m0, m0, 1024
    s_add_u32 s58, s58, 6144
    buffer_load_dwordx4 v2, s[8:11], s58 offen nt lds
K1_tb4:
    v_dot2_f32_bf16 v39, v23, v223, 0
    v_dot2_f32_bf16 v38, v23, v222, 0
    v_dot2_f32_bf16 v37, v22, v221, 0
    v_dot2_f32_bf16 v36, v22, v220, 0
    v_dot2_f32_bf16 v35, v21, v219, 0
    v_dot2_f32_bf16 v34, v21, v218, 0
    v_dot2_f32_bf16 v33, v20, v217, 0
    v_dot2_f32_bf16 v32, v20, v216, 0
    v_pk_add_f32 v[202:203], v[202:203], v[38:39]
    v_pk_fma_f32 v[206:207], v[38:39], v[38:39], v[206:207]
    v_pk_add_f32 v[200:201], v[200:201], v[36:37]
    v_pk_fma_f32 v[204:205], v[36:37], v[36:37], v[204:205]
    v_pk_add_f32 v[202:203], v[202:203], v[34:35]
    v_pk_fma_f32 v[206:207], v[34:35], v[34:35], v[206:207]
    v_pk_add_f32 v[200:201], v[200:201], v[32:33]
    v_pk_fma_f32 v[204:205], v[32:33], v[32:33], v[204:205]
    ds_read_b128 v[216:219], v5 offset:128
    ds_read_b128 v[220:223], v5 offset:144
    s_waitcnt lgkmcnt(2)
    s_nop 0
    v_dot2_f32_bf16 v31, v19, v231, 0
    v_dot2_f32_bf16 v30, v19, v230, 0
    v_dot2_f32_bf16 v29, v18, v229, 0
    v_dot2_f32_bf16 v28, v18, v228, 0
    v_dot2_f32_bf16 v27, v17, v227, 0
    v_dot2_f32_bf16 v26, v17, v226, 0
    v_dot2_f32_bf16 v25, v16, v225, 0
    v_dot2_f32_bf16 v24, v16, v224, 0
    v_pk_add_f32 v[202:203], v[202:203], v[30:31]
    v_pk_fma_f32 v[206:207], v[30:31], v[30:31], v[206:207]
    v_pk_add_f32 v[200:201], v[200:201], v[28:29]
    v_pk_fma_f32 v[204:205], v[28:29], v[28:29], v[204:205]
    v_pk_add_f32 v[202:203], v[202:203], v[26:27]
    v_pk_fma_f32 v[206:207], v[26:27], v[26:27], v[206:207]
    v_pk_add_f32 v[200:201], v[200:201], v[24:25]
    v_pk_fma_f32 v[204:205], v[24:25], v[24:25], v[204:205]
    s_cbranch_vccnz K1_ta5
    s_waitcnt vmcnt(10)
    ds_read_b128 v[8:11], v213 offset:4096
    ds_read_b128 v[12:15], v213 offset:4160
K1_ta5:
    ds_read_b128 v[224:227], v5 offset:0
    ds_read_b128 v[228:231], v5 offset:16
    s_waitcnt lgkmcnt(2)
    s_cbranch_vccnz K1_tb5
    s_add_u32 m0, s3, 4096
    s_add_u32 s58, s40, 12288
    buffer_load_dwordx4 v2, s[8:11], s58 offen nt lds
    s_add_u32 m0, m0, 1024
    s_add_u32 s58, s58, 6144
    buffer_load_dwordx4 v2, s[8:11], s58 offen nt lds
K1_tb5:
    v_dot2_f32_bf16 v23, v15, v223, 0
    v_dot2_f32_bf16 v22, v15, v222, 0
    v_dot2_f32_bf16 v21, v14, v221, 0
    v_dot2_f32_bf16 v20, v14, v220, 0
    v_dot2_f32_bf16 v19, v13, v219, 0
    v_dot2_f32_bf16 v18, v13, v218, 0
    v_dot2_f32_bf16 v17, v12, v217, 0
    v_dot2_f32_bf16 v16, v12, v216, 0
    v_pk_add_f32 v[202:203], v[202:203], v[22:23]
    v_pk_fma_f32 v[206:207], v[22:23], v[22:23], v[206:207]
    v_pk_add_f32 v[200:201], v[200:201], v[20:21]
    v_pk_fma_f32 v[204:205], v[20:21], v[20:21], v[204:205]
    v_pk_add_f32 v[202:203], v[202:203], v[18:19]
    v_pk_fma_f32 v[206:207], v[18:19], v[18:19], v[206:207]
    v_pk_add_f32 v[200:201], v[200:201], v[16:17]
    v_pk_fma_f32 v[204:205], v[16:17], v[16:17], v[204:205]
    ds_read_b128 v[216:219], v5 offset:768
    ds_read_b128 v[220:223], v5 offset:784
    s_waitcnt lgkmcnt(2)
    s_nop 0
    v_dot2_f32_bf16 v15, v11, v231, 0
    v_dot2_f32_bf16 v14, v11, v230, 0
    v_dot2_f32_bf16 v13, v10, v229, 0
    v_dot2_f32_bf16 v12, v10, v228, 0
    v_dot2_f32_bf16 v11, v9, v227, 0
    v_dot2_f32_bf16 v10, v9, v226, 0
    v_dot2_f32_bf16 v9, v8, v225, 0
    v_dot2_f32_bf16 v8, v8, v224, 0
    v_pk_add_f32 v[202:203], v[202:203], v[14:15]
    v_pk_fma_f32 v[206:207], v[14:15], v[14:15], v[206:207]
    v_pk_add_f32 v[200:201], v[200:201], v[12:13]
    v_pk_fma_f32 v[204:205], v[12:13], v[12:13], v[204:205]
    v_pk_add_f32 v[202:203], v[202:203], v[10:11]
    v_pk_fma_f32 v[206:207], v[10:11], v[10:11], v[206:207]
    v_pk_add_f32 v[200:201], v[200:201], v[8:9]
    v_pk_fma_f32 v[204:205], v[8:9], v[8:9], v[204:205]
    v_pk_add_f32 v[200:201], v[200:201], v[202:203]
    v_pk_add_f32 v[204:205], v[204:205], v[206:207]
    v_add_f32 v200, v200, v201
    v_add_f32 v204, v204, v205
    v_mov_b32 v201, v200
    v_mov_b32 v205, v204
    s_nop 0
    v_permlane16_swap_b32 v200, v201
    v_permlane16_swap_b32 v204, v205
    v_add_f32 v200, v200, v201
    v_add_f32 v204, v204, v205
    v_mov_b32 v201, v200
    v_mov_b32 v205, v204
    s_nop 0
    v_permlane32_swap_b32 v200, v201
    v_permlane32_swap_b32 v204, v205
    v_add_f32 v200, v200, v201
    v_add_f32 v204, v204, v205
    v_mul_f32 v200, 0xbb2aaaab, v200
    v_mul_f32 v204, 0x3b2aaaab, v204
    v_fma_f32 v204, -v200, v200, v204
    v_max_f32_e64 v204, 0, v204
    v_add_f32 v204, 0x3727c5ac, v204
    v_rsq_f32 v204, v204
    s_nop 0
    v_mul_f32 v204, 0x3eefde6e, v204
    v_mul_f32_e64 v200, v200, v204
    v_pk_fma_f32 v[8:9], v[8:9], v[204:205], v[200:201] op_sel_hi:[1,0,0]
    v_pk_fma_f32 v[10:11], v[10:11], v[204:205], v[200:201] op_sel_hi:[1,0,0]
    v_pk_fma_f32 v[12:13], v[12:13], v[204:205], v[200:201] op_sel_hi:[1,0,0]
    v_pk_fma_f32 v[14:15], v[14:15], v[204:205], v[200:201] op_sel_hi:[1,0,0]
    v_cvt_pk_bf16_f32 v8, v8, v9
    v_cvt_pk_bf16_f32 v9, v10, v11
    v_cvt_pk_bf16_f32 v10, v12, v13
    v_cvt_pk_bf16_f32 v11, v14, v15
    v_pk_fma_f32 v[16:17], v[16:17], v[204:205], v[200:201] op_sel_hi:[1,0,0]
    v_pk_fma_f32 v[18:19], v[18:19], v[204:205], v[200:201] op_sel_hi:[1,0,0]
    v_pk_fma_f32 v[20:21], v[20:21], v[204:205], v[200:201] op_sel_hi:[1,0,0]
    v_pk_fma_f32 v[22:23], v[22:23], v[204:205], v[200:201] op_sel_hi:[1,0,0]
    v_cvt_pk_bf16_f32 v12, v16, v17
    v_cvt_pk_bf16_f32 v13, v18, v19
    v_cvt_pk_bf16_f32 v14, v20, v21
    v_cvt_pk_bf16_f32 v15, v22, v23
    v_pk_fma_f32 v[24:25], v[24:25], v[204:205], v[200:201] op_sel_hi:[1,0,0]
    v_pk_fma_f32 v[26:27], v[26:27], v[204:205], v[200:201] op_sel_hi:[1,0,0]
    v_pk_fma_f32 v[28:29], v[28:29], v[204:205], v[200:201] op_sel_hi:[1,0,0]
    v_pk_fma_f32 v[30:31], v[30:31], v[204:205], v[200:201] op_sel_hi:[1,0,0]
    v_cvt_pk_bf16_f32 v16, v24, v25
    v_cvt_pk_bf16_f32 v17, v26, v27
    v_cvt_pk_bf16_f32 v18, v28, v29
    v_cvt_pk_bf16_f32 v19, v30, v31
    v_pk_fma_f32 v[32:33], v[32:33], v[204:205], v[200:201] op_sel_hi:[1,0,0]
    v_pk_fma_f32 v[34:35], v[34:35], v[204:205], v[200:201] op_sel_hi:[1,0,0]
    v_pk_fma_f32 v[36:37], v[36:37], v[204:205], v[200:201] op_sel_hi:[1,0,0]
    v_pk_fma_f32 v[38:39], v[38:39], v[204:205], v[200:201] op_sel_hi:[1,0,0]
    v_cvt_pk_bf16_f32 v20, v32, v33
    v_cvt_pk_bf16_f32 v21, v34, v35
    v_cvt_pk_bf16_f32 v22, v36, v37
    v_cvt_pk_bf16_f32 v23, v38, v39
    v_pk_fma_f32 v[40:41], v[40:41], v[204:205], v[200:201] op_sel_hi:[1,0,0]
    v_pk_fma_f32 v[42:43], v[42:43], v[204:205], v[200:201] op_sel_hi:[1,0,0]
    v_pk_fma_f32 v[44:45], v[44:45], v[204:205], v[200:201] op_sel_hi:[1,0,0]
    v_pk_fma_f32 v[46:47], v[46:47], v[204:205], v[200:201] op_sel_hi:[1,0,0]
    v_cvt_pk_bf16_f32 v24, v40, v41
    v_cvt_pk_bf16_f32 v25, v42, v43
    v_cvt_pk_bf16_f32 v26, v44, v45
    v_cvt_pk_bf16_f32 v27, v46, v47
    v_pk_fma_f32 v[48:49], v[48:49], v[204:205], v[200:201] op_sel_hi:[1,0,0]
    v_pk_fma_f32 v[50:51], v[50:51], v[204:205], v[200:201] op_sel_hi:[1,0,0]
    v_pk_fma_f32 v[52:53], v[52:53], v[204:205], v[200:201] op_sel_hi:[1,0,0]
    v_pk_fma_f32 v[54:55], v[54:55], v[204:205], v[200:201] op_sel_hi:[1,0,0]
    v_cvt_pk_bf16_f32 v28, v48, v49
    v_cvt_pk_bf16_f32 v29, v50, v51
    v_cvt_pk_bf16_f32 v30, v52, v53
    v_cvt_pk_bf16_f32 v31, v54, v55
    v_pk_fma_f32 v[152:153], v[152:153], v[204:205], v[200:201] op_sel_hi:[1,0,0]
    v_pk_fma_f32 v[154:155], v[154:155], v[204:205], v[200:201] op_sel_hi:[1,0,0]
    v_pk_fma_f32 v[156:157], v[156:157], v[204:205], v[200:201] op_sel_hi:[1,0,0]
    v_pk_fma_f32 v[158:159], v[158:159], v[204:205], v[200:201] op_sel_hi:[1,0,0]
    v_cvt_pk_bf16_f32 v32, v152, v153
    v_cvt_pk_bf16_f32 v33, v154, v155
    v_cvt_pk_bf16_f32 v34, v156, v157
    v_cvt_pk_bf16_f32 v35, v158, v159
    v_pk_fma_f32 v[160:161], v[160:161], v[204:205], v[200:201] op_sel_hi:[1,0,0]
    v_pk_fma_f32 v[162:163], v[162:163], v[204:205], v[200:201] op_sel_hi:[1,0,0]
    v_pk_fma_f32 v[164:165], v[164:165], v[204:205], v[200:201] op_sel_hi:[1,0,0]
    v_pk_fma_f32 v[166:167], v[166:167], v[204:205], v[200:201] op_sel_hi:[1,0,0]
    v_cvt_pk_bf16_f32 v36, v160, v161
    v_cvt_pk_bf16_f32 v37, v162, v163
    v_cvt_pk_bf16_f32 v38, v164, v165
    v_cvt_pk_bf16_f32 v39, v166, v167
    v_pk_fma_f32 v[168:169], v[168:169], v[204:205], v[200:201] op_sel_hi:[1,0,0]
    v_pk_fma_f32 v[170:171], v[170:171], v[204:205], v[200:201] op_sel_hi:[1,0,0]
    v_pk_fma_f32 v[172:173], v[172:173], v[204:205], v[200:201] op_sel_hi:[1,0,0]
    v_pk_fma_f32 v[174:175], v[174:175], v[204:205], v[200:201] op_sel_hi:[1,0,0]
    v_cvt_pk_bf16_f32 v40, v168, v169
    v_cvt_pk_bf16_f32 v41, v170, v171
    v_cvt_pk_bf16_f32 v42, v172, v173
    v_cvt_pk_bf16_f32 v43, v174, v175
    v_pk_fma_f32 v[176:177], v[176:177], v[204:205], v[200:201] op_sel_hi:[1,0,0]
    v_pk_fma_f32 v[178:179], v[178:179], v[204:205], v[200:201] op_sel_hi:[1,0,0]
    v_pk_fma_f32 v[180:181], v[180:181], v[204:205], v[200:201] op_sel_hi:[1,0,0]
    v_pk_fma_f32 v[182:183], v[182:183], v[204:205], v[200:201] op_sel_hi:[1,0,0]
    v_cvt_pk_bf16_f32 v44, v176, v177
    v_cvt_pk_bf16_f32 v45, v178, v179
    v_cvt_pk_bf16_f32 v46, v180, v181
    v_cvt_pk_bf16_f32 v47, v182, v183
    v_pk_fma_f32 v[184:185], v[184:185], v[204:205], v[200:201] op_sel_hi:[1,0,0]
    v_pk_fma_f32 v[186:187], v[186:187], v[204:205], v[200:201] op_sel_hi:[1,0,0]
    v_pk_fma_f32 v[188:189], v[188:189], v[204:205], v[200:201] op_sel_hi:[1,0,0]
    v_pk_fma_f32 v[190:191], v[190:191], v[204:205], v[200:201] op_sel_hi:[1,0,0]
    v_cvt_pk_bf16_f32 v48, v184, v185
    v_cvt_pk_bf16_f32 v49, v186, v187
    v_cvt_pk_bf16_f32 v50, v188, v189
    v_cvt_pk_bf16_f32 v51, v190, v191
    v_pk_fma_f32 v[192:193], v[192:193], v[204:205], v[200:201] op_sel_hi:[1,0,0]
    v_pk_fma_f32 v[194:195], v[194:195], v[204:205], v[200:201] op_sel_hi:[1,0,0]
    v_pk_fma_f32 v[196:197], v[196:197], v[204:205], v[200:201] op_sel_hi:[1,0,0]
    v_pk_fma_f32 v[198:199], v[198:199], v[204:205], v[200:201] op_sel_hi:[1,0,0]
    v_cvt_pk_bf16_f32 v52, v192, v193
    v_cvt_pk_bf16_f32 v53, v194, v195
    v_cvt_pk_bf16_f32 v54, v196, v197
    v_cvt_pk_bf16_f32 v55, v198, v199
    s_waitcnt vmcnt(10)
    ds_read_b128 v[80:83], v212 offset:0
    ds_read_b128 v[84:87], v212 offset:64
    ds_read_b128 v[224:227], v5 offset:896
    ds_read_b128 v[228:231], v5 offset:912
    s_waitcnt lgkmcnt(2)
    s_add_u32 m0, s57, 0
    s_add_u32 s58, s40, 24960
    buffer_load_dwordx4 v2, s[8:11], s58 offen nt lds
    s_add_u32 m0, m0, 1024
    s_add_u32 s58, s58, 6144
    buffer_load_dwordx4 v2, s[8:11], s58 offen nt lds
    s_nop 0
    v_dot2_f32_bf16 v159, v83, v223, 0
    v_dot2_f32_bf16 v158, v83, v222, 0
    v_dot2_f32_bf16 v157, v82, v221, 0
    v_dot2_f32_bf16 v156, v82, v220, 0
    v_dot2_f32_bf16 v155, v81, v219, 0
    v_dot2_f32_bf16 v154, v81, v218, 0
    v_dot2_f32_bf16 v153, v80, v217, 0
    v_dot2_f32_bf16 v152, v80, v216, 0
    v_pk_mul_f32 v[202:203], v[158:159], 1.0 op_sel_hi:[1,0]
    v_pk_mul_f32 v[206:207], v[158:159], v[158:159]
    v_pk_mul_f32 v[200:201], v[156:157], 1.0 op_sel_hi:[1,0]
    v_pk_mul_f32 v[204:205], v[156:157], v[156:157]
    v_pk_add_f32 v[202:203], v[202:203], v[154:155]
    v_pk_fma_f32 v[206:207], v[154:155], v[154:155], v[206:207]
    v_pk_add_f32 v[200:201], v[200:201], v[152:153]
    v_pk_fma_f32 v[204:205], v[152:153], v[152:153], v[204:205]
    ds_read_b128 v[216:219], v5 offset:1024
    ds_read_b128 v[220:223], v5 offset:1040
    s_waitcnt lgkmcnt(2)
    s_nop 0
    v_dot2_f32_bf16 v167, v87, v231, 0
    v_dot2_f32_bf16 v166, v87, v230, 0
    v_dot2_f32_bf16 v165, v86, v229, 0
    v_dot2_f32_bf16 v164, v86, v228, 0
    v_dot2_f32_bf16 v163, v85, v227, 0
    v_dot2_f32_bf16 v162, v85, v226, 0
    v_dot2_f32_bf16 v161, v84, v225, 0
    v_dot2_f32_bf16 v160, v84, v224, 0
    v_pk_add_f32 v[202:203], v[202:203], v[166:167]
    v_pk_fma_f32 v[206:207], v[166:167], v[166:167], v[206:207]
    v_pk_add_f32 v[200:201], v[200:201], v[164:165]
    v_pk_fma_f32 v[204:205], v[164:165], v[164:165], v[204:205]
    v_pk_add_f32 v[202:203], v[202:203], v[162:163]
    v_pk_fma_f32 v[206:207], v[162:163], v[162:163], v[206:207]
    v_pk_add_f32 v[200:201], v[200:201], v[160:161]
    v_pk_fma_f32 v[204:205], v[160:161], v[160:161], v[204:205]
    s_waitcnt vmcnt(10)
    ds_read_b128 v[88:91], v212 offset:2048
    ds_read_b128 v[92:95], v212 offset:2112
    ds_read_b128 v[224:227], v5 offset:1152
    ds_read_b128 v[228:231], v5 offset:1168
    s_waitcnt lgkmcnt(2)
    s_add_u32 m0, s57, 2048
    s_add_u32 s58, s40, 25088
    buffer_load_dwordx4 v2, s[8:11], s58 offen nt lds
    s_add_u32 m0, m0, 1024
    s_add_u32 s58, s58, 6144
    buffer_load_dwordx4 v2, s[8:11], s58 offen nt lds
    v_dot2_f32_bf16 v175, v91, v223, 0
    v_dot2_f32_bf16 v174, v91, v222, 0
    v_dot2_f32_bf16 v173, v90, v221, 0
    v_dot2_f32_bf16 v172, v90, v220, 0
    v_dot2_f32_bf16 v171, v89, v219, 0
    v_dot2_f32_bf16 v170, v89, v218, 0
    v_dot2_f32_bf16 v169, v88, v217, 0
    v_dot2_f32_bf16 v168, v88, v216, 0
    v_pk_add_f32 v[202:203], v[202:203], v[174:175]
    v_pk_fma_f32 v[206:207], v[174:175], v[174:175], v[206:207]
    v_pk_add_f32 v[200:201], v[200:201], v[172:173]
    v_pk_fma_f32 v[204:205], v[172:173], v[172:173], v[204:205]
    v_pk_add_f32 v[202:203], v[202:203], v[170:171]
    v_pk_fma_f32 v[206:207], v[170:171], v[170:171], v[206:207]
    v_pk_add_f32 v[200:201], v[200:201], v[168:169]
    v_pk_fma_f32 v[204:205], v[168:169], v[168:169], v[204:205]
    ds_read_b128 v[216:219], v5 offset:1280
    ds_read_b128 v[220:223], v5 offset:1296
    s_waitcnt lgkmcnt(2)
    s_nop 0
    v_dot2_f32_bf16 v183, v95, v231, 0
    v_dot2_f32_bf16 v182, v95, v230, 0
    v_dot2_f32_bf16 v181, v94, v229, 0
    v_dot2_f32_bf16 v180, v94, v228, 0
    v_dot2_f32_bf16 v179, v93, v227, 0
    v_dot2_f32_bf16 v178, v93, v226, 0
    v_dot2_f32_bf16 v177, v92, v225, 0
    v_dot2_f32_bf16 v176, v92, v224, 0
    v_pk_add_f32 v[202:203], v[202:203], v[182:183]
    v_pk_fma_f32 v[206:207], v[182:183], v[182:183], v[206:207]
    v_pk_add_f32 v[200:201], v[200:201], v[180:181]
    v_pk_fma_f32 v[204:205], v[180:181], v[180:181], v[204:205]
    v_pk_add_f32 v[202:203], v[202:203], v[178:179]
    v_pk_fma_f32 v[206:207], v[178:179], v[178:179], v[206:207]
    v_pk_add_f32 v[200:201], v[200:201], v[176:177]
    v_pk_fma_f32 v[204:205], v[176:177], v[176:177], v[204:205]
    s_waitcnt vmcnt(10)
    ds_read_b128 v[96:99], v212 offset:4096
    ds_read_b128 v[100:103], v212 offset:4160
    ds_read_b128 v[224:227], v5 offset:1408
    ds_read_b128 v[228:231], v5 offset:1424
    s_waitcnt lgkmcnt(2)
    s_add_u32 m0, s57, 4096
    s_add_u32 s58, s40, 25216
    buffer_load_dwordx4 v2, s[8:11], s58 offen nt lds
    s_add_u32 m0, m0, 1024
    s_add_u32 s58, s58, 6144
    buffer_load_dwordx4 v2, s[8:11], s58 offen nt lds
    v_dot2_f32_bf16 v191, v99, v223, 0
    v_dot2_f32_bf16 v190, v99, v222, 0
    v_dot2_f32_bf16 v189, v98, v221, 0
    v_dot2_f32_bf16 v188, v98, v220, 0
    v_dot2_f32_bf16 v187, v97, v219, 0
    v_dot2_f32_bf16 v186, v97, v218, 0
    v_dot2_f32_bf16 v185, v96, v217, 0
    v_dot2_f32_bf16 v184, v96, v216, 0
    v_pk_add_f32 v[202:203], v[202:203], v[190:191]
    v_pk_fma_f32 v[206:207], v[190:191], v[190:191], v[206:207]
    v_pk_add_f32 v[200:201], v[200:201], v[188:189]
    v_pk_fma_f32 v[204:205], v[188:189], v[188:189], v[204:205]
    v_pk_add_f32 v[202:203], v[202:203], v[186:187]
    v_pk_fma_f32 v[206:207], v[186:187], v[186:187], v[206:207]
    v_pk_add_f32 v[200:201], v[200:201], v[184:185]
    v_pk_fma_f32 v[204:205], v[184:185], v[184:185], v[204:205]
    ds_read_b128 v[216:219], v5 offset:640
    ds_read_b128 v[220:223], v5 offset:656
    s_waitcnt lgkmcnt(2)
    s_nop 0
    v_dot2_f32_bf16 v199, v103, v231, 0
    v_dot2_f32_bf16 v198, v103, v230, 0
    v_dot2_f32_bf16 v197, v102, v229, 0
    v_dot2_f32_bf16 v196, v102, v228, 0
    v_dot2_f32_bf16 v195, v101, v227, 0
    v_dot2_f32_bf16 v194, v101, v226, 0
    v_dot2_f32_bf16 v193, v100, v225, 0
    v_dot2_f32_bf16 v192, v100, v224, 0
    v_pk_add_f32 v[202:203], v[202:203], v[198:199]
    v_pk_fma_f32 v[206:207], v[198:199], v[198:199], v[206:207]
    v_pk_add_f32 v[200:201], v[200:201], v[196:197]
    v_pk_fma_f32 v[204:205], v[196:197], v[196:197], v[204:205]
    v_pk_add_f32 v[202:203], v[202:203], v[194:195]
    v_pk_fma_f32 v[206:207], v[194:195], v[194:195], v[206:207]
    v_pk_add_f32 v[200:201], v[200:201], v[192:193]
    v_pk_fma_f32 v[204:205], v[192:193], v[192:193], v[204:205]
    s_waitcnt vmcnt(10)
    ds_read_b128 v[72:75], v213 offset:0
    ds_read_b128 v[76:79], v213 offset:64
    ds_read_b128 v[224:227], v5 offset:512
    ds_read_b128 v[228:231], v5 offset:528
    s_waitcnt lgkmcnt(2)
    s_add_u32 m0, s3, 0
    s_add_u32 s58, s40, 24832
    buffer_load_dwordx4 v2, s[8:11], s58 offen nt lds
    s_add_u32 m0, m0, 1024
    s_add_u32 s58, s58, 6144
    buffer_load_dwordx4 v2, s[8:11], s58 offen nt lds
    s_nop 0
    v_dot2_f32_bf16 v103, v79, v223, 0
    v_dot2_f32_bf16 v102, v79, v222, 0
    v_dot2_f32_bf16 v101, v78, v221, 0
    v_dot2_f32_bf16 v100, v78, v220, 0
    v_dot2_f32_bf16 v99, v77, v219, 0
    v_dot2_f32_bf16 v98, v77, v218, 0
    v_dot2_f32_bf16 v97, v76, v217, 0
    v_dot2_f32_bf16 v96, v76, v216, 0
    v_pk_add_f32 v[202:203], v[202:203], v[102:103]
    v_pk_fma_f32 v[206:207], v[102:103], v[102:103], v[206:207]
    v_pk_add_f32 v[200:201], v[200:201], v[100:101]
    v_pk_fma_f32 v[204:205], v[100:101], v[100:101], v[204:205]
    v_pk_add_f32 v[202:203], v[202:203], v[98:99]
    v_pk_fma_f32 v[206:207], v[98:99], v[98:99], v[206:207]
    v_pk_add_f32 v[200:201], v[200:201], v[96:97]
    v_pk_fma_f32 v[204:205], v[96:97], v[96:97], v[204:205]
    ds_read_b128 v[216:219], v5 offset:384
    ds_read_b128 v[220:223], v5 offset:400
    s_waitcnt lgkmcnt(2)
    s_nop 0
    v_dot2_f32_bf16 v95, v75, v231, 0
    v_dot2_f32_bf16 v94, v75, v230, 0
    v_dot2_f32_bf16 v93, v74, v229, 0
    v_dot2_f32_bf16 v92, v74, v228, 0
    v_dot2_f32_bf16 v91, v73, v227, 0
    v_dot2_f32_bf16 v90, v73, v226, 0
    v_dot2_f32_bf16 v89, v72, v225, 0
    v_dot2_f32_bf16 v88, v72, v224, 0
    v_pk_add_f32 v[202:203], v[202:203], v[94:95]
    v_pk_fma_f32 v[206:207], v[94:95], v[94:95], v[206:207]
    v_pk_add_f32 v[200:201], v[200:201], v[92:93]
    v_pk_fma_f32 v[204:205], v[92:93], v[92:93], v[204:205]
    v_pk_add_f32 v[202:203], v[202:203], v[90:91]
    v_pk_fma_f32 v[206:207], v[90:91], v[90:91], v[206:207]
    v_pk_add_f32 v[200:201], v[200:201], v[88:89]
    v_pk_fma_f32 v[204:205], v[88:89], v[88:89], v[204:205]
    s_waitcnt vmcnt(10)
    ds_read_b128 v[64:67], v213 offset:2048
    ds_read_b128 v[68:71], v213 offset:2112
    ds_read_b128 v[224:227], v5 offset:256
    ds_read_b128 v[228:231], v5 offset:272
    s_waitcnt lgkmcnt(2)
    s_add_u32 m0, s3, 2048
    s_add_u32 s58, s40, 24704
    buffer_load_dwordx4 v2, s[8:11], s58 offen nt lds
    s_add_u32 m0, m0, 1024
    s_add_u32 s58, s58, 6144
    buffer_load_dwordx4 v2, s[8:11], s58 offen nt lds
    v_dot2_f32_bf16 v87, v71, v223, 0
    v_dot2_f32_bf16 v86, v71, v222, 0
    v_dot2_f32_bf16 v85, v70, v221, 0
    v_dot2_f32_bf16 v84, v70, v220, 0
    v_dot2_f32_bf16 v83, v69, v219, 0
    v_dot2_f32_bf16 v82, v69, v218, 0
    v_dot2_f32_bf16 v81, v68, v217, 0
    v_dot2_f32_bf16 v80, v68, v216, 0
    v_pk_add_f32 v[202:203], v[202:203], v[86:87]
    v_pk_fma_f32 v[206:207], v[86:87], v[86:87], v[206:207]
    v_pk_add_f32 v[200:201], v[200:201], v[84:85]
    v_pk_fma_f32 v[204:205], v[84:85], v[84:85], v[204:205]
    v_pk_add_f32 v[202:203], v[202:203], v[82:83]
    v_pk_fma_f32 v[206:207], v[82:83], v[82:83], v[206:207]
    v_pk_add_f32 v[200:201], v[200:201], v[80:81]
    v_pk_fma_f32 v[204:205], v[80:81], v[80:81], v[204:205]
    ds_read_b128 v[216:219], v5 offset:128
    ds_read_b128 v[220:223], v5 offset:144
    s_waitcnt lgkmcnt(2)
    s_nop 0
    v_dot2_f32_bf16 v79, v67, v231, 0
    v_dot2_f32_bf16 v78, v67, v230, 0
    v_dot2_f32_bf16 v77, v66, v229, 0
    v_dot2_f32_bf16 v76, v66, v228, 0
    v_dot2_f32_bf16 v75, v65, v227, 0
    v_dot2_f32_bf16 v74, v65, v226, 0
    v_dot2_f32_bf16 v73, v64, v225, 0
    v_dot2_f32_bf16 v72, v64, v224, 0
    v_pk_add_f32 v[202:203], v[202:203], v[78:79]
    v_pk_fma_f32 v[206:207], v[78:79], v[78:79], v[206:207]
    v_pk_add_f32 v[200:201], v[200:201], v[76:77]
    v_pk_fma_f32 v[204:205], v[76:77], v[76:77], v[204:205]
    v_pk_add_f32 v[202:203], v[202:203], v[74:75]
    v_pk_fma_f32 v[206:207], v[74:75], v[74:75], v[206:207]
    v_pk_add_f32 v[200:201], v[200:201], v[72:73]
    v_pk_fma_f32 v[204:205], v[72:73], v[72:73], v[204:205]
    s_waitcnt vmcnt(10)
    ds_read_b128 v[56:59], v213 offset:4096
    ds_read_b128 v[60:63], v213 offset:4160
    ds_read_b128 v[224:227], v5 offset:0
    ds_read_b128 v[228:231], v5 offset:16
    s_waitcnt lgkmcnt(2)
    s_add_u32 m0, s3, 4096
    s_add_u32 s58, s40, 24576
    buffer_load_dwordx4 v2, s[8:11], s58 offen nt lds
    s_add_u32 m0, m0, 1024
    s_add_u32 s58, s58, 6144
    buffer_load_dwordx4 v2, s[8:11], s58 offen nt lds
    v_dot2_f32_bf16 v71, v63, v223, 0
    v_dot2_f32_bf16 v70, v63, v222, 0
    v_dot2_f32_bf16 v69, v62, v221, 0
    v_dot2_f32_bf16 v68, v62, v220, 0
    v_dot2_f32_bf16 v67, v61, v219, 0
    v_dot2_f32_bf16 v66, v61, v218, 0
    v_dot2_f32_bf16 v65, v60, v217, 0
    v_dot2_f32_bf16 v64, v60, v216, 0
    v_pk_add_f32 v[202:203], v[202:203], v[70:71]
    v_pk_fma_f32 v[206:207], v[70:71], v[70:71], v[206:207]
    v_pk_add_f32 v[200:201], v[200:201], v[68:69]
    v_pk_fma_f32 v[204:205], v[68:69], v[68:69], v[204:205]
    v_pk_add_f32 v[202:203], v[202:203], v[66:67]
    v_pk_fma_f32 v[206:207], v[66:67], v[66:67], v[206:207]
    v_pk_add_f32 v[200:201], v[200:201], v[64:65]
    v_pk_fma_f32 v[204:205], v[64:65], v[64:65], v[204:205]
    ds_read_b128 v[216:219], v5 offset:768
    ds_read_b128 v[220:223], v5 offset:784
    s_waitcnt lgkmcnt(2)
    s_nop 0
    v_dot2_f32_bf16 v63, v59, v231, 0
    v_dot2_f32_bf16 v62, v59, v230, 0
    v_dot2_f32_bf16 v61, v58, v229, 0
    v_dot2_f32_bf16 v60, v58, v228, 0
    v_dot2_f32_bf16 v59, v57, v227, 0
    v_dot2_f32_bf16 v58, v57, v226, 0
    v_dot2_f32_bf16 v57, v56, v225, 0
    v_dot2_f32_bf16 v56, v56, v224, 0
    v_pk_add_f32 v[202:203], v[202:203], v[62:63]
    v_pk_fma_f32 v[206:207], v[62:63], v[62:63], v[206:207]
    v_pk_add_f32 v[200:201], v[200:201], v[60:61]
    v_pk_fma_f32 v[204:205], v[60:61], v[60:61], v[204:205]
    v_pk_add_f32 v[202:203], v[202:203], v[58:59]
    v_pk_fma_f32 v[206:207], v[58:59], v[58:59], v[206:207]
    v_pk_add_f32 v[200:201], v[200:201], v[56:57]
    v_pk_fma_f32 v[204:205], v[56:57], v[56:57], v[204:205]
    v_pk_add_f32 v[200:201], v[200:201], v[202:203]
    v_pk_add_f32 v[204:205], v[204:205], v[206:207]
    v_add_f32 v200, v200, v201
    v_add_f32 v204, v204, v205
    v_mov_b32 v201, v200
    v_mov_b32 v205, v204
    s_nop 0
    v_permlane16_swap_b32 v200, v201
    v_permlane16_swap_b32 v204, v205
    v_add_f32 v200, v200, v201
    v_add_f32 v204, v204, v205
    v_mov_b32 v201, v200
    v_mov_b32 v205, v204
    s_nop 0
    v_permlane32_swap_b32 v200, v201
    v_permlane32_swap_b32 v204, v205
    v_add_f32 v200, v200, v201
    v_add_f32 v204, v204, v205
    v_mul_f32 v200, 0xbb2aaaab, v200
    v_mul_f32 v204, 0x3b2aaaab, v204
    v_fma_f32 v204, -v200, v200, v204
    v_max_f32_e64 v204, 0, v204
    v_add_f32 v204, 0x3727c5ac, v204
    v_rsq_f32 v204, v204
    s_nop 0
    v_mul_f32 v204, 0x3eefde6e, v204
    v_mul_f32_e64 v200, v200, v204
    v_pk_fma_f32 v[56:57], v[56:57], v[204:205], v[200:201] op_sel_hi:[1,0,0]
    v_pk_fma_f32 v[58:59], v[58:59], v[204:205], v[200:201] op_sel_hi:[1,0,0]
    v_pk_fma_f32 v[60:61], v[60:61], v[204:205], v[200:201] op_sel_hi:[1,0,0]
    v_pk_fma_f32 v[62:63], v[62:63], v[204:205], v[200:201] op_sel_hi:[1,0,0]
    v_cvt_pk_bf16_f32 v56, v56, v57
    v_cvt_pk_bf16_f32 v57, v58, v59
    v_cvt_pk_bf16_f32 v58, v60, v61
    v_cvt_pk_bf16_f32 v59, v62, v63
    v_pk_fma_f32 v[64:65], v[64:65], v[204:205], v[200:201] op_sel_hi:[1,0,0]
    v_pk_fma_f32 v[66:67], v[66:67], v[204:205], v[200:201] op_sel_hi:[1,0,0]
    v_pk_fma_f32 v[68:69], v[68:69], v[204:205], v[200:201] op_sel_hi:[1,0,0]
    v_pk_fma_f32 v[70:71], v[70:71], v[204:205], v[200:201] op_sel_hi:[1,0,0]
    v_cvt_pk_bf16_f32 v60, v64, v65
    v_cvt_pk_bf16_f32 v61, v66, v67
    v_cvt_pk_bf16_f32 v62, v68, v69
    v_cvt_pk_bf16_f32 v63, v70, v71
    v_pk_fma_f32 v[72:73], v[72:73], v[204:205], v[200:201] op_sel_hi:[1,0,0]
    v_pk_fma_f32 v[74:75], v[74:75], v[204:205], v[200:201] op_sel_hi:[1,0,0]
    v_pk_fma_f32 v[76:77], v[76:77], v[204:205], v[200:201] op_sel_hi:[1,0,0]
    v_pk_fma_f32 v[78:79], v[78:79], v[204:205], v[200:201] op_sel_hi:[1,0,0]
    v_cvt_pk_bf16_f32 v64, v72, v73
    v_cvt_pk_bf16_f32 v65, v74, v75
    v_cvt_pk_bf16_f32 v66, v76, v77
    v_cvt_pk_bf16_f32 v67, v78, v79
    v_pk_fma_f32 v[80:81], v[80:81], v[204:205], v[200:201] op_sel_hi:[1,0,0]
    v_pk_fma_f32 v[82:83], v[82:83], v[204:205], v[200:201] op_sel_hi:[1,0,0]
    v_pk_fma_f32 v[84:85], v[84:85], v[204:205], v[200:201] op_sel_hi:[1,0,0]
    v_pk_fma_f32 v[86:87], v[86:87], v[204:205], v[200:201] op_sel_hi:[1,0,0]
    v_cvt_pk_bf16_f32 v68, v80, v81
    v_cvt_pk_bf16_f32 v69, v82, v83
    v_cvt_pk_bf16_f32 v70, v84, v85
    v_cvt_pk_bf16_f32 v71, v86, v87
    v_pk_fma_f32 v[88:89], v[88:89], v[204:205], v[200:201] op_sel_hi:[1,0,0]
    v_pk_fma_f32 v[90:91], v[90:91], v[204:205], v[200:201] op_sel_hi:[1,0,0]
    v_pk_fma_f32 v[92:93], v[92:93], v[204:205], v[200:201] op_sel_hi:[1,0,0]
    v_pk_fma_f32 v[94:95], v[94:95], v[204:205], v[200:201] op_sel_hi:[1,0,0]
    v_cvt_pk_bf16_f32 v72, v88, v89
    v_cvt_pk_bf16_f32 v73, v90, v91
    v_cvt_pk_bf16_f32 v74, v92, v93
    v_cvt_pk_bf16_f32 v75, v94, v95
    v_pk_fma_f32 v[96:97], v[96:97], v[204:205], v[200:201] op_sel_hi:[1,0,0]
    v_pk_fma_f32 v[98:99], v[98:99], v[204:205], v[200:201] op_sel_hi:[1,0,0]
    v_pk_fma_f32 v[100:101], v[100:101], v[204:205], v[200:201] op_sel_hi:[1,0,0]
    v_pk_fma_f32 v[102:103], v[102:103], v[204:205], v[200:201] op_sel_hi:[1,0,0]
    v_cvt_pk_bf16_f32 v76, v96, v97
    v_cvt_pk_bf16_f32 v77, v98, v99
    v_cvt_pk_bf16_f32 v78, v100, v101
    v_cvt_pk_bf16_f32 v79, v102, v103
    v_pk_fma_f32 v[152:153], v[152:153], v[204:205], v[200:201] op_sel_hi:[1,0,0]
    v_pk_fma_f32 v[154:155], v[154:155], v[204:205], v[200:201] op_sel_hi:[1,0,0]
    v_pk_fma_f32 v[156:157], v[156:157], v[204:205], v[200:201] op_sel_hi:[1,0,0]
    v_pk_fma_f32 v[158:159], v[158:159], v[204:205], v[200:201] op_sel_hi:[1,0,0]
    v_cvt_pk_bf16_f32 v80, v152, v153
    v_cvt_pk_bf16_f32 v81, v154, v155
    v_cvt_pk_bf16_f32 v82, v156, v157
    v_cvt_pk_bf16_f32 v83, v158, v159
    v_pk_fma_f32 v[160:161], v[160:161], v[204:205], v[200:201] op_sel_hi:[1,0,0]
    v_pk_fma_f32 v[162:163], v[162:163], v[204:205], v[200:201] op_sel_hi:[1,0,0]
    v_pk_fma_f32 v[164:165], v[164:165], v[204:205], v[200:201] op_sel_hi:[1,0,0]
    v_pk_fma_f32 v[166:167], v[166:167], v[204:205], v[200:201] op_sel_hi:[1,0,0]
    v_cvt_pk_bf16_f32 v84, v160, v161
    v_cvt_pk_bf16_f32 v85, v162, v163
    v_cvt_pk_bf16_f32 v86, v164, v165
    v_cvt_pk_bf16_f32 v87, v166, v167
    v_pk_fma_f32 v[168:169], v[168:169], v[204:205], v[200:201] op_sel_hi:[1,0,0]
    v_pk_fma_f32 v[170:171], v[170:171], v[204:205], v[200:201] op_sel_hi:[1,0,0]
    v_pk_fma_f32 v[172:173], v[172:173], v[204:205], v[200:201] op_sel_hi:[1,0,0]
    v_pk_fma_f32 v[174:175], v[174:175], v[204:205], v[200:201] op_sel_hi:[1,0,0]
    v_cvt_pk_bf16_f32 v88, v168, v169
    v_cvt_pk_bf16_f32 v89, v170, v171
    v_cvt_pk_bf16_f32 v90, v172, v173
    v_cvt_pk_bf16_f32 v91, v174, v175
    v_pk_fma_f32 v[176:177], v[176:177], v[204:205], v[200:201] op_sel_hi:[1,0,0]
    v_pk_fma_f32 v[178:179], v[178:179], v[204:205], v[200:201] op_sel_hi:[1,0,0]
    v_pk_fma_f32 v[180:181], v[180:181], v[204:205], v[200:201] op_sel_hi:[1,0,0]
    v_pk_fma_f32 v[182:183], v[182:183], v[204:205], v[200:201] op_sel_hi:[1,0,0]
    v_cvt_pk_bf16_f32 v92, v176, v177
    v_cvt_pk_bf16_f32 v93, v178, v179
    v_cvt_pk_bf16_f32 v94, v180, v181
    v_cvt_pk_bf16_f32 v95, v182, v183
    v_pk_fma_f32 v[184:185], v[184:185], v[204:205], v[200:201] op_sel_hi:[1,0,0]
    v_pk_fma_f32 v[186:187], v[186:187], v[204:205], v[200:201] op_sel_hi:[1,0,0]
    v_pk_fma_f32 v[188:189], v[188:189], v[204:205], v[200:201] op_sel_hi:[1,0,0]
    v_pk_fma_f32 v[190:191], v[190:191], v[204:205], v[200:201] op_sel_hi:[1,0,0]
    v_cvt_pk_bf16_f32 v96, v184, v185
    v_cvt_pk_bf16_f32 v97, v186, v187
    v_cvt_pk_bf16_f32 v98, v188, v189
    v_cvt_pk_bf16_f32 v99, v190, v191
    v_pk_fma_f32 v[192:193], v[192:193], v[204:205], v[200:201] op_sel_hi:[1,0,0]
    v_pk_fma_f32 v[194:195], v[194:195], v[204:205], v[200:201] op_sel_hi:[1,0,0]
    v_pk_fma_f32 v[196:197], v[196:197], v[204:205], v[200:201] op_sel_hi:[1,0,0]
    v_pk_fma_f32 v[198:199], v[198:199], v[204:205], v[200:201] op_sel_hi:[1,0,0]
    v_cvt_pk_bf16_f32 v100, v192, v193
    v_cvt_pk_bf16_f32 v101, v194, v195
    v_cvt_pk_bf16_f32 v102, v196, v197
    v_cvt_pk_bf16_f32 v103, v198, v199
    s_waitcnt vmcnt(10)
    ds_read_b128 v[128:131], v212 offset:0
    ds_read_b128 v[132:135], v212 offset:64
    ds_read_b128 v[224:227], v5 offset:896
    ds_read_b128 v[228:231], v5 offset:912
    s_waitcnt lgkmcnt(2)
    v_dot2_f32_bf16 v159, v131, v223, 0
    v_dot2_f32_bf16 v158, v131, v222, 0
    v_dot2_f32_bf16 v157, v130, v221, 0
    v_dot2_f32_bf16 v156, v130, v220, 0
    v_dot2_f32_bf16 v155, v129, v219, 0
    v_dot2_f32_bf16 v154, v129, v218, 0
    v_dot2_f32_bf16 v153, v128, v217, 0
    v_dot2_f32_bf16 v152, v128, v216, 0
    v_pk_mul_f32 v[202:203], v[158:159], 1.0 op_sel_hi:[1,0]
    v_pk_mul_f32 v[206:207], v[158:159], v[158:159]
    v_pk_mul_f32 v[200:201], v[156:157], 1.0 op_sel_hi:[1,0]
    v_pk_mul_f32 v[204:205], v[156:157], v[156:157]
    v_pk_add_f32 v[202:203], v[202:203], v[154:155]
    v_pk_fma_f32 v[206:207], v[154:155], v[154:155], v[206:207]
    v_pk_add_f32 v[200:201], v[200:201], v[152:153]
    v_pk_fma_f32 v[204:205], v[152:153], v[152:153], v[204:205]
    ds_read_b128 v[216:219], v5 offset:1024
    ds_read_b128 v[220:223], v5 offset:1040
    s_waitcnt lgkmcnt(2)
    s_nop 0
    v_dot2_f32_bf16 v167, v135, v231, 0
    v_dot2_f32_bf16 v166, v135, v230, 0
    v_dot2_f32_bf16 v165, v134, v229, 0
    v_dot2_f32_bf16 v164, v134, v228, 0
    v_dot2_f32_bf16 v163, v133, v227, 0
    v_dot2_f32_bf16 v162, v133, v226, 0
    v_dot2_f32_bf16 v161, v132, v225, 0
    v_dot2_f32_bf16 v160, v132, v224, 0
    v_pk_add_f32 v[202:203], v[202:203], v[166:167]
    v_pk_fma_f32 v[206:207], v[166:167], v[166:167], v[206:207]
    v_pk_add_f32 v[200:201], v[200:201], v[164:165]
    v_pk_fma_f32 v[204:205], v[164:165], v[164:165], v[204:205]
    v_pk_add_f32 v[202:203], v[202:203], v[162:163]
    v_pk_fma_f32 v[206:207], v[162:163], v[162:163], v[206:207]
    v_pk_add_f32 v[200:201], v[200:201], v[160:161]
    v_pk_fma_f32 v[204:205], v[160:161], v[160:161], v[204:205]
    s_waitcnt vmcnt(8)
    ds_read_b128 v[136:139], v212 offset:2048
    ds_read_b128 v[140:143], v212 offset:2112
    ds_read_b128 v[224:227], v5 offset:1152
    ds_read_b128 v[228:231], v5 offset:1168
    s_waitcnt lgkmcnt(2)
    v_dot2_f32_bf16 v175, v139, v223, 0
    v_dot2_f32_bf16 v174, v139, v222, 0
    v_dot2_f32_bf16 v173, v138, v221, 0
    v_dot2_f32_bf16 v172, v138, v220, 0
    v_dot2_f32_bf16 v171, v137, v219, 0
    v_dot2_f32_bf16 v170, v137, v218, 0
    v_dot2_f32_bf16 v169, v136, v217, 0
    v_dot2_f32_bf16 v168, v136, v216, 0
    v_pk_add_f32 v[202:203], v[202:203], v[174:175]
    v_pk_fma_f32 v[206:207], v[174:175], v[174:175], v[206:207]
    v_pk_add_f32 v[200:201], v[200:201], v[172:173]
    v_pk_fma_f32 v[204:205], v[172:173], v[172:173], v[204:205]
    v_pk_add_f32 v[202:203], v[202:203], v[170:171]
    v_pk_fma_f32 v[206:207], v[170:171], v[170:171], v[206:207]
    v_pk_add_f32 v[200:201], v[200:201], v[168:169]
    v_pk_fma_f32 v[204:205], v[168:169], v[168:169], v[204:205]
    ds_read_b128 v[216:219], v5 offset:1280
    ds_read_b128 v[220:223], v5 offset:1296
    s_waitcnt lgkmcnt(2)
    s_nop 0
    v_dot2_f32_bf16 v183, v143, v231, 0
    v_dot2_f32_bf16 v182, v143, v230, 0
    v_dot2_f32_bf16 v181, v142, v229, 0
    v_dot2_f32_bf16 v180, v142, v228, 0
    v_dot2_f32_bf16 v179, v141, v227, 0
    v_dot2_f32_bf16 v178, v141, v226, 0
    v_dot2_f32_bf16 v177, v140, v225, 0
    v_dot2_f32_bf16 v176, v140, v224, 0
    v_pk_add_f32 v[202:203], v[202:203], v[182:183]
    v_pk_fma_f32 v[206:207], v[182:183], v[182:183], v[206:207]
    v_pk_add_f32 v[200:201], v[200:201], v[180:181]
    v_pk_fma_f32 v[204:205], v[180:181], v[180:181], v[204:205]
    v_pk_add_f32 v[202:203], v[202:203], v[178:179]
    v_pk_fma_f32 v[206:207], v[178:179], v[178:179], v[206:207]
    v_pk_add_f32 v[200:201], v[200:201], v[176:177]
    v_pk_fma_f32 v[204:205], v[176:177], v[176:177], v[204:205]
    s_setprio 0
    s_waitcnt vmcnt(6)
    ds_read_b128 v[144:147], v212 offset:4096
    ds_read_b128 v[148:151], v212 offset:4160
    ds_read_b128 v[224:227], v5 offset:1408
    ds_read_b128 v[228:231], v5 offset:1424
    s_waitcnt lgkmcnt(2)
    s_mov_b32 m0, s35
    s_mov_b32 s36, s45
    buffer_load_dwordx4 v1, s[12:15], s36 offen lds
    s_add_u32 m0, m0, 1024
    s_add_u32 s36, s36, 24576
    buffer_load_dwordx4 v6, s[12:15], s36 offen lds
    s_add_u32 m0, m0, 1024
    s_add_u32 s36, s36, 24576
    buffer_load_dwordx4 v1, s[12:15], s36 offen lds
    s_add_u32 m0, m0, 1024
    s_add_u32 s36, s36, 24576
    buffer_load_dwordx4 v6, s[12:15], s36 offen lds
    s_add_u32 m0, m0, 1024
    s_add_u32 s36, s36, 24576
    buffer_load_dwordx4 v1, s[12:15], s36 offen lds
    s_add_u32 m0, m0, 1024
    s_add_u32 s36, s36, 24576
    buffer_load_dwordx4 v6, s[12:15], s36 offen lds
    s_add_u32 s35, s35, 49152
    s_cmp_ge_u32 s35, 147456
    s_cselect_b32 s35, s46, s35
    s_add_u32 s45, s45, 128
    s_cmp_eq_u32 s45, s55
    s_cselect_b32 s45, s54, s45
    s_sub_u32 s87, s87, 1
    s_cmp_lg_u32 s87, 0
    s_cbranch_scc1 K1_ds1
    s_lshl_b32 s54, s83, 7
    s_add_u32 s54, s54, s50
    s_lshl_b32 s55, s84, 7
    s_add_u32 s55, s55, s50
    s_lshl_b32 s45, s56, 7
    s_add_u32 s45, s45, s54
    s_nop 0
K1_ds1:
    v_dot2_f32_bf16 v191, v147, v223, 0
    v_dot2_f32_bf16 v190, v147, v222, 0
    v_dot2_f32_bf16 v189, v146, v221, 0
    v_dot2_f32_bf16 v188, v146, v220, 0
    v_dot2_f32_bf16 v187, v145, v219, 0
    v_dot2_f32_bf16 v186, v145, v218, 0
    v_dot2_f32_bf16 v185, v144, v217, 0
    v_dot2_f32_bf16 v184, v144, v216, 0
    v_pk_add_f32 v[202:203], v[202:203], v[190:191]
    v_pk_fma_f32 v[206:207], v[190:191], v[190:191], v[206:207]
    v_pk_add_f32 v[200:201], v[200:201], v[188:189]
    v_pk_fma_f32 v[204:205], v[188:189], v[188:189], v[204:205]
    v_pk_add_f32 v[202:203], v[202:203], v[186:187]
    v_pk_fma_f32 v[206:207], v[186:187], v[186:187], v[206:207]
    v_pk_add_f32 v[200:201], v[200:201], v[184:185]
    v_pk_fma_f32 v[204:205], v[184:185], v[184:185], v[204:205]
    ds_read_b128 v[216:219], v5 offset:640
    ds_read_b128 v[220:223], v5 offset:656
    s_waitcnt lgkmcnt(2)
    s_nop 0
    v_dot2_f32_bf16 v199, v151, v231, 0
    v_dot2_f32_bf16 v198, v151, v230, 0
    v_dot2_f32_bf16 v197, v150, v229, 0
    v_dot2_f32_bf16 v196, v150, v228, 0
    v_dot2_f32_bf16 v195, v149, v227, 0
    v_dot2_f32_bf16 v194, v149, v226, 0
    v_dot2_f32_bf16 v193, v148, v225, 0
    v_dot2_f32_bf16 v192, v148, v224, 0
    v_pk_add_f32 v[202:203], v[202:203], v[198:199]
    v_pk_fma_f32 v[206:207], v[198:199], v[198:199], v[206:207]
    v_pk_add_f32 v[200:201], v[200:201], v[196:197]
    v_pk_fma_f32 v[204:205], v[196:197], v[196:197], v[204:205]
    v_pk_add_f32 v[202:203], v[202:203], v[194:195]
    v_pk_fma_f32 v[206:207], v[194:195], v[194:195], v[206:207]
    v_pk_add_f32 v[200:201], v[200:201], v[192:193]
    v_pk_fma_f32 v[204:205], v[192:193], v[192:193], v[204:205]
    s_waitcnt vmcnt(10)
    ds_read_b128 v[120:123], v213 offset:0
    ds_read_b128 v[124:127], v213 offset:64
    ds_read_b128 v[224:227], v5 offset:512
    ds_read_b128 v[228:231], v5 offset:528
    s_waitcnt lgkmcnt(2)
    v_dot2_f32_bf16 v151, v127, v223, 0
    v_dot2_f32_bf16 v150, v127, v222, 0
    v_dot2_f32_bf16 v149, v126, v221, 0
    v_dot2_f32_bf16 v148, v126, v220, 0
    v_dot2_f32_bf16 v147, v125, v219, 0
    v_dot2_f32_bf16 v146, v125, v218, 0
    v_dot2_f32_bf16 v145, v124, v217, 0
    v_dot2_f32_bf16 v144, v124, v216, 0
    v_pk_add_f32 v[202:203], v[202:203], v[150:151]
    v_pk_fma_f32 v[206:207], v[150:151], v[150:151], v[206:207]
    v_pk_add_f32 v[200:201], v[200:201], v[148:149]
    v_pk_fma_f32 v[204:205], v[148:149], v[148:149], v[204:205]
    v_pk_add_f32 v[202:203], v[202:203], v[146:147]
    v_pk_fma_f32 v[206:207], v[146:147], v[146:147], v[206:207]
    v_pk_add_f32 v[200:201], v[200:201], v[144:145]
    v_pk_fma_f32 v[204:205], v[144:145], v[144:145], v[204:205]
    ds_read_b128 v[216:219], v5 offset:384
    ds_read_b128 v[220:223], v5 offset:400
    s_waitcnt lgkmcnt(2)
    s_nop 0
    v_dot2_f32_bf16 v143, v123, v231, 0
    v_dot2_f32_bf16 v142, v123, v230, 0
    v_dot2_f32_bf16 v141, v122, v229, 0
    v_dot2_f32_bf16 v140, v122, v228, 0
    v_dot2_f32_bf16 v139, v121, v227, 0
    v_dot2_f32_bf16 v138, v121, v226, 0
    v_dot2_f32_bf16 v137, v120, v225, 0
    v_dot2_f32_bf16 v136, v120, v224, 0
    v_pk_add_f32 v[202:203], v[202:203], v[142:143]
    v_pk_fma_f32 v[206:207], v[142:143], v[142:143], v[206:207]
    v_pk_add_f32 v[200:201], v[200:201], v[140:141]
    v_pk_fma_f32 v[204:205], v[140:141], v[140:141], v[204:205]
    v_pk_add_f32 v[202:203], v[202:203], v[138:139]
    v_pk_fma_f32 v[206:207], v[138:139], v[138:139], v[206:207]
    v_pk_add_f32 v[200:201], v[200:201], v[136:137]
    v_pk_fma_f32 v[204:205], v[136:137], v[136:137], v[204:205]
    s_waitcnt vmcnt(8)
    ds_read_b128 v[112:115], v213 offset:2048
    ds_read_b128 v[116:119], v213 offset:2112
    ds_read_b128 v[224:227], v5 offset:256
    ds_read_b128 v[228:231], v5 offset:272
    s_waitcnt lgkmcnt(2)
    v_dot2_f32_bf16 v135, v119, v223, 0
    v_dot2_f32_bf16 v134, v119, v222, 0
    v_dot2_f32_bf16 v133, v118, v221, 0
    v_dot2_f32_bf16 v132, v118, v220, 0
    v_dot2_f32_bf16 v131, v117, v219, 0
    v_dot2_f32_bf16 v130, v117, v218, 0
    v_dot2_f32_bf16 v129, v116, v217, 0
    v_dot2_f32_bf16 v128, v116, v216, 0
    v_pk_add_f32 v[202:203], v[202:203], v[134:135]
    v_pk_fma_f32 v[206:207], v[134:135], v[134:135], v[206:207]
    v_pk_add_f32 v[200:201], v[200:201], v[132:133]
    v_pk_fma_f32 v[204:205], v[132:133], v[132:133], v[204:205]
    v_pk_add_f32 v[202:203], v[202:203], v[130:131]
    v_pk_fma_f32 v[206:207], v[130:131], v[130:131], v[206:207]
    v_pk_add_f32 v[200:201], v[200:201], v[128:129]
    v_pk_fma_f32 v[204:205], v[128:129], v[128:129], v[204:205]
    ds_read_b128 v[216:219], v5 offset:128
    ds_read_b128 v[220:223], v5 offset:144
    s_waitcnt lgkmcnt(2)
    s_nop 0
    v_dot2_f32_bf16 v127, v115, v231, 0
    v_dot2_f32_bf16 v126, v115, v230, 0
    v_dot2_f32_bf16 v125, v114, v229, 0
    v_dot2_f32_bf16 v124, v114, v228, 0
    v_dot2_f32_bf16 v123, v113, v227, 0
    v_dot2_f32_bf16 v122, v113, v226, 0
    v_dot2_f32_bf16 v121, v112, v225, 0
    v_dot2_f32_bf16 v120, v112, v224, 0
    v_pk_add_f32 v[202:203], v[202:203], v[126:127]
    v_pk_fma_f32 v[206:207], v[126:127], v[126:127], v[206:207]
    v_pk_add_f32 v[200:201], v[200:201], v[124:125]
    v_pk_fma_f32 v[204:205], v[124:125], v[124:125], v[204:205]
    v_pk_add_f32 v[202:203], v[202:203], v[122:123]
    v_pk_fma_f32 v[206:207], v[122:123], v[122:123], v[206:207]
    v_pk_add_f32 v[200:201], v[200:201], v[120:121]
    v_pk_fma_f32 v[204:205], v[120:121], v[120:121], v[204:205]
    s_waitcnt vmcnt(6)
    ds_read_b128 v[104:107], v213 offset:4096
    ds_read_b128 v[108:111], v213 offset:4160
    ds_read_b128 v[224:227], v5 offset:0
    ds_read_b128 v[228:231], v5 offset:16
    s_waitcnt lgkmcnt(2)
    s_mov_b32 m0, s35
    s_mov_b32 s36, s45
    buffer_load_dwordx4 v1, s[12:15], s36 offen lds
    s_add_u32 m0, m0, 1024
    s_add_u32 s36, s36, 24576
    buffer_load_dwordx4 v6, s[12:15], s36 offen lds
    s_add_u32 m0, m0, 1024
    s_add_u32 s36, s36, 24576
    buffer_load_dwordx4 v1, s[12:15], s36 offen lds
    s_add_u32 m0, m0, 1024
    s_add_u32 s36, s36, 24576
    buffer_load_dwordx4 v6, s[12:15], s36 offen lds
    s_add_u32 m0, m0, 1024
    s_add_u32 s36, s36, 24576
    buffer_load_dwordx4 v1, s[12:15], s36 offen lds
    s_add_u32 m0, m0, 1024
    s_add_u32 s36, s36, 24576
    buffer_load_dwordx4 v6, s[12:15], s36 offen lds
    s_add_u32 s35, s35, 49152
    s_cmp_ge_u32 s35, 147456
    s_cselect_b32 s35, s46, s35
    s_add_u32 s45, s45, 128
    s_cmp_eq_u32 s45, s55
    s_cselect_b32 s45, s54, s45
    s_sub_u32 s87, s87, 1
    s_cmp_lg_u32 s87, 0
    s_cbranch_scc1 K1_ds2
    s_lshl_b32 s54, s83, 7
    s_add_u32 s54, s54, s50
    s_lshl_b32 s55, s84, 7
    s_add_u32 s55, s55, s50
    s_lshl_b32 s45, s56, 7
    s_add_u32 s45, s45, s54
K1_ds2:
    v_dot2_f32_bf16 v119, v111, v223, 0
    v_dot2_f32_bf16 v118, v111, v222, 0
    v_dot2_f32_bf16 v117, v110, v221, 0
    v_dot2_f32_bf16 v116, v110, v220, 0
    v_dot2_f32_bf16 v115, v109, v219, 0
    v_dot2_f32_bf16 v114, v109, v218, 0
    v_dot2_f32_bf16 v113, v108, v217, 0
    v_dot2_f32_bf16 v112, v108, v216, 0
    v_pk_add_f32 v[202:203], v[202:203], v[118:119]
    v_pk_fma_f32 v[206:207], v[118:119], v[118:119], v[206:207]
    v_pk_add_f32 v[200:201], v[200:201], v[116:117]
    v_pk_fma_f32 v[204:205], v[116:117], v[116:117], v[204:205]
    v_pk_add_f32 v[202:203], v[202:203], v[114:115]
    v_pk_fma_f32 v[206:207], v[114:115], v[114:115], v[206:207]
    v_pk_add_f32 v[200:201], v[200:201], v[112:113]
    v_pk_fma_f32 v[204:205], v[112:113], v[112:113], v[204:205]
    s_waitcnt lgkmcnt(0)
    s_nop 0
    v_dot2_f32_bf16 v111, v107, v231, 0
    v_dot2_f32_bf16 v110, v107, v230, 0
    v_dot2_f32_bf16 v109, v106, v229, 0
    v_dot2_f32_bf16 v108, v106, v228, 0
    v_dot2_f32_bf16 v107, v105, v227, 0
    v_dot2_f32_bf16 v106, v105, v226, 0
    v_dot2_f32_bf16 v105, v104, v225, 0
    v_dot2_f32_bf16 v104, v104, v224, 0
    v_pk_add_f32 v[202:203], v[202:203], v[110:111]
    v_pk_fma_f32 v[206:207], v[110:111], v[110:111], v[206:207]
    v_pk_add_f32 v[200:201], v[200:201], v[108:109]
    v_pk_fma_f32 v[204:205], v[108:109], v[108:109], v[204:205]
    v_pk_add_f32 v[202:203], v[202:203], v[106:107]
    v_pk_fma_f32 v[206:207], v[106:107], v[106:107], v[206:207]
    v_pk_add_f32 v[200:201], v[200:201], v[104:105]
    v_pk_fma_f32 v[204:205], v[104:105], v[104:105], v[204:205]
    v_pk_add_f32 v[200:201], v[200:201], v[202:203]
    v_pk_add_f32 v[204:205], v[204:205], v[206:207]
    v_add_f32 v200, v200, v201
    v_add_f32 v204, v204, v205
    v_mov_b32 v201, v200
    v_mov_b32 v205, v204
    s_nop 0
    v_permlane16_swap_b32 v200, v201
    v_permlane16_swap_b32 v204, v205
    v_add_f32 v200, v200, v201
    v_add_f32 v204, v204, v205
    v_mov_b32 v201, v200
    v_mov_b32 v205, v204
    s_nop 0
    v_permlane32_swap_b32 v200, v201
    v_permlane32_swap_b32 v204, v205
    v_add_f32 v200, v200, v201
    v_add_f32 v204, v204, v205
    v_mul_f32 v200, 0xbb2aaaab, v200
    v_mul_f32 v204, 0x3b2aaaab, v204
    v_fma_f32 v204, -v200, v200, v204
    v_max_f32_e64 v204, 0, v204
    v_add_f32 v204, 0x3727c5ac, v204
    v_rsq_f32 v204, v204
    s_nop 0
    v_mul_f32 v204, 0x3eefde6e, v204
    v_mul_f32_e64 v200, v200, v204
    v_pk_fma_f32 v[104:105], v[104:105], v[204:205], v[200:201] op_sel_hi:[1,0,0]
    v_pk_fma_f32 v[106:107], v[106:107], v[204:205], v[200:201] op_sel_hi:[1,0,0]
    v_pk_fma_f32 v[108:109], v[108:109], v[204:205], v[200:201] op_sel_hi:[1,0,0]
    v_pk_fma_f32 v[110:111], v[110:111], v[204:205], v[200:201] op_sel_hi:[1,0,0]
    v_cvt_pk_bf16_f32 v104, v104, v105
    v_cvt_pk_bf16_f32 v105, v106, v107
    v_cvt_pk_bf16_f32 v106, v108, v109
    v_cvt_pk_bf16_f32 v107, v110, v111
    v_pk_fma_f32 v[112:113], v[112:113], v[204:205], v[200:201] op_sel_hi:[1,0,0]
    v_pk_fma_f32 v[114:115], v[114:115], v[204:205], v[200:201] op_sel_hi:[1,0,0]
    v_pk_fma_f32 v[116:117], v[116:117], v[204:205], v[200:201] op_sel_hi:[1,0,0]
    v_pk_fma_f32 v[118:119], v[118:119], v[204:205], v[200:201] op_sel_hi:[1,0,0]
    v_cvt_pk_bf16_f32 v108, v112, v113
    v_cvt_pk_bf16_f32 v109, v114, v115
    v_cvt_pk_bf16_f32 v110, v116, v117
    v_cvt_pk_bf16_f32 v111, v118, v119
    v_pk_fma_f32 v[120:121], v[120:121], v[204:205], v[200:201] op_sel_hi:[1,0,0]
    v_pk_fma_f32 v[122:123], v[122:123], v[204:205], v[200:201] op_sel_hi:[1,0,0]
    v_pk_fma_f32 v[124:125], v[124:125], v[204:205], v[200:201] op_sel_hi:[1,0,0]
    v_pk_fma_f32 v[126:127], v[126:127], v[204:205], v[200:201] op_sel_hi:[1,0,0]
    v_cvt_pk_bf16_f32 v112, v120, v121
    v_cvt_pk_bf16_f32 v113, v122, v123
    v_cvt_pk_bf16_f32 v114, v124, v125
    v_cvt_pk_bf16_f32 v115, v126, v127
    v_pk_fma_f32 v[128:129], v[128:129], v[204:205], v[200:201] op_sel_hi:[1,0,0]
    v_pk_fma_f32 v[130:131], v[130:131], v[204:205], v[200:201] op_sel_hi:[1,0,0]
    v_pk_fma_f32 v[132:133], v[132:133], v[204:205], v[200:201] op_sel_hi:[1,0,0]
    v_pk_fma_f32 v[134:135], v[134:135], v[204:205], v[200:201] op_sel_hi:[1,0,0]
    v_cvt_pk_bf16_f32 v116, v128, v129
    v_cvt_pk_bf16_f32 v117, v130, v131
    v_cvt_pk_bf16_f32 v118, v132, v133
    v_cvt_pk_bf16_f32 v119, v134, v135
    v_pk_fma_f32 v[136:137], v[136:137], v[204:205], v[200:201] op_sel_hi:[1,0,0]
    v_pk_fma_f32 v[138:139], v[138:139], v[204:205], v[200:201] op_sel_hi:[1,0,0]
    v_pk_fma_f32 v[140:141], v[140:141], v[204:205], v[200:201] op_sel_hi:[1,0,0]
    v_pk_fma_f32 v[142:143], v[142:143], v[204:205], v[200:201] op_sel_hi:[1,0,0]
    v_cvt_pk_bf16_f32 v120, v136, v137
    v_cvt_pk_bf16_f32 v121, v138, v139
    v_cvt_pk_bf16_f32 v122, v140, v141
    v_cvt_pk_bf16_f32 v123, v142, v143
    v_pk_fma_f32 v[144:145], v[144:145], v[204:205], v[200:201] op_sel_hi:[1,0,0]
    v_pk_fma_f32 v[146:147], v[146:147], v[204:205], v[200:201] op_sel_hi:[1,0,0]
    v_pk_fma_f32 v[148:149], v[148:149], v[204:205], v[200:201] op_sel_hi:[1,0,0]
    v_pk_fma_f32 v[150:151], v[150:151], v[204:205], v[200:201] op_sel_hi:[1,0,0]
    v_cvt_pk_bf16_f32 v124, v144, v145
    v_cvt_pk_bf16_f32 v125, v146, v147
    v_cvt_pk_bf16_f32 v126, v148, v149
    v_cvt_pk_bf16_f32 v127, v150, v151
    v_pk_fma_f32 v[152:153], v[152:153], v[204:205], v[200:201] op_sel_hi:[1,0,0]
    v_pk_fma_f32 v[154:155], v[154:155], v[204:205], v[200:201] op_sel_hi:[1,0,0]
    v_pk_fma_f32 v[156:157], v[156:157], v[204:205], v[200:201] op_sel_hi:[1,0,0]
    v_pk_fma_f32 v[158:159], v[158:159], v[204:205], v[200:201] op_sel_hi:[1,0,0]
    v_cvt_pk_bf16_f32 v128, v152, v153
    v_cvt_pk_bf16_f32 v129, v154, v155
    v_cvt_pk_bf16_f32 v130, v156, v157
    v_cvt_pk_bf16_f32 v131, v158, v159
    v_pk_fma_f32 v[160:161], v[160:161], v[204:205], v[200:201] op_sel_hi:[1,0,0]
    v_pk_fma_f32 v[162:163], v[162:163], v[204:205], v[200:201] op_sel_hi:[1,0,0]
    v_pk_fma_f32 v[164:165], v[164:165], v[204:205], v[200:201] op_sel_hi:[1,0,0]
    v_pk_fma_f32 v[166:167], v[166:167], v[204:205], v[200:201] op_sel_hi:[1,0,0]
    v_cvt_pk_bf16_f32 v132, v160, v161
    v_cvt_pk_bf16_f32 v133, v162, v163
    v_cvt_pk_bf16_f32 v134, v164, v165
    v_cvt_pk_bf16_f32 v135, v166, v167
    v_pk_fma_f32 v[168:169], v[168:169], v[204:205], v[200:201] op_sel_hi:[1,0,0]
    v_pk_fma_f32 v[170:171], v[170:171], v[204:205], v[200:201] op_sel_hi:[1,0,0]
    v_pk_fma_f32 v[172:173], v[172:173], v[204:205], v[200:201] op_sel_hi:[1,0,0]
    v_pk_fma_f32 v[174:175], v[174:175], v[204:205], v[200:201] op_sel_hi:[1,0,0]
    v_cvt_pk_bf16_f32 v136, v168, v169
    v_cvt_pk_bf16_f32 v137, v170, v171
    v_cvt_pk_bf16_f32 v138, v172, v173
    v_cvt_pk_bf16_f32 v139, v174, v175
    v_pk_fma_f32 v[176:177], v[176:177], v[204:205], v[200:201] op_sel_hi:[1,0,0]
    v_pk_fma_f32 v[178:179], v[178:179], v[204:205], v[200:201] op_sel_hi:[1,0,0]
    v_pk_fma_f32 v[180:181], v[180:181], v[204:205], v[200:201] op_sel_hi:[1,0,0]
    v_pk_fma_f32 v[182:183], v[182:183], v[204:205], v[200:201] op_sel_hi:[1,0,0]
    v_cvt_pk_bf16_f32 v140, v176, v177
    v_cvt_pk_bf16_f32 v141, v178, v179
    v_cvt_pk_bf16_f32 v142, v180, v181
    v_cvt_pk_bf16_f32 v143, v182, v183
    v_pk_fma_f32 v[184:185], v[184:185], v[204:205], v[200:201] op_sel_hi:[1,0,0]
    v_pk_fma_f32 v[186:187], v[186:187], v[204:205], v[200:201] op_sel_hi:[1,0,0]
    v_pk_fma_f32 v[188:189], v[188:189], v[204:205], v[200:201] op_sel_hi:[1,0,0]
    v_pk_fma_f32 v[190:191], v[190:191], v[204:205], v[200:201] op_sel_hi:[1,0,0]
    v_cvt_pk_bf16_f32 v144, v184, v185
    v_cvt_pk_bf16_f32 v145, v186, v187
    v_cvt_pk_bf16_f32 v146, v188, v189
    v_cvt_pk_bf16_f32 v147, v190, v191
    v_pk_fma_f32 v[192:193], v[192:193], v[204:205], v[200:201] op_sel_hi:[1,0,0]
    v_pk_fma_f32 v[194:195], v[194:195], v[204:205], v[200:201] op_sel_hi:[1,0,0]
    v_pk_fma_f32 v[196:197], v[196:197], v[204:205], v[200:201] op_sel_hi:[1,0,0]
    v_pk_fma_f32 v[198:199], v[198:199], v[204:205], v[200:201] op_sel_hi:[1,0,0]
    v_cvt_pk_bf16_f32 v148, v192, v193
    v_cvt_pk_bf16_f32 v149, v194, v195
    v_cvt_pk_bf16_f32 v150, v196, v197
    v_cvt_pk_bf16_f32 v151, v198, v199
    s_cmp_lg_u32 s32, 0
    s_cbranch_scc1 K1_chk
    s_lshr_b32 s36, s2, 3
    s_lshl_b32 s36, s36, 3
    s_add_u32 s36, s36, s30
    s_mul_i32 s36, s36, 4608
    v_and_b32 v152, 63, v0
    v_min_u32 v152, 35, v152
    v_lshlrev_b32 v152, 7, v152
    s_mov_b32 m0, 149504
    s_waitcnt vmcnt(0)
    buffer_load_dword v152, s[12:15], s36 offen lds
    v_readfirstlane_b32 s51, v208
    s_nop 3
    s_cmp_lg_u32 s51, 0
    s_cbranch_scc1 K1_flag
    s_add_u32 s60, s24, 449056768
    s_addc_u32 s61, s25, 0
    s_mov_b32 s62, 49152
    s_mov_b32 s63, 0x00020000
    s_and_b32 s36, s2, 7
    s_mul_i32 s37, s36, 6144
    s_add_u32 s43, s37, 4096
    v_mov_b32 v152, 0
    v_mov_b32 v153, 0
    v_mov_b32 v154, 0
    v_mov_b32 v155, 0
    v_lshlrev_b32 v156, 4, v0
    buffer_store_dwordx4 v[152:155], v156, s[60:63], s37 offen offset:0 sc0 sc1
    buffer_store_dwordx4 v[152:155], v156, s[60:63], s37 offen offset:1024 sc0 sc1
    buffer_store_dwordx4 v[152:155], v156, s[60:63], s37 offen offset:2048 sc0 sc1
    buffer_store_dwordx4 v[152:155], v156, s[60:63], s37 offen offset:3072 sc0 sc1
    buffer_store_dwordx4 v[152:155], v156, s[60:63], s43 offen offset:0 sc0 sc1
    buffer_store_dwordx4 v[152:155], v156, s[60:63], s43 offen offset:1024 sc0 sc1
    v_lshlrev_b32 v157, 8, v0
    v_mov_b32 v158, 1
    s_lshl_b32 s36, s36, 2
    s_waitcnt vmcnt(0)
    buffer_store_dword v158, v157, s[20:23], s36 offen offset:64 sc0 sc1
    s_branch K1_flag
K1_chk:
    s_mov_b32 s36, 0x100000
K1_chk2:
    v_readfirstlane_b32 s37, v215
    s_sub_u32 s36, s36, 1
    s_cbranch_scc1 K1_flag
    s_nop 1
    s_cmp_lg_u32 s37, 0
    s_cbranch_scc1 K1_flag
    v_mov_b32 v214, 0
    buffer_load_dword v215, v214, s[20:23], s43 offen offset:64 sc0 sc1
    s_waitcnt vmcnt(0)
    s_branch K1_chk2
K1_flag:
    s_cmp_eq_u32 s32, 0
    s_cbranch_scc1 K1_fl2
    s_waitcnt vmcnt(0)
K1_fl2:
    s_barrier
    v_add_u32 v3, s34, v7
    ds_read_b64_tr_b16 v[200:201], v3 offset:0
    ds_read_b64_tr_b16 v[202:203], v3 offset:512
    ds_read_b64_tr_b16 v[204:205], v3 offset:4096
    ds_read_b64_tr_b16 v[206:207], v3 offset:4608
    ds_read_b64_tr_b16 v[208:209], v3 offset:8192
    ds_read_b64_tr_b16 v[210:211], v3 offset:8704
    ds_read_b64_tr_b16 v[212:213], v3 offset:12288
    ds_read_b64_tr_b16 v[214:215], v3 offset:12800
    s_mov_b32 s18, 0
    s_mov_b32 s47, 0
    s_mov_b32 s48, 0
    s_cmp_eq_u32 s31, 0
    s_cbranch_scc1 K1_regA
    s_barrier
    s_branch K1_regB
.p2align 6
K1_regA:
    s_setprio 3
    s_waitcnt lgkmcnt(0)
    v_mfma_f32_16x16x32_bf16 v[152:155], v[8:11], v[200:203], 0
    ds_read_b64_tr_b16 v[216:217], v3 offset:16384
    v_mfma_f32_16x16x32_bf16 v[152:155], v[12:15], v[204:207], v[152:155]
    ds_read_b64_tr_b16 v[218:219], v3 offset:16896
    v_mfma_f32_16x16x32_bf16 v[152:155], v[16:19], v[208:211], v[152:155]
    ds_read_b64_tr_b16 v[220:221], v3 offset:20480
    v_mfma_f32_16x16x32_bf16 v[152:155], v[20:23], v[212:215], v[152:155]
    ds_read_b64_tr_b16 v[222:223], v3 offset:20992
    v_mfma_f32_16x16x32_bf16 v[160:163], v[56:59], v[200:203], 0
    ds_read_b64_tr_b16 v[224:225], v3 offset:24576
    v_mfma_f32_16x16x32_bf16 v[160:163], v[60:63], v[204:207], v[160:163]
    ds_read_b64_tr_b16 v[226:227], v3 offset:25088
    v_mfma_f32_16x16x32_bf16 v[160:163], v[64:67], v[208:211], v[160:163]
    ds_read_b64_tr_b16 v[228:229], v3 offset:28672
    v_mfma_f32_16x16x32_bf16 v[160:163], v[68:71], v[212:215], v[160:163]
    ds_read_b64_tr_b16 v[230:231], v3 offset:29184
    v_mfma_f32_16x16x32_bf16 v[168:171], v[104:107], v[200:203], 0
    buffer_store_dwordx4 v[156:159], v4, s[16:19], s47 offen offset:0
    v_mfma_f32_16x16x32_bf16 v[168:171], v[108:111], v[204:207], v[168:171]
    s_add_u32 s34, s34, 49152
    v_mfma_f32_16x16x32_bf16 v[168:171], v[112:115], v[208:211], v[168:171]
    s_cmp_eq_u32 s34, 147456
    v_mfma_f32_16x16x32_bf16 v[168:171], v[116:119], v[212:215], v[168:171]
    buffer_store_dwordx4 v[164:167], v4, s[16:19], s47 offen offset:1024
    s_waitcnt lgkmcnt(0)
    v_mfma_f32_16x16x32_bf16 v[152:155], v[24:27], v[216:219], v[152:155]
    ds_read_b64_tr_b16 v[200:201], v3 offset:32768
    v_mfma_f32_16x16x32_bf16 v[152:155], v[28:31], v[220:223], v[152:155]
    ds_read_b64_tr_b16 v[202:203], v3 offset:33280
    v_mfma_f32_16x16x32_bf16 v[152:155], v[32:35], v[224:227], v[152:155]
    ds_read_b64_tr_b16 v[204:205], v3 offset:36864
    v_mfma_f32_16x16x32_bf16 v[152:155], v[36:39], v[228:231], v[152:155]
    ds_read_b64_tr_b16 v[206:207], v3 offset:37376
    v_mfma_f32_16x16x32_bf16 v[160:163], v[72:75], v[216:219], v[160:163]
    ds_read_b64_tr_b16 v[208:209], v3 offset:40960
    v_mfma_f32_16x16x32_bf16 v[160:163], v[76:79], v[220:223], v[160:163]
    ds_read_b64_tr_b16 v[210:211], v3 offset:41472
    v_mfma_f32_16x16x32_bf16 v[160:163], v[80:83], v[224:227], v[160:163]
    ds_read_b64_tr_b16 v[212:213], v3 offset:45056
    v_mfma_f32_16x16x32_bf16 v[160:163], v[84:87], v[228:231], v[160:163]
    ds_read_b64_tr_b16 v[214:215], v3 offset:45568
    v_mfma_f32_16x16x32_bf16 v[168:171], v[120:123], v[216:219], v[168:171]
    s_cselect_b32 s34, 0, s34
    v_mfma_f32_16x16x32_bf16 v[168:171], v[124:127], v[220:223], v[168:171]
    s_add_u32 s32, s32, 1
    v_mfma_f32_16x16x32_bf16 v[168:171], v[128:131], v[224:227], v[168:171]
    buffer_store_dwordx4 v[172:175], v4, s[16:19], s47 offen offset:2048
    v_mfma_f32_16x16x32_bf16 v[168:171], v[132:135], v[228:231], v[168:171]
    v_xor_b32 v3, 32, v3
    s_waitcnt lgkmcnt(0)
    v_mfma_f32_16x16x32_bf16 v[152:155], v[40:43], v[200:203], v[152:155]
    ds_read_b64_tr_b16 v[216:217], v3 offset:0
    v_mfma_f32_16x16x32_bf16 v[152:155], v[44:47], v[204:207], v[152:155]
    ds_read_b64_tr_b16 v[218:219], v3 offset:512
    v_mfma_f32_16x16x32_bf16 v[152:155], v[48:51], v[208:211], v[152:155]
    ds_read_b64_tr_b16 v[220:221], v3 offset:4096
    v_mfma_f32_16x16x32_bf16 v[152:155], v[52:55], v[212:215], v[152:155]
    ds_read_b64_tr_b16 v[222:223], v3 offset:4608
    v_mfma_f32_16x16x32_bf16 v[160:163], v[88:91], v[200:203], v[160:163]
    ds_read_b64_tr_b16 v[224:225], v3 offset:8192
    v_mfma_f32_16x16x32_bf16 v[160:163], v[92:95], v[204:207], v[160:163]
    ds_read_b64_tr_b16 v[226:227], v3 offset:8704
    v_mfma_f32_16x16x32_bf16 v[160:163], v[96:99], v[208:211], v[160:163]
    ds_read_b64_tr_b16 v[228:229], v3 offset:12288
    v_mfma_f32_16x16x32_bf16 v[160:163], v[100:103], v[212:215], v[160:163]
    ds_read_b64_tr_b16 v[230:231], v3 offset:12800
    v_mfma_f32_16x16x32_bf16 v[168:171], v[136:139], v[200:203], v[168:171]
    v_mfma_f32_16x16x32_bf16 v[168:171], v[140:143], v[204:207], v[168:171]
    buffer_store_dwordx4 v[180:183], v4, s[16:19], s48 offen offset:0 nt
    v_mfma_f32_16x16x32_bf16 v[168:171], v[144:147], v[208:211], v[168:171]
    v_mfma_f32_16x16x32_bf16 v[168:171], v[148:151], v[212:215], v[168:171]
    buffer_store_dwordx4 v[188:191], v4, s[16:19], s48 offen offset:1024 nt
    s_waitcnt lgkmcnt(0)
    v_mfma_f32_16x16x32_bf16 v[156:159], v[8:11], v[216:219], 0
    ds_read_b64_tr_b16 v[200:201], v3 offset:16384
    v_mfma_f32_16x16x32_bf16 v[156:159], v[12:15], v[220:223], v[156:159]
    ds_read_b64_tr_b16 v[202:203], v3 offset:16896
    v_mfma_f32_16x16x32_bf16 v[156:159], v[16:19], v[224:227], v[156:159]
    ds_read_b64_tr_b16 v[204:205], v3 offset:20480
    v_mfma_f32_16x16x32_bf16 v[156:159], v[20:23], v[228:231], v[156:159]
    ds_read_b64_tr_b16 v[206:207], v3 offset:20992
    v_mfma_f32_16x16x32_bf16 v[164:167], v[56:59], v[216:219], 0
    ds_read_b64_tr_b16 v[208:209], v3 offset:24576
    v_mfma_f32_16x16x32_bf16 v[164:167], v[60:63], v[220:223], v[164:167]
    ds_read_b64_tr_b16 v[210:211], v3 offset:25088
    v_mfma_f32_16x16x32_bf16 v[164:167], v[64:67], v[224:227], v[164:167]
    ds_read_b64_tr_b16 v[212:213], v3 offset:28672
    v_mfma_f32_16x16x32_bf16 v[164:167], v[68:71], v[228:231], v[164:167]
    ds_read_b64_tr_b16 v[214:215], v3 offset:29184
    v_mfma_f32_16x16x32_bf16 v[172:175], v[104:107], v[216:219], 0
    v_mfma_f32_16x16x32_bf16 v[172:175], v[108:111], v[220:223], v[172:175]
    buffer_store_dwordx4 v[196:199], v4, s[16:19], s48 offen offset:2048 nt
    v_mfma_f32_16x16x32_bf16 v[172:175], v[112:115], v[224:227], v[172:175]
    s_mul_i32 s47, s42, 24576
    v_mfma_f32_16x16x32_bf16 v[172:175], v[116:119], v[228:231], v[172:175]
    s_add_u32 s47, s47, s39
    s_waitcnt lgkmcnt(0)
    v_mfma_f32_16x16x32_bf16 v[156:159], v[24:27], v[200:203], v[156:159]
    ds_read_b64_tr_b16 v[216:217], v3 offset:32768
    v_mfma_f32_16x16x32_bf16 v[156:159], v[28:31], v[204:207], v[156:159]
    ds_read_b64_tr_b16 v[218:219], v3 offset:33280
    v_mfma_f32_16x16x32_bf16 v[156:159], v[32:35], v[208:211], v[156:159]
    ds_read_b64_tr_b16 v[220:221], v3 offset:36864
    v_mfma_f32_16x16x32_bf16 v[156:159], v[36:39], v[212:215], v[156:159]
    ds_read_b64_tr_b16 v[222:223], v3 offset:37376
    v_mfma_f32_16x16x32_bf16 v[164:167], v[72:75], v[200:203], v[164:167]
    ds_read_b64_tr_b16 v[224:225], v3 offset:40960
    v_mfma_f32_16x16x32_bf16 v[164:167], v[76:79], v[204:207], v[164:167]
    ds_read_b64_tr_b16 v[226:227], v3 offset:41472
    v_mfma_f32_16x16x32_bf16 v[164:167], v[80:83], v[208:211], v[164:167]
    ds_read_b64_tr_b16 v[228:229], v3 offset:45056
    v_mfma_f32_16x16x32_bf16 v[164:167], v[84:87], v[212:215], v[164:167]
    ds_read_b64_tr_b16 v[230:231], v3 offset:45568
    v_mfma_f32_16x16x32_bf16 v[172:175], v[120:123], v[200:203], v[172:175]
    v_mfma_f32_16x16x32_bf16 v[172:175], v[124:127], v[204:207], v[172:175]
    s_waitcnt vmcnt(6)
    s_barrier
    v_mfma_f32_16x16x32_bf16 v[172:175], v[128:131], v[208:211], v[172:175]
    s_mov_b32 m0, s35
    v_mfma_f32_16x16x32_bf16 v[172:175], v[132:135], v[212:215], v[172:175]
    s_nop 0
    v_xor_b32 v3, 96, v3
    s_waitcnt lgkmcnt(0)
    v_mfma_f32_16x16x32_bf16 v[156:159], v[40:43], v[216:219], v[156:159]
    ds_read_b64_tr_b16 v[200:201], v3 offset:0
    v_mfma_f32_16x16x32_bf16 v[156:159], v[44:47], v[220:223], v[156:159]
    ds_read_b64_tr_b16 v[202:203], v3 offset:512
    v_mfma_f32_16x16x32_bf16 v[156:159], v[48:51], v[224:227], v[156:159]
    ds_read_b64_tr_b16 v[204:205], v3 offset:4096
    v_mfma_f32_16x16x32_bf16 v[156:159], v[52:55], v[228:231], v[156:159]
    ds_read_b64_tr_b16 v[206:207], v3 offset:4608
    v_mfma_f32_16x16x32_bf16 v[164:167], v[88:91], v[216:219], v[164:167]
    ds_read_b64_tr_b16 v[208:209], v3 offset:8192
    v_mfma_f32_16x16x32_bf16 v[164:167], v[92:95], v[220:223], v[164:167]
    ds_read_b64_tr_b16 v[210:211], v3 offset:8704
    v_mfma_f32_16x16x32_bf16 v[164:167], v[96:99], v[224:227], v[164:167]
    ds_read_b64_tr_b16 v[212:213], v3 offset:12288
    v_mfma_f32_16x16x32_bf16 v[164:167], v[100:103], v[228:231], v[164:167]
    ds_read_b64_tr_b16 v[214:215], v3 offset:12800
    v_mfma_f32_16x16x32_bf16 v[172:175], v[136:139], v[216:219], v[172:175]
    s_mov_b32 s36, s45
    v_mfma_f32_16x16x32_bf16 v[172:175], v[140:143], v[220:223], v[172:175]
    buffer_load_dwordx4 v1, s[12:15], s36 offen lds
    v_mfma_f32_16x16x32_bf16 v[172:175], v[144:147], v[224:227], v[172:175]
    s_add_u32 m0, m0, 1024
    v_mfma_f32_16x16x32_bf16 v[172:175], v[148:151], v[228:231], v[172:175]
    s_add_u32 s36, s36, 24576
    s_waitcnt lgkmcnt(0)
    v_mfma_f32_16x16x32_bf16 v[176:179], v[8:11], v[200:203], 0
    ds_read_b64_tr_b16 v[216:217], v3 offset:16384
    v_mfma_f32_16x16x32_bf16 v[176:179], v[12:15], v[204:207], v[176:179]
    ds_read_b64_tr_b16 v[218:219], v3 offset:16896
    v_mfma_f32_16x16x32_bf16 v[176:179], v[16:19], v[208:211], v[176:179]
    ds_read_b64_tr_b16 v[220:221], v3 offset:20480
    v_mfma_f32_16x16x32_bf16 v[176:179], v[20:23], v[212:215], v[176:179]
    ds_read_b64_tr_b16 v[222:223], v3 offset:20992
    v_mfma_f32_16x16x32_bf16 v[184:187], v[56:59], v[200:203], 0
    ds_read_b64_tr_b16 v[224:225], v3 offset:24576
    v_mfma_f32_16x16x32_bf16 v[184:187], v[60:63], v[204:207], v[184:187]
    ds_read_b64_tr_b16 v[226:227], v3 offset:25088
    v_mfma_f32_16x16x32_bf16 v[184:187], v[64:67], v[208:211], v[184:187]
    ds_read_b64_tr_b16 v[228:229], v3 offset:28672
    v_mfma_f32_16x16x32_bf16 v[184:187], v[68:71], v[212:215], v[184:187]
    ds_read_b64_tr_b16 v[230:231], v3 offset:29184
    v_mfma_f32_16x16x32_bf16 v[192:195], v[104:107], v[200:203], 0
    buffer_load_dwordx4 v6, s[12:15], s36 offen lds
    v_mfma_f32_16x16x32_bf16 v[192:195], v[108:111], v[204:207], v[192:195]
    s_add_u32 m0, m0, 1024
    v_mfma_f32_16x16x32_bf16 v[192:195], v[112:115], v[208:211], v[192:195]
    s_add_u32 s36, s36, 24576
    v_mfma_f32_16x16x32_bf16 v[192:195], v[116:119], v[212:215], v[192:195]
    buffer_load_dwordx4 v1, s[12:15], s36 offen lds
    s_waitcnt lgkmcnt(0)
    v_mfma_f32_16x16x32_bf16 v[176:179], v[24:27], v[216:219], v[176:179]
    ds_read_b64_tr_b16 v[200:201], v3 offset:32768
    v_mfma_f32_16x16x32_bf16 v[176:179], v[28:31], v[220:223], v[176:179]
    ds_read_b64_tr_b16 v[202:203], v3 offset:33280
    v_mfma_f32_16x16x32_bf16 v[176:179], v[32:35], v[224:227], v[176:179]
    ds_read_b64_tr_b16 v[204:205], v3 offset:36864
    v_mfma_f32_16x16x32_bf16 v[176:179], v[36:39], v[228:231], v[176:179]
    ds_read_b64_tr_b16 v[206:207], v3 offset:37376
    v_mfma_f32_16x16x32_bf16 v[184:187], v[72:75], v[216:219], v[184:187]
    ds_read_b64_tr_b16 v[208:209], v3 offset:40960
    v_mfma_f32_16x16x32_bf16 v[184:187], v[76:79], v[220:223], v[184:187]
    ds_read_b64_tr_b16 v[210:211], v3 offset:41472
    v_mfma_f32_16x16x32_bf16 v[184:187], v[80:83], v[224:227], v[184:187]
    ds_read_b64_tr_b16 v[212:213], v3 offset:45056
    v_mfma_f32_16x16x32_bf16 v[184:187], v[84:87], v[228:231], v[184:187]
    ds_read_b64_tr_b16 v[214:215], v3 offset:45568
    v_mfma_f32_16x16x32_bf16 v[192:195], v[120:123], v[216:219], v[192:195]
    s_add_u32 m0, m0, 1024
    v_mfma_f32_16x16x32_bf16 v[192:195], v[124:127], v[220:223], v[192:195]
    s_add_u32 s36, s36, 24576
    v_mfma_f32_16x16x32_bf16 v[192:195], v[128:131], v[224:227], v[192:195]
    buffer_load_dwordx4 v6, s[12:15], s36 offen lds
    v_mfma_f32_16x16x32_bf16 v[192:195], v[132:135], v[228:231], v[192:195]
    v_xor_b32 v3, 32, v3
    s_waitcnt lgkmcnt(0)
    v_mfma_f32_16x16x32_bf16 v[176:179], v[40:43], v[200:203], v[176:179]
    ds_read_b64_tr_b16 v[216:217], v3 offset:0
    v_mfma_f32_16x16x32_bf16 v[176:179], v[44:47], v[204:207], v[176:179]
    ds_read_b64_tr_b16 v[218:219], v3 offset:512
    v_mfma_f32_16x16x32_bf16 v[176:179], v[48:51], v[208:211], v[176:179]
    ds_read_b64_tr_b16 v[220:221], v3 offset:4096
    v_mfma_f32_16x16x32_bf16 v[176:179], v[52:55], v[212:215], v[176:179]
    ds_read_b64_tr_b16 v[222:223], v3 offset:4608
    v_mfma_f32_16x16x32_bf16 v[184:187], v[88:91], v[200:203], v[184:187]
    ds_read_b64_tr_b16 v[224:225], v3 offset:8192
    v_mfma_f32_16x16x32_bf16 v[184:187], v[92:95], v[204:207], v[184:187]
    ds_read_b64_tr_b16 v[226:227], v3 offset:8704
    v_mfma_f32_16x16x32_bf16 v[184:187], v[96:99], v[208:211], v[184:187]
    ds_read_b64_tr_b16 v[228:229], v3 offset:12288
    v_mfma_f32_16x16x32_bf16 v[184:187], v[100:103], v[212:215], v[184:187]
    ds_read_b64_tr_b16 v[230:231], v3 offset:12800
    v_mfma_f32_16x16x32_bf16 v[192:195], v[136:139], v[200:203], v[192:195]
    s_add_u32 m0, m0, 1024
    v_mfma_f32_16x16x32_bf16 v[192:195], v[140:143], v[204:207], v[192:195]
    s_add_u32 s36, s36, 24576
    v_mfma_f32_16x16x32_bf16 v[192:195], v[144:147], v[208:211], v[192:195]
    buffer_load_dwordx4 v1, s[12:15], s36 offen lds
    v_mfma_f32_16x16x32_bf16 v[192:195], v[148:151], v[212:215], v[192:195]
    s_add_u32 m0, m0, 1024
    s_waitcnt lgkmcnt(0)
    v_mfma_f32_16x16x32_bf16 v[180:183], v[8:11], v[216:219], 0
    ds_read_b64_tr_b16 v[200:201], v3 offset:16384
    v_mfma_f32_16x16x32_bf16 v[180:183], v[12:15], v[220:223], v[180:183]
    ds_read_b64_tr_b16 v[202:203], v3 offset:16896
    v_mfma_f32_16x16x32_bf16 v[180:183], v[16:19], v[224:227], v[180:183]
    ds_read_b64_tr_b16 v[204:205], v3 offset:20480
    v_mfma_f32_16x16x32_bf16 v[180:183], v[20:23], v[228:231], v[180:183]
    ds_read_b64_tr_b16 v[206:207], v3 offset:20992
    v_mfma_f32_16x16x32_bf16 v[188:191], v[56:59], v[216:219], 0
    ds_read_b64_tr_b16 v[208:209], v3 offset:24576
    v_mfma_f32_16x16x32_bf16 v[188:191], v[60:63], v[220:223], v[188:191]
    ds_read_b64_tr_b16 v[210:211], v3 offset:25088
    v_mfma_f32_16x16x32_bf16 v[188:191], v[64:67], v[224:227], v[188:191]
    ds_read_b64_tr_b16 v[212:213], v3 offset:28672
    v_mfma_f32_16x16x32_bf16 v[188:191], v[68:71], v[228:231], v[188:191]
    ds_read_b64_tr_b16 v[214:215], v3 offset:29184
    v_mfma_f32_16x16x32_bf16 v[196:199], v[104:107], v[216:219], 0
    s_add_u32 s36, s36, 24576
    v_mfma_f32_16x16x32_bf16 v[196:199], v[108:111], v[220:223], v[196:199]
    buffer_load_dwordx4 v6, s[12:15], s36 offen lds
    v_mfma_f32_16x16x32_bf16 v[196:199], v[112:115], v[224:227], v[196:199]
    s_add_u32 s35, s35, 49152
    v_mfma_f32_16x16x32_bf16 v[196:199], v[116:119], v[228:231], v[196:199]
    s_cmp_ge_u32 s35, 147456
    s_waitcnt lgkmcnt(0)
    v_mfma_f32_16x16x32_bf16 v[180:183], v[24:27], v[200:203], v[180:183]
    ds_read_b64_tr_b16 v[216:217], v3 offset:32768
    v_mfma_f32_16x16x32_bf16 v[180:183], v[28:31], v[204:207], v[180:183]
    ds_read_b64_tr_b16 v[218:219], v3 offset:33280
    v_mfma_f32_16x16x32_bf16 v[180:183], v[32:35], v[208:211], v[180:183]
    ds_read_b64_tr_b16 v[220:221], v3 offset:36864
    v_mfma_f32_16x16x32_bf16 v[180:183], v[36:39], v[212:215], v[180:183]
    ds_read_b64_tr_b16 v[222:223], v3 offset:37376
    v_mfma_f32_16x16x32_bf16 v[188:191], v[72:75], v[200:203], v[188:191]
    ds_read_b64_tr_b16 v[224:225], v3 offset:40960
    v_mfma_f32_16x16x32_bf16 v[188:191], v[76:79], v[204:207], v[188:191]
    ds_read_b64_tr_b16 v[226:227], v3 offset:41472
    v_mfma_f32_16x16x32_bf16 v[188:191], v[80:83], v[208:211], v[188:191]
    ds_read_b64_tr_b16 v[228:229], v3 offset:45056
    v_mfma_f32_16x16x32_bf16 v[188:191], v[84:87], v[212:215], v[188:191]
    ds_read_b64_tr_b16 v[230:231], v3 offset:45568
    v_mfma_f32_16x16x32_bf16 v[196:199], v[120:123], v[200:203], v[196:199]
    s_cselect_b32 s35, s46, s35
    v_mfma_f32_16x16x32_bf16 v[196:199], v[124:127], v[204:207], v[196:199]
    s_add_u32 s45, s45, 128
    v_mfma_f32_16x16x32_bf16 v[196:199], v[128:131], v[208:211], v[196:199]
    s_cmp_eq_u32 s45, s55
    v_mfma_f32_16x16x32_bf16 v[196:199], v[132:135], v[212:215], v[196:199]
    s_cselect_b32 s45, s54, s45
    s_waitcnt lgkmcnt(0)
    v_mfma_f32_16x16x32_bf16 v[180:183], v[40:43], v[216:219], v[180:183]
    s_sub_u32 s87, s87, 1
    v_mfma_f32_16x16x32_bf16 v[180:183], v[44:47], v[220:223], v[180:183]
    s_cmp_lg_u32 s87, 0
    v_mfma_f32_16x16x32_bf16 v[180:183], v[48:51], v[224:227], v[180:183]
    s_cbranch_scc1 K1_ds3
    s_lshl_b32 s54, s83, 7
    s_add_u32 s54, s54, s50
    s_lshl_b32 s55, s84, 7
    s_add_u32 s55, s55, s50
    s_lshl_b32 s45, s56, 7
    s_add_u32 s45, s45, s54
K1_ds3:
    v_mfma_f32_16x16x32_bf16 v[180:183], v[52:55], v[228:231], v[180:183]
    s_cmp_eq_u32 s42, s85
    v_mfma_f32_16x16x32_bf16 v[188:191], v[88:91], v[216:219], v[188:191]
    s_cselect_b32 s16, s26, s24
    v_mfma_f32_16x16x32_bf16 v[188:191], v[92:95], v[220:223], v[188:191]
    s_cselect_b32 s17, s27, s25
    v_mfma_f32_16x16x32_bf16 v[188:191], v[96:99], v[224:227], v[188:191]
    s_cselect_b32 s47, s59, s47
    v_mfma_f32_16x16x32_bf16 v[188:191], v[100:103], v[228:231], v[188:191]
    s_mov_b32 s37, 113246208
    v_mfma_f32_16x16x32_bf16 v[196:199], v[136:139], v[216:219], v[196:199]
    s_cselect_b32 s18, s37, 446693376
    v_mfma_f32_16x16x32_bf16 v[196:199], v[140:143], v[220:223], v[196:199]
    s_add_u32 s48, s47, 12288
    v_mfma_f32_16x16x32_bf16 v[196:199], v[144:147], v[224:227], v[196:199]
    v_mfma_f32_16x16x32_bf16 v[196:199], v[148:151], v[228:231], v[196:199]
    s_setprio 0
    v_cvt_pk_f16_f32 v216, v152, v153
    v_cvt_pk_f16_f32 v217, v154, v155
    v_cvt_pk_f16_f32 v218, v156, v157
    v_cvt_pk_f16_f32 v219, v158, v159
    v_pk_fma_f16 v220, v216, v216, s44 neg_lo:[1,0,0] neg_hi:[1,0,0]
    v_pk_fma_f16 v221, v217, v217, s44 neg_lo:[1,0,0] neg_hi:[1,0,0]
    v_pk_fma_f16 v222, v218, v218, s44 neg_lo:[1,0,0] neg_hi:[1,0,0]
    v_pk_fma_f16 v223, v219, v219, s44 neg_lo:[1,0,0] neg_hi:[1,0,0]
    v_pk_mul_f16 v220, v220, v216
    v_pk_mul_f16 v221, v221, v217
    v_pk_mul_f16 v222, v222, v218
    v_pk_mul_f16 v223, v223, v219
    v_exp_f16 v216, v220
    v_exp_f16 v217, v221
    v_exp_f16 v218, v222
    v_exp_f16 v219, v223
    v_exp_f16_sdwa v216, v220 dst_sel:WORD_1 dst_unused:UNUSED_PRESERVE src0_sel:WORD_1
    v_exp_f16_sdwa v217, v221 dst_sel:WORD_1 dst_unused:UNUSED_PRESERVE src0_sel:WORD_1
    v_exp_f16_sdwa v218, v222 dst_sel:WORD_1 dst_unused:UNUSED_PRESERVE src0_sel:WORD_1
    v_exp_f16_sdwa v219, v223 dst_sel:WORD_1 dst_unused:UNUSED_PRESERVE src0_sel:WORD_1
    v_pk_add_f16 v216, v216, 1.0 op_sel_hi:[1,0]
    v_pk_add_f16 v217, v217, 1.0 op_sel_hi:[1,0]
    v_pk_add_f16 v218, v218, 1.0 op_sel_hi:[1,0]
    v_pk_add_f16 v219, v219, 1.0 op_sel_hi:[1,0]
    v_rcp_f16 v220, v216
    v_rcp_f16 v221, v217
    v_rcp_f16 v222, v218
    v_rcp_f16 v223, v219
    v_rcp_f16_sdwa v216, v216 dst_sel:DWORD dst_unused:UNUSED_PAD src0_sel:WORD_1
    v_rcp_f16_sdwa v217, v217 dst_sel:DWORD dst_unused:UNUSED_PAD src0_sel:WORD_1
    v_rcp_f16_sdwa v218, v218 dst_sel:DWORD dst_unused:UNUSED_PAD src0_sel:WORD_1
    v_rcp_f16_sdwa v219, v219 dst_sel:DWORD dst_unused:UNUSED_PAD src0_sel:WORD_1
    v_fma_mix_f32 v152, v152, v220, 0 op_sel_hi:[0,1,0]
    v_fma_mix_f32 v154, v154, v221, 0 op_sel_hi:[0,1,0]
    v_fma_mix_f32 v156, v156, v222, 0 op_sel_hi:[0,1,0]
    v_fma_mix_f32 v158, v158, v223, 0 op_sel_hi:[0,1,0]
    v_fma_mix_f32 v153, v153, v216, 0 op_sel_hi:[0,1,0]
    v_fma_mix_f32 v155, v155, v217, 0 op_sel_hi:[0,1,0]
    v_fma_mix_f32 v157, v157, v218, 0 op_sel_hi:[0,1,0]
    v_fma_mix_f32 v159, v159, v219, 0 op_sel_hi:[0,1,0]
    v_cvt_pk_bf16_f32 v159, v158, v159
    v_cvt_pk_bf16_f32 v158, v156, v157
    v_cvt_pk_bf16_f32 v157, v154, v155
    v_cvt_pk_bf16_f32 v156, v152, v153
    v_cvt_pk_f16_f32 v216, v160, v161
    v_cvt_pk_f16_f32 v217, v162, v163
    v_cvt_pk_f16_f32 v218, v164, v165
    v_cvt_pk_f16_f32 v219, v166, v167
    v_pk_fma_f16 v220, v216, v216, s44 neg_lo:[1,0,0] neg_hi:[1,0,0]
    v_pk_fma_f16 v221, v217, v217, s44 neg_lo:[1,0,0] neg_hi:[1,0,0]
    v_pk_fma_f16 v222, v218, v218, s44 neg_lo:[1,0,0] neg_hi:[1,0,0]
    v_pk_fma_f16 v223, v219, v219, s44 neg_lo:[1,0,0] neg_hi:[1,0,0]
    v_pk_mul_f16 v220, v220, v216
    v_pk_mul_f16 v221, v221, v217
    v_pk_mul_f16 v222, v222, v218
    v_pk_mul_f16 v223, v223, v219
    v_exp_f16 v216, v220
    v_exp_f16 v217, v221
    v_exp_f16 v218, v222
    v_exp_f16 v219, v223
    v_exp_f16_sdwa v216, v220 dst_sel:WORD_1 dst_unused:UNUSED_PRESERVE src0_sel:WORD_1
    v_exp_f16_sdwa v217, v221 dst_sel:WORD_1 dst_unused:UNUSED_PRESERVE src0_sel:WORD_1
    v_exp_f16_sdwa v218, v222 dst_sel:WORD_1 dst_unused:UNUSED_PRESERVE src0_sel:WORD_1
    v_exp_f16_sdwa v219, v223 dst_sel:WORD_1 dst_unused:UNUSED_PRESERVE src0_sel:WORD_1
    v_pk_add_f16 v216, v216, 1.0 op_sel_hi:[1,0]
    v_pk_add_f16 v217, v217, 1.0 op_sel_hi:[1,0]
    v_pk_add_f16 v218, v218, 1.0 op_sel_hi:[1,0]
    v_pk_add_f16 v219, v219, 1.0 op_sel_hi:[1,0]
    v_rcp_f16 v220, v216
    v_rcp_f16 v221, v217
    v_rcp_f16 v222, v218
    v_rcp_f16 v223, v219
    v_rcp_f16_sdwa v216, v216 dst_sel:DWORD dst_unused:UNUSED_PAD src0_sel:WORD_1
    v_rcp_f16_sdwa v217, v217 dst_sel:DWORD dst_unused:UNUSED_PAD src0_sel:WORD_1
    v_rcp_f16_sdwa v218, v218 dst_sel:DWORD dst_unused:UNUSED_PAD src0_sel:WORD_1
    v_rcp_f16_sdwa v219, v219 dst_sel:DWORD dst_unused:UNUSED_PAD src0_sel:WORD_1
    v_fma_mix_f32 v160, v160, v220, 0 op_sel_hi:[0,1,0]
    v_fma_mix_f32 v162, v162, v221, 0 op_sel_hi:[0,1,0]
    v_fma_mix_f32 v164, v164, v222, 0 op_sel_hi:[0,1,0]
    v_fma_mix_f32 v166, v166, v223, 0 op_sel_hi:[0,1,0]
    v_fma_mix_f32 v161, v161, v216, 0 op_sel_hi:[0,1,0]
    v_fma_mix_f32 v163, v163, v217, 0 op_sel_hi:[0,1,0]
    v_fma_mix_f32 v165, v165, v218, 0 op_sel_hi:[0,1,0]
    v_fma_mix_f32 v167, v167, v219, 0 op_sel_hi:[0,1,0]
    v_cvt_pk_bf16_f32 v167, v166, v167
    v_cvt_pk_bf16_f32 v166, v164, v165
    v_cvt_pk_bf16_f32 v165, v162, v163
    v_cvt_pk_bf16_f32 v164, v160, v161
    s_setprio 1
    s_nop 0
    v_cvt_pk_f16_f32 v216, v168, v169
    v_cvt_pk_f16_f32 v217, v170, v171
    v_cvt_pk_f16_f32 v218, v172, v173
    v_cvt_pk_f16_f32 v219, v174, v175
    v_pk_fma_f16 v220, v216, v216, s44 neg_lo:[1,0,0] neg_hi:[1,0,0]
    v_pk_fma_f16 v221, v217, v217, s44 neg_lo:[1,0,0] neg_hi:[1,0,0]
    v_pk_fma_f16 v222, v218, v218, s44 neg_lo:[1,0,0] neg_hi:[1,0,0]
    v_pk_fma_f16 v223, v219, v219, s44 neg_lo:[1,0,0] neg_hi:[1,0,0]
    v_pk_mul_f16 v220, v220, v216
    v_pk_mul_f16 v221, v221, v217
    v_pk_mul_f16 v222, v222, v218
    v_pk_mul_f16 v223, v223, v219
    v_exp_f16 v216, v220
    v_exp_f16 v217, v221
    v_exp_f16 v218, v222
    v_exp_f16 v219, v223
    v_exp_f16_sdwa v216, v220 dst_sel:WORD_1 dst_unused:UNUSED_PRESERVE src0_sel:WORD_1
    v_exp_f16_sdwa v217, v221 dst_sel:WORD_1 dst_unused:UNUSED_PRESERVE src0_sel:WORD_1
    v_exp_f16_sdwa v218, v222 dst_sel:WORD_1 dst_unused:UNUSED_PRESERVE src0_sel:WORD_1
    v_exp_f16_sdwa v219, v223 dst_sel:WORD_1 dst_unused:UNUSED_PRESERVE src0_sel:WORD_1
    v_pk_add_f16 v216, v216, 1.0 op_sel_hi:[1,0]
    v_pk_add_f16 v217, v217, 1.0 op_sel_hi:[1,0]
    v_pk_add_f16 v218, v218, 1.0 op_sel_hi:[1,0]
    v_pk_add_f16 v219, v219, 1.0 op_sel_hi:[1,0]
    v_rcp_f16 v220, v216
    v_rcp_f16 v221, v217
    v_rcp_f16 v222, v218
    v_rcp_f16 v223, v219
    v_rcp_f16_sdwa v216, v216 dst_sel:DWORD dst_unused:UNUSED_PAD src0_sel:WORD_1
    v_rcp_f16_sdwa v217, v217 dst_sel:DWORD dst_unused:UNUSED_PAD src0_sel:WORD_1
    v_rcp_f16_sdwa v218, v218 dst_sel:DWORD dst_unused:UNUSED_PAD src0_sel:WORD_1
    v_rcp_f16_sdwa v219, v219 dst_sel:DWORD dst_unused:UNUSED_PAD src0_sel:WORD_1
    v_fma_mix_f32 v168, v168, v220, 0 op_sel_hi:[0,1,0]
    v_fma_mix_f32 v170, v170, v221, 0 op_sel_hi:[0,1,0]
    v_fma_mix_f32 v172, v172, v222, 0 op_sel_hi:[0,1,0]
    v_fma_mix_f32 v174, v174, v223, 0 op_sel_hi:[0,1,0]
    v_fma_mix_f32 v169, v169, v216, 0 op_sel_hi:[0,1,0]
    v_fma_mix_f32 v171, v171, v217, 0 op_sel_hi:[0,1,0]
    v_fma_mix_f32 v173, v173, v218, 0 op_sel_hi:[0,1,0]
    v_fma_mix_f32 v175, v175, v219, 0 op_sel_hi:[0,1,0]
    v_cvt_pk_bf16_f32 v175, v174, v175
    v_cvt_pk_bf16_f32 v174, v172, v173
    v_cvt_pk_bf16_f32 v173, v170, v171
    v_cvt_pk_bf16_f32 v172, v168, v169
    v_cvt_pk_f16_f32 v216, v176, v177
    v_cvt_pk_f16_f32 v217, v178, v179
    v_cvt_pk_f16_f32 v218, v180, v181
    v_cvt_pk_f16_f32 v219, v182, v183
    v_pk_fma_f16 v220, v216, v216, s44 neg_lo:[1,0,0] neg_hi:[1,0,0]
    v_pk_fma_f16 v221, v217, v217, s44 neg_lo:[1,0,0] neg_hi:[1,0,0]
    v_pk_fma_f16 v222, v218, v218, s44 neg_lo:[1,0,0] neg_hi:[1,0,0]
    v_pk_fma_f16 v223, v219, v219, s44 neg_lo:[1,0,0] neg_hi:[1,0,0]
    v_pk_mul_f16 v220, v220, v216
    v_pk_mul_f16 v221, v221, v217
    v_pk_mul_f16 v222, v222, v218
    v_pk_mul_f16 v223, v223, v219
    v_exp_f16 v216, v220
    v_exp_f16 v217, v221
    v_exp_f16 v218, v222
    v_exp_f16 v219, v223
    v_exp_f16_sdwa v216, v220 dst_sel:WORD_1 dst_unused:UNUSED_PRESERVE src0_sel:WORD_1
    v_exp_f16_sdwa v217, v221 dst_sel:WORD_1 dst_unused:UNUSED_PRESERVE src0_sel:WORD_1
    v_exp_f16_sdwa v218, v222 dst_sel:WORD_1 dst_unused:UNUSED_PRESERVE src0_sel:WORD_1
    v_exp_f16_sdwa v219, v223 dst_sel:WORD_1 dst_unused:UNUSED_PRESERVE src0_sel:WORD_1
    v_pk_add_f16 v216, v216, 1.0 op_sel_hi:[1,0]
    v_pk_add_f16 v217, v217, 1.0 op_sel_hi:[1,0]
    v_pk_add_f16 v218, v218, 1.0 op_sel_hi:[1,0]
    v_pk_add_f16 v219, v219, 1.0 op_sel_hi:[1,0]
    v_rcp_f16 v220, v216
    v_rcp_f16 v221, v217
    v_rcp_f16 v222, v218
    v_rcp_f16 v223, v219
    v_rcp_f16_sdwa v216, v216 dst_sel:DWORD dst_unused:UNUSED_PAD src0_sel:WORD_1
    v_rcp_f16_sdwa v217, v217 dst_sel:DWORD dst_unused:UNUSED_PAD src0_sel:WORD_1
    v_rcp_f16_sdwa v218, v218 dst_sel:DWORD dst_unused:UNUSED_PAD src0_sel:WORD_1
    v_rcp_f16_sdwa v219, v219 dst_sel:DWORD dst_unused:UNUSED_PAD src0_sel:WORD_1
    v_fma_mix_f32 v176, v176, v220, 0 op_sel_hi:[0,1,0]
    v_fma_mix_f32 v178, v178, v221, 0 op_sel_hi:[0,1,0]
    v_fma_mix_f32 v180, v180, v222, 0 op_sel_hi:[0,1,0]
    v_fma_mix_f32 v182, v182, v223, 0 op_sel_hi:[0,1,0]
    v_fma_mix_f32 v177, v177, v216, 0 op_sel_hi:[0,1,0]
    v_fma_mix_f32 v179, v179, v217, 0 op_sel_hi:[0,1,0]
    v_fma_mix_f32 v181, v181, v218, 0 op_sel_hi:[0,1,0]
    v_fma_mix_f32 v183, v183, v219, 0 op_sel_hi:[0,1,0]
    v_cvt_pk_bf16_f32 v183, v182, v183
    v_cvt_pk_bf16_f32 v182, v180, v181
    v_cvt_pk_bf16_f32 v181, v178, v179
    v_cvt_pk_bf16_f32 v180, v176, v177
    v_cvt_pk_f16_f32 v216, v184, v185
    v_cvt_pk_f16_f32 v217, v186, v187
    v_cvt_pk_f16_f32 v218, v188, v189
    v_cvt_pk_f16_f32 v219, v190, v191
    v_pk_fma_f16 v220, v216, v216, s44 neg_lo:[1,0,0] neg_hi:[1,0,0]
    v_pk_fma_f16 v221, v217, v217, s44 neg_lo:[1,0,0] neg_hi:[1,0,0]
    v_pk_fma_f16 v222, v218, v218, s44 neg_lo:[1,0,0] neg_hi:[1,0,0]
    v_pk_fma_f16 v223, v219, v219, s44 neg_lo:[1,0,0] neg_hi:[1,0,0]
    v_pk_mul_f16 v220, v220, v216
    v_pk_mul_f16 v221, v221, v217
    v_pk_mul_f16 v222, v222, v218
    v_pk_mul_f16 v223, v223, v219
    v_exp_f16 v216, v220
    v_exp_f16 v217, v221
    v_exp_f16 v218, v222
    v_exp_f16 v219, v223
    v_exp_f16_sdwa v216, v220 dst_sel:WORD_1 dst_unused:UNUSED_PRESERVE src0_sel:WORD_1
    v_exp_f16_sdwa v217, v221 dst_sel:WORD_1 dst_unused:UNUSED_PRESERVE src0_sel:WORD_1
    v_exp_f16_sdwa v218, v222 dst_sel:WORD_1 dst_unused:UNUSED_PRESERVE src0_sel:WORD_1
    v_exp_f16_sdwa v219, v223 dst_sel:WORD_1 dst_unused:UNUSED_PRESERVE src0_sel:WORD_1
    v_pk_add_f16 v216, v216, 1.0 op_sel_hi:[1,0]
    v_pk_add_f16 v217, v217, 1.0 op_sel_hi:[1,0]
    v_pk_add_f16 v218, v218, 1.0 op_sel_hi:[1,0]
    v_pk_add_f16 v219, v219, 1.0 op_sel_hi:[1,0]
    v_rcp_f16 v220, v216
    v_rcp_f16 v221, v217
    v_rcp_f16 v222, v218
    v_rcp_f16 v223, v219
    v_rcp_f16_sdwa v216, v216 dst_sel:DWORD dst_unused:UNUSED_PAD src0_sel:WORD_1
    v_rcp_f16_sdwa v217, v217 dst_sel:DWORD dst_unused:UNUSED_PAD src0_sel:WORD_1
    v_rcp_f16_sdwa v218, v218 dst_sel:DWORD dst_unused:UNUSED_PAD src0_sel:WORD_1
    v_rcp_f16_sdwa v219, v219 dst_sel:DWORD dst_unused:UNUSED_PAD src0_sel:WORD_1
    v_fma_mix_f32 v184, v184, v220, 0 op_sel_hi:[0,1,0]
    v_fma_mix_f32 v186, v186, v221, 0 op_sel_hi:[0,1,0]
    v_fma_mix_f32 v188, v188, v222, 0 op_sel_hi:[0,1,0]
    v_fma_mix_f32 v190, v190, v223, 0 op_sel_hi:[0,1,0]
    v_fma_mix_f32 v185, v185, v216, 0 op_sel_hi:[0,1,0]
    v_fma_mix_f32 v187, v187, v217, 0 op_sel_hi:[0,1,0]
    v_fma_mix_f32 v189, v189, v218, 0 op_sel_hi:[0,1,0]
    v_fma_mix_f32 v191, v191, v219, 0 op_sel_hi:[0,1,0]
    v_cvt_pk_bf16_f32 v191, v190, v191
    v_cvt_pk_bf16_f32 v190, v188, v189
    v_cvt_pk_bf16_f32 v189, v186, v187
    v_cvt_pk_bf16_f32 v188, v184, v185
    v_cvt_pk_f16_f32 v216, v192, v193
    v_cvt_pk_f16_f32 v217, v194, v195
    v_cvt_pk_f16_f32 v218, v196, v197
    v_cvt_pk_f16_f32 v219, v198, v199
    v_pk_fma_f16 v220, v216, v216, s44 neg_lo:[1,0,0] neg_hi:[1,0,0]
    v_pk_fma_f16 v221, v217, v217, s44 neg_lo:[1,0,0] neg_hi:[1,0,0]
    v_pk_fma_f16 v222, v218, v218, s44 neg_lo:[1,0,0] neg_hi:[1,0,0]
    v_pk_fma_f16 v223, v219, v219, s44 neg_lo:[1,0,0] neg_hi:[1,0,0]
    v_pk_mul_f16 v220, v220, v216
    v_pk_mul_f16 v221, v221, v217
    v_pk_mul_f16 v222, v222, v218
    v_pk_mul_f16 v223, v223, v219
    v_exp_f16 v216, v220
    v_exp_f16 v217, v221
    v_exp_f16 v218, v222
    v_exp_f16 v219, v223
    v_exp_f16_sdwa v216, v220 dst_sel:WORD_1 dst_unused:UNUSED_PRESERVE src0_sel:WORD_1
    v_exp_f16_sdwa v217, v221 dst_sel:WORD_1 dst_unused:UNUSED_PRESERVE src0_sel:WORD_1
    v_exp_f16_sdwa v218, v222 dst_sel:WORD_1 dst_unused:UNUSED_PRESERVE src0_sel:WORD_1
    v_exp_f16_sdwa v219, v223 dst_sel:WORD_1 dst_unused:UNUSED_PRESERVE src0_sel:WORD_1
    v_pk_add_f16 v216, v216, 1.0 op_sel_hi:[1,0]
    v_pk_add_f16 v217, v217, 1.0 op_sel_hi:[1,0]
    v_pk_add_f16 v218, v218, 1.0 op_sel_hi:[1,0]
    v_pk_add_f16 v219, v219, 1.0 op_sel_hi:[1,0]
    v_rcp_f16 v220, v216
    v_rcp_f16 v221, v217
    v_rcp_f16 v222, v218
    v_rcp_f16 v223, v219
    v_rcp_f16_sdwa v216, v216 dst_sel:DWORD dst_unused:UNUSED_PAD src0_sel:WORD_1
    v_rcp_f16_sdwa v217, v217 dst_sel:DWORD dst_unused:UNUSED_PAD src0_sel:WORD_1
    v_rcp_f16_sdwa v218, v218 dst_sel:DWORD dst_unused:UNUSED_PAD src0_sel:WORD_1
    v_rcp_f16_sdwa v219, v219 dst_sel:DWORD dst_unused:UNUSED_PAD src0_sel:WORD_1
    v_fma_mix_f32 v192, v192, v220, 0 op_sel_hi:[0,1,0]
    v_fma_mix_f32 v194, v194, v221, 0 op_sel_hi:[0,1,0]
    v_fma_mix_f32 v196, v196, v222, 0 op_sel_hi:[0,1,0]
    v_fma_mix_f32 v198, v198, v223, 0 op_sel_hi:[0,1,0]
    v_fma_mix_f32 v193, v193, v216, 0 op_sel_hi:[0,1,0]
    v_fma_mix_f32 v195, v195, v217, 0 op_sel_hi:[0,1,0]
    v_fma_mix_f32 v197, v197, v218, 0 op_sel_hi:[0,1,0]
    v_fma_mix_f32 v199, v199, v219, 0 op_sel_hi:[0,1,0]
    v_cvt_pk_bf16_f32 v199, v198, v199
    v_cvt_pk_bf16_f32 v198, v196, v197
    v_cvt_pk_bf16_f32 v197, v194, v195
    v_cvt_pk_bf16_f32 v196, v192, v193
    v_dot2_f32_bf16 v224, v156, v156, 0
    v_dot2_f32_bf16 v225, v158, v158, 0
    v_dot2_f32_bf16 v226, v180, v180, 0
    v_dot2_f32_bf16 v227, v182, v182, 0
    v_add_u32 v3, s34, v7
    ds_read_b64_tr_b16 v[200:201], v3 offset:0
    ds_read_b64_tr_b16 v[202:203], v3 offset:512
    v_dot2c_f32_bf16 v224, v157, v157
    v_dot2c_f32_bf16 v225, v159, v159
    v_dot2c_f32_bf16 v226, v181, v181
    v_dot2c_f32_bf16 v227, v183, v183
    ds_read_b64_tr_b16 v[204:205], v3 offset:4096
    ds_read_b64_tr_b16 v[206:207], v3 offset:4608
    v_dot2c_f32_bf16 v224, v164, v164
    v_dot2c_f32_bf16 v225, v166, v166
    v_dot2c_f32_bf16 v226, v188, v188
    v_dot2c_f32_bf16 v227, v190, v190
    ds_read_b64_tr_b16 v[208:209], v3 offset:8192
    ds_read_b64_tr_b16 v[210:211], v3 offset:8704
    v_dot2c_f32_bf16 v224, v165, v165
    v_dot2c_f32_bf16 v225, v167, v167
    v_dot2c_f32_bf16 v226, v189, v189
    v_dot2c_f32_bf16 v227, v191, v191
    ds_read_b64_tr_b16 v[212:213], v3 offset:12288
    ds_read_b64_tr_b16 v[214:215], v3 offset:12800
    v_dot2c_f32_bf16 v224, v172, v172
    v_dot2c_f32_bf16 v225, v174, v174
    v_dot2c_f32_bf16 v226, v196, v196
    v_dot2c_f32_bf16 v227, v198, v198
    v_dot2c_f32_bf16 v224, v173, v173
    v_dot2c_f32_bf16 v225, v175, v175
    v_dot2c_f32_bf16 v226, v197, v197
    v_dot2c_f32_bf16 v227, v199, v199
    s_add_u32 s37, s42, 1
    v_permlane16_swap_b32 v224, v225
    s_cmp_eq_u32 s37, s53
    v_permlane16_swap_b32 v226, v227
    v_add_f32 v224, v224, v225
    v_add_f32 v226, v226, v227
    s_cselect_b32 s37, s52, s37
    s_nop 0
    v_permlane32_swap_b32 v224, v226
    v_add_f32 v224, v224, v226
    s_set_gpr_idx_on s42, gpr_idx(SRC0,DST)
    s_mov_b32 s42, s37
    v_add_f32 v232, v232, v224
    s_set_gpr_idx_off
    s_cmp_lg_u32 s32, s33
    s_cbranch_scc1 K1_regA
K1_outA:
    s_cmp_eq_u32 s32, 34
    s_cbranch_scc1 K1_pretailA
.p2align 6
K1_preA:
    s_setprio 3
    s_waitcnt lgkmcnt(0)
    v_mfma_f32_16x16x32_bf16 v[152:155], v[8:11], v[200:203], 0
    ds_read_b64_tr_b16 v[216:217], v3 offset:16384
    v_mfma_f32_16x16x32_bf16 v[152:155], v[12:15], v[204:207], v[152:155]
    ds_read_b64_tr_b16 v[218:219], v3 offset:16896
    v_mfma_f32_16x16x32_bf16 v[152:155], v[16:19], v[208:211], v[152:155]
    ds_read_b64_tr_b16 v[220:221], v3 offset:20480
    v_mfma_f32_16x16x32_bf16 v[152:155], v[20:23], v[212:215], v[152:155]
    ds_read_b64_tr_b16 v[222:223], v3 offset:20992
    v_mfma_f32_16x16x32_bf16 v[160:163], v[56:59], v[200:203], 0
    ds_read_b64_tr_b16 v[224:225], v3 offset:24576
    v_mfma_f32_16x16x32_bf16 v[160:163], v[60:63], v[204:207], v[160:163]
    ds_read_b64_tr_b16 v[226:227], v3 offset:25088
    v_mfma_f32_16x16x32_bf16 v[160:163], v[64:67], v[208:211], v[160:163]
    ds_read_b64_tr_b16 v[228:229], v3 offset:28672
    v_mfma_f32_16x16x32_bf16 v[160:163], v[68:71], v[212:215], v[160:163]
    ds_read_b64_tr_b16 v[230:231], v3 offset:29184
    v_mfma_f32_16x16x32_bf16 v[168:171], v[104:107], v[200:203], 0
    buffer_store_dwordx4 v[156:159], v4, s[16:19], s47 offen offset:0
    v_mfma_f32_16x16x32_bf16 v[168:171], v[108:111], v[204:207], v[168:171]
    s_add_u32 s34, s34, 49152
    v_mfma_f32_16x16x32_bf16 v[168:171], v[112:115], v[208:211], v[168:171]
    s_cmp_eq_u32 s34, 147456
    v_mfma_f32_16x16x32_bf16 v[168:171], v[116:119], v[212:215], v[168:171]
    buffer_store_dwordx4 v[164:167], v4, s[16:19], s47 offen offset:1024
    s_waitcnt lgkmcnt(0)
    v_mfma_f32_16x16x32_bf16 v[152:155], v[24:27], v[216:219], v[152:155]
    ds_read_b64_tr_b16 v[200:201], v3 offset:32768
    v_mfma_f32_16x16x32_bf16 v[152:155], v[28:31], v[220:223], v[152:155]
    ds_read_b64_tr_b16 v[202:203], v3 offset:33280
    v_mfma_f32_16x16x32_bf16 v[152:155], v[32:35], v[224:227], v[152:155]
    ds_read_b64_tr_b16 v[204:205], v3 offset:36864
    v_mfma_f32_16x16x32_bf16 v[152:155], v[36:39], v[228:231], v[152:155]
    ds_read_b64_tr_b16 v[206:207], v3 offset:37376
    v_mfma_f32_16x16x32_bf16 v[160:163], v[72:75], v[216:219], v[160:163]
    ds_read_b64_tr_b16 v[208:209], v3 offset:40960
    v_mfma_f32_16x16x32_bf16 v[160:163], v[76:79], v[220:223], v[160:163]
    ds_read_b64_tr_b16 v[210:211], v3 offset:41472
    v_mfma_f32_16x16x32_bf16 v[160:163], v[80:83], v[224:227], v[160:163]
    ds_read_b64_tr_b16 v[212:213], v3 offset:45056
    v_mfma_f32_16x16x32_bf16 v[160:163], v[84:87], v[228:231], v[160:163]
    ds_read_b64_tr_b16 v[214:215], v3 offset:45568
    v_mfma_f32_16x16x32_bf16 v[168:171], v[120:123], v[216:219], v[168:171]
    s_cselect_b32 s34, 0, s34
    v_mfma_f32_16x16x32_bf16 v[168:171], v[124:127], v[220:223], v[168:171]
    s_add_u32 s32, s32, 1
    v_mfma_f32_16x16x32_bf16 v[168:171], v[128:131], v[224:227], v[168:171]
    buffer_store_dwordx4 v[172:175], v4, s[16:19], s47 offen offset:2048
    v_mfma_f32_16x16x32_bf16 v[168:171], v[132:135], v[228:231], v[168:171]
    v_xor_b32 v3, 32, v3
    s_waitcnt lgkmcnt(0)
    v_mfma_f32_16x16x32_bf16 v[152:155], v[40:43], v[200:203], v[152:155]
    ds_read_b64_tr_b16 v[216:217], v3 offset:0
    v_mfma_f32_16x16x32_bf16 v[152:155], v[44:47], v[204:207], v[152:155]
    ds_read_b64_tr_b16 v[218:219], v3 offset:512
    v_mfma_f32_16x16x32_bf16 v[152:155], v[48:51], v[208:211], v[152:155]
    ds_read_b64_tr_b16 v[220:221], v3 offset:4096
    v_mfma_f32_16x16x32_bf16 v[152:155], v[52:55], v[212:215], v[152:155]
    ds_read_b64_tr_b16 v[222:223], v3 offset:4608
    v_mfma_f32_16x16x32_bf16 v[160:163], v[88:91], v[200:203], v[160:163]
    ds_read_b64_tr_b16 v[224:225], v3 offset:8192
    v_mfma_f32_16x16x32_bf16 v[160:163], v[92:95], v[204:207], v[160:163]
    ds_read_b64_tr_b16 v[226:227], v3 offset:8704
    v_mfma_f32_16x16x32_bf16 v[160:163], v[96:99], v[208:211], v[160:163]
    ds_read_b64_tr_b16 v[228:229], v3 offset:12288
    v_mfma_f32_16x16x32_bf16 v[160:163], v[100:103], v[212:215], v[160:163]
    ds_read_b64_tr_b16 v[230:231], v3 offset:12800
    v_mfma_f32_16x16x32_bf16 v[168:171], v[136:139], v[200:203], v[168:171]
    v_mfma_f32_16x16x32_bf16 v[168:171], v[140:143], v[204:207], v[168:171]
    buffer_store_dwordx4 v[180:183], v4, s[16:19], s48 offen offset:0 nt
    v_mfma_f32_16x16x32_bf16 v[168:171], v[144:147], v[208:211], v[168:171]
    v_mfma_f32_16x16x32_bf16 v[168:171], v[148:151], v[212:215], v[168:171]
    buffer_store_dwordx4 v[188:191], v4, s[16:19], s48 offen offset:1024 nt
    s_waitcnt lgkmcnt(0)
    v_mfma_f32_16x16x32_bf16 v[156:159], v[8:11], v[216:219], 0
    ds_read_b64_tr_b16 v[200:201], v3 offset:16384
    v_mfma_f32_16x16x32_bf16 v[156:159], v[12:15], v[220:223], v[156:159]
    ds_read_b64_tr_b16 v[202:203], v3 offset:16896
    v_mfma_f32_16x16x32_bf16 v[156:159], v[16:19], v[224:227], v[156:159]
    ds_read_b64_tr_b16 v[204:205], v3 offset:20480
    v_mfma_f32_16x16x32_bf16 v[156:159], v[20:23], v[228:231], v[156:159]
    ds_read_b64_tr_b16 v[206:207], v3 offset:20992
    v_mfma_f32_16x16x32_bf16 v[164:167], v[56:59], v[216:219], 0
    ds_read_b64_tr_b16 v[208:209], v3 offset:24576
    v_mfma_f32_16x16x32_bf16 v[164:167], v[60:63], v[220:223], v[164:167]
    ds_read_b64_tr_b16 v[210:211], v3 offset:25088
    v_mfma_f32_16x16x32_bf16 v[164:167], v[64:67], v[224:227], v[164:167]
    ds_read_b64_tr_b16 v[212:213], v3 offset:28672
    v_mfma_f32_16x16x32_bf16 v[164:167], v[68:71], v[228:231], v[164:167]
    ds_read_b64_tr_b16 v[214:215], v3 offset:29184
    v_mfma_f32_16x16x32_bf16 v[172:175], v[104:107], v[216:219], 0
    v_mfma_f32_16x16x32_bf16 v[172:175], v[108:111], v[220:223], v[172:175]
    buffer_store_dwordx4 v[196:199], v4, s[16:19], s48 offen offset:2048 nt
    v_mfma_f32_16x16x32_bf16 v[172:175], v[112:115], v[224:227], v[172:175]
    s_mul_i32 s47, s42, 24576
    v_mfma_f32_16x16x32_bf16 v[172:175], v[116:119], v[228:231], v[172:175]
    s_add_u32 s47, s47, s39
    s_waitcnt lgkmcnt(0)
    v_mfma_f32_16x16x32_bf16 v[156:159], v[24:27], v[200:203], v[156:159]
    ds_read_b64_tr_b16 v[216:217], v3 offset:32768
    v_mfma_f32_16x16x32_bf16 v[156:159], v[28:31], v[204:207], v[156:159]
    ds_read_b64_tr_b16 v[218:219], v3 offset:33280
    v_mfma_f32_16x16x32_bf16 v[156:159], v[32:35], v[208:211], v[156:159]
    ds_read_b64_tr_b16 v[220:221], v3 offset:36864
    v_mfma_f32_16x16x32_bf16 v[156:159], v[36:39], v[212:215], v[156:159]
    ds_read_b64_tr_b16 v[222:223], v3 offset:37376
    v_mfma_f32_16x16x32_bf16 v[164:167], v[72:75], v[200:203], v[164:167]
    ds_read_b64_tr_b16 v[224:225], v3 offset:40960
    v_mfma_f32_16x16x32_bf16 v[164:167], v[76:79], v[204:207], v[164:167]
    ds_read_b64_tr_b16 v[226:227], v3 offset:41472
    v_mfma_f32_16x16x32_bf16 v[164:167], v[80:83], v[208:211], v[164:167]
    ds_read_b64_tr_b16 v[228:229], v3 offset:45056
    v_mfma_f32_16x16x32_bf16 v[164:167], v[84:87], v[212:215], v[164:167]
    ds_read_b64_tr_b16 v[230:231], v3 offset:45568
    v_mfma_f32_16x16x32_bf16 v[172:175], v[120:123], v[200:203], v[172:175]
    v_mfma_f32_16x16x32_bf16 v[172:175], v[124:127], v[204:207], v[172:175]
    s_waitcnt vmcnt(6)
    s_barrier
    v_mfma_f32_16x16x32_bf16 v[172:175], v[128:131], v[208:211], v[172:175]
    s_mov_b32 s57, s35
    v_mfma_f32_16x16x32_bf16 v[172:175], v[132:135], v[212:215], v[172:175]
    s_nop 0
    v_xor_b32 v3, 96, v3
    s_waitcnt lgkmcnt(0)
    v_mfma_f32_16x16x32_bf16 v[156:159], v[40:43], v[216:219], v[156:159]
    ds_read_b64_tr_b16 v[200:201], v3 offset:0
    v_mfma_f32_16x16x32_bf16 v[156:159], v[44:47], v[220:223], v[156:159]
    ds_read_b64_tr_b16 v[202:203], v3 offset:512
    v_mfma_f32_16x16x32_bf16 v[156:159], v[48:51], v[224:227], v[156:159]
    ds_read_b64_tr_b16 v[204:205], v3 offset:4096
    v_mfma_f32_16x16x32_bf16 v[156:159], v[52:55], v[228:231], v[156:159]
    ds_read_b64_tr_b16 v[206:207], v3 offset:4608
    v_mfma_f32_16x16x32_bf16 v[164:167], v[88:91], v[216:219], v[164:167]
    ds_read_b64_tr_b16 v[208:209], v3 offset:8192
    v_mfma_f32_16x16x32_bf16 v[164:167], v[92:95], v[220:223], v[164:167]
    ds_read_b64_tr_b16 v[210:211], v3 offset:8704
    v_mfma_f32_16x16x32_bf16 v[164:167], v[96:99], v[224:227], v[164:167]
    ds_read_b64_tr_b16 v[212:213], v3 offset:12288
    v_mfma_f32_16x16x32_bf16 v[164:167], v[100:103], v[228:231], v[164:167]
    ds_read_b64_tr_b16 v[214:215], v3 offset:12800
    v_mfma_f32_16x16x32_bf16 v[172:175], v[136:139], v[216:219], v[172:175]
    s_mov_b32 s40, s49
    v_mfma_f32_16x16x32_bf16 v[172:175], v[140:143], v[220:223], v[172:175]
    s_add_u32 s3, s35, 49152
    v_mfma_f32_16x16x32_bf16 v[172:175], v[144:147], v[224:227], v[172:175]
    s_cmp_ge_u32 s3, 147456
    v_mfma_f32_16x16x32_bf16 v[172:175], v[148:151], v[228:231], v[172:175]
    s_cselect_b32 s3, s46, s3
    s_waitcnt lgkmcnt(0)
    v_mfma_f32_16x16x32_bf16 v[176:179], v[8:11], v[200:203], 0
    ds_read_b64_tr_b16 v[216:217], v3 offset:16384
    v_mfma_f32_16x16x32_bf16 v[176:179], v[12:15], v[204:207], v[176:179]
    ds_read_b64_tr_b16 v[218:219], v3 offset:16896
    v_mfma_f32_16x16x32_bf16 v[176:179], v[16:19], v[208:211], v[176:179]
    ds_read_b64_tr_b16 v[220:221], v3 offset:20480
    v_mfma_f32_16x16x32_bf16 v[176:179], v[20:23], v[212:215], v[176:179]
    ds_read_b64_tr_b16 v[222:223], v3 offset:20992
    v_mfma_f32_16x16x32_bf16 v[184:187], v[56:59], v[200:203], 0
    ds_read_b64_tr_b16 v[224:225], v3 offset:24576
    v_mfma_f32_16x16x32_bf16 v[184:187], v[60:63], v[204:207], v[184:187]
    ds_read_b64_tr_b16 v[226:227], v3 offset:25088
    v_mfma_f32_16x16x32_bf16 v[184:187], v[64:67], v[208:211], v[184:187]
    ds_read_b64_tr_b16 v[228:229], v3 offset:28672
    v_mfma_f32_16x16x32_bf16 v[184:187], v[68:71], v[212:215], v[184:187]
    ds_read_b64_tr_b16 v[230:231], v3 offset:29184
    v_mfma_f32_16x16x32_bf16 v[192:195], v[104:107], v[200:203], 0
    s_add_u32 m0, s57, 0
    v_mfma_f32_16x16x32_bf16 v[192:195], v[108:111], v[204:207], v[192:195]
    s_add_u32 s58, s40, 384
    v_mfma_f32_16x16x32_bf16 v[192:195], v[112:115], v[208:211], v[192:195]
    buffer_load_dwordx4 v2, s[8:11], s58 offen nt lds
    v_mfma_f32_16x16x32_bf16 v[192:195], v[116:119], v[212:215], v[192:195]
    s_add_u32 m0, m0, 1024
    s_waitcnt lgkmcnt(0)
    v_mfma_f32_16x16x32_bf16 v[176:179], v[24:27], v[216:219], v[176:179]
    ds_read_b64_tr_b16 v[200:201], v3 offset:32768
    v_mfma_f32_16x16x32_bf16 v[176:179], v[28:31], v[220:223], v[176:179]
    ds_read_b64_tr_b16 v[202:203], v3 offset:33280
    v_mfma_f32_16x16x32_bf16 v[176:179], v[32:35], v[224:227], v[176:179]
    ds_read_b64_tr_b16 v[204:205], v3 offset:36864
    v_mfma_f32_16x16x32_bf16 v[176:179], v[36:39], v[228:231], v[176:179]
    ds_read_b64_tr_b16 v[206:207], v3 offset:37376
    v_mfma_f32_16x16x32_bf16 v[184:187], v[72:75], v[216:219], v[184:187]
    ds_read_b64_tr_b16 v[208:209], v3 offset:40960
    v_mfma_f32_16x16x32_bf16 v[184:187], v[76:79], v[220:223], v[184:187]
    ds_read_b64_tr_b16 v[210:211], v3 offset:41472
    v_mfma_f32_16x16x32_bf16 v[184:187], v[80:83], v[224:227], v[184:187]
    ds_read_b64_tr_b16 v[212:213], v3 offset:45056
    v_mfma_f32_16x16x32_bf16 v[184:187], v[84:87], v[228:231], v[184:187]
    ds_read_b64_tr_b16 v[214:215], v3 offset:45568
    v_mfma_f32_16x16x32_bf16 v[192:195], v[120:123], v[216:219], v[192:195]
    s_add_u32 s58, s58, 6144
    v_mfma_f32_16x16x32_bf16 v[192:195], v[124:127], v[220:223], v[192:195]
    buffer_load_dwordx4 v2, s[8:11], s58 offen nt lds
    v_mfma_f32_16x16x32_bf16 v[192:195], v[128:131], v[224:227], v[192:195]
    s_add_u32 m0, s57, 2048
    v_mfma_f32_16x16x32_bf16 v[192:195], v[132:135], v[228:231], v[192:195]
    v_xor_b32 v3, 32, v3
    s_waitcnt lgkmcnt(0)
    v_mfma_f32_16x16x32_bf16 v[176:179], v[40:43], v[200:203], v[176:179]
    ds_read_b64_tr_b16 v[216:217], v3 offset:0
    v_mfma_f32_16x16x32_bf16 v[176:179], v[44:47], v[204:207], v[176:179]
    ds_read_b64_tr_b16 v[218:219], v3 offset:512
    v_mfma_f32_16x16x32_bf16 v[176:179], v[48:51], v[208:211], v[176:179]
    ds_read_b64_tr_b16 v[220:221], v3 offset:4096
    v_mfma_f32_16x16x32_bf16 v[176:179], v[52:55], v[212:215], v[176:179]
    ds_read_b64_tr_b16 v[222:223], v3 offset:4608
    v_mfma_f32_16x16x32_bf16 v[184:187], v[88:91], v[200:203], v[184:187]
    ds_read_b64_tr_b16 v[224:225], v3 offset:8192
    v_mfma_f32_16x16x32_bf16 v[184:187], v[92:95], v[204:207], v[184:187]
    ds_read_b64_tr_b16 v[226:227], v3 offset:8704
    v_mfma_f32_16x16x32_bf16 v[184:187], v[96:99], v[208:211], v[184:187]
    ds_read_b64_tr_b16 v[228:229], v3 offset:12288
    v_mfma_f32_16x16x32_bf16 v[184:187], v[100:103], v[212:215], v[184:187]
    ds_read_b64_tr_b16 v[230:231], v3 offset:12800
    v_mfma_f32_16x16x32_bf16 v[192:195], v[136:139], v[200:203], v[192:195]
    s_add_u32 s58, s40, 512
    v_mfma_f32_16x16x32_bf16 v[192:195], v[140:143], v[204:207], v[192:195]
    buffer_load_dwordx4 v2, s[8:11], s58 offen nt lds
    v_mfma_f32_16x16x32_bf16 v[192:195], v[144:147], v[208:211], v[192:195]
    s_add_u32 m0, m0, 1024
    v_mfma_f32_16x16x32_bf16 v[192:195], v[148:151], v[212:215], v[192:195]
    s_add_u32 s58, s58, 6144
    s_waitcnt lgkmcnt(0)
    v_mfma_f32_16x16x32_bf16 v[180:183], v[8:11], v[216:219], 0
    ds_read_b64_tr_b16 v[200:201], v3 offset:16384
    v_mfma_f32_16x16x32_bf16 v[180:183], v[12:15], v[220:223], v[180:183]
    ds_read_b64_tr_b16 v[202:203], v3 offset:16896
    v_mfma_f32_16x16x32_bf16 v[180:183], v[16:19], v[224:227], v[180:183]
    ds_read_b64_tr_b16 v[204:205], v3 offset:20480
    v_mfma_f32_16x16x32_bf16 v[180:183], v[20:23], v[228:231], v[180:183]
    ds_read_b64_tr_b16 v[206:207], v3 offset:20992
    v_mfma_f32_16x16x32_bf16 v[188:191], v[56:59], v[216:219], 0
    ds_read_b64_tr_b16 v[208:209], v3 offset:24576
    v_mfma_f32_16x16x32_bf16 v[188:191], v[60:63], v[220:223], v[188:191]
    ds_read_b64_tr_b16 v[210:211], v3 offset:25088
    v_mfma_f32_16x16x32_bf16 v[188:191], v[64:67], v[224:227], v[188:191]
    ds_read_b64_tr_b16 v[212:213], v3 offset:28672
    v_mfma_f32_16x16x32_bf16 v[188:191], v[68:71], v[228:231], v[188:191]
    ds_read_b64_tr_b16 v[214:215], v3 offset:29184
    v_mfma_f32_16x16x32_bf16 v[196:199], v[104:107], v[216:219], 0
    buffer_load_dwordx4 v2, s[8:11], s58 offen nt lds
    v_mfma_f32_16x16x32_bf16 v[196:199], v[108:111], v[220:223], v[196:199]
    s_add_u32 m0, s57, 4096
    v_mfma_f32_16x16x32_bf16 v[196:199], v[112:115], v[224:227], v[196:199]
    s_add_u32 s58, s40, 640
    v_mfma_f32_16x16x32_bf16 v[196:199], v[116:119], v[228:231], v[196:199]
    buffer_load_dwordx4 v2, s[8:11], s58 offen nt lds
    s_waitcnt lgkmcnt(0)
    v_mfma_f32_16x16x32_bf16 v[180:183], v[24:27], v[200:203], v[180:183]
    ds_read_b64_tr_b16 v[216:217], v3 offset:32768
    v_mfma_f32_16x16x32_bf16 v[180:183], v[28:31], v[204:207], v[180:183]
    ds_read_b64_tr_b16 v[218:219], v3 offset:33280
    v_mfma_f32_16x16x32_bf16 v[180:183], v[32:35], v[208:211], v[180:183]
    ds_read_b64_tr_b16 v[220:221], v3 offset:36864
    v_mfma_f32_16x16x32_bf16 v[180:183], v[36:39], v[212:215], v[180:183]
    ds_read_b64_tr_b16 v[222:223], v3 offset:37376
    v_mfma_f32_16x16x32_bf16 v[188:191], v[72:75], v[200:203], v[188:191]
    ds_read_b64_tr_b16 v[224:225], v3 offset:40960
    v_mfma_f32_16x16x32_bf16 v[188:191], v[76:79], v[204:207], v[188:191]
    ds_read_b64_tr_b16 v[226:227], v3 offset:41472
    v_mfma_f32_16x16x32_bf16 v[188:191], v[80:83], v[208:211], v[188:191]
    ds_read_b64_tr_b16 v[228:229], v3 offset:45056
    v_mfma_f32_16x16x32_bf16 v[188:191], v[84:87], v[212:215], v[188:191]
    ds_read_b64_tr_b16 v[230:231], v3 offset:45568
    v_mfma_f32_16x16x32_bf16 v[196:199], v[120:123], v[200:203], v[196:199]
    s_add_u32 m0, m0, 1024
    v_mfma_f32_16x16x32_bf16 v[196:199], v[124:127], v[204:207], v[196:199]
    s_add_u32 s58, s58, 6144
    v_mfma_f32_16x16x32_bf16 v[196:199], v[128:131], v[208:211], v[196:199]
    buffer_load_dwordx4 v2, s[8:11], s58 offen nt lds
    v_mfma_f32_16x16x32_bf16 v[196:199], v[132:135], v[212:215], v[196:199]
    s_cmp_eq_u32 s42, s85
    s_waitcnt lgkmcnt(0)
    v_mfma_f32_16x16x32_bf16 v[180:183], v[40:43], v[216:219], v[180:183]
    s_cselect_b32 s16, s26, s24
    v_mfma_f32_16x16x32_bf16 v[180:183], v[44:47], v[220:223], v[180:183]
    s_cselect_b32 s17, s27, s25
    v_mfma_f32_16x16x32_bf16 v[180:183], v[48:51], v[224:227], v[180:183]
    s_cselect_b32 s47, s59, s47
    v_mfma_f32_16x16x32_bf16 v[180:183], v[52:55], v[228:231], v[180:183]
    s_mov_b32 s37, 113246208
    v_mfma_f32_16x16x32_bf16 v[188:191], v[88:91], v[216:219], v[188:191]
    s_cselect_b32 s18, s37, 446693376
    v_mfma_f32_16x16x32_bf16 v[188:191], v[92:95], v[220:223], v[188:191]
    s_add_u32 s48, s47, 12288
    v_mfma_f32_16x16x32_bf16 v[188:191], v[96:99], v[224:227], v[188:191]
    v_mfma_f32_16x16x32_bf16 v[188:191], v[100:103], v[228:231], v[188:191]
    v_mfma_f32_16x16x32_bf16 v[196:199], v[136:139], v[216:219], v[196:199]
    v_mfma_f32_16x16x32_bf16 v[196:199], v[140:143], v[220:223], v[196:199]
    v_mfma_f32_16x16x32_bf16 v[196:199], v[144:147], v[224:227], v[196:199]
    v_mfma_f32_16x16x32_bf16 v[196:199], v[148:151], v[228:231], v[196:199]
    s_setprio 0
    v_cvt_pk_f16_f32 v216, v152, v153
    v_cvt_pk_f16_f32 v217, v154, v155
    v_cvt_pk_f16_f32 v218, v156, v157
    v_cvt_pk_f16_f32 v219, v158, v159
    v_pk_fma_f16 v220, v216, v216, s44 neg_lo:[1,0,0] neg_hi:[1,0,0]
    v_pk_fma_f16 v221, v217, v217, s44 neg_lo:[1,0,0] neg_hi:[1,0,0]
    v_pk_fma_f16 v222, v218, v218, s44 neg_lo:[1,0,0] neg_hi:[1,0,0]
    v_pk_fma_f16 v223, v219, v219, s44 neg_lo:[1,0,0] neg_hi:[1,0,0]
    v_pk_mul_f16 v220, v220, v216
    v_pk_mul_f16 v221, v221, v217
    v_pk_mul_f16 v222, v222, v218
    v_pk_mul_f16 v223, v223, v219
    v_exp_f16 v216, v220
    v_exp_f16 v217, v221
    v_exp_f16 v218, v222
    v_exp_f16 v219, v223
    v_exp_f16_sdwa v216, v220 dst_sel:WORD_1 dst_unused:UNUSED_PRESERVE src0_sel:WORD_1
    v_exp_f16_sdwa v217, v221 dst_sel:WORD_1 dst_unused:UNUSED_PRESERVE src0_sel:WORD_1
    v_exp_f16_sdwa v218, v222 dst_sel:WORD_1 dst_unused:UNUSED_PRESERVE src0_sel:WORD_1
    v_exp_f16_sdwa v219, v223 dst_sel:WORD_1 dst_unused:UNUSED_PRESERVE src0_sel:WORD_1
    v_pk_add_f16 v216, v216, 1.0 op_sel_hi:[1,0]
    v_pk_add_f16 v217, v217, 1.0 op_sel_hi:[1,0]
    v_pk_add_f16 v218, v218, 1.0 op_sel_hi:[1,0]
    v_pk_add_f16 v219, v219, 1.0 op_sel_hi:[1,0]
    v_rcp_f16 v220, v216
    v_rcp_f16 v221, v217
    v_rcp_f16 v222, v218
    v_rcp_f16 v223, v219
    v_rcp_f16_sdwa v216, v216 dst_sel:DWORD dst_unused:UNUSED_PAD src0_sel:WORD_1
    v_rcp_f16_sdwa v217, v217 dst_sel:DWORD dst_unused:UNUSED_PAD src0_sel:WORD_1
    v_rcp_f16_sdwa v218, v218 dst_sel:DWORD dst_unused:UNUSED_PAD src0_sel:WORD_1
    v_rcp_f16_sdwa v219, v219 dst_sel:DWORD dst_unused:UNUSED_PAD src0_sel:WORD_1
    v_fma_mix_f32 v152, v152, v220, 0 op_sel_hi:[0,1,0]
    v_fma_mix_f32 v154, v154, v221, 0 op_sel_hi:[0,1,0]
    v_fma_mix_f32 v156, v156, v222, 0 op_sel_hi:[0,1,0]
    v_fma_mix_f32 v158, v158, v223, 0 op_sel_hi:[0,1,0]
    v_fma_mix_f32 v153, v153, v216, 0 op_sel_hi:[0,1,0]
    v_fma_mix_f32 v155, v155, v217, 0 op_sel_hi:[0,1,0]
    v_fma_mix_f32 v157, v157, v218, 0 op_sel_hi:[0,1,0]
    v_fma_mix_f32 v159, v159, v219, 0 op_sel_hi:[0,1,0]
    v_cvt_pk_bf16_f32 v159, v158, v159
    v_cvt_pk_bf16_f32 v158, v156, v157
    v_cvt_pk_bf16_f32 v157, v154, v155
    v_cvt_pk_bf16_f32 v156, v152, v153
    v_cvt_pk_f16_f32 v216, v160, v161
    v_cvt_pk_f16_f32 v217, v162, v163
    v_cvt_pk_f16_f32 v218, v164, v165
    v_cvt_pk_f16_f32 v219, v166, v167
    v_pk_fma_f16 v220, v216, v216, s44 neg_lo:[1,0,0] neg_hi:[1,0,0]
    v_pk_fma_f16 v221, v217, v217, s44 neg_lo:[1,0,0] neg_hi:[1,0,0]
    v_pk_fma_f16 v222, v218, v218, s44 neg_lo:[1,0,0] neg_hi:[1,0,0]
    v_pk_fma_f16 v223, v219, v219, s44 neg_lo:[1,0,0] neg_hi:[1,0,0]
    v_pk_mul_f16 v220, v220, v216
    v_pk_mul_f16 v221, v221, v217
    v_pk_mul_f16 v222, v222, v218
    v_pk_mul_f16 v223, v223, v219
    v_exp_f16 v216, v220
    v_exp_f16 v217, v221
    v_exp_f16 v218, v222
    v_exp_f16 v219, v223
    v_exp_f16_sdwa v216, v220 dst_sel:WORD_1 dst_unused:UNUSED_PRESERVE src0_sel:WORD_1
    v_exp_f16_sdwa v217, v221 dst_sel:WORD_1 dst_unused:UNUSED_PRESERVE src0_sel:WORD_1
    v_exp_f16_sdwa v218, v222 dst_sel:WORD_1 dst_unused:UNUSED_PRESERVE src0_sel:WORD_1
    v_exp_f16_sdwa v219, v223 dst_sel:WORD_1 dst_unused:UNUSED_PRESERVE src0_sel:WORD_1
    v_pk_add_f16 v216, v216, 1.0 op_sel_hi:[1,0]
    v_pk_add_f16 v217, v217, 1.0 op_sel_hi:[1,0]
    v_pk_add_f16 v218, v218, 1.0 op_sel_hi:[1,0]
    v_pk_add_f16 v219, v219, 1.0 op_sel_hi:[1,0]
    v_rcp_f16 v220, v216
    v_rcp_f16 v221, v217
    v_rcp_f16 v222, v218
    v_rcp_f16 v223, v219
    v_rcp_f16_sdwa v216, v216 dst_sel:DWORD dst_unused:UNUSED_PAD src0_sel:WORD_1
    v_rcp_f16_sdwa v217, v217 dst_sel:DWORD dst_unused:UNUSED_PAD src0_sel:WORD_1
    v_rcp_f16_sdwa v218, v218 dst_sel:DWORD dst_unused:UNUSED_PAD src0_sel:WORD_1
    v_rcp_f16_sdwa v219, v219 dst_sel:DWORD dst_unused:UNUSED_PAD src0_sel:WORD_1
    v_fma_mix_f32 v160, v160, v220, 0 op_sel_hi:[0,1,0]
    v_fma_mix_f32 v162, v162, v221, 0 op_sel_hi:[0,1,0]
    v_fma_mix_f32 v164, v164, v222, 0 op_sel_hi:[0,1,0]
    v_fma_mix_f32 v166, v166, v223, 0 op_sel_hi:[0,1,0]
    v_fma_mix_f32 v161, v161, v216, 0 op_sel_hi:[0,1,0]
    v_fma_mix_f32 v163, v163, v217, 0 op_sel_hi:[0,1,0]
    v_fma_mix_f32 v165, v165, v218, 0 op_sel_hi:[0,1,0]
    v_fma_mix_f32 v167, v167, v219, 0 op_sel_hi:[0,1,0]
    v_cvt_pk_bf16_f32 v167, v166, v167
    v_cvt_pk_bf16_f32 v166, v164, v165
    v_cvt_pk_bf16_f32 v165, v162, v163
    v_cvt_pk_bf16_f32 v164, v160, v161
    s_setprio 1
    s_nop 0
    v_cvt_pk_f16_f32 v216, v168, v169
    v_cvt_pk_f16_f32 v217, v170, v171
    v_cvt_pk_f16_f32 v218, v172, v173
    v_cvt_pk_f16_f32 v219, v174, v175
    v_pk_fma_f16 v220, v216, v216, s44 neg_lo:[1,0,0] neg_hi:[1,0,0]
    v_pk_fma_f16 v221, v217, v217, s44 neg_lo:[1,0,0] neg_hi:[1,0,0]
    v_pk_fma_f16 v222, v218, v218, s44 neg_lo:[1,0,0] neg_hi:[1,0,0]
    v_pk_fma_f16 v223, v219, v219, s44 neg_lo:[1,0,0] neg_hi:[1,0,0]
    v_pk_mul_f16 v220, v220, v216
    v_pk_mul_f16 v221, v221, v217
    v_pk_mul_f16 v222, v222, v218
    v_pk_mul_f16 v223, v223, v219
    v_exp_f16 v216, v220
    v_exp_f16 v217, v221
    v_exp_f16 v218, v222
    v_exp_f16 v219, v223
    v_exp_f16_sdwa v216, v220 dst_sel:WORD_1 dst_unused:UNUSED_PRESERVE src0_sel:WORD_1
    v_exp_f16_sdwa v217, v221 dst_sel:WORD_1 dst_unused:UNUSED_PRESERVE src0_sel:WORD_1
    v_exp_f16_sdwa v218, v222 dst_sel:WORD_1 dst_unused:UNUSED_PRESERVE src0_sel:WORD_1
    v_exp_f16_sdwa v219, v223 dst_sel:WORD_1 dst_unused:UNUSED_PRESERVE src0_sel:WORD_1
    v_pk_add_f16 v216, v216, 1.0 op_sel_hi:[1,0]
    v_pk_add_f16 v217, v217, 1.0 op_sel_hi:[1,0]
    v_pk_add_f16 v218, v218, 1.0 op_sel_hi:[1,0]
    v_pk_add_f16 v219, v219, 1.0 op_sel_hi:[1,0]
    v_rcp_f16 v220, v216
    v_rcp_f16 v221, v217
    v_rcp_f16 v222, v218
    v_rcp_f16 v223, v219
    v_rcp_f16_sdwa v216, v216 dst_sel:DWORD dst_unused:UNUSED_PAD src0_sel:WORD_1
    v_rcp_f16_sdwa v217, v217 dst_sel:DWORD dst_unused:UNUSED_PAD src0_sel:WORD_1
    v_rcp_f16_sdwa v218, v218 dst_sel:DWORD dst_unused:UNUSED_PAD src0_sel:WORD_1
    v_rcp_f16_sdwa v219, v219 dst_sel:DWORD dst_unused:UNUSED_PAD src0_sel:WORD_1
    v_fma_mix_f32 v168, v168, v220, 0 op_sel_hi:[0,1,0]
    v_fma_mix_f32 v170, v170, v221, 0 op_sel_hi:[0,1,0]
    v_fma_mix_f32 v172, v172, v222, 0 op_sel_hi:[0,1,0]
    v_fma_mix_f32 v174, v174, v223, 0 op_sel_hi:[0,1,0]
    v_fma_mix_f32 v169, v169, v216, 0 op_sel_hi:[0,1,0]
    v_fma_mix_f32 v171, v171, v217, 0 op_sel_hi:[0,1,0]
    v_fma_mix_f32 v173, v173, v218, 0 op_sel_hi:[0,1,0]
    v_fma_mix_f32 v175, v175, v219, 0 op_sel_hi:[0,1,0]
    v_cvt_pk_bf16_f32 v175, v174, v175
    v_cvt_pk_bf16_f32 v174, v172, v173
    v_cvt_pk_bf16_f32 v173, v170, v171
    v_cvt_pk_bf16_f32 v172, v168, v169
    v_cvt_pk_f16_f32 v216, v176, v177
    v_cvt_pk_f16_f32 v217, v178, v179
    v_cvt_pk_f16_f32 v218, v180, v181
    v_cvt_pk_f16_f32 v219, v182, v183
    v_pk_fma_f16 v220, v216, v216, s44 neg_lo:[1,0,0] neg_hi:[1,0,0]
    v_pk_fma_f16 v221, v217, v217, s44 neg_lo:[1,0,0] neg_hi:[1,0,0]
    v_pk_fma_f16 v222, v218, v218, s44 neg_lo:[1,0,0] neg_hi:[1,0,0]
    v_pk_fma_f16 v223, v219, v219, s44 neg_lo:[1,0,0] neg_hi:[1,0,0]
    v_pk_mul_f16 v220, v220, v216
    v_pk_mul_f16 v221, v221, v217
    v_pk_mul_f16 v222, v222, v218
    v_pk_mul_f16 v223, v223, v219
    v_exp_f16 v216, v220
    v_exp_f16 v217, v221
    v_exp_f16 v218, v222
    v_exp_f16 v219, v223
    v_exp_f16_sdwa v216, v220 dst_sel:WORD_1 dst_unused:UNUSED_PRESERVE src0_sel:WORD_1
    v_exp_f16_sdwa v217, v221 dst_sel:WORD_1 dst_unused:UNUSED_PRESERVE src0_sel:WORD_1
    v_exp_f16_sdwa v218, v222 dst_sel:WORD_1 dst_unused:UNUSED_PRESERVE src0_sel:WORD_1
    v_exp_f16_sdwa v219, v223 dst_sel:WORD_1 dst_unused:UNUSED_PRESERVE src0_sel:WORD_1
    v_pk_add_f16 v216, v216, 1.0 op_sel_hi:[1,0]
    v_pk_add_f16 v217, v217, 1.0 op_sel_hi:[1,0]
    v_pk_add_f16 v218, v218, 1.0 op_sel_hi:[1,0]
    v_pk_add_f16 v219, v219, 1.0 op_sel_hi:[1,0]
    v_rcp_f16 v220, v216
    v_rcp_f16 v221, v217
    v_rcp_f16 v222, v218
    v_rcp_f16 v223, v219
    v_rcp_f16_sdwa v216, v216 dst_sel:DWORD dst_unused:UNUSED_PAD src0_sel:WORD_1
    v_rcp_f16_sdwa v217, v217 dst_sel:DWORD dst_unused:UNUSED_PAD src0_sel:WORD_1
    v_rcp_f16_sdwa v218, v218 dst_sel:DWORD dst_unused:UNUSED_PAD src0_sel:WORD_1
    v_rcp_f16_sdwa v219, v219 dst_sel:DWORD dst_unused:UNUSED_PAD src0_sel:WORD_1
    v_fma_mix_f32 v176, v176, v220, 0 op_sel_hi:[0,1,0]
    v_fma_mix_f32 v178, v178, v221, 0 op_sel_hi:[0,1,0]
    v_fma_mix_f32 v180, v180, v222, 0 op_sel_hi:[0,1,0]
    v_fma_mix_f32 v182, v182, v223, 0 op_sel_hi:[0,1,0]
    v_fma_mix_f32 v177, v177, v216, 0 op_sel_hi:[0,1,0]
    v_fma_mix_f32 v179, v179, v217, 0 op_sel_hi:[0,1,0]
    v_fma_mix_f32 v181, v181, v218, 0 op_sel_hi:[0,1,0]
    v_fma_mix_f32 v183, v183, v219, 0 op_sel_hi:[0,1,0]
    v_cvt_pk_bf16_f32 v183, v182, v183
    v_cvt_pk_bf16_f32 v182, v180, v181
    v_cvt_pk_bf16_f32 v181, v178, v179
    v_cvt_pk_bf16_f32 v180, v176, v177
    v_cvt_pk_f16_f32 v216, v184, v185
    v_cvt_pk_f16_f32 v217, v186, v187
    v_cvt_pk_f16_f32 v218, v188, v189
    v_cvt_pk_f16_f32 v219, v190, v191
    v_pk_fma_f16 v220, v216, v216, s44 neg_lo:[1,0,0] neg_hi:[1,0,0]
    v_pk_fma_f16 v221, v217, v217, s44 neg_lo:[1,0,0] neg_hi:[1,0,0]
    v_pk_fma_f16 v222, v218, v218, s44 neg_lo:[1,0,0] neg_hi:[1,0,0]
    v_pk_fma_f16 v223, v219, v219, s44 neg_lo:[1,0,0] neg_hi:[1,0,0]
    v_pk_mul_f16 v220, v220, v216
    v_pk_mul_f16 v221, v221, v217
    v_pk_mul_f16 v222, v222, v218
    v_pk_mul_f16 v223, v223, v219
    v_exp_f16 v216, v220
    v_exp_f16 v217, v221
    v_exp_f16 v218, v222
    v_exp_f16 v219, v223
    v_exp_f16_sdwa v216, v220 dst_sel:WORD_1 dst_unused:UNUSED_PRESERVE src0_sel:WORD_1
    v_exp_f16_sdwa v217, v221 dst_sel:WORD_1 dst_unused:UNUSED_PRESERVE src0_sel:WORD_1
    v_exp_f16_sdwa v218, v222 dst_sel:WORD_1 dst_unused:UNUSED_PRESERVE src0_sel:WORD_1
    v_exp_f16_sdwa v219, v223 dst_sel:WORD_1 dst_unused:UNUSED_PRESERVE src0_sel:WORD_1
    v_pk_add_f16 v216, v216, 1.0 op_sel_hi:[1,0]
    v_pk_add_f16 v217, v217, 1.0 op_sel_hi:[1,0]
    v_pk_add_f16 v218, v218, 1.0 op_sel_hi:[1,0]
    v_pk_add_f16 v219, v219, 1.0 op_sel_hi:[1,0]
    v_rcp_f16 v220, v216
    v_rcp_f16 v221, v217
    v_rcp_f16 v222, v218
    v_rcp_f16 v223, v219
    v_rcp_f16_sdwa v216, v216 dst_sel:DWORD dst_unused:UNUSED_PAD src0_sel:WORD_1
    v_rcp_f16_sdwa v217, v217 dst_sel:DWORD dst_unused:UNUSED_PAD src0_sel:WORD_1
    v_rcp_f16_sdwa v218, v218 dst_sel:DWORD dst_unused:UNUSED_PAD src0_sel:WORD_1
    v_rcp_f16_sdwa v219, v219 dst_sel:DWORD dst_unused:UNUSED_PAD src0_sel:WORD_1
    v_fma_mix_f32 v184, v184, v220, 0 op_sel_hi:[0,1,0]
    v_fma_mix_f32 v186, v186, v221, 0 op_sel_hi:[0,1,0]
    v_fma_mix_f32 v188, v188, v222, 0 op_sel_hi:[0,1,0]
    v_fma_mix_f32 v190, v190, v223, 0 op_sel_hi:[0,1,0]
    v_fma_mix_f32 v185, v185, v216, 0 op_sel_hi:[0,1,0]
    v_fma_mix_f32 v187, v187, v217, 0 op_sel_hi:[0,1,0]
    v_fma_mix_f32 v189, v189, v218, 0 op_sel_hi:[0,1,0]
    v_fma_mix_f32 v191, v191, v219, 0 op_sel_hi:[0,1,0]
    v_cvt_pk_bf16_f32 v191, v190, v191
    v_cvt_pk_bf16_f32 v190, v188, v189
    v_cvt_pk_bf16_f32 v189, v186, v187
    v_cvt_pk_bf16_f32 v188, v184, v185
    v_cvt_pk_f16_f32 v216, v192, v193
    v_cvt_pk_f16_f32 v217, v194, v195
    v_cvt_pk_f16_f32 v218, v196, v197
    v_cvt_pk_f16_f32 v219, v198, v199
    v_pk_fma_f16 v220, v216, v216, s44 neg_lo:[1,0,0] neg_hi:[1,0,0]
    v_pk_fma_f16 v221, v217, v217, s44 neg_lo:[1,0,0] neg_hi:[1,0,0]
    v_pk_fma_f16 v222, v218, v218, s44 neg_lo:[1,0,0] neg_hi:[1,0,0]
    v_pk_fma_f16 v223, v219, v219, s44 neg_lo:[1,0,0] neg_hi:[1,0,0]
    v_pk_mul_f16 v220, v220, v216
    v_pk_mul_f16 v221, v221, v217
    v_pk_mul_f16 v222, v222, v218
    v_pk_mul_f16 v223, v223, v219
    v_exp_f16 v216, v220
    v_exp_f16 v217, v221
    v_exp_f16 v218, v222
    v_exp_f16 v219, v223
    v_exp_f16_sdwa v216, v220 dst_sel:WORD_1 dst_unused:UNUSED_PRESERVE src0_sel:WORD_1
    v_exp_f16_sdwa v217, v221 dst_sel:WORD_1 dst_unused:UNUSED_PRESERVE src0_sel:WORD_1
    v_exp_f16_sdwa v218, v222 dst_sel:WORD_1 dst_unused:UNUSED_PRESERVE src0_sel:WORD_1
    v_exp_f16_sdwa v219, v223 dst_sel:WORD_1 dst_unused:UNUSED_PRESERVE src0_sel:WORD_1
    v_pk_add_f16 v216, v216, 1.0 op_sel_hi:[1,0]
    v_pk_add_f16 v217, v217, 1.0 op_sel_hi:[1,0]
    v_pk_add_f16 v218, v218, 1.0 op_sel_hi:[1,0]
    v_pk_add_f16 v219, v219, 1.0 op_sel_hi:[1,0]
    v_rcp_f16 v220, v216
    v_rcp_f16 v221, v217
    v_rcp_f16 v222, v218
    v_rcp_f16 v223, v219
    v_rcp_f16_sdwa v216, v216 dst_sel:DWORD dst_unused:UNUSED_PAD src0_sel:WORD_1
    v_rcp_f16_sdwa v217, v217 dst_sel:DWORD dst_unused:UNUSED_PAD src0_sel:WORD_1
    v_rcp_f16_sdwa v218, v218 dst_sel:DWORD dst_unused:UNUSED_PAD src0_sel:WORD_1
    v_rcp_f16_sdwa v219, v219 dst_sel:DWORD dst_unused:UNUSED_PAD src0_sel:WORD_1
    v_fma_mix_f32 v192, v192, v220, 0 op_sel_hi:[0,1,0]
    v_fma_mix_f32 v194, v194, v221, 0 op_sel_hi:[0,1,0]
    v_fma_mix_f32 v196, v196, v222, 0 op_sel_hi:[0,1,0]
    v_fma_mix_f32 v198, v198, v223, 0 op_sel_hi:[0,1,0]
    v_fma_mix_f32 v193, v193, v216, 0 op_sel_hi:[0,1,0]
    v_fma_mix_f32 v195, v195, v217, 0 op_sel_hi:[0,1,0]
    v_fma_mix_f32 v197, v197, v218, 0 op_sel_hi:[0,1,0]
    v_fma_mix_f32 v199, v199, v219, 0 op_sel_hi:[0,1,0]
    v_cvt_pk_bf16_f32 v199, v198, v199
    v_cvt_pk_bf16_f32 v198, v196, v197
    v_cvt_pk_bf16_f32 v197, v194, v195
    v_cvt_pk_bf16_f32 v196, v192, v193
    v_dot2_f32_bf16 v224, v156, v156, 0
    v_dot2_f32_bf16 v225, v158, v158, 0
    v_dot2_f32_bf16 v226, v180, v180, 0
    v_dot2_f32_bf16 v227, v182, v182, 0
    v_add_u32 v3, s34, v7
    ds_read_b64_tr_b16 v[200:201], v3 offset:0
    ds_read_b64_tr_b16 v[202:203], v3 offset:512
    v_dot2c_f32_bf16 v224, v157, v157
    v_dot2c_f32_bf16 v225, v159, v159
    v_dot2c_f32_bf16 v226, v181, v181
    v_dot2c_f32_bf16 v227, v183, v183
    ds_read_b64_tr_b16 v[204:205], v3 offset:4096
    ds_read_b64_tr_b16 v[206:207], v3 offset:4608
    v_dot2c_f32_bf16 v224, v164, v164
    v_dot2c_f32_bf16 v225, v166, v166
    v_dot2c_f32_bf16 v226, v188, v188
    v_dot2c_f32_bf16 v227, v190, v190
    ds_read_b64_tr_b16 v[208:209], v3 offset:8192
    ds_read_b64_tr_b16 v[210:211], v3 offset:8704
    v_dot2c_f32_bf16 v224, v165, v165
    v_dot2c_f32_bf16 v225, v167, v167
    v_dot2c_f32_bf16 v226, v189, v189
    v_dot2c_f32_bf16 v227, v191, v191
    ds_read_b64_tr_b16 v[212:213], v3 offset:12288
    ds_read_b64_tr_b16 v[214:215], v3 offset:12800
    v_dot2c_f32_bf16 v224, v172, v172
    v_dot2c_f32_bf16 v225, v174, v174
    v_dot2c_f32_bf16 v226, v196, v196
    v_dot2c_f32_bf16 v227, v198, v198
    v_dot2c_f32_bf16 v224, v173, v173
    v_dot2c_f32_bf16 v225, v175, v175
    v_dot2c_f32_bf16 v226, v197, v197
    v_dot2c_f32_bf16 v227, v199, v199
    s_add_u32 s37, s42, 1
    v_permlane16_swap_b32 v224, v225
    s_cmp_eq_u32 s37, s53
    v_permlane16_swap_b32 v226, v227
    v_add_f32 v224, v224, v225
    v_add_f32 v226, v226, v227
    s_cselect_b32 s37, s52, s37
    s_nop 0
    v_permlane32_swap_b32 v224, v226
    v_add_f32 v224, v224, v226
    s_set_gpr_idx_on s42, gpr_idx(SRC0,DST)
    s_mov_b32 s42, s37
    v_add_f32 v232, v232, v224
    s_set_gpr_idx_off
.p2align 6
K1_lastA:
    s_setprio 3
    s_waitcnt lgkmcnt(0)
    v_mfma_f32_16x16x32_bf16 v[152:155], v[8:11], v[200:203], 0
    ds_read_b64_tr_b16 v[216:217], v3 offset:16384
    v_mfma_f32_16x16x32_bf16 v[152:155], v[12:15], v[204:207], v[152:155]
    ds_read_b64_tr_b16 v[218:219], v3 offset:16896
    v_mfma_f32_16x16x32_bf16 v[152:155], v[16:19], v[208:211], v[152:155]
    ds_read_b64_tr_b16 v[220:221], v3 offset:20480
    v_mfma_f32_16x16x32_bf16 v[152:155], v[20:23], v[212:215], v[152:155]
    ds_read_b64_tr_b16 v[222:223], v3 offset:20992
    v_mfma_f32_16x16x32_bf16 v[160:163], v[56:59], v[200:203], 0
    ds_read_b64_tr_b16 v[224:225], v3 offset:24576
    v_mfma_f32_16x16x32_bf16 v[160:163], v[60:63], v[204:207], v[160:163]
    ds_read_b64_tr_b16 v[226:227], v3 offset:25088
    v_mfma_f32_16x16x32_bf16 v[160:163], v[64:67], v[208:211], v[160:163]
    ds_read_b64_tr_b16 v[228:229], v3 offset:28672
    v_mfma_f32_16x16x32_bf16 v[160:163], v[68:71], v[212:215], v[160:163]
    ds_read_b64_tr_b16 v[230:231], v3 offset:29184
    v_mfma_f32_16x16x32_bf16 v[168:171], v[104:107], v[200:203], 0
    buffer_store_dwordx4 v[156:159], v4, s[16:19], s47 offen offset:0
    v_mfma_f32_16x16x32_bf16 v[168:171], v[108:111], v[204:207], v[168:171]
    s_add_u32 s34, s34, 49152
    v_mfma_f32_16x16x32_bf16 v[168:171], v[112:115], v[208:211], v[168:171]
    s_cmp_eq_u32 s34, 147456
    v_mfma_f32_16x16x32_bf16 v[168:171], v[116:119], v[212:215], v[168:171]
    buffer_store_dwordx4 v[164:167], v4, s[16:19], s47 offen offset:1024
    s_waitcnt lgkmcnt(0)
    v_mfma_f32_16x16x32_bf16 v[152:155], v[24:27], v[216:219], v[152:155]
    ds_read_b64_tr_b16 v[200:201], v3 offset:32768
    v_mfma_f32_16x16x32_bf16 v[152:155], v[28:31], v[220:223], v[152:155]
    ds_read_b64_tr_b16 v[202:203], v3 offset:33280
    v_mfma_f32_16x16x32_bf16 v[152:155], v[32:35], v[224:227], v[152:155]
    ds_read_b64_tr_b16 v[204:205], v3 offset:36864
    v_mfma_f32_16x16x32_bf16 v[152:155], v[36:39], v[228:231], v[152:155]
    ds_read_b64_tr_b16 v[206:207], v3 offset:37376
    v_mfma_f32_16x16x32_bf16 v[160:163], v[72:75], v[216:219], v[160:163]
    ds_read_b64_tr_b16 v[208:209], v3 offset:40960
    v_mfma_f32_16x16x32_bf16 v[160:163], v[76:79], v[220:223], v[160:163]
    ds_read_b64_tr_b16 v[210:211], v3 offset:41472
    v_mfma_f32_16x16x32_bf16 v[160:163], v[80:83], v[224:227], v[160:163]
    ds_read_b64_tr_b16 v[212:213], v3 offset:45056
    v_mfma_f32_16x16x32_bf16 v[160:163], v[84:87], v[228:231], v[160:163]
    ds_read_b64_tr_b16 v[214:215], v3 offset:45568
    v_mfma_f32_16x16x32_bf16 v[168:171], v[120:123], v[216:219], v[168:171]
    s_cselect_b32 s34, 0, s34
    v_mfma_f32_16x16x32_bf16 v[168:171], v[124:127], v[220:223], v[168:171]
    s_add_u32 s32, s32, 1
    v_mfma_f32_16x16x32_bf16 v[168:171], v[128:131], v[224:227], v[168:171]
    buffer_store_dwordx4 v[172:175], v4, s[16:19], s47 offen offset:2048
    v_mfma_f32_16x16x32_bf16 v[168:171], v[132:135], v[228:231], v[168:171]
    v_xor_b32 v3, 32, v3
    s_waitcnt lgkmcnt(0)
    v_mfma_f32_16x16x32_bf16 v[152:155], v[40:43], v[200:203], v[152:155]
    ds_read_b64_tr_b16 v[216:217], v3 offset:0
    v_mfma_f32_16x16x32_bf16 v[152:155], v[44:47], v[204:207], v[152:155]
    ds_read_b64_tr_b16 v[218:219], v3 offset:512
    v_mfma_f32_16x16x32_bf16 v[152:155], v[48:51], v[208:211], v[152:155]
    ds_read_b64_tr_b16 v[220:221], v3 offset:4096
    v_mfma_f32_16x16x32_bf16 v[152:155], v[52:55], v[212:215], v[152:155]
    ds_read_b64_tr_b16 v[222:223], v3 offset:4608
    v_mfma_f32_16x16x32_bf16 v[160:163], v[88:91], v[200:203], v[160:163]
    ds_read_b64_tr_b16 v[224:225], v3 offset:8192
    v_mfma_f32_16x16x32_bf16 v[160:163], v[92:95], v[204:207], v[160:163]
    ds_read_b64_tr_b16 v[226:227], v3 offset:8704
    v_mfma_f32_16x16x32_bf16 v[160:163], v[96:99], v[208:211], v[160:163]
    ds_read_b64_tr_b16 v[228:229], v3 offset:12288
    v_mfma_f32_16x16x32_bf16 v[160:163], v[100:103], v[212:215], v[160:163]
    ds_read_b64_tr_b16 v[230:231], v3 offset:12800
    v_mfma_f32_16x16x32_bf16 v[168:171], v[136:139], v[200:203], v[168:171]
    v_mfma_f32_16x16x32_bf16 v[168:171], v[140:143], v[204:207], v[168:171]
    buffer_store_dwordx4 v[180:183], v4, s[16:19], s48 offen offset:0 nt
    v_mfma_f32_16x16x32_bf16 v[168:171], v[144:147], v[208:211], v[168:171]
    v_mfma_f32_16x16x32_bf16 v[168:171], v[148:151], v[212:215], v[168:171]
    buffer_store_dwordx4 v[188:191], v4, s[16:19], s48 offen offset:1024 nt
    s_waitcnt lgkmcnt(0)
    v_mfma_f32_16x16x32_bf16 v[156:159], v[8:11], v[216:219], 0
    ds_read_b64_tr_b16 v[200:201], v3 offset:16384
    v_mfma_f32_16x16x32_bf16 v[156:159], v[12:15], v[220:223], v[156:159]
    ds_read_b64_tr_b16 v[202:203], v3 offset:16896
    v_mfma_f32_16x16x32_bf16 v[156:159], v[16:19], v[224:227], v[156:159]
    ds_read_b64_tr_b16 v[204:205], v3 offset:20480
    v_mfma_f32_16x16x32_bf16 v[156:159], v[20:23], v[228:231], v[156:159]
    ds_read_b64_tr_b16 v[206:207], v3 offset:20992
    v_mfma_f32_16x16x32_bf16 v[164:167], v[56:59], v[216:219], 0
    ds_read_b64_tr_b16 v[208:209], v3 offset:24576
    v_mfma_f32_16x16x32_bf16 v[164:167], v[60:63], v[220:223], v[164:167]
    ds_read_b64_tr_b16 v[210:211], v3 offset:25088
    v_mfma_f32_16x16x32_bf16 v[164:167], v[64:67], v[224:227], v[164:167]
    ds_read_b64_tr_b16 v[212:213], v3 offset:28672
    v_mfma_f32_16x16x32_bf16 v[164:167], v[68:71], v[228:231], v[164:167]
    ds_read_b64_tr_b16 v[214:215], v3 offset:29184
    v_mfma_f32_16x16x32_bf16 v[172:175], v[104:107], v[216:219], 0
    v_mfma_f32_16x16x32_bf16 v[172:175], v[108:111], v[220:223], v[172:175]
    buffer_store_dwordx4 v[196:199], v4, s[16:19], s48 offen offset:2048 nt
    v_mfma_f32_16x16x32_bf16 v[172:175], v[112:115], v[224:227], v[172:175]
    s_mul_i32 s47, s42, 24576
    v_mfma_f32_16x16x32_bf16 v[172:175], v[116:119], v[228:231], v[172:175]
    s_add_u32 s47, s47, s39
    s_waitcnt lgkmcnt(0)
    v_mfma_f32_16x16x32_bf16 v[156:159], v[24:27], v[200:203], v[156:159]
    ds_read_b64_tr_b16 v[216:217], v3 offset:32768
    v_mfma_f32_16x16x32_bf16 v[156:159], v[28:31], v[204:207], v[156:159]
    ds_read_b64_tr_b16 v[218:219], v3 offset:33280
    v_mfma_f32_16x16x32_bf16 v[156:159], v[32:35], v[208:211], v[156:159]
    ds_read_b64_tr_b16 v[220:221], v3 offset:36864
    v_mfma_f32_16x16x32_bf16 v[156:159], v[36:39], v[212:215], v[156:159]
    ds_read_b64_tr_b16 v[222:223], v3 offset:37376
    v_mfma_f32_16x16x32_bf16 v[164:167], v[72:75], v[200:203], v[164:167]
    ds_read_b64_tr_b16 v[224:225], v3 offset:40960
    v_mfma_f32_16x16x32_bf16 v[164:167], v[76:79], v[204:207], v[164:167]
    ds_read_b64_tr_b16 v[226:227], v3 offset:41472
    v_mfma_f32_16x16x32_bf16 v[164:167], v[80:83], v[208:211], v[164:167]
    ds_read_b64_tr_b16 v[228:229], v3 offset:45056
    v_mfma_f32_16x16x32_bf16 v[164:167], v[84:87], v[212:215], v[164:167]
    ds_read_b64_tr_b16 v[230:231], v3 offset:45568
    v_mfma_f32_16x16x32_bf16 v[172:175], v[120:123], v[200:203], v[172:175]
    v_mfma_f32_16x16x32_bf16 v[172:175], v[124:127], v[204:207], v[172:175]
    s_barrier
    v_mfma_f32_16x16x32_bf16 v[172:175], v[128:131], v[208:211], v[172:175]
    s_add_u32 m0, s3, 0
    v_mfma_f32_16x16x32_bf16 v[172:175], v[132:135], v[212:215], v[172:175]
    v_xor_b32 v3, 96, v3
    s_waitcnt lgkmcnt(0)
    v_mfma_f32_16x16x32_bf16 v[156:159], v[40:43], v[216:219], v[156:159]
    ds_read_b64_tr_b16 v[200:201], v3 offset:0
    v_mfma_f32_16x16x32_bf16 v[156:159], v[44:47], v[220:223], v[156:159]
    ds_read_b64_tr_b16 v[202:203], v3 offset:512
    v_mfma_f32_16x16x32_bf16 v[156:159], v[48:51], v[224:227], v[156:159]
    ds_read_b64_tr_b16 v[204:205], v3 offset:4096
    v_mfma_f32_16x16x32_bf16 v[156:159], v[52:55], v[228:231], v[156:159]
    ds_read_b64_tr_b16 v[206:207], v3 offset:4608
    v_mfma_f32_16x16x32_bf16 v[164:167], v[88:91], v[216:219], v[164:167]
    ds_read_b64_tr_b16 v[208:209], v3 offset:8192
    v_mfma_f32_16x16x32_bf16 v[164:167], v[92:95], v[220:223], v[164:167]
    ds_read_b64_tr_b16 v[210:211], v3 offset:8704
    v_mfma_f32_16x16x32_bf16 v[164:167], v[96:99], v[224:227], v[164:167]
    ds_read_b64_tr_b16 v[212:213], v3 offset:12288
    v_mfma_f32_16x16x32_bf16 v[164:167], v[100:103], v[228:231], v[164:167]
    ds_read_b64_tr_b16 v[214:215], v3 offset:12800
    v_mfma_f32_16x16x32_bf16 v[172:175], v[136:139], v[216:219], v[172:175]
    s_add_u32 s58, s40, 256
    v_mfma_f32_16x16x32_bf16 v[172:175], v[140:143], v[220:223], v[172:175]
    buffer_load_dwordx4 v2, s[8:11], s58 offen nt lds
    v_mfma_f32_16x16x32_bf16 v[172:175], v[144:147], v[224:227], v[172:175]
    s_add_u32 m0, m0, 1024
    v_mfma_f32_16x16x32_bf16 v[172:175], v[148:151], v[228:231], v[172:175]
    s_add_u32 s58, s58, 6144
    s_waitcnt lgkmcnt(0)
    v_mfma_f32_16x16x32_bf16 v[176:179], v[8:11], v[200:203], 0
    ds_read_b64_tr_b16 v[216:217], v3 offset:16384
    v_mfma_f32_16x16x32_bf16 v[176:179], v[12:15], v[204:207], v[176:179]
    ds_read_b64_tr_b16 v[218:219], v3 offset:16896
    v_mfma_f32_16x16x32_bf16 v[176:179], v[16:19], v[208:211], v[176:179]
    ds_read_b64_tr_b16 v[220:221], v3 offset:20480
    v_mfma_f32_16x16x32_bf16 v[176:179], v[20:23], v[212:215], v[176:179]
    ds_read_b64_tr_b16 v[222:223], v3 offset:20992
    v_mfma_f32_16x16x32_bf16 v[184:187], v[56:59], v[200:203], 0
    ds_read_b64_tr_b16 v[224:225], v3 offset:24576
    v_mfma_f32_16x16x32_bf16 v[184:187], v[60:63], v[204:207], v[184:187]
    ds_read_b64_tr_b16 v[226:227], v3 offset:25088
    v_mfma_f32_16x16x32_bf16 v[184:187], v[64:67], v[208:211], v[184:187]
    ds_read_b64_tr_b16 v[228:229], v3 offset:28672
    v_mfma_f32_16x16x32_bf16 v[184:187], v[68:71], v[212:215], v[184:187]
    ds_read_b64_tr_b16 v[230:231], v3 offset:29184
    v_mfma_f32_16x16x32_bf16 v[192:195], v[104:107], v[200:203], 0
    buffer_load_dwordx4 v2, s[8:11], s58 offen nt lds
    v_mfma_f32_16x16x32_bf16 v[192:195], v[108:111], v[204:207], v[192:195]
    s_add_u32 m0, s3, 2048
    v_mfma_f32_16x16x32_bf16 v[192:195], v[112:115], v[208:211], v[192:195]
    s_add_u32 s58, s40, 128
    v_mfma_f32_16x16x32_bf16 v[192:195], v[116:119], v[212:215], v[192:195]
    buffer_load_dwordx4 v2, s[8:11], s58 offen nt lds
    s_waitcnt lgkmcnt(0)
    v_mfma_f32_16x16x32_bf16 v[176:179], v[24:27], v[216:219], v[176:179]
    ds_read_b64_tr_b16 v[200:201], v3 offset:32768
    v_mfma_f32_16x16x32_bf16 v[176:179], v[28:31], v[220:223], v[176:179]
    ds_read_b64_tr_b16 v[202:203], v3 offset:33280
    v_mfma_f32_16x16x32_bf16 v[176:179], v[32:35], v[224:227], v[176:179]
    ds_read_b64_tr_b16 v[204:205], v3 offset:36864
    v_mfma_f32_16x16x32_bf16 v[176:179], v[36:39], v[228:231], v[176:179]
    ds_read_b64_tr_b16 v[206:207], v3 offset:37376
    v_mfma_f32_16x16x32_bf16 v[184:187], v[72:75], v[216:219], v[184:187]
    ds_read_b64_tr_b16 v[208:209], v3 offset:40960
    v_mfma_f32_16x16x32_bf16 v[184:187], v[76:79], v[220:223], v[184:187]
    ds_read_b64_tr_b16 v[210:211], v3 offset:41472
    v_mfma_f32_16x16x32_bf16 v[184:187], v[80:83], v[224:227], v[184:187]
    ds_read_b64_tr_b16 v[212:213], v3 offset:45056
    v_mfma_f32_16x16x32_bf16 v[184:187], v[84:87], v[228:231], v[184:187]
    ds_read_b64_tr_b16 v[214:215], v3 offset:45568
    v_mfma_f32_16x16x32_bf16 v[192:195], v[120:123], v[216:219], v[192:195]
    s_add_u32 m0, m0, 1024
    v_mfma_f32_16x16x32_bf16 v[192:195], v[124:127], v[220:223], v[192:195]
    s_add_u32 s58, s58, 6144
    v_mfma_f32_16x16x32_bf16 v[192:195], v[128:131], v[224:227], v[192:195]
    buffer_load_dwordx4 v2, s[8:11], s58 offen nt lds
    v_mfma_f32_16x16x32_bf16 v[192:195], v[132:135], v[228:231], v[192:195]
    v_xor_b32 v3, 32, v3
    s_waitcnt lgkmcnt(0)
    v_mfma_f32_16x16x32_bf16 v[176:179], v[40:43], v[200:203], v[176:179]
    ds_read_b64_tr_b16 v[216:217], v3 offset:0
    v_mfma_f32_16x16x32_bf16 v[176:179], v[44:47], v[204:207], v[176:179]
    ds_read_b64_tr_b16 v[218:219], v3 offset:512
    v_mfma_f32_16x16x32_bf16 v[176:179], v[48:51], v[208:211], v[176:179]
    ds_read_b64_tr_b16 v[220:221], v3 offset:4096
    v_mfma_f32_16x16x32_bf16 v[176:179], v[52:55], v[212:215], v[176:179]
    ds_read_b64_tr_b16 v[222:223], v3 offset:4608
    v_mfma_f32_16x16x32_bf16 v[184:187], v[88:91], v[200:203], v[184:187]
    ds_read_b64_tr_b16 v[224:225], v3 offset:8192
    v_mfma_f32_16x16x32_bf16 v[184:187], v[92:95], v[204:207], v[184:187]
    ds_read_b64_tr_b16 v[226:227], v3 offset:8704
    v_mfma_f32_16x16x32_bf16 v[184:187], v[96:99], v[208:211], v[184:187]
    ds_read_b64_tr_b16 v[228:229], v3 offset:12288
    v_mfma_f32_16x16x32_bf16 v[184:187], v[100:103], v[212:215], v[184:187]
    ds_read_b64_tr_b16 v[230:231], v3 offset:12800
    v_mfma_f32_16x16x32_bf16 v[192:195], v[136:139], v[200:203], v[192:195]
    s_add_u32 m0, s3, 4096
    v_mfma_f32_16x16x32_bf16 v[192:195], v[140:143], v[204:207], v[192:195]
    s_add_u32 s58, s40, 0
    v_mfma_f32_16x16x32_bf16 v[192:195], v[144:147], v[208:211], v[192:195]
    buffer_load_dwordx4 v2, s[8:11], s58 offen nt lds
    v_mfma_f32_16x16x32_bf16 v[192:195], v[148:151], v[212:215], v[192:195]
    s_add_u32 m0, m0, 1024
    s_waitcnt lgkmcnt(0)
    v_mfma_f32_16x16x32_bf16 v[180:183], v[8:11], v[216:219], 0
    ds_read_b64_tr_b16 v[200:201], v3 offset:16384
    v_mfma_f32_16x16x32_bf16 v[180:183], v[12:15], v[220:223], v[180:183]
    ds_read_b64_tr_b16 v[202:203], v3 offset:16896
    v_mfma_f32_16x16x32_bf16 v[180:183], v[16:19], v[224:227], v[180:183]
    ds_read_b64_tr_b16 v[204:205], v3 offset:20480
    v_mfma_f32_16x16x32_bf16 v[180:183], v[20:23], v[228:231], v[180:183]
    ds_read_b64_tr_b16 v[206:207], v3 offset:20992
    v_mfma_f32_16x16x32_bf16 v[188:191], v[56:59], v[216:219], 0
    ds_read_b64_tr_b16 v[208:209], v3 offset:24576
    v_mfma_f32_16x16x32_bf16 v[188:191], v[60:63], v[220:223], v[188:191]
    ds_read_b64_tr_b16 v[210:211], v3 offset:25088
    v_mfma_f32_16x16x32_bf16 v[188:191], v[64:67], v[224:227], v[188:191]
    ds_read_b64_tr_b16 v[212:213], v3 offset:28672
    v_mfma_f32_16x16x32_bf16 v[188:191], v[68:71], v[228:231], v[188:191]
    ds_read_b64_tr_b16 v[214:215], v3 offset:29184
    v_mfma_f32_16x16x32_bf16 v[196:199], v[104:107], v[216:219], 0
    s_add_u32 s58, s58, 6144
    v_mfma_f32_16x16x32_bf16 v[196:199], v[108:111], v[220:223], v[196:199]
    buffer_load_dwordx4 v2, s[8:11], s58 offen nt lds
    v_mfma_f32_16x16x32_bf16 v[196:199], v[112:115], v[224:227], v[196:199]
    s_cmp_eq_u32 s42, s85
    v_mfma_f32_16x16x32_bf16 v[196:199], v[116:119], v[228:231], v[196:199]
    s_cselect_b32 s16, s26, s24
    s_waitcnt lgkmcnt(0)
    v_mfma_f32_16x16x32_bf16 v[180:183], v[24:27], v[200:203], v[180:183]
    ds_read_b64_tr_b16 v[216:217], v3 offset:32768
    v_mfma_f32_16x16x32_bf16 v[180:183], v[28:31], v[204:207], v[180:183]
    ds_read_b64_tr_b16 v[218:219], v3 offset:33280
    v_mfma_f32_16x16x32_bf16 v[180:183], v[32:35], v[208:211], v[180:183]
    ds_read_b64_tr_b16 v[220:221], v3 offset:36864
    v_mfma_f32_16x16x32_bf16 v[180:183], v[36:39], v[212:215], v[180:183]
    ds_read_b64_tr_b16 v[222:223], v3 offset:37376
    v_mfma_f32_16x16x32_bf16 v[188:191], v[72:75], v[200:203], v[188:191]
    ds_read_b64_tr_b16 v[224:225], v3 offset:40960
    v_mfma_f32_16x16x32_bf16 v[188:191], v[76:79], v[204:207], v[188:191]
    ds_read_b64_tr_b16 v[226:227], v3 offset:41472
    v_mfma_f32_16x16x32_bf16 v[188:191], v[80:83], v[208:211], v[188:191]
    ds_read_b64_tr_b16 v[228:229], v3 offset:45056
    v_mfma_f32_16x16x32_bf16 v[188:191], v[84:87], v[212:215], v[188:191]
    ds_read_b64_tr_b16 v[230:231], v3 offset:45568
    v_mfma_f32_16x16x32_bf16 v[196:199], v[120:123], v[200:203], v[196:199]
    s_cselect_b32 s17, s27, s25
    v_mfma_f32_16x16x32_bf16 v[196:199], v[124:127], v[204:207], v[196:199]
    s_cselect_b32 s47, s59, s47
    v_mfma_f32_16x16x32_bf16 v[196:199], v[128:131], v[208:211], v[196:199]
    s_mov_b32 s37, 113246208
    v_mfma_f32_16x16x32_bf16 v[196:199], v[132:135], v[212:215], v[196:199]
    s_cselect_b32 s18, s37, 446693376
    s_waitcnt lgkmcnt(0)
    v_mfma_f32_16x16x32_bf16 v[180:183], v[40:43], v[216:219], v[180:183]
    s_add_u32 s48, s47, 12288
    v_mfma_f32_16x16x32_bf16 v[180:183], v[44:47], v[220:223], v[180:183]
    v_mfma_f32_16x16x32_bf16 v[180:183], v[48:51], v[224:227], v[180:183]
    v_mfma_f32_16x16x32_bf16 v[180:183], v[52:55], v[228:231], v[180:183]
    v_mfma_f32_16x16x32_bf16 v[188:191], v[88:91], v[216:219], v[188:191]
    v_mfma_f32_16x16x32_bf16 v[188:191], v[92:95], v[220:223], v[188:191]
    v_mfma_f32_16x16x32_bf16 v[188:191], v[96:99], v[224:227], v[188:191]
    v_mfma_f32_16x16x32_bf16 v[188:191], v[100:103], v[228:231], v[188:191]
    v_mfma_f32_16x16x32_bf16 v[196:199], v[136:139], v[216:219], v[196:199]
    v_mfma_f32_16x16x32_bf16 v[196:199], v[140:143], v[220:223], v[196:199]
    v_mfma_f32_16x16x32_bf16 v[196:199], v[144:147], v[224:227], v[196:199]
    v_mfma_f32_16x16x32_bf16 v[196:199], v[148:151], v[228:231], v[196:199]
    s_setprio 0
    v_and_b32 v213, 15, v0
    v_lshlrev_b32 v212, 7, v213
    v_bfe_u32 v213, v0, 1, 2
    v_bfe_u32 v214, v0, 4, 2
    v_xor_b32_e64 v213, v213, v214
    v_lshl_add_u32 v212, v213, 4, v212
    v_add_u32 v213, s3, v212
    v_add_u32 v212, s57, v212
    v_cvt_pk_f16_f32 v216, v152, v153
    v_cvt_pk_f16_f32 v217, v154, v155
    v_cvt_pk_f16_f32 v218, v156, v157
    v_cvt_pk_f16_f32 v219, v158, v159
    v_pk_fma_f16 v220, v216, v216, s44 neg_lo:[1,0,0] neg_hi:[1,0,0]
    v_pk_fma_f16 v221, v217, v217, s44 neg_lo:[1,0,0] neg_hi:[1,0,0]
    v_pk_fma_f16 v222, v218, v218, s44 neg_lo:[1,0,0] neg_hi:[1,0,0]
    v_pk_fma_f16 v223, v219, v219, s44 neg_lo:[1,0,0] neg_hi:[1,0,0]
    v_pk_mul_f16 v220, v220, v216
    v_pk_mul_f16 v221, v221, v217
    v_pk_mul_f16 v222, v222, v218
    v_pk_mul_f16 v223, v223, v219
    v_exp_f16 v216, v220
    v_exp_f16 v217, v221
    v_exp_f16 v218, v222
    v_exp_f16 v219, v223
    v_exp_f16_sdwa v216, v220 dst_sel:WORD_1 dst_unused:UNUSED_PRESERVE src0_sel:WORD_1
    v_exp_f16_sdwa v217, v221 dst_sel:WORD_1 dst_unused:UNUSED_PRESERVE src0_sel:WORD_1
    v_exp_f16_sdwa v218, v222 dst_sel:WORD_1 dst_unused:UNUSED_PRESERVE src0_sel:WORD_1
    v_exp_f16_sdwa v219, v223 dst_sel:WORD_1 dst_unused:UNUSED_PRESERVE src0_sel:WORD_1
    v_pk_add_f16 v216, v216, 1.0 op_sel_hi:[1,0]
    v_pk_add_f16 v217, v217, 1.0 op_sel_hi:[1,0]
    v_pk_add_f16 v218, v218, 1.0 op_sel_hi:[1,0]
    v_pk_add_f16 v219, v219, 1.0 op_sel_hi:[1,0]
    v_rcp_f16 v220, v216
    v_rcp_f16 v221, v217
    v_rcp_f16 v222, v218
    v_rcp_f16 v223, v219
    v_rcp_f16_sdwa v216, v216 dst_sel:DWORD dst_unused:UNUSED_PAD src0_sel:WORD_1
    v_rcp_f16_sdwa v217, v217 dst_sel:DWORD dst_unused:UNUSED_PAD src0_sel:WORD_1
    v_rcp_f16_sdwa v218, v218 dst_sel:DWORD dst_unused:UNUSED_PAD src0_sel:WORD_1
    v_rcp_f16_sdwa v219, v219 dst_sel:DWORD dst_unused:UNUSED_PAD src0_sel:WORD_1
    v_fma_mix_f32 v152, v152, v220, 0 op_sel_hi:[0,1,0]
    v_fma_mix_f32 v154, v154, v221, 0 op_sel_hi:[0,1,0]
    v_fma_mix_f32 v156, v156, v222, 0 op_sel_hi:[0,1,0]
    v_fma_mix_f32 v158, v158, v223, 0 op_sel_hi:[0,1,0]
    v_fma_mix_f32 v153, v153, v216, 0 op_sel_hi:[0,1,0]
    v_fma_mix_f32 v155, v155, v217, 0 op_sel_hi:[0,1,0]
    v_fma_mix_f32 v157, v157, v218, 0 op_sel_hi:[0,1,0]
    v_fma_mix_f32 v159, v159, v219, 0 op_sel_hi:[0,1,0]
    v_cvt_pk_bf16_f32 v159, v158, v159
    v_cvt_pk_bf16_f32 v158, v156, v157
    v_cvt_pk_bf16_f32 v157, v154, v155
    v_cvt_pk_bf16_f32 v156, v152, v153
    buffer_store_dwordx4 v[156:159], v4, s[16:19], s47 offen offset:0
    s_waitcnt vmcnt(13)
    ds_read_b128 v[32:35], v212 offset:0
    ds_read_b128 v[36:39], v212 offset:64
    s_waitcnt lgkmcnt(0)
    s_add_u32 m0, s57, 0
    s_add_u32 s58, s40, 12672
    buffer_load_dwordx4 v2, s[8:11], s58 offen nt lds
    s_add_u32 m0, m0, 1024
    s_add_u32 s58, s58, 6144
    buffer_load_dwordx4 v2, s[8:11], s58 offen nt lds
    s_nop 0
    v_cvt_pk_f16_f32 v216, v160, v161
    v_cvt_pk_f16_f32 v217, v162, v163
    v_cvt_pk_f16_f32 v218, v164, v165
    v_cvt_pk_f16_f32 v219, v166, v167
    v_pk_fma_f16 v220, v216, v216, s44 neg_lo:[1,0,0] neg_hi:[1,0,0]
    v_pk_fma_f16 v221, v217, v217, s44 neg_lo:[1,0,0] neg_hi:[1,0,0]
    v_pk_fma_f16 v222, v218, v218, s44 neg_lo:[1,0,0] neg_hi:[1,0,0]
    v_pk_fma_f16 v223, v219, v219, s44 neg_lo:[1,0,0] neg_hi:[1,0,0]
    v_pk_mul_f16 v220, v220, v216
    v_pk_mul_f16 v221, v221, v217
    v_pk_mul_f16 v222, v222, v218
    v_pk_mul_f16 v223, v223, v219
    v_exp_f16 v216, v220
    v_exp_f16 v217, v221
    v_exp_f16 v218, v222
    v_exp_f16 v219, v223
    v_exp_f16_sdwa v216, v220 dst_sel:WORD_1 dst_unused:UNUSED_PRESERVE src0_sel:WORD_1
    v_exp_f16_sdwa v217, v221 dst_sel:WORD_1 dst_unused:UNUSED_PRESERVE src0_sel:WORD_1
    v_exp_f16_sdwa v218, v222 dst_sel:WORD_1 dst_unused:UNUSED_PRESERVE src0_sel:WORD_1
    v_exp_f16_sdwa v219, v223 dst_sel:WORD_1 dst_unused:UNUSED_PRESERVE src0_sel:WORD_1
    v_pk_add_f16 v216, v216, 1.0 op_sel_hi:[1,0]
    v_pk_add_f16 v217, v217, 1.0 op_sel_hi:[1,0]
    v_pk_add_f16 v218, v218, 1.0 op_sel_hi:[1,0]
    v_pk_add_f16 v219, v219, 1.0 op_sel_hi:[1,0]
    v_rcp_f16 v220, v216
    v_rcp_f16 v221, v217
    v_rcp_f16 v222, v218
    v_rcp_f16 v223, v219
    v_rcp_f16_sdwa v216, v216 dst_sel:DWORD dst_unused:UNUSED_PAD src0_sel:WORD_1
    v_rcp_f16_sdwa v217, v217 dst_sel:DWORD dst_unused:UNUSED_PAD src0_sel:WORD_1
    v_rcp_f16_sdwa v218, v218 dst_sel:DWORD dst_unused:UNUSED_PAD src0_sel:WORD_1
    v_rcp_f16_sdwa v219, v219 dst_sel:DWORD dst_unused:UNUSED_PAD src0_sel:WORD_1
    v_fma_mix_f32 v160, v160, v220, 0 op_sel_hi:[0,1,0]
    v_fma_mix_f32 v162, v162, v221, 0 op_sel_hi:[0,1,0]
    v_fma_mix_f32 v164, v164, v222, 0 op_sel_hi:[0,1,0]
    v_fma_mix_f32 v166, v166, v223, 0 op_sel_hi:[0,1,0]
    v_fma_mix_f32 v161, v161, v216, 0 op_sel_hi:[0,1,0]
    v_fma_mix_f32 v163, v163, v217, 0 op_sel_hi:[0,1,0]
    v_fma_mix_f32 v165, v165, v218, 0 op_sel_hi:[0,1,0]
    v_fma_mix_f32 v167, v167, v219, 0 op_sel_hi:[0,1,0]
    v_cvt_pk_bf16_f32 v167, v166, v167
    v_cvt_pk_bf16_f32 v166, v164, v165
    v_cvt_pk_bf16_f32 v165, v162, v163
    v_cvt_pk_bf16_f32 v164, v160, v161
    buffer_store_dwordx4 v[164:167], v4, s[16:19], s47 offen offset:1024
    s_waitcnt vmcnt(16)
    ds_read_b128 v[40:43], v212 offset:2048
    ds_read_b128 v[44:47], v212 offset:2112
    s_waitcnt lgkmcnt(0)
    s_add_u32 m0, s57, 2048
    s_add_u32 s58, s40, 12800
    buffer_load_dwordx4 v2, s[8:11], s58 offen nt lds
    s_add_u32 m0, m0, 1024
    s_add_u32 s58, s58, 6144
    buffer_load_dwordx4 v2, s[8:11], s58 offen nt lds
    s_setprio 1
    s_nop 0
    v_cvt_pk_f16_f32 v216, v168, v169
    v_cvt_pk_f16_f32 v217, v170, v171
    v_cvt_pk_f16_f32 v218, v172, v173
    v_cvt_pk_f16_f32 v219, v174, v175
    v_pk_fma_f16 v220, v216, v216, s44 neg_lo:[1,0,0] neg_hi:[1,0,0]
    v_pk_fma_f16 v221, v217, v217, s44 neg_lo:[1,0,0] neg_hi:[1,0,0]
    v_pk_fma_f16 v222, v218, v218, s44 neg_lo:[1,0,0] neg_hi:[1,0,0]
    v_pk_fma_f16 v223, v219, v219, s44 neg_lo:[1,0,0] neg_hi:[1,0,0]
    v_pk_mul_f16 v220, v220, v216
    v_pk_mul_f16 v221, v221, v217
    v_pk_mul_f16 v222, v222, v218
    v_pk_mul_f16 v223, v223, v219
    v_exp_f16 v216, v220
    v_exp_f16 v217, v221
    v_exp_f16 v218, v222
    v_exp_f16 v219, v223
    v_exp_f16_sdwa v216, v220 dst_sel:WORD_1 dst_unused:UNUSED_PRESERVE src0_sel:WORD_1
    v_exp_f16_sdwa v217, v221 dst_sel:WORD_1 dst_unused:UNUSED_PRESERVE src0_sel:WORD_1
    v_exp_f16_sdwa v218, v222 dst_sel:WORD_1 dst_unused:UNUSED_PRESERVE src0_sel:WORD_1
    v_exp_f16_sdwa v219, v223 dst_sel:WORD_1 dst_unused:UNUSED_PRESERVE src0_sel:WORD_1
    v_pk_add_f16 v216, v216, 1.0 op_sel_hi:[1,0]
    v_pk_add_f16 v217, v217, 1.0 op_sel_hi:[1,0]
    v_pk_add_f16 v218, v218, 1.0 op_sel_hi:[1,0]
    v_pk_add_f16 v219, v219, 1.0 op_sel_hi:[1,0]
    v_rcp_f16 v220, v216
    v_rcp_f16 v221, v217
    v_rcp_f16 v222, v218
    v_rcp_f16 v223, v219
    v_rcp_f16_sdwa v216, v216 dst_sel:DWORD dst_unused:UNUSED_PAD src0_sel:WORD_1
    v_rcp_f16_sdwa v217, v217 dst_sel:DWORD dst_unused:UNUSED_PAD src0_sel:WORD_1
    v_rcp_f16_sdwa v218, v218 dst_sel:DWORD dst_unused:UNUSED_PAD src0_sel:WORD_1
    v_rcp_f16_sdwa v219, v219 dst_sel:DWORD dst_unused:UNUSED_PAD src0_sel:WORD_1
    v_fma_mix_f32 v168, v168, v220, 0 op_sel_hi:[0,1,0]
    v_fma_mix_f32 v170, v170, v221, 0 op_sel_hi:[0,1,0]
    v_fma_mix_f32 v172, v172, v222, 0 op_sel_hi:[0,1,0]
    v_fma_mix_f32 v174, v174, v223, 0 op_sel_hi:[0,1,0]
    v_fma_mix_f32 v169, v169, v216, 0 op_sel_hi:[0,1,0]
    v_fma_mix_f32 v171, v171, v217, 0 op_sel_hi:[0,1,0]
    v_fma_mix_f32 v173, v173, v218, 0 op_sel_hi:[0,1,0]
    v_fma_mix_f32 v175, v175, v219, 0 op_sel_hi:[0,1,0]
    v_cvt_pk_bf16_f32 v175, v174, v175
    v_cvt_pk_bf16_f32 v174, v172, v173
    v_cvt_pk_bf16_f32 v173, v170, v171
    v_cvt_pk_bf16_f32 v172, v168, v169
    buffer_store_dwordx4 v[172:175], v4, s[16:19], s47 offen offset:2048
    s_waitcnt vmcnt(19)
    ds_read_b128 v[48:51], v212 offset:4096
    ds_read_b128 v[52:55], v212 offset:4160
    s_waitcnt lgkmcnt(0)
    s_add_u32 m0, s57, 4096
    s_add_u32 s58, s40, 12928
    buffer_load_dwordx4 v2, s[8:11], s58 offen nt lds
    s_add_u32 m0, m0, 1024
    s_add_u32 s58, s58, 6144
    buffer_load_dwordx4 v2, s[8:11], s58 offen nt lds
    v_cvt_pk_f16_f32 v216, v176, v177
    v_cvt_pk_f16_f32 v217, v178, v179
    v_cvt_pk_f16_f32 v218, v180, v181
    v_cvt_pk_f16_f32 v219, v182, v183
    v_pk_fma_f16 v220, v216, v216, s44 neg_lo:[1,0,0] neg_hi:[1,0,0]
    v_pk_fma_f16 v221, v217, v217, s44 neg_lo:[1,0,0] neg_hi:[1,0,0]
    v_pk_fma_f16 v222, v218, v218, s44 neg_lo:[1,0,0] neg_hi:[1,0,0]
    v_pk_fma_f16 v223, v219, v219, s44 neg_lo:[1,0,0] neg_hi:[1,0,0]
    v_pk_mul_f16 v220, v220, v216
    v_pk_mul_f16 v221, v221, v217
    v_pk_mul_f16 v222, v222, v218
    v_pk_mul_f16 v223, v223, v219
    v_exp_f16 v216, v220
    v_exp_f16 v217, v221
    v_exp_f16 v218, v222
    v_exp_f16 v219, v223
    v_exp_f16_sdwa v216, v220 dst_sel:WORD_1 dst_unused:UNUSED_PRESERVE src0_sel:WORD_1
    v_exp_f16_sdwa v217, v221 dst_sel:WORD_1 dst_unused:UNUSED_PRESERVE src0_sel:WORD_1
    v_exp_f16_sdwa v218, v222 dst_sel:WORD_1 dst_unused:UNUSED_PRESERVE src0_sel:WORD_1
    v_exp_f16_sdwa v219, v223 dst_sel:WORD_1 dst_unused:UNUSED_PRESERVE src0_sel:WORD_1
    v_pk_add_f16 v216, v216, 1.0 op_sel_hi:[1,0]
    v_pk_add_f16 v217, v217, 1.0 op_sel_hi:[1,0]
    v_pk_add_f16 v218, v218, 1.0 op_sel_hi:[1,0]
    v_pk_add_f16 v219, v219, 1.0 op_sel_hi:[1,0]
    v_rcp_f16 v220, v216
    v_rcp_f16 v221, v217
    v_rcp_f16 v222, v218
    v_rcp_f16 v223, v219
    v_rcp_f16_sdwa v216, v216 dst_sel:DWORD dst_unused:UNUSED_PAD src0_sel:WORD_1
    v_rcp_f16_sdwa v217, v217 dst_sel:DWORD dst_unused:UNUSED_PAD src0_sel:WORD_1
    v_rcp_f16_sdwa v218, v218 dst_sel:DWORD dst_unused:UNUSED_PAD src0_sel:WORD_1
    v_rcp_f16_sdwa v219, v219 dst_sel:DWORD dst_unused:UNUSED_PAD src0_sel:WORD_1
    v_fma_mix_f32 v176, v176, v220, 0 op_sel_hi:[0,1,0]
    v_fma_mix_f32 v178, v178, v221, 0 op_sel_hi:[0,1,0]
    v_fma_mix_f32 v180, v180, v222, 0 op_sel_hi:[0,1,0]
    v_fma_mix_f32 v182, v182, v223, 0 op_sel_hi:[0,1,0]
    v_fma_mix_f32 v177, v177, v216, 0 op_sel_hi:[0,1,0]
    v_fma_mix_f32 v179, v179, v217, 0 op_sel_hi:[0,1,0]
    v_fma_mix_f32 v181, v181, v218, 0 op_sel_hi:[0,1,0]
    v_fma_mix_f32 v183, v183, v219, 0 op_sel_hi:[0,1,0]
    v_cvt_pk_bf16_f32 v183, v182, v183
    v_cvt_pk_bf16_f32 v182, v180, v181
    v_cvt_pk_bf16_f32 v181, v178, v179
    v_cvt_pk_bf16_f32 v180, v176, v177
    buffer_store_dwordx4 v[180:183], v4, s[16:19], s48 offen offset:0 nt
    s_waitcnt vmcnt(14)
    ds_read_b128 v[24:27], v213 offset:0
    ds_read_b128 v[28:31], v213 offset:64
    s_waitcnt lgkmcnt(0)
    s_add_u32 m0, s3, 0
    s_add_u32 s58, s40, 12544
    buffer_load_dwordx4 v2, s[8:11], s58 offen nt lds
    s_add_u32 m0, m0, 1024
    s_add_u32 s58, s58, 6144
    buffer_load_dwordx4 v2, s[8:11], s58 offen nt lds
    s_nop 0
    v_cvt_pk_f16_f32 v216, v184, v185
    v_cvt_pk_f16_f32 v217, v186, v187
    v_cvt_pk_f16_f32 v218, v188, v189
    v_cvt_pk_f16_f32 v219, v190, v191
    v_pk_fma_f16 v220, v216, v216, s44 neg_lo:[1,0,0] neg_hi:[1,0,0]
    v_pk_fma_f16 v221, v217, v217, s44 neg_lo:[1,0,0] neg_hi:[1,0,0]
    v_pk_fma_f16 v222, v218, v218, s44 neg_lo:[1,0,0] neg_hi:[1,0,0]
    v_pk_fma_f16 v223, v219, v219, s44 neg_lo:[1,0,0] neg_hi:[1,0,0]
    v_pk_mul_f16 v220, v220, v216
    v_pk_mul_f16 v221, v221, v217
    v_pk_mul_f16 v222, v222, v218
    v_pk_mul_f16 v223, v223, v219
    v_exp_f16 v216, v220
    v_exp_f16 v217, v221
    v_exp_f16 v218, v222
    v_exp_f16 v219, v223
    v_exp_f16_sdwa v216, v220 dst_sel:WORD_1 dst_unused:UNUSED_PRESERVE src0_sel:WORD_1
    v_exp_f16_sdwa v217, v221 dst_sel:WORD_1 dst_unused:UNUSED_PRESERVE src0_sel:WORD_1
    v_exp_f16_sdwa v218, v222 dst_sel:WORD_1 dst_unused:UNUSED_PRESERVE src0_sel:WORD_1
    v_exp_f16_sdwa v219, v223 dst_sel:WORD_1 dst_unused:UNUSED_PRESERVE src0_sel:WORD_1
    v_pk_add_f16 v216, v216, 1.0 op_sel_hi:[1,0]
    v_pk_add_f16 v217, v217, 1.0 op_sel_hi:[1,0]
    v_pk_add_f16 v218, v218, 1.0 op_sel_hi:[1,0]
    v_pk_add_f16 v219, v219, 1.0 op_sel_hi:[1,0]
    v_rcp_f16 v220, v216
    v_rcp_f16 v221, v217
    v_rcp_f16 v222, v218
    v_rcp_f16 v223, v219
    v_rcp_f16_sdwa v216, v216 dst_sel:DWORD dst_unused:UNUSED_PAD src0_sel:WORD_1
    v_rcp_f16_sdwa v217, v217 dst_sel:DWORD dst_unused:UNUSED_PAD src0_sel:WORD_1
    v_rcp_f16_sdwa v218, v218 dst_sel:DWORD dst_unused:UNUSED_PAD src0_sel:WORD_1
    v_rcp_f16_sdwa v219, v219 dst_sel:DWORD dst_unused:UNUSED_PAD src0_sel:WORD_1
    v_fma_mix_f32 v184, v184, v220, 0 op_sel_hi:[0,1,0]
    v_fma_mix_f32 v186, v186, v221, 0 op_sel_hi:[0,1,0]
    v_fma_mix_f32 v188, v188, v222, 0 op_sel_hi:[0,1,0]
    v_fma_mix_f32 v190, v190, v223, 0 op_sel_hi:[0,1,0]
    v_fma_mix_f32 v185, v185, v216, 0 op_sel_hi:[0,1,0]
    v_fma_mix_f32 v187, v187, v217, 0 op_sel_hi:[0,1,0]
    v_fma_mix_f32 v189, v189, v218, 0 op_sel_hi:[0,1,0]
    v_fma_mix_f32 v191, v191, v219, 0 op_sel_hi:[0,1,0]
    v_cvt_pk_bf16_f32 v191, v190, v191
    v_cvt_pk_bf16_f32 v190, v188, v189
    v_cvt_pk_bf16_f32 v189, v186, v187
    v_cvt_pk_bf16_f32 v188, v184, v185
    buffer_store_dwordx4 v[188:191], v4, s[16:19], s48 offen offset:1024 nt
    s_waitcnt vmcnt(15)
    ds_read_b128 v[16:19], v213 offset:2048
    ds_read_b128 v[20:23], v213 offset:2112
    s_waitcnt lgkmcnt(0)
    s_add_u32 m0, s3, 2048
    s_add_u32 s58, s40, 12416
    buffer_load_dwordx4 v2, s[8:11], s58 offen nt lds
    s_add_u32 m0, m0, 1024
    s_add_u32 s58, s58, 6144
    buffer_load_dwordx4 v2, s[8:11], s58 offen nt lds
    v_cvt_pk_f16_f32 v216, v192, v193
    v_cvt_pk_f16_f32 v217, v194, v195
    v_cvt_pk_f16_f32 v218, v196, v197
    v_cvt_pk_f16_f32 v219, v198, v199
    v_pk_fma_f16 v220, v216, v216, s44 neg_lo:[1,0,0] neg_hi:[1,0,0]
    v_pk_fma_f16 v221, v217, v217, s44 neg_lo:[1,0,0] neg_hi:[1,0,0]
    v_pk_fma_f16 v222, v218, v218, s44 neg_lo:[1,0,0] neg_hi:[1,0,0]
    v_pk_fma_f16 v223, v219, v219, s44 neg_lo:[1,0,0] neg_hi:[1,0,0]
    v_pk_mul_f16 v220, v220, v216
    v_pk_mul_f16 v221, v221, v217
    v_pk_mul_f16 v222, v222, v218
    v_pk_mul_f16 v223, v223, v219
    v_exp_f16 v216, v220
    v_exp_f16 v217, v221
    v_exp_f16 v218, v222
    v_exp_f16 v219, v223
    v_exp_f16_sdwa v216, v220 dst_sel:WORD_1 dst_unused:UNUSED_PRESERVE src0_sel:WORD_1
    v_exp_f16_sdwa v217, v221 dst_sel:WORD_1 dst_unused:UNUSED_PRESERVE src0_sel:WORD_1
    v_exp_f16_sdwa v218, v222 dst_sel:WORD_1 dst_unused:UNUSED_PRESERVE src0_sel:WORD_1
    v_exp_f16_sdwa v219, v223 dst_sel:WORD_1 dst_unused:UNUSED_PRESERVE src0_sel:WORD_1
    v_pk_add_f16 v216, v216, 1.0 op_sel_hi:[1,0]
    v_pk_add_f16 v217, v217, 1.0 op_sel_hi:[1,0]
    v_pk_add_f16 v218, v218, 1.0 op_sel_hi:[1,0]
    v_pk_add_f16 v219, v219, 1.0 op_sel_hi:[1,0]
    v_rcp_f16 v220, v216
    v_rcp_f16 v221, v217
    v_rcp_f16 v222, v218
    v_rcp_f16 v223, v219
    v_rcp_f16_sdwa v216, v216 dst_sel:DWORD dst_unused:UNUSED_PAD src0_sel:WORD_1
    v_rcp_f16_sdwa v217, v217 dst_sel:DWORD dst_unused:UNUSED_PAD src0_sel:WORD_1
    v_rcp_f16_sdwa v218, v218 dst_sel:DWORD dst_unused:UNUSED_PAD src0_sel:WORD_1
    v_rcp_f16_sdwa v219, v219 dst_sel:DWORD dst_unused:UNUSED_PAD src0_sel:WORD_1
    v_fma_mix_f32 v192, v192, v220, 0 op_sel_hi:[0,1,0]
    v_fma_mix_f32 v194, v194, v221, 0 op_sel_hi:[0,1,0]
    v_fma_mix_f32 v196, v196, v222, 0 op_sel_hi:[0,1,0]
    v_fma_mix_f32 v198, v198, v223, 0 op_sel_hi:[0,1,0]
    v_fma_mix_f32 v193, v193, v216, 0 op_sel_hi:[0,1,0]
    v_fma_mix_f32 v195, v195, v217, 0 op_sel_hi:[0,1,0]
    v_fma_mix_f32 v197, v197, v218, 0 op_sel_hi:[0,1,0]
    v_fma_mix_f32 v199, v199, v219, 0 op_sel_hi:[0,1,0]
    v_cvt_pk_bf16_f32 v199, v198, v199
    v_cvt_pk_bf16_f32 v198, v196, v197
    v_cvt_pk_bf16_f32 v197, v194, v195
    v_cvt_pk_bf16_f32 v196, v192, v193
    buffer_store_dwordx4 v[196:199], v4, s[16:19], s48 offen offset:2048 nt
    s_waitcnt vmcnt(16)
    ds_read_b128 v[8:11], v213 offset:4096
    ds_read_b128 v[12:15], v213 offset:4160
    s_waitcnt lgkmcnt(0)
    s_add_u32 m0, s3, 4096
    s_add_u32 s58, s40, 12288
    buffer_load_dwordx4 v2, s[8:11], s58 offen nt lds
    s_add_u32 m0, m0, 1024
    s_add_u32 s58, s58, 6144
    buffer_load_dwordx4 v2, s[8:11], s58 offen nt lds
    v_dot2_f32_bf16 v224, v156, v156, 0
    v_dot2_f32_bf16 v225, v158, v158, 0
    v_dot2_f32_bf16 v226, v180, v180, 0
    v_dot2_f32_bf16 v227, v182, v182, 0
    v_dot2c_f32_bf16 v224, v157, v157
    v_dot2c_f32_bf16 v225, v159, v159
    v_dot2c_f32_bf16 v226, v181, v181
    v_dot2c_f32_bf16 v227, v183, v183
    v_dot2c_f32_bf16 v224, v164, v164
    v_dot2c_f32_bf16 v225, v166, v166
    v_dot2c_f32_bf16 v226, v188, v188
    v_dot2c_f32_bf16 v227, v190, v190
    v_dot2c_f32_bf16 v224, v165, v165
    v_dot2c_f32_bf16 v225, v167, v167
    v_dot2c_f32_bf16 v226, v189, v189
    v_dot2c_f32_bf16 v227, v191, v191
    v_dot2c_f32_bf16 v224, v172, v172
    v_dot2c_f32_bf16 v225, v174, v174
    v_dot2c_f32_bf16 v226, v196, v196
    v_dot2c_f32_bf16 v227, v198, v198
    v_dot2c_f32_bf16 v224, v173, v173
    v_dot2c_f32_bf16 v225, v175, v175
    v_dot2c_f32_bf16 v226, v197, v197
    v_dot2c_f32_bf16 v227, v199, v199
    s_add_u32 s37, s42, 1
    v_permlane16_swap_b32 v224, v225
    s_cmp_eq_u32 s37, s53
    v_permlane16_swap_b32 v226, v227
    v_add_f32 v224, v224, v225
    v_add_f32 v226, v226, v227
    s_cselect_b32 s37, s52, s37
    s_nop 0
    v_permlane32_swap_b32 v224, v226
    v_add_f32 v224, v224, v226
    s_set_gpr_idx_on s42, gpr_idx(SRC0,DST)
    s_mov_b32 s42, s37
    v_add_f32 v232, v232, v224
    s_set_gpr_idx_off
    s_branch K1_sw
K1_pretailA:
.p2align 6
K1_tailA:
    s_setprio 3
    s_waitcnt lgkmcnt(0)
    v_mfma_f32_16x16x32_bf16 v[152:155], v[8:11], v[200:203], 0
    ds_read_b64_tr_b16 v[216:217], v3 offset:16384
    v_mfma_f32_16x16x32_bf16 v[152:155], v[12:15], v[204:207], v[152:155]
    ds_read_b64_tr_b16 v[218:219], v3 offset:16896
    v_mfma_f32_16x16x32_bf16 v[152:155], v[16:19], v[208:211], v[152:155]
    ds_read_b64_tr_b16 v[220:221], v3 offset:20480
    v_mfma_f32_16x16x32_bf16 v[152:155], v[20:23], v[212:215], v[152:155]
    ds_read_b64_tr_b16 v[222:223], v3 offset:20992
    v_mfma_f32_16x16x32_bf16 v[160:163], v[56:59], v[200:203], 0
    ds_read_b64_tr_b16 v[224:225], v3 offset:24576
    v_mfma_f32_16x16x32_bf16 v[160:163], v[60:63], v[204:207], v[160:163]
    ds_read_b64_tr_b16 v[226:227], v3 offset:25088
    v_mfma_f32_16x16x32_bf16 v[160:163], v[64:67], v[208:211], v[160:163]
    ds_read_b64_tr_b16 v[228:229], v3 offset:28672
    v_mfma_f32_16x16x32_bf16 v[160:163], v[68:71], v[212:215], v[160:163]
    ds_read_b64_tr_b16 v[230:231], v3 offset:29184
    v_mfma_f32_16x16x32_bf16 v[168:171], v[104:107], v[200:203], 0
    buffer_store_dwordx4 v[156:159], v4, s[16:19], s47 offen offset:0 nt
    v_mfma_f32_16x16x32_bf16 v[168:171], v[108:111], v[204:207], v[168:171]
    s_add_u32 s34, s34, 49152
    v_mfma_f32_16x16x32_bf16 v[168:171], v[112:115], v[208:211], v[168:171]
    s_cmp_eq_u32 s34, 147456
    v_mfma_f32_16x16x32_bf16 v[168:171], v[116:119], v[212:215], v[168:171]
    buffer_store_dwordx4 v[164:167], v4, s[16:19], s47 offen offset:1024 nt
    s_waitcnt lgkmcnt(0)
    v_mfma_f32_16x16x32_bf16 v[152:155], v[24:27], v[216:219], v[152:155]
    ds_read_b64_tr_b16 v[200:201], v3 offset:32768
    v_mfma_f32_16x16x32_bf16 v[152:155], v[28:31], v[220:223], v[152:155]
    ds_read_b64_tr_b16 v[202:203], v3 offset:33280
    v_mfma_f32_16x16x32_bf16 v[152:155], v[32:35], v[224:227], v[152:155]
    ds_read_b64_tr_b16 v[204:205], v3 offset:36864
    v_mfma_f32_16x16x32_bf16 v[152:155], v[36:39], v[228:231], v[152:155]
    ds_read_b64_tr_b16 v[206:207], v3 offset:37376
    v_mfma_f32_16x16x32_bf16 v[160:163], v[72:75], v[216:219], v[160:163]
    ds_read_b64_tr_b16 v[208:209], v3 offset:40960
    v_mfma_f32_16x16x32_bf16 v[160:163], v[76:79], v[220:223], v[160:163]
    ds_read_b64_tr_b16 v[210:211], v3 offset:41472
    v_mfma_f32_16x16x32_bf16 v[160:163], v[80:83], v[224:227], v[160:163]
    ds_read_b64_tr_b16 v[212:213], v3 offset:45056
    v_mfma_f32_16x16x32_bf16 v[160:163], v[84:87], v[228:231], v[160:163]
    ds_read_b64_tr_b16 v[214:215], v3 offset:45568
    v_mfma_f32_16x16x32_bf16 v[168:171], v[120:123], v[216:219], v[168:171]
    s_cselect_b32 s34, 0, s34
    v_mfma_f32_16x16x32_bf16 v[168:171], v[124:127], v[220:223], v[168:171]
    s_add_u32 s32, s32, 1
    v_mfma_f32_16x16x32_bf16 v[168:171], v[128:131], v[224:227], v[168:171]
    buffer_store_dwordx4 v[172:175], v4, s[16:19], s47 offen offset:2048 nt
    v_mfma_f32_16x16x32_bf16 v[168:171], v[132:135], v[228:231], v[168:171]
    v_xor_b32 v3, 32, v3
    s_waitcnt lgkmcnt(0)
    v_mfma_f32_16x16x32_bf16 v[152:155], v[40:43], v[200:203], v[152:155]
    ds_read_b64_tr_b16 v[216:217], v3 offset:0
    v_mfma_f32_16x16x32_bf16 v[152:155], v[44:47], v[204:207], v[152:155]
    ds_read_b64_tr_b16 v[218:219], v3 offset:512
    v_mfma_f32_16x16x32_bf16 v[152:155], v[48:51], v[208:211], v[152:155]
    ds_read_b64_tr_b16 v[220:221], v3 offset:4096
    v_mfma_f32_16x16x32_bf16 v[152:155], v[52:55], v[212:215], v[152:155]
    ds_read_b64_tr_b16 v[222:223], v3 offset:4608
    v_mfma_f32_16x16x32_bf16 v[160:163], v[88:91], v[200:203], v[160:163]
    ds_read_b64_tr_b16 v[224:225], v3 offset:8192
    v_mfma_f32_16x16x32_bf16 v[160:163], v[92:95], v[204:207], v[160:163]
    ds_read_b64_tr_b16 v[226:227], v3 offset:8704
    v_mfma_f32_16x16x32_bf16 v[160:163], v[96:99], v[208:211], v[160:163]
    ds_read_b64_tr_b16 v[228:229], v3 offset:12288
    v_mfma_f32_16x16x32_bf16 v[160:163], v[100:103], v[212:215], v[160:163]
    ds_read_b64_tr_b16 v[230:231], v3 offset:12800
    v_mfma_f32_16x16x32_bf16 v[168:171], v[136:139], v[200:203], v[168:171]
    v_mfma_f32_16x16x32_bf16 v[168:171], v[140:143], v[204:207], v[168:171]
    buffer_store_dwordx4 v[180:183], v4, s[16:19], s48 offen offset:0 nt
    v_mfma_f32_16x16x32_bf16 v[168:171], v[144:147], v[208:211], v[168:171]
    v_mfma_f32_16x16x32_bf16 v[168:171], v[148:151], v[212:215], v[168:171]
    buffer_store_dwordx4 v[188:191], v4, s[16:19], s48 offen offset:1024 nt
    s_waitcnt lgkmcnt(0)
    v_mfma_f32_16x16x32_bf16 v[156:159], v[8:11], v[216:219], 0
    ds_read_b64_tr_b16 v[200:201], v3 offset:16384
    v_mfma_f32_16x16x32_bf16 v[156:159], v[12:15], v[220:223], v[156:159]
    ds_read_b64_tr_b16 v[202:203], v3 offset:16896
    v_mfma_f32_16x16x32_bf16 v[156:159], v[16:19], v[224:227], v[156:159]
    ds_read_b64_tr_b16 v[204:205], v3 offset:20480
    v_mfma_f32_16x16x32_bf16 v[156:159], v[20:23], v[228:231], v[156:159]
    ds_read_b64_tr_b16 v[206:207], v3 offset:20992
    v_mfma_f32_16x16x32_bf16 v[164:167], v[56:59], v[216:219], 0
    ds_read_b64_tr_b16 v[208:209], v3 offset:24576
    v_mfma_f32_16x16x32_bf16 v[164:167], v[60:63], v[220:223], v[164:167]
    ds_read_b64_tr_b16 v[210:211], v3 offset:25088
    v_mfma_f32_16x16x32_bf16 v[164:167], v[64:67], v[224:227], v[164:167]
    ds_read_b64_tr_b16 v[212:213], v3 offset:28672
    v_mfma_f32_16x16x32_bf16 v[164:167], v[68:71], v[228:231], v[164:167]
    ds_read_b64_tr_b16 v[214:215], v3 offset:29184
    v_mfma_f32_16x16x32_bf16 v[172:175], v[104:107], v[216:219], 0
    v_mfma_f32_16x16x32_bf16 v[172:175], v[108:111], v[220:223], v[172:175]
    buffer_store_dwordx4 v[196:199], v4, s[16:19], s48 offen offset:2048 nt
    v_mfma_f32_16x16x32_bf16 v[172:175], v[112:115], v[224:227], v[172:175]
    s_mul_i32 s47, s42, 24576
    v_mfma_f32_16x16x32_bf16 v[172:175], v[116:119], v[228:231], v[172:175]
    s_add_u32 s47, s47, s39
    s_waitcnt lgkmcnt(0)
    v_mfma_f32_16x16x32_bf16 v[156:159], v[24:27], v[200:203], v[156:159]
    ds_read_b64_tr_b16 v[216:217], v3 offset:32768
    v_mfma_f32_16x16x32_bf16 v[156:159], v[28:31], v[204:207], v[156:159]
    ds_read_b64_tr_b16 v[218:219], v3 offset:33280
    v_mfma_f32_16x16x32_bf16 v[156:159], v[32:35], v[208:211], v[156:159]
    ds_read_b64_tr_b16 v[220:221], v3 offset:36864
    v_mfma_f32_16x16x32_bf16 v[156:159], v[36:39], v[212:215], v[156:159]
    ds_read_b64_tr_b16 v[222:223], v3 offset:37376
    v_mfma_f32_16x16x32_bf16 v[164:167], v[72:75], v[200:203], v[164:167]
    ds_read_b64_tr_b16 v[224:225], v3 offset:40960
    v_mfma_f32_16x16x32_bf16 v[164:167], v[76:79], v[204:207], v[164:167]
    ds_read_b64_tr_b16 v[226:227], v3 offset:41472
    v_mfma_f32_16x16x32_bf16 v[164:167], v[80:83], v[208:211], v[164:167]
    ds_read_b64_tr_b16 v[228:229], v3 offset:45056
    v_mfma_f32_16x16x32_bf16 v[164:167], v[84:87], v[212:215], v[164:167]
    ds_read_b64_tr_b16 v[230:231], v3 offset:45568
    v_mfma_f32_16x16x32_bf16 v[172:175], v[120:123], v[200:203], v[172:175]
    v_mfma_f32_16x16x32_bf16 v[172:175], v[124:127], v[204:207], v[172:175]
    s_waitcnt vmcnt(6)
    s_barrier
    v_mfma_f32_16x16x32_bf16 v[172:175], v[128:131], v[208:211], v[172:175]
    v_mfma_f32_16x16x32_bf16 v[172:175], v[132:135], v[212:215], v[172:175]
    v_xor_b32 v3, 96, v3
    s_waitcnt lgkmcnt(0)
    v_mfma_f32_16x16x32_bf16 v[156:159], v[40:43], v[216:219], v[156:159]
    ds_read_b64_tr_b16 v[200:201], v3 offset:0
    v_mfma_f32_16x16x32_bf16 v[156:159], v[44:47], v[220:223], v[156:159]
    ds_read_b64_tr_b16 v[202:203], v3 offset:512
    v_mfma_f32_16x16x32_bf16 v[156:159], v[48:51], v[224:227], v[156:159]
    ds_read_b64_tr_b16 v[204:205], v3 offset:4096
    v_mfma_f32_16x16x32_bf16 v[156:159], v[52:55], v[228:231], v[156:159]
    ds_read_b64_tr_b16 v[206:207], v3 offset:4608
    v_mfma_f32_16x16x32_bf16 v[164:167], v[88:91], v[216:219], v[164:167]
    ds_read_b64_tr_b16 v[208:209], v3 offset:8192
    v_mfma_f32_16x16x32_bf16 v[164:167], v[92:95], v[220:223], v[164:167]
    ds_read_b64_tr_b16 v[210:211], v3 offset:8704
    v_mfma_f32_16x16x32_bf16 v[164:167], v[96:99], v[224:227], v[164:167]
    ds_read_b64_tr_b16 v[212:213], v3 offset:12288
    v_mfma_f32_16x16x32_bf16 v[164:167], v[100:103], v[228:231], v[164:167]
    ds_read_b64_tr_b16 v[214:215], v3 offset:12800
    v_mfma_f32_16x16x32_bf16 v[172:175], v[136:139], v[216:219], v[172:175]
    v_mfma_f32_16x16x32_bf16 v[172:175], v[140:143], v[220:223], v[172:175]
    v_mfma_f32_16x16x32_bf16 v[172:175], v[144:147], v[224:227], v[172:175]
    v_mfma_f32_16x16x32_bf16 v[172:175], v[148:151], v[228:231], v[172:175]
    s_waitcnt lgkmcnt(0)
    v_mfma_f32_16x16x32_bf16 v[176:179], v[8:11], v[200:203], 0
    ds_read_b64_tr_b16 v[216:217], v3 offset:16384
    v_mfma_f32_16x16x32_bf16 v[176:179], v[12:15], v[204:207], v[176:179]
    ds_read_b64_tr_b16 v[218:219], v3 offset:16896
    v_mfma_f32_16x16x32_bf16 v[176:179], v[16:19], v[208:211], v[176:179]
    ds_read_b64_tr_b16 v[220:221], v3 offset:20480
    v_mfma_f32_16x16x32_bf16 v[176:179], v[20:23], v[212:215], v[176:179]
    ds_read_b64_tr_b16 v[222:223], v3 offset:20992
    v_mfma_f32_16x16x32_bf16 v[184:187], v[56:59], v[200:203], 0
    ds_read_b64_tr_b16 v[224:225], v3 offset:24576
    v_mfma_f32_16x16x32_bf16 v[184:187], v[60:63], v[204:207], v[184:187]
    ds_read_b64_tr_b16 v[226:227], v3 offset:25088
    v_mfma_f32_16x16x32_bf16 v[184:187], v[64:67], v[208:211], v[184:187]
    ds_read_b64_tr_b16 v[228:229], v3 offset:28672
    v_mfma_f32_16x16x32_bf16 v[184:187], v[68:71], v[212:215], v[184:187]
    ds_read_b64_tr_b16 v[230:231], v3 offset:29184
    v_mfma_f32_16x16x32_bf16 v[192:195], v[104:107], v[200:203], 0
    v_mfma_f32_16x16x32_bf16 v[192:195], v[108:111], v[204:207], v[192:195]
    v_mfma_f32_16x16x32_bf16 v[192:195], v[112:115], v[208:211], v[192:195]
    v_mfma_f32_16x16x32_bf16 v[192:195], v[116:119], v[212:215], v[192:195]
    s_cmp_eq_u32 s42, s85
    s_waitcnt lgkmcnt(0)
    v_mfma_f32_16x16x32_bf16 v[176:179], v[24:27], v[216:219], v[176:179]
    ds_read_b64_tr_b16 v[200:201], v3 offset:32768
    v_mfma_f32_16x16x32_bf16 v[176:179], v[28:31], v[220:223], v[176:179]
    ds_read_b64_tr_b16 v[202:203], v3 offset:33280
    v_mfma_f32_16x16x32_bf16 v[176:179], v[32:35], v[224:227], v[176:179]
    ds_read_b64_tr_b16 v[204:205], v3 offset:36864
    v_mfma_f32_16x16x32_bf16 v[176:179], v[36:39], v[228:231], v[176:179]
    ds_read_b64_tr_b16 v[206:207], v3 offset:37376
    v_mfma_f32_16x16x32_bf16 v[184:187], v[72:75], v[216:219], v[184:187]
    ds_read_b64_tr_b16 v[208:209], v3 offset:40960
    v_mfma_f32_16x16x32_bf16 v[184:187], v[76:79], v[220:223], v[184:187]
    ds_read_b64_tr_b16 v[210:211], v3 offset:41472
    v_mfma_f32_16x16x32_bf16 v[184:187], v[80:83], v[224:227], v[184:187]
    ds_read_b64_tr_b16 v[212:213], v3 offset:45056
    v_mfma_f32_16x16x32_bf16 v[184:187], v[84:87], v[228:231], v[184:187]
    ds_read_b64_tr_b16 v[214:215], v3 offset:45568
    v_mfma_f32_16x16x32_bf16 v[192:195], v[120:123], v[216:219], v[192:195]
    s_cselect_b32 s16, s26, s24
    v_mfma_f32_16x16x32_bf16 v[192:195], v[124:127], v[220:223], v[192:195]
    s_cselect_b32 s17, s27, s25
    v_mfma_f32_16x16x32_bf16 v[192:195], v[128:131], v[224:227], v[192:195]
    s_cselect_b32 s47, s59, s47
    v_mfma_f32_16x16x32_bf16 v[192:195], v[132:135], v[228:231], v[192:195]
    v_xor_b32 v3, 32, v3
    s_waitcnt lgkmcnt(0)
    v_mfma_f32_16x16x32_bf16 v[176:179], v[40:43], v[200:203], v[176:179]
    ds_read_b64_tr_b16 v[216:217], v3 offset:0
    v_mfma_f32_16x16x32_bf16 v[176:179], v[44:47], v[204:207], v[176:179]
    ds_read_b64_tr_b16 v[218:219], v3 offset:512
    v_mfma_f32_16x16x32_bf16 v[176:179], v[48:51], v[208:211], v[176:179]
    ds_read_b64_tr_b16 v[220:221], v3 offset:4096
    v_mfma_f32_16x16x32_bf16 v[176:179], v[52:55], v[212:215], v[176:179]
    ds_read_b64_tr_b16 v[222:223], v3 offset:4608
    v_mfma_f32_16x16x32_bf16 v[184:187], v[88:91], v[200:203], v[184:187]
    ds_read_b64_tr_b16 v[224:225], v3 offset:8192
    v_mfma_f32_16x16x32_bf16 v[184:187], v[92:95], v[204:207], v[184:187]
    ds_read_b64_tr_b16 v[226:227], v3 offset:8704
    v_mfma_f32_16x16x32_bf16 v[184:187], v[96:99], v[208:211], v[184:187]
    ds_read_b64_tr_b16 v[228:229], v3 offset:12288
    v_mfma_f32_16x16x32_bf16 v[184:187], v[100:103], v[212:215], v[184:187]
    ds_read_b64_tr_b16 v[230:231], v3 offset:12800
    v_mfma_f32_16x16x32_bf16 v[192:195], v[136:139], v[200:203], v[192:195]
    s_mov_b32 s37, 113246208
    v_mfma_f32_16x16x32_bf16 v[192:195], v[140:143], v[204:207], v[192:195]
    s_cselect_b32 s18, s37, 446693376
    v_mfma_f32_16x16x32_bf16 v[192:195], v[144:147], v[208:211], v[192:195]
    s_add_u32 s48, s47, 12288
    v_mfma_f32_16x16x32_bf16 v[192:195], v[148:151], v[212:215], v[192:195]
    s_waitcnt lgkmcnt(0)
    v_mfma_f32_16x16x32_bf16 v[180:183], v[8:11], v[216:219], 0
    ds_read_b64_tr_b16 v[200:201], v3 offset:16384
    v_mfma_f32_16x16x32_bf16 v[180:183], v[12:15], v[220:223], v[180:183]
    ds_read_b64_tr_b16 v[202:203], v3 offset:16896
    v_mfma_f32_16x16x32_bf16 v[180:183], v[16:19], v[224:227], v[180:183]
    ds_read_b64_tr_b16 v[204:205], v3 offset:20480
    v_mfma_f32_16x16x32_bf16 v[180:183], v[20:23], v[228:231], v[180:183]
    ds_read_b64_tr_b16 v[206:207], v3 offset:20992
    v_mfma_f32_16x16x32_bf16 v[188:191], v[56:59], v[216:219], 0
    ds_read_b64_tr_b16 v[208:209], v3 offset:24576
    v_mfma_f32_16x16x32_bf16 v[188:191], v[60:63], v[220:223], v[188:191]
    ds_read_b64_tr_b16 v[210:211], v3 offset:25088
    v_mfma_f32_16x16x32_bf16 v[188:191], v[64:67], v[224:227], v[188:191]
    ds_read_b64_tr_b16 v[212:213], v3 offset:28672
    v_mfma_f32_16x16x32_bf16 v[188:191], v[68:71], v[228:231], v[188:191]
    ds_read_b64_tr_b16 v[214:215], v3 offset:29184
    v_mfma_f32_16x16x32_bf16 v[196:199], v[104:107], v[216:219], 0
    v_mfma_f32_16x16x32_bf16 v[196:199], v[108:111], v[220:223], v[196:199]
    v_mfma_f32_16x16x32_bf16 v[196:199], v[112:115], v[224:227], v[196:199]
    v_mfma_f32_16x16x32_bf16 v[196:199], v[116:119], v[228:231], v[196:199]
    s_waitcnt lgkmcnt(0)
    v_mfma_f32_16x16x32_bf16 v[180:183], v[24:27], v[200:203], v[180:183]
    ds_read_b64_tr_b16 v[216:217], v3 offset:32768
    v_mfma_f32_16x16x32_bf16 v[180:183], v[28:31], v[204:207], v[180:183]
    ds_read_b64_tr_b16 v[218:219], v3 offset:33280
    v_mfma_f32_16x16x32_bf16 v[180:183], v[32:35], v[208:211], v[180:183]
    ds_read_b64_tr_b16 v[220:221], v3 offset:36864
    v_mfma_f32_16x16x32_bf16 v[180:183], v[36:39], v[212:215], v[180:183]
    ds_read_b64_tr_b16 v[222:223], v3 offset:37376
    v_mfma_f32_16x16x32_bf16 v[188:191], v[72:75], v[200:203], v[188:191]
    ds_read_b64_tr_b16 v[224:225], v3 offset:40960
    v_mfma_f32_16x16x32_bf16 v[188:191], v[76:79], v[204:207], v[188:191]
    ds_read_b64_tr_b16 v[226:227], v3 offset:41472
    v_mfma_f32_16x16x32_bf16 v[188:191], v[80:83], v[208:211], v[188:191]
    ds_read_b64_tr_b16 v[228:229], v3 offset:45056
    v_mfma_f32_16x16x32_bf16 v[188:191], v[84:87], v[212:215], v[188:191]
    ds_read_b64_tr_b16 v[230:231], v3 offset:45568
    v_mfma_f32_16x16x32_bf16 v[196:199], v[120:123], v[200:203], v[196:199]
    v_mfma_f32_16x16x32_bf16 v[196:199], v[124:127], v[204:207], v[196:199]
    v_mfma_f32_16x16x32_bf16 v[196:199], v[128:131], v[208:211], v[196:199]
    v_mfma_f32_16x16x32_bf16 v[196:199], v[132:135], v[212:215], v[196:199]
    s_waitcnt lgkmcnt(0)
    v_mfma_f32_16x16x32_bf16 v[180:183], v[40:43], v[216:219], v[180:183]
    v_mfma_f32_16x16x32_bf16 v[180:183], v[44:47], v[220:223], v[180:183]
    v_mfma_f32_16x16x32_bf16 v[180:183], v[48:51], v[224:227], v[180:183]
    v_mfma_f32_16x16x32_bf16 v[180:183], v[52:55], v[228:231], v[180:183]
    v_mfma_f32_16x16x32_bf16 v[188:191], v[88:91], v[216:219], v[188:191]
    v_mfma_f32_16x16x32_bf16 v[188:191], v[92:95], v[220:223], v[188:191]
    v_mfma_f32_16x16x32_bf16 v[188:191], v[96:99], v[224:227], v[188:191]
    v_mfma_f32_16x16x32_bf16 v[188:191], v[100:103], v[228:231], v[188:191]
    v_mfma_f32_16x16x32_bf16 v[196:199], v[136:139], v[216:219], v[196:199]
    v_mfma_f32_16x16x32_bf16 v[196:199], v[140:143], v[220:223], v[196:199]
    v_mfma_f32_16x16x32_bf16 v[196:199], v[144:147], v[224:227], v[196:199]
    v_mfma_f32_16x16x32_bf16 v[196:199], v[148:151], v[228:231], v[196:199]
    s_setprio 0
    s_nop 0
    v_cvt_pk_f16_f32 v216, v152, v153
    v_cvt_pk_f16_f32 v217, v154, v155
    v_cvt_pk_f16_f32 v218, v156, v157
    v_cvt_pk_f16_f32 v219, v158, v159
    v_pk_fma_f16 v220, v216, v216, s44 neg_lo:[1,0,0] neg_hi:[1,0,0]
    v_pk_fma_f16 v221, v217, v217, s44 neg_lo:[1,0,0] neg_hi:[1,0,0]
    v_pk_fma_f16 v222, v218, v218, s44 neg_lo:[1,0,0] neg_hi:[1,0,0]
    v_pk_fma_f16 v223, v219, v219, s44 neg_lo:[1,0,0] neg_hi:[1,0,0]
    v_pk_mul_f16 v220, v220, v216
    v_pk_mul_f16 v221, v221, v217
    v_pk_mul_f16 v222, v222, v218
    v_pk_mul_f16 v223, v223, v219
    v_exp_f16 v216, v220
    v_exp_f16 v217, v221
    v_exp_f16 v218, v222
    v_exp_f16 v219, v223
    v_exp_f16_sdwa v216, v220 dst_sel:WORD_1 dst_unused:UNUSED_PRESERVE src0_sel:WORD_1
    v_exp_f16_sdwa v217, v221 dst_sel:WORD_1 dst_unused:UNUSED_PRESERVE src0_sel:WORD_1
    v_exp_f16_sdwa v218, v222 dst_sel:WORD_1 dst_unused:UNUSED_PRESERVE src0_sel:WORD_1
    v_exp_f16_sdwa v219, v223 dst_sel:WORD_1 dst_unused:UNUSED_PRESERVE src0_sel:WORD_1
    v_pk_add_f16 v216, v216, 1.0 op_sel_hi:[1,0]
    v_pk_add_f16 v217, v217, 1.0 op_sel_hi:[1,0]
    v_pk_add_f16 v218, v218, 1.0 op_sel_hi:[1,0]
    v_pk_add_f16 v219, v219, 1.0 op_sel_hi:[1,0]
    v_rcp_f16 v220, v216
    v_rcp_f16 v221, v217
    v_rcp_f16 v222, v218
    v_rcp_f16 v223, v219
    v_rcp_f16_sdwa v216, v216 dst_sel:DWORD dst_unused:UNUSED_PAD src0_sel:WORD_1
    v_rcp_f16_sdwa v217, v217 dst_sel:DWORD dst_unused:UNUSED_PAD src0_sel:WORD_1
    v_rcp_f16_sdwa v218, v218 dst_sel:DWORD dst_unused:UNUSED_PAD src0_sel:WORD_1
    v_rcp_f16_sdwa v219, v219 dst_sel:DWORD dst_unused:UNUSED_PAD src0_sel:WORD_1
    v_fma_mix_f32 v152, v152, v220, 0 op_sel_hi:[0,1,0]
    v_fma_mix_f32 v154, v154, v221, 0 op_sel_hi:[0,1,0]
    v_fma_mix_f32 v156, v156, v222, 0 op_sel_hi:[0,1,0]
    v_fma_mix_f32 v158, v158, v223, 0 op_sel_hi:[0,1,0]
    v_fma_mix_f32 v153, v153, v216, 0 op_sel_hi:[0,1,0]
    v_fma_mix_f32 v155, v155, v217, 0 op_sel_hi:[0,1,0]
    v_fma_mix_f32 v157, v157, v218, 0 op_sel_hi:[0,1,0]
    v_fma_mix_f32 v159, v159, v219, 0 op_sel_hi:[0,1,0]
    v_cvt_pk_bf16_f32 v159, v158, v159
    v_cvt_pk_bf16_f32 v158, v156, v157
    v_cvt_pk_bf16_f32 v157, v154, v155
    v_cvt_pk_bf16_f32 v156, v152, v153
    v_cvt_pk_f16_f32 v216, v160, v161
    v_cvt_pk_f16_f32 v217, v162, v163
    v_cvt_pk_f16_f32 v218, v164, v165
    v_cvt_pk_f16_f32 v219, v166, v167
    v_pk_fma_f16 v220, v216, v216, s44 neg_lo:[1,0,0] neg_hi:[1,0,0]
    v_pk_fma_f16 v221, v217, v217, s44 neg_lo:[1,0,0] neg_hi:[1,0,0]
    v_pk_fma_f16 v222, v218, v218, s44 neg_lo:[1,0,0] neg_hi:[1,0,0]
    v_pk_fma_f16 v223, v219, v219, s44 neg_lo:[1,0,0] neg_hi:[1,0,0]
    v_pk_mul_f16 v220, v220, v216
    v_pk_mul_f16 v221, v221, v217
    v_pk_mul_f16 v222, v222, v218
    v_pk_mul_f16 v223, v223, v219
    v_exp_f16 v216, v220
    v_exp_f16 v217, v221
    v_exp_f16 v218, v222
    v_exp_f16 v219, v223
    v_exp_f16_sdwa v216, v220 dst_sel:WORD_1 dst_unused:UNUSED_PRESERVE src0_sel:WORD_1
    v_exp_f16_sdwa v217, v221 dst_sel:WORD_1 dst_unused:UNUSED_PRESERVE src0_sel:WORD_1
    v_exp_f16_sdwa v218, v222 dst_sel:WORD_1 dst_unused:UNUSED_PRESERVE src0_sel:WORD_1
    v_exp_f16_sdwa v219, v223 dst_sel:WORD_1 dst_unused:UNUSED_PRESERVE src0_sel:WORD_1
    v_pk_add_f16 v216, v216, 1.0 op_sel_hi:[1,0]
    v_pk_add_f16 v217, v217, 1.0 op_sel_hi:[1,0]
    v_pk_add_f16 v218, v218, 1.0 op_sel_hi:[1,0]
    v_pk_add_f16 v219, v219, 1.0 op_sel_hi:[1,0]
    v_rcp_f16 v220, v216
    v_rcp_f16 v221, v217
    v_rcp_f16 v222, v218
    v_rcp_f16 v223, v219
    v_rcp_f16_sdwa v216, v216 dst_sel:DWORD dst_unused:UNUSED_PAD src0_sel:WORD_1
    v_rcp_f16_sdwa v217, v217 dst_sel:DWORD dst_unused:UNUSED_PAD src0_sel:WORD_1
    v_rcp_f16_sdwa v218, v218 dst_sel:DWORD dst_unused:UNUSED_PAD src0_sel:WORD_1
    v_rcp_f16_sdwa v219, v219 dst_sel:DWORD dst_unused:UNUSED_PAD src0_sel:WORD_1
    v_fma_mix_f32 v160, v160, v220, 0 op_sel_hi:[0,1,0]
    v_fma_mix_f32 v162, v162, v221, 0 op_sel_hi:[0,1,0]
    v_fma_mix_f32 v164, v164, v222, 0 op_sel_hi:[0,1,0]
    v_fma_mix_f32 v166, v166, v223, 0 op_sel_hi:[0,1,0]
    v_fma_mix_f32 v161, v161, v216, 0 op_sel_hi:[0,1,0]
    v_fma_mix_f32 v163, v163, v217, 0 op_sel_hi:[0,1,0]
    v_fma_mix_f32 v165, v165, v218, 0 op_sel_hi:[0,1,0]
    v_fma_mix_f32 v167, v167, v219, 0 op_sel_hi:[0,1,0]
    v_cvt_pk_bf16_f32 v167, v166, v167
    v_cvt_pk_bf16_f32 v166, v164, v165
    v_cvt_pk_bf16_f32 v165, v162, v163
    v_cvt_pk_bf16_f32 v164, v160, v161
    s_setprio 1
    s_nop 0
    v_cvt_pk_f16_f32 v216, v168, v169
    v_cvt_pk_f16_f32 v217, v170, v171
    v_cvt_pk_f16_f32 v218, v172, v173
    v_cvt_pk_f16_f32 v219, v174, v175
    v_pk_fma_f16 v220, v216, v216, s44 neg_lo:[1,0,0] neg_hi:[1,0,0]
    v_pk_fma_f16 v221, v217, v217, s44 neg_lo:[1,0,0] neg_hi:[1,0,0]
    v_pk_fma_f16 v222, v218, v218, s44 neg_lo:[1,0,0] neg_hi:[1,0,0]
    v_pk_fma_f16 v223, v219, v219, s44 neg_lo:[1,0,0] neg_hi:[1,0,0]
    v_pk_mul_f16 v220, v220, v216
    v_pk_mul_f16 v221, v221, v217
    v_pk_mul_f16 v222, v222, v218
    v_pk_mul_f16 v223, v223, v219
    v_exp_f16 v216, v220
    v_exp_f16 v217, v221
    v_exp_f16 v218, v222
    v_exp_f16 v219, v223
    v_exp_f16_sdwa v216, v220 dst_sel:WORD_1 dst_unused:UNUSED_PRESERVE src0_sel:WORD_1
    v_exp_f16_sdwa v217, v221 dst_sel:WORD_1 dst_unused:UNUSED_PRESERVE src0_sel:WORD_1
    v_exp_f16_sdwa v218, v222 dst_sel:WORD_1 dst_unused:UNUSED_PRESERVE src0_sel:WORD_1
    v_exp_f16_sdwa v219, v223 dst_sel:WORD_1 dst_unused:UNUSED_PRESERVE src0_sel:WORD_1
    v_pk_add_f16 v216, v216, 1.0 op_sel_hi:[1,0]
    v_pk_add_f16 v217, v217, 1.0 op_sel_hi:[1,0]
    v_pk_add_f16 v218, v218, 1.0 op_sel_hi:[1,0]
    v_pk_add_f16 v219, v219, 1.0 op_sel_hi:[1,0]
    v_rcp_f16 v220, v216
    v_rcp_f16 v221, v217
    v_rcp_f16 v222, v218
    v_rcp_f16 v223, v219
    v_rcp_f16_sdwa v216, v216 dst_sel:DWORD dst_unused:UNUSED_PAD src0_sel:WORD_1
    v_rcp_f16_sdwa v217, v217 dst_sel:DWORD dst_unused:UNUSED_PAD src0_sel:WORD_1
    v_rcp_f16_sdwa v218, v218 dst_sel:DWORD dst_unused:UNUSED_PAD src0_sel:WORD_1
    v_rcp_f16_sdwa v219, v219 dst_sel:DWORD dst_unused:UNUSED_PAD src0_sel:WORD_1
    v_fma_mix_f32 v168, v168, v220, 0 op_sel_hi:[0,1,0]
    v_fma_mix_f32 v170, v170, v221, 0 op_sel_hi:[0,1,0]
    v_fma_mix_f32 v172, v172, v222, 0 op_sel_hi:[0,1,0]
    v_fma_mix_f32 v174, v174, v223, 0 op_sel_hi:[0,1,0]
    v_fma_mix_f32 v169, v169, v216, 0 op_sel_hi:[0,1,0]
    v_fma_mix_f32 v171, v171, v217, 0 op_sel_hi:[0,1,0]
    v_fma_mix_f32 v173, v173, v218, 0 op_sel_hi:[0,1,0]
    v_fma_mix_f32 v175, v175, v219, 0 op_sel_hi:[0,1,0]
    v_cvt_pk_bf16_f32 v175, v174, v175
    v_cvt_pk_bf16_f32 v174, v172, v173
    v_cvt_pk_bf16_f32 v173, v170, v171
    v_cvt_pk_bf16_f32 v172, v168, v169
    v_cvt_pk_f16_f32 v216, v176, v177
    v_cvt_pk_f16_f32 v217, v178, v179
    v_cvt_pk_f16_f32 v218, v180, v181
    v_cvt_pk_f16_f32 v219, v182, v183
    v_pk_fma_f16 v220, v216, v216, s44 neg_lo:[1,0,0] neg_hi:[1,0,0]
    v_pk_fma_f16 v221, v217, v217, s44 neg_lo:[1,0,0] neg_hi:[1,0,0]
    v_pk_fma_f16 v222, v218, v218, s44 neg_lo:[1,0,0] neg_hi:[1,0,0]
    v_pk_fma_f16 v223, v219, v219, s44 neg_lo:[1,0,0] neg_hi:[1,0,0]
    v_pk_mul_f16 v220, v220, v216
    v_pk_mul_f16 v221, v221, v217
    v_pk_mul_f16 v222, v222, v218
    v_pk_mul_f16 v223, v223, v219
    v_exp_f16 v216, v220
    v_exp_f16 v217, v221
    v_exp_f16 v218, v222
    v_exp_f16 v219, v223
    v_exp_f16_sdwa v216, v220 dst_sel:WORD_1 dst_unused:UNUSED_PRESERVE src0_sel:WORD_1
    v_exp_f16_sdwa v217, v221 dst_sel:WORD_1 dst_unused:UNUSED_PRESERVE src0_sel:WORD_1
    v_exp_f16_sdwa v218, v222 dst_sel:WORD_1 dst_unused:UNUSED_PRESERVE src0_sel:WORD_1
    v_exp_f16_sdwa v219, v223 dst_sel:WORD_1 dst_unused:UNUSED_PRESERVE src0_sel:WORD_1
    v_pk_add_f16 v216, v216, 1.0 op_sel_hi:[1,0]
    v_pk_add_f16 v217, v217, 1.0 op_sel_hi:[1,0]
    v_pk_add_f16 v218, v218, 1.0 op_sel_hi:[1,0]
    v_pk_add_f16 v219, v219, 1.0 op_sel_hi:[1,0]
    v_rcp_f16 v220, v216
    v_rcp_f16 v221, v217
    v_rcp_f16 v222, v218
    v_rcp_f16 v223, v219
    v_rcp_f16_sdwa v216, v216 dst_sel:DWORD dst_unused:UNUSED_PAD src0_sel:WORD_1
    v_rcp_f16_sdwa v217, v217 dst_sel:DWORD dst_unused:UNUSED_PAD src0_sel:WORD_1
    v_rcp_f16_sdwa v218, v218 dst_sel:DWORD dst_unused:UNUSED_PAD src0_sel:WORD_1
    v_rcp_f16_sdwa v219, v219 dst_sel:DWORD dst_unused:UNUSED_PAD src0_sel:WORD_1
    v_fma_mix_f32 v176, v176, v220, 0 op_sel_hi:[0,1,0]
    v_fma_mix_f32 v178, v178, v221, 0 op_sel_hi:[0,1,0]
    v_fma_mix_f32 v180, v180, v222, 0 op_sel_hi:[0,1,0]
    v_fma_mix_f32 v182, v182, v223, 0 op_sel_hi:[0,1,0]
    v_fma_mix_f32 v177, v177, v216, 0 op_sel_hi:[0,1,0]
    v_fma_mix_f32 v179, v179, v217, 0 op_sel_hi:[0,1,0]
    v_fma_mix_f32 v181, v181, v218, 0 op_sel_hi:[0,1,0]
    v_fma_mix_f32 v183, v183, v219, 0 op_sel_hi:[0,1,0]
    v_cvt_pk_bf16_f32 v183, v182, v183
    v_cvt_pk_bf16_f32 v182, v180, v181
    v_cvt_pk_bf16_f32 v181, v178, v179
    v_cvt_pk_bf16_f32 v180, v176, v177
    v_cvt_pk_f16_f32 v216, v184, v185
    v_cvt_pk_f16_f32 v217, v186, v187
    v_cvt_pk_f16_f32 v218, v188, v189
    v_cvt_pk_f16_f32 v219, v190, v191
    v_pk_fma_f16 v220, v216, v216, s44 neg_lo:[1,0,0] neg_hi:[1,0,0]
    v_pk_fma_f16 v221, v217, v217, s44 neg_lo:[1,0,0] neg_hi:[1,0,0]
    v_pk_fma_f16 v222, v218, v218, s44 neg_lo:[1,0,0] neg_hi:[1,0,0]
    v_pk_fma_f16 v223, v219, v219, s44 neg_lo:[1,0,0] neg_hi:[1,0,0]
    v_pk_mul_f16 v220, v220, v216
    v_pk_mul_f16 v221, v221, v217
    v_pk_mul_f16 v222, v222, v218
    v_pk_mul_f16 v223, v223, v219
    v_exp_f16 v216, v220
    v_exp_f16 v217, v221
    v_exp_f16 v218, v222
    v_exp_f16 v219, v223
    v_exp_f16_sdwa v216, v220 dst_sel:WORD_1 dst_unused:UNUSED_PRESERVE src0_sel:WORD_1
    v_exp_f16_sdwa v217, v221 dst_sel:WORD_1 dst_unused:UNUSED_PRESERVE src0_sel:WORD_1
    v_exp_f16_sdwa v218, v222 dst_sel:WORD_1 dst_unused:UNUSED_PRESERVE src0_sel:WORD_1
    v_exp_f16_sdwa v219, v223 dst_sel:WORD_1 dst_unused:UNUSED_PRESERVE src0_sel:WORD_1
    v_pk_add_f16 v216, v216, 1.0 op_sel_hi:[1,0]
    v_pk_add_f16 v217, v217, 1.0 op_sel_hi:[1,0]
    v_pk_add_f16 v218, v218, 1.0 op_sel_hi:[1,0]
    v_pk_add_f16 v219, v219, 1.0 op_sel_hi:[1,0]
    v_rcp_f16 v220, v216
    v_rcp_f16 v221, v217
    v_rcp_f16 v222, v218
    v_rcp_f16 v223, v219
    v_rcp_f16_sdwa v216, v216 dst_sel:DWORD dst_unused:UNUSED_PAD src0_sel:WORD_1
    v_rcp_f16_sdwa v217, v217 dst_sel:DWORD dst_unused:UNUSED_PAD src0_sel:WORD_1
    v_rcp_f16_sdwa v218, v218 dst_sel:DWORD dst_unused:UNUSED_PAD src0_sel:WORD_1
    v_rcp_f16_sdwa v219, v219 dst_sel:DWORD dst_unused:UNUSED_PAD src0_sel:WORD_1
    v_fma_mix_f32 v184, v184, v220, 0 op_sel_hi:[0,1,0]
    v_fma_mix_f32 v186, v186, v221, 0 op_sel_hi:[0,1,0]
    v_fma_mix_f32 v188, v188, v222, 0 op_sel_hi:[0,1,0]
    v_fma_mix_f32 v190, v190, v223, 0 op_sel_hi:[0,1,0]
    v_fma_mix_f32 v185, v185, v216, 0 op_sel_hi:[0,1,0]
    v_fma_mix_f32 v187, v187, v217, 0 op_sel_hi:[0,1,0]
    v_fma_mix_f32 v189, v189, v218, 0 op_sel_hi:[0,1,0]
    v_fma_mix_f32 v191, v191, v219, 0 op_sel_hi:[0,1,0]
    v_cvt_pk_bf16_f32 v191, v190, v191
    v_cvt_pk_bf16_f32 v190, v188, v189
    v_cvt_pk_bf16_f32 v189, v186, v187
    v_cvt_pk_bf16_f32 v188, v184, v185
    v_cvt_pk_f16_f32 v216, v192, v193
    v_cvt_pk_f16_f32 v217, v194, v195
    v_cvt_pk_f16_f32 v218, v196, v197
    v_cvt_pk_f16_f32 v219, v198, v199
    v_pk_fma_f16 v220, v216, v216, s44 neg_lo:[1,0,0] neg_hi:[1,0,0]
    v_pk_fma_f16 v221, v217, v217, s44 neg_lo:[1,0,0] neg_hi:[1,0,0]
    v_pk_fma_f16 v222, v218, v218, s44 neg_lo:[1,0,0] neg_hi:[1,0,0]
    v_pk_fma_f16 v223, v219, v219, s44 neg_lo:[1,0,0] neg_hi:[1,0,0]
    v_pk_mul_f16 v220, v220, v216
    v_pk_mul_f16 v221, v221, v217
    v_pk_mul_f16 v222, v222, v218
    v_pk_mul_f16 v223, v223, v219
    v_exp_f16 v216, v220
    v_exp_f16 v217, v221
    v_exp_f16 v218, v222
    v_exp_f16 v219, v223
    v_exp_f16_sdwa v216, v220 dst_sel:WORD_1 dst_unused:UNUSED_PRESERVE src0_sel:WORD_1
    v_exp_f16_sdwa v217, v221 dst_sel:WORD_1 dst_unused:UNUSED_PRESERVE src0_sel:WORD_1
    v_exp_f16_sdwa v218, v222 dst_sel:WORD_1 dst_unused:UNUSED_PRESERVE src0_sel:WORD_1
    v_exp_f16_sdwa v219, v223 dst_sel:WORD_1 dst_unused:UNUSED_PRESERVE src0_sel:WORD_1
    v_pk_add_f16 v216, v216, 1.0 op_sel_hi:[1,0]
    v_pk_add_f16 v217, v217, 1.0 op_sel_hi:[1,0]
    v_pk_add_f16 v218, v218, 1.0 op_sel_hi:[1,0]
    v_pk_add_f16 v219, v219, 1.0 op_sel_hi:[1,0]
    v_rcp_f16 v220, v216
    v_rcp_f16 v221, v217
    v_rcp_f16 v222, v218
    v_rcp_f16 v223, v219
    v_rcp_f16_sdwa v216, v216 dst_sel:DWORD dst_unused:UNUSED_PAD src0_sel:WORD_1
    v_rcp_f16_sdwa v217, v217 dst_sel:DWORD dst_unused:UNUSED_PAD src0_sel:WORD_1
    v_rcp_f16_sdwa v218, v218 dst_sel:DWORD dst_unused:UNUSED_PAD src0_sel:WORD_1
    v_rcp_f16_sdwa v219, v219 dst_sel:DWORD dst_unused:UNUSED_PAD src0_sel:WORD_1
    v_fma_mix_f32 v192, v192, v220, 0 op_sel_hi:[0,1,0]
    v_fma_mix_f32 v194, v194, v221, 0 op_sel_hi:[0,1,0]
    v_fma_mix_f32 v196, v196, v222, 0 op_sel_hi:[0,1,0]
    v_fma_mix_f32 v198, v198, v223, 0 op_sel_hi:[0,1,0]
    v_fma_mix_f32 v193, v193, v216, 0 op_sel_hi:[0,1,0]
    v_fma_mix_f32 v195, v195, v217, 0 op_sel_hi:[0,1,0]
    v_fma_mix_f32 v197, v197, v218, 0 op_sel_hi:[0,1,0]
    v_fma_mix_f32 v199, v199, v219, 0 op_sel_hi:[0,1,0]
    v_cvt_pk_bf16_f32 v199, v198, v199
    v_cvt_pk_bf16_f32 v198, v196, v197
    v_cvt_pk_bf16_f32 v197, v194, v195
    v_cvt_pk_bf16_f32 v196, v192, v193
    v_dot2_f32_bf16 v224, v156, v156, 0
    v_dot2_f32_bf16 v225, v158, v158, 0
    v_dot2_f32_bf16 v226, v180, v180, 0
    v_dot2_f32_bf16 v227, v182, v182, 0
    v_add_u32 v3, s34, v7
    ds_read_b64_tr_b16 v[200:201], v3 offset:0
    ds_read_b64_tr_b16 v[202:203], v3 offset:512
    v_dot2c_f32_bf16 v224, v157, v157
    v_dot2c_f32_bf16 v225, v159, v159
    v_dot2c_f32_bf16 v226, v181, v181
    v_dot2c_f32_bf16 v227, v183, v183
    ds_read_b64_tr_b16 v[204:205], v3 offset:4096
    ds_read_b64_tr_b16 v[206:207], v3 offset:4608
    v_dot2c_f32_bf16 v224, v164, v164
    v_dot2c_f32_bf16 v225, v166, v166
    v_dot2c_f32_bf16 v226, v188, v188
    v_dot2c_f32_bf16 v227, v190, v190
    ds_read_b64_tr_b16 v[208:209], v3 offset:8192
    ds_read_b64_tr_b16 v[210:211], v3 offset:8704
    v_dot2c_f32_bf16 v224, v165, v165
    v_dot2c_f32_bf16 v225, v167, v167
    v_dot2c_f32_bf16 v226, v189, v189
    v_dot2c_f32_bf16 v227, v191, v191
    ds_read_b64_tr_b16 v[212:213], v3 offset:12288
    ds_read_b64_tr_b16 v[214:215], v3 offset:12800
    v_dot2c_f32_bf16 v224, v172, v172
    v_dot2c_f32_bf16 v225, v174, v174
    v_dot2c_f32_bf16 v226, v196, v196
    v_dot2c_f32_bf16 v227, v198, v198
    v_dot2c_f32_bf16 v224, v173, v173
    v_dot2c_f32_bf16 v225, v175, v175
    v_dot2c_f32_bf16 v226, v197, v197
    v_dot2c_f32_bf16 v227, v199, v199
    s_add_u32 s37, s42, 1
    v_permlane16_swap_b32 v224, v225
    s_cmp_eq_u32 s37, s53
    v_permlane16_swap_b32 v226, v227
    v_add_f32 v224, v224, v225
    v_add_f32 v226, v226, v227
    s_cselect_b32 s37, s52, s37
    s_nop 0
    v_permlane32_swap_b32 v224, v226
    v_add_f32 v224, v224, v226
    s_set_gpr_idx_on s42, gpr_idx(SRC0,DST)
    s_mov_b32 s42, s37
    v_add_f32 v232, v232, v224
    s_set_gpr_idx_off
    s_cmp_lg_u32 s32, 36
    s_cbranch_scc1 K1_tailA
    s_branch K1_fin
.p2align 6
K1_regB:
    s_setprio 3
    s_waitcnt lgkmcnt(0)
    v_mfma_f32_16x16x32_bf16 v[152:155], v[8:11], v[200:203], 0
    ds_read_b64_tr_b16 v[216:217], v3 offset:16384
    v_mfma_f32_16x16x32_bf16 v[152:155], v[12:15], v[204:207], v[152:155]
    ds_read_b64_tr_b16 v[218:219], v3 offset:16896
    v_mfma_f32_16x16x32_bf16 v[152:155], v[16:19], v[208:211], v[152:155]
    ds_read_b64_tr_b16 v[220:221], v3 offset:20480
    v_mfma_f32_16x16x32_bf16 v[152:155], v[20:23], v[212:215], v[152:155]
    ds_read_b64_tr_b16 v[222:223], v3 offset:20992
    v_mfma_f32_16x16x32_bf16 v[160:163], v[56:59], v[200:203], 0
    ds_read_b64_tr_b16 v[224:225], v3 offset:24576
    v_mfma_f32_16x16x32_bf16 v[160:163], v[60:63], v[204:207], v[160:163]
    ds_read_b64_tr_b16 v[226:227], v3 offset:25088
    v_mfma_f32_16x16x32_bf16 v[160:163], v[64:67], v[208:211], v[160:163]
    ds_read_b64_tr_b16 v[228:229], v3 offset:28672
    v_mfma_f32_16x16x32_bf16 v[160:163], v[68:71], v[212:215], v[160:163]
    ds_read_b64_tr_b16 v[230:231], v3 offset:29184
    v_mfma_f32_16x16x32_bf16 v[168:171], v[104:107], v[200:203], 0
    buffer_store_dwordx4 v[156:159], v4, s[16:19], s47 offen offset:0
    v_mfma_f32_16x16x32_bf16 v[168:171], v[108:111], v[204:207], v[168:171]
    s_mov_b32 m0, s35
    v_mfma_f32_16x16x32_bf16 v[168:171], v[112:115], v[208:211], v[168:171]
    s_mov_b32 s36, s45
    v_mfma_f32_16x16x32_bf16 v[168:171], v[116:119], v[212:215], v[168:171]
    buffer_load_dwordx4 v1, s[12:15], s36 offen lds
    s_waitcnt lgkmcnt(0)
    v_mfma_f32_16x16x32_bf16 v[152:155], v[24:27], v[216:219], v[152:155]
    ds_read_b64_tr_b16 v[200:201], v3 offset:32768
    v_mfma_f32_16x16x32_bf16 v[152:155], v[28:31], v[220:223], v[152:155]
    ds_read_b64_tr_b16 v[202:203], v3 offset:33280
    v_mfma_f32_16x16x32_bf16 v[152:155], v[32:35], v[224:227], v[152:155]
    ds_read_b64_tr_b16 v[204:205], v3 offset:36864
    v_mfma_f32_16x16x32_bf16 v[152:155], v[36:39], v[228:231], v[152:155]
    ds_read_b64_tr_b16 v[206:207], v3 offset:37376
    v_mfma_f32_16x16x32_bf16 v[160:163], v[72:75], v[216:219], v[160:163]
    ds_read_b64_tr_b16 v[208:209], v3 offset:40960
    v_mfma_f32_16x16x32_bf16 v[160:163], v[76:79], v[220:223], v[160:163]
    ds_read_b64_tr_b16 v[210:211], v3 offset:41472
    v_mfma_f32_16x16x32_bf16 v[160:163], v[80:83], v[224:227], v[160:163]
    ds_read_b64_tr_b16 v[212:213], v3 offset:45056
    v_mfma_f32_16x16x32_bf16 v[160:163], v[84:87], v[228:231], v[160:163]
    ds_read_b64_tr_b16 v[214:215], v3 offset:45568
    v_mfma_f32_16x16x32_bf16 v[168:171], v[120:123], v[216:219], v[168:171]
    buffer_store_dwordx4 v[164:167], v4, s[16:19], s47 offen offset:1024
    v_mfma_f32_16x16x32_bf16 v[168:171], v[124:127], v[220:223], v[168:171]
    s_add_u32 m0, m0, 1024
    v_mfma_f32_16x16x32_bf16 v[168:171], v[128:131], v[224:227], v[168:171]
    s_add_u32 s36, s36, 24576
    v_mfma_f32_16x16x32_bf16 v[168:171], v[132:135], v[228:231], v[168:171]
    v_xor_b32 v3, 32, v3
    s_waitcnt lgkmcnt(0)
    v_mfma_f32_16x16x32_bf16 v[152:155], v[40:43], v[200:203], v[152:155]
    ds_read_b64_tr_b16 v[216:217], v3 offset:0
    v_mfma_f32_16x16x32_bf16 v[152:155], v[44:47], v[204:207], v[152:155]
    ds_read_b64_tr_b16 v[218:219], v3 offset:512
    v_mfma_f32_16x16x32_bf16 v[152:155], v[48:51], v[208:211], v[152:155]
    ds_read_b64_tr_b16 v[220:221], v3 offset:4096
    v_mfma_f32_16x16x32_bf16 v[152:155], v[52:55], v[212:215], v[152:155]
    ds_read_b64_tr_b16 v[222:223], v3 offset:4608
    v_mfma_f32_16x16x32_bf16 v[160:163], v[88:91], v[200:203], v[160:163]
    ds_read_b64_tr_b16 v[224:225], v3 offset:8192
    v_mfma_f32_16x16x32_bf16 v[160:163], v[92:95], v[204:207], v[160:163]
    ds_read_b64_tr_b16 v[226:227], v3 offset:8704
    v_mfma_f32_16x16x32_bf16 v[160:163], v[96:99], v[208:211], v[160:163]
    ds_read_b64_tr_b16 v[228:229], v3 offset:12288
    v_mfma_f32_16x16x32_bf16 v[160:163], v[100:103], v[212:215], v[160:163]
    ds_read_b64_tr_b16 v[230:231], v3 offset:12800
    v_mfma_f32_16x16x32_bf16 v[168:171], v[136:139], v[200:203], v[168:171]
    buffer_load_dwordx4 v6, s[12:15], s36 offen lds
    v_mfma_f32_16x16x32_bf16 v[168:171], v[140:143], v[204:207], v[168:171]
    buffer_store_dwordx4 v[172:175], v4, s[16:19], s47 offen offset:2048
    v_mfma_f32_16x16x32_bf16 v[168:171], v[144:147], v[208:211], v[168:171]
    s_add_u32 m0, m0, 1024
    v_mfma_f32_16x16x32_bf16 v[168:171], v[148:151], v[212:215], v[168:171]
    s_add_u32 s36, s36, 24576
    s_waitcnt lgkmcnt(0)
    v_mfma_f32_16x16x32_bf16 v[156:159], v[8:11], v[216:219], 0
    ds_read_b64_tr_b16 v[200:201], v3 offset:16384
    v_mfma_f32_16x16x32_bf16 v[156:159], v[12:15], v[220:223], v[156:159]
    ds_read_b64_tr_b16 v[202:203], v3 offset:16896
    v_mfma_f32_16x16x32_bf16 v[156:159], v[16:19], v[224:227], v[156:159]
    ds_read_b64_tr_b16 v[204:205], v3 offset:20480
    v_mfma_f32_16x16x32_bf16 v[156:159], v[20:23], v[228:231], v[156:159]
    ds_read_b64_tr_b16 v[206:207], v3 offset:20992
    v_mfma_f32_16x16x32_bf16 v[164:167], v[56:59], v[216:219], 0
    ds_read_b64_tr_b16 v[208:209], v3 offset:24576
    v_mfma_f32_16x16x32_bf16 v[164:167], v[60:63], v[220:223], v[164:167]
    ds_read_b64_tr_b16 v[210:211], v3 offset:25088
    v_mfma_f32_16x16x32_bf16 v[164:167], v[64:67], v[224:227], v[164:167]
    ds_read_b64_tr_b16 v[212:213], v3 offset:28672
    v_mfma_f32_16x16x32_bf16 v[164:167], v[68:71], v[228:231], v[164:167]
    ds_read_b64_tr_b16 v[214:215], v3 offset:29184
    v_mfma_f32_16x16x32_bf16 v[172:175], v[104:107], v[216:219], 0
    buffer_load_dwordx4 v1, s[12:15], s36 offen lds
    v_mfma_f32_16x16x32_bf16 v[172:175], v[108:111], v[220:223], v[172:175]
    s_add_u32 m0, m0, 1024
    v_mfma_f32_16x16x32_bf16 v[172:175], v[112:115], v[224:227], v[172:175]
    s_add_u32 s36, s36, 24576
    v_mfma_f32_16x16x32_bf16 v[172:175], v[116:119], v[228:231], v[172:175]
    buffer_load_dwordx4 v6, s[12:15], s36 offen lds
    s_waitcnt lgkmcnt(0)
    v_mfma_f32_16x16x32_bf16 v[156:159], v[24:27], v[200:203], v[156:159]
    ds_read_b64_tr_b16 v[216:217], v3 offset:32768
    v_mfma_f32_16x16x32_bf16 v[156:159], v[28:31], v[204:207], v[156:159]
    ds_read_b64_tr_b16 v[218:219], v3 offset:33280
    v_mfma_f32_16x16x32_bf16 v[156:159], v[32:35], v[208:211], v[156:159]
    ds_read_b64_tr_b16 v[220:221], v3 offset:36864
    v_mfma_f32_16x16x32_bf16 v[156:159], v[36:39], v[212:215], v[156:159]
    ds_read_b64_tr_b16 v[222:223], v3 offset:37376
    v_mfma_f32_16x16x32_bf16 v[164:167], v[72:75], v[200:203], v[164:167]
    ds_read_b64_tr_b16 v[224:225], v3 offset:40960
    v_mfma_f32_16x16x32_bf16 v[164:167], v[76:79], v[204:207], v[164:167]
    ds_read_b64_tr_b16 v[226:227], v3 offset:41472
    v_mfma_f32_16x16x32_bf16 v[164:167], v[80:83], v[208:211], v[164:167]
    ds_read_b64_tr_b16 v[228:229], v3 offset:45056
    v_mfma_f32_16x16x32_bf16 v[164:167], v[84:87], v[212:215], v[164:167]
    ds_read_b64_tr_b16 v[230:231], v3 offset:45568
    v_mfma_f32_16x16x32_bf16 v[172:175], v[120:123], v[200:203], v[172:175]
    s_add_u32 m0, m0, 1024
    v_mfma_f32_16x16x32_bf16 v[172:175], v[124:127], v[204:207], v[172:175]
    s_add_u32 s36, s36, 24576
    v_mfma_f32_16x16x32_bf16 v[172:175], v[128:131], v[208:211], v[172:175]
    buffer_load_dwordx4 v1, s[12:15], s36 offen lds
    v_mfma_f32_16x16x32_bf16 v[172:175], v[132:135], v[212:215], v[172:175]
    s_nop 0
    v_xor_b32 v3, 96, v3
    s_waitcnt lgkmcnt(0)
    v_mfma_f32_16x16x32_bf16 v[156:159], v[40:43], v[216:219], v[156:159]
    ds_read_b64_tr_b16 v[200:201], v3 offset:0
    v_mfma_f32_16x16x32_bf16 v[156:159], v[44:47], v[220:223], v[156:159]
    ds_read_b64_tr_b16 v[202:203], v3 offset:512
    v_mfma_f32_16x16x32_bf16 v[156:159], v[48:51], v[224:227], v[156:159]
    ds_read_b64_tr_b16 v[204:205], v3 offset:4096
    v_mfma_f32_16x16x32_bf16 v[156:159], v[52:55], v[228:231], v[156:159]
    ds_read_b64_tr_b16 v[206:207], v3 offset:4608
    v_mfma_f32_16x16x32_bf16 v[164:167], v[88:91], v[216:219], v[164:167]
    ds_read_b64_tr_b16 v[208:209], v3 offset:8192
    v_mfma_f32_16x16x32_bf16 v[164:167], v[92:95], v[220:223], v[164:167]
    ds_read_b64_tr_b16 v[210:211], v3 offset:8704
    v_mfma_f32_16x16x32_bf16 v[164:167], v[96:99], v[224:227], v[164:167]
    ds_read_b64_tr_b16 v[212:213], v3 offset:12288
    v_mfma_f32_16x16x32_bf16 v[164:167], v[100:103], v[228:231], v[164:167]
    ds_read_b64_tr_b16 v[214:215], v3 offset:12800
    v_mfma_f32_16x16x32_bf16 v[172:175], v[136:139], v[216:219], v[172:175]
    s_add_u32 m0, m0, 1024
    v_mfma_f32_16x16x32_bf16 v[172:175], v[140:143], v[220:223], v[172:175]
    s_add_u32 s36, s36, 24576
    v_mfma_f32_16x16x32_bf16 v[172:175], v[144:147], v[224:227], v[172:175]
    buffer_load_dwordx4 v6, s[12:15], s36 offen lds
    v_mfma_f32_16x16x32_bf16 v[172:175], v[148:151], v[228:231], v[172:175]
    s_add_u32 s35, s35, 49152
    s_waitcnt lgkmcnt(0)
    v_mfma_f32_16x16x32_bf16 v[176:179], v[8:11], v[200:203], 0
    ds_read_b64_tr_b16 v[216:217], v3 offset:16384
    v_mfma_f32_16x16x32_bf16 v[176:179], v[12:15], v[204:207], v[176:179]
    ds_read_b64_tr_b16 v[218:219], v3 offset:16896
    v_mfma_f32_16x16x32_bf16 v[176:179], v[16:19], v[208:211], v[176:179]
    ds_read_b64_tr_b16 v[220:221], v3 offset:20480
    v_mfma_f32_16x16x32_bf16 v[176:179], v[20:23], v[212:215], v[176:179]
    ds_read_b64_tr_b16 v[222:223], v3 offset:20992
    v_mfma_f32_16x16x32_bf16 v[184:187], v[56:59], v[200:203], 0
    ds_read_b64_tr_b16 v[224:225], v3 offset:24576
    v_mfma_f32_16x16x32_bf16 v[184:187], v[60:63], v[204:207], v[184:187]
    ds_read_b64_tr_b16 v[226:227], v3 offset:25088
    v_mfma_f32_16x16x32_bf16 v[184:187], v[64:67], v[208:211], v[184:187]
    ds_read_b64_tr_b16 v[228:229], v3 offset:28672
    v_mfma_f32_16x16x32_bf16 v[184:187], v[68:71], v[212:215], v[184:187]
    ds_read_b64_tr_b16 v[230:231], v3 offset:29184
    v_mfma_f32_16x16x32_bf16 v[192:195], v[104:107], v[200:203], 0
    buffer_store_dwordx4 v[180:183], v4, s[16:19], s48 offen offset:0 nt
    v_mfma_f32_16x16x32_bf16 v[192:195], v[108:111], v[204:207], v[192:195]
    s_cmp_ge_u32 s35, 147456
    v_mfma_f32_16x16x32_bf16 v[192:195], v[112:115], v[208:211], v[192:195]
    s_cselect_b32 s35, s46, s35
    v_mfma_f32_16x16x32_bf16 v[192:195], v[116:119], v[212:215], v[192:195]
    buffer_store_dwordx4 v[188:191], v4, s[16:19], s48 offen offset:1024 nt
    s_waitcnt lgkmcnt(0)
    v_mfma_f32_16x16x32_bf16 v[176:179], v[24:27], v[216:219], v[176:179]
    ds_read_b64_tr_b16 v[200:201], v3 offset:32768
    v_mfma_f32_16x16x32_bf16 v[176:179], v[28:31], v[220:223], v[176:179]
    ds_read_b64_tr_b16 v[202:203], v3 offset:33280
    v_mfma_f32_16x16x32_bf16 v[176:179], v[32:35], v[224:227], v[176:179]
    ds_read_b64_tr_b16 v[204:205], v3 offset:36864
    v_mfma_f32_16x16x32_bf16 v[176:179], v[36:39], v[228:231], v[176:179]
    ds_read_b64_tr_b16 v[206:207], v3 offset:37376
    v_mfma_f32_16x16x32_bf16 v[184:187], v[72:75], v[216:219], v[184:187]
    ds_read_b64_tr_b16 v[208:209], v3 offset:40960
    v_mfma_f32_16x16x32_bf16 v[184:187], v[76:79], v[220:223], v[184:187]
    ds_read_b64_tr_b16 v[210:211], v3 offset:41472
    v_mfma_f32_16x16x32_bf16 v[184:187], v[80:83], v[224:227], v[184:187]
    ds_read_b64_tr_b16 v[212:213], v3 offset:45056
    v_mfma_f32_16x16x32_bf16 v[184:187], v[84:87], v[228:231], v[184:187]
    ds_read_b64_tr_b16 v[214:215], v3 offset:45568
    v_mfma_f32_16x16x32_bf16 v[192:195], v[120:123], v[216:219], v[192:195]
    s_add_u32 s45, s45, 128
    v_mfma_f32_16x16x32_bf16 v[192:195], v[124:127], v[220:223], v[192:195]
    s_cmp_eq_u32 s45, s55
    v_mfma_f32_16x16x32_bf16 v[192:195], v[128:131], v[224:227], v[192:195]
    buffer_store_dwordx4 v[196:199], v4, s[16:19], s48 offen offset:2048 nt
    v_mfma_f32_16x16x32_bf16 v[192:195], v[132:135], v[228:231], v[192:195]
    v_xor_b32 v3, 32, v3
    s_waitcnt lgkmcnt(0)
    v_mfma_f32_16x16x32_bf16 v[176:179], v[40:43], v[200:203], v[176:179]
    ds_read_b64_tr_b16 v[216:217], v3 offset:0
    v_mfma_f32_16x16x32_bf16 v[176:179], v[44:47], v[204:207], v[176:179]
    ds_read_b64_tr_b16 v[218:219], v3 offset:512
    v_mfma_f32_16x16x32_bf16 v[176:179], v[48:51], v[208:211], v[176:179]
    ds_read_b64_tr_b16 v[220:221], v3 offset:4096
    v_mfma_f32_16x16x32_bf16 v[176:179], v[52:55], v[212:215], v[176:179]
    ds_read_b64_tr_b16 v[222:223], v3 offset:4608
    v_mfma_f32_16x16x32_bf16 v[184:187], v[88:91], v[200:203], v[184:187]
    ds_read_b64_tr_b16 v[224:225], v3 offset:8192
    v_mfma_f32_16x16x32_bf16 v[184:187], v[92:95], v[204:207], v[184:187]
    ds_read_b64_tr_b16 v[226:227], v3 offset:8704
    v_mfma_f32_16x16x32_bf16 v[184:187], v[96:99], v[208:211], v[184:187]
    ds_read_b64_tr_b16 v[228:229], v3 offset:12288
    v_mfma_f32_16x16x32_bf16 v[184:187], v[100:103], v[212:215], v[184:187]
    ds_read_b64_tr_b16 v[230:231], v3 offset:12800
    v_mfma_f32_16x16x32_bf16 v[192:195], v[136:139], v[200:203], v[192:195]
    s_cselect_b32 s45, s54, s45
    v_mfma_f32_16x16x32_bf16 v[192:195], v[140:143], v[204:207], v[192:195]
    s_sub_u32 s87, s87, 1
    v_mfma_f32_16x16x32_bf16 v[192:195], v[144:147], v[208:211], v[192:195]
    s_cmp_lg_u32 s87, 0
    v_mfma_f32_16x16x32_bf16 v[192:195], v[148:151], v[212:215], v[192:195]
    s_cbranch_scc1 K1_ds7
    s_lshl_b32 s54, s83, 7
    s_add_u32 s54, s54, s50
    s_lshl_b32 s55, s84, 7
    s_add_u32 s55, s55, s50
    s_lshl_b32 s45, s56, 7
    s_add_u32 s45, s45, s54
K1_ds7:
    s_waitcnt lgkmcnt(0)
    v_mfma_f32_16x16x32_bf16 v[180:183], v[8:11], v[216:219], 0
    ds_read_b64_tr_b16 v[200:201], v3 offset:16384
    v_mfma_f32_16x16x32_bf16 v[180:183], v[12:15], v[220:223], v[180:183]
    ds_read_b64_tr_b16 v[202:203], v3 offset:16896
    v_mfma_f32_16x16x32_bf16 v[180:183], v[16:19], v[224:227], v[180:183]
    ds_read_b64_tr_b16 v[204:205], v3 offset:20480
    v_mfma_f32_16x16x32_bf16 v[180:183], v[20:23], v[228:231], v[180:183]
    ds_read_b64_tr_b16 v[206:207], v3 offset:20992
    v_mfma_f32_16x16x32_bf16 v[188:191], v[56:59], v[216:219], 0
    ds_read_b64_tr_b16 v[208:209], v3 offset:24576
    v_mfma_f32_16x16x32_bf16 v[188:191], v[60:63], v[220:223], v[188:191]
    ds_read_b64_tr_b16 v[210:211], v3 offset:25088
    v_mfma_f32_16x16x32_bf16 v[188:191], v[64:67], v[224:227], v[188:191]
    ds_read_b64_tr_b16 v[212:213], v3 offset:28672
    v_mfma_f32_16x16x32_bf16 v[188:191], v[68:71], v[228:231], v[188:191]
    ds_read_b64_tr_b16 v[214:215], v3 offset:29184
    v_mfma_f32_16x16x32_bf16 v[196:199], v[104:107], v[216:219], 0
    s_add_u32 s34, s34, 49152
    v_mfma_f32_16x16x32_bf16 v[196:199], v[108:111], v[220:223], v[196:199]
    s_cmp_eq_u32 s34, 147456
    v_mfma_f32_16x16x32_bf16 v[196:199], v[112:115], v[224:227], v[196:199]
    s_cselect_b32 s34, 0, s34
    v_mfma_f32_16x16x32_bf16 v[196:199], v[116:119], v[228:231], v[196:199]
    s_add_u32 s32, s32, 1
    s_waitcnt lgkmcnt(0)
    v_mfma_f32_16x16x32_bf16 v[180:183], v[24:27], v[200:203], v[180:183]
    ds_read_b64_tr_b16 v[216:217], v3 offset:32768
    v_mfma_f32_16x16x32_bf16 v[180:183], v[28:31], v[204:207], v[180:183]
    ds_read_b64_tr_b16 v[218:219], v3 offset:33280
    v_mfma_f32_16x16x32_bf16 v[180:183], v[32:35], v[208:211], v[180:183]
    ds_read_b64_tr_b16 v[220:221], v3 offset:36864
    v_mfma_f32_16x16x32_bf16 v[180:183], v[36:39], v[212:215], v[180:183]
    ds_read_b64_tr_b16 v[222:223], v3 offset:37376
    v_mfma_f32_16x16x32_bf16 v[188:191], v[72:75], v[200:203], v[188:191]
    ds_read_b64_tr_b16 v[224:225], v3 offset:40960
    v_mfma_f32_16x16x32_bf16 v[188:191], v[76:79], v[204:207], v[188:191]
    ds_read_b64_tr_b16 v[226:227], v3 offset:41472
    v_mfma_f32_16x16x32_bf16 v[188:191], v[80:83], v[208:211], v[188:191]
    ds_read_b64_tr_b16 v[228:229], v3 offset:45056
    v_mfma_f32_16x16x32_bf16 v[188:191], v[84:87], v[212:215], v[188:191]
    ds_read_b64_tr_b16 v[230:231], v3 offset:45568
    v_mfma_f32_16x16x32_bf16 v[196:199], v[120:123], v[200:203], v[196:199]
    s_mul_i32 s47, s42, 24576
    v_mfma_f32_16x16x32_bf16 v[196:199], v[124:127], v[204:207], v[196:199]
    s_add_u32 s47, s47, s39
    v_mfma_f32_16x16x32_bf16 v[196:199], v[128:131], v[208:211], v[196:199]
    s_cmp_eq_u32 s42, s85
    v_mfma_f32_16x16x32_bf16 v[196:199], v[132:135], v[212:215], v[196:199]
    s_cselect_b32 s16, s26, s24
    s_waitcnt lgkmcnt(0)
    v_mfma_f32_16x16x32_bf16 v[180:183], v[40:43], v[216:219], v[180:183]
    s_cselect_b32 s17, s27, s25
    v_mfma_f32_16x16x32_bf16 v[180:183], v[44:47], v[220:223], v[180:183]
    s_cselect_b32 s47, s59, s47
    v_mfma_f32_16x16x32_bf16 v[180:183], v[48:51], v[224:227], v[180:183]
    s_mov_b32 s37, 113246208
    v_mfma_f32_16x16x32_bf16 v[180:183], v[52:55], v[228:231], v[180:183]
    s_cselect_b32 s18, s37, 446693376
    v_mfma_f32_16x16x32_bf16 v[188:191], v[88:91], v[216:219], v[188:191]
    s_add_u32 s48, s47, 12288
    v_mfma_f32_16x16x32_bf16 v[188:191], v[92:95], v[220:223], v[188:191]
    v_mfma_f32_16x16x32_bf16 v[188:191], v[96:99], v[224:227], v[188:191]
    v_mfma_f32_16x16x32_bf16 v[188:191], v[100:103], v[228:231], v[188:191]
    v_mfma_f32_16x16x32_bf16 v[196:199], v[136:139], v[216:219], v[196:199]
    v_mfma_f32_16x16x32_bf16 v[196:199], v[140:143], v[220:223], v[196:199]
    v_mfma_f32_16x16x32_bf16 v[196:199], v[144:147], v[224:227], v[196:199]
    v_mfma_f32_16x16x32_bf16 v[196:199], v[148:151], v[228:231], v[196:199]
    s_setprio 0
    v_cvt_pk_f16_f32 v216, v152, v153
    v_cvt_pk_f16_f32 v217, v154, v155
    v_cvt_pk_f16_f32 v218, v156, v157
    v_cvt_pk_f16_f32 v219, v158, v159
    v_pk_fma_f16 v220, v216, v216, s44 neg_lo:[1,0,0] neg_hi:[1,0,0]
    v_pk_fma_f16 v221, v217, v217, s44 neg_lo:[1,0,0] neg_hi:[1,0,0]
    v_pk_fma_f16 v222, v218, v218, s44 neg_lo:[1,0,0] neg_hi:[1,0,0]
    v_pk_fma_f16 v223, v219, v219, s44 neg_lo:[1,0,0] neg_hi:[1,0,0]
    v_pk_mul_f16 v220, v220, v216
    v_pk_mul_f16 v221, v221, v217
    v_pk_mul_f16 v222, v222, v218
    v_pk_mul_f16 v223, v223, v219
    v_exp_f16 v216, v220
    v_exp_f16 v217, v221
    v_exp_f16 v218, v222
    v_exp_f16 v219, v223
    v_exp_f16_sdwa v216, v220 dst_sel:WORD_1 dst_unused:UNUSED_PRESERVE src0_sel:WORD_1
    v_exp_f16_sdwa v217, v221 dst_sel:WORD_1 dst_unused:UNUSED_PRESERVE src0_sel:WORD_1
    v_exp_f16_sdwa v218, v222 dst_sel:WORD_1 dst_unused:UNUSED_PRESERVE src0_sel:WORD_1
    v_exp_f16_sdwa v219, v223 dst_sel:WORD_1 dst_unused:UNUSED_PRESERVE src0_sel:WORD_1
    v_pk_add_f16 v216, v216, 1.0 op_sel_hi:[1,0]
    v_pk_add_f16 v217, v217, 1.0 op_sel_hi:[1,0]
    v_pk_add_f16 v218, v218, 1.0 op_sel_hi:[1,0]
    v_pk_add_f16 v219, v219, 1.0 op_sel_hi:[1,0]
    v_rcp_f16 v220, v216
    v_rcp_f16 v221, v217
    v_rcp_f16 v222, v218
    v_rcp_f16 v223, v219
    v_rcp_f16_sdwa v216, v216 dst_sel:DWORD dst_unused:UNUSED_PAD src0_sel:WORD_1
    v_rcp_f16_sdwa v217, v217 dst_sel:DWORD dst_unused:UNUSED_PAD src0_sel:WORD_1
    v_rcp_f16_sdwa v218, v218 dst_sel:DWORD dst_unused:UNUSED_PAD src0_sel:WORD_1
    v_rcp_f16_sdwa v219, v219 dst_sel:DWORD dst_unused:UNUSED_PAD src0_sel:WORD_1
    v_fma_mix_f32 v152, v152, v220, 0 op_sel_hi:[0,1,0]
    v_fma_mix_f32 v154, v154, v221, 0 op_sel_hi:[0,1,0]
    v_fma_mix_f32 v156, v156, v222, 0 op_sel_hi:[0,1,0]
    v_fma_mix_f32 v158, v158, v223, 0 op_sel_hi:[0,1,0]
    v_fma_mix_f32 v153, v153, v216, 0 op_sel_hi:[0,1,0]
    v_fma_mix_f32 v155, v155, v217, 0 op_sel_hi:[0,1,0]
    v_fma_mix_f32 v157, v157, v218, 0 op_sel_hi:[0,1,0]
    v_fma_mix_f32 v159, v159, v219, 0 op_sel_hi:[0,1,0]
    v_cvt_pk_bf16_f32 v159, v158, v159
    v_cvt_pk_bf16_f32 v158, v156, v157
    v_cvt_pk_bf16_f32 v157, v154, v155
    v_cvt_pk_bf16_f32 v156, v152, v153
    v_cvt_pk_f16_f32 v216, v160, v161
    v_cvt_pk_f16_f32 v217, v162, v163
    v_cvt_pk_f16_f32 v218, v164, v165
    v_cvt_pk_f16_f32 v219, v166, v167
    v_pk_fma_f16 v220, v216, v216, s44 neg_lo:[1,0,0] neg_hi:[1,0,0]
    v_pk_fma_f16 v221, v217, v217, s44 neg_lo:[1,0,0] neg_hi:[1,0,0]
    v_pk_fma_f16 v222, v218, v218, s44 neg_lo:[1,0,0] neg_hi:[1,0,0]
    v_pk_fma_f16 v223, v219, v219, s44 neg_lo:[1,0,0] neg_hi:[1,0,0]
    v_pk_mul_f16 v220, v220, v216
    v_pk_mul_f16 v221, v221, v217
    v_pk_mul_f16 v222, v222, v218
    v_pk_mul_f16 v223, v223, v219
    v_exp_f16 v216, v220
    v_exp_f16 v217, v221
    v_exp_f16 v218, v222
    v_exp_f16 v219, v223
    v_exp_f16_sdwa v216, v220 dst_sel:WORD_1 dst_unused:UNUSED_PRESERVE src0_sel:WORD_1
    v_exp_f16_sdwa v217, v221 dst_sel:WORD_1 dst_unused:UNUSED_PRESERVE src0_sel:WORD_1
    v_exp_f16_sdwa v218, v222 dst_sel:WORD_1 dst_unused:UNUSED_PRESERVE src0_sel:WORD_1
    v_exp_f16_sdwa v219, v223 dst_sel:WORD_1 dst_unused:UNUSED_PRESERVE src0_sel:WORD_1
    v_pk_add_f16 v216, v216, 1.0 op_sel_hi:[1,0]
    v_pk_add_f16 v217, v217, 1.0 op_sel_hi:[1,0]
    v_pk_add_f16 v218, v218, 1.0 op_sel_hi:[1,0]
    v_pk_add_f16 v219, v219, 1.0 op_sel_hi:[1,0]
    v_rcp_f16 v220, v216
    v_rcp_f16 v221, v217
    v_rcp_f16 v222, v218
    v_rcp_f16 v223, v219
    v_rcp_f16_sdwa v216, v216 dst_sel:DWORD dst_unused:UNUSED_PAD src0_sel:WORD_1
    v_rcp_f16_sdwa v217, v217 dst_sel:DWORD dst_unused:UNUSED_PAD src0_sel:WORD_1
    v_rcp_f16_sdwa v218, v218 dst_sel:DWORD dst_unused:UNUSED_PAD src0_sel:WORD_1
    v_rcp_f16_sdwa v219, v219 dst_sel:DWORD dst_unused:UNUSED_PAD src0_sel:WORD_1
    v_fma_mix_f32 v160, v160, v220, 0 op_sel_hi:[0,1,0]
    v_fma_mix_f32 v162, v162, v221, 0 op_sel_hi:[0,1,0]
    v_fma_mix_f32 v164, v164, v222, 0 op_sel_hi:[0,1,0]
    v_fma_mix_f32 v166, v166, v223, 0 op_sel_hi:[0,1,0]
    v_fma_mix_f32 v161, v161, v216, 0 op_sel_hi:[0,1,0]
    v_fma_mix_f32 v163, v163, v217, 0 op_sel_hi:[0,1,0]
    v_fma_mix_f32 v165, v165, v218, 0 op_sel_hi:[0,1,0]
    v_fma_mix_f32 v167, v167, v219, 0 op_sel_hi:[0,1,0]
    v_cvt_pk_bf16_f32 v167, v166, v167
    v_cvt_pk_bf16_f32 v166, v164, v165
    v_cvt_pk_bf16_f32 v165, v162, v163
    v_cvt_pk_bf16_f32 v164, v160, v161
    s_setprio 1
    s_nop 0
    v_cvt_pk_f16_f32 v216, v168, v169
    v_cvt_pk_f16_f32 v217, v170, v171
    v_cvt_pk_f16_f32 v218, v172, v173
    v_cvt_pk_f16_f32 v219, v174, v175
    v_pk_fma_f16 v220, v216, v216, s44 neg_lo:[1,0,0] neg_hi:[1,0,0]
    v_pk_fma_f16 v221, v217, v217, s44 neg_lo:[1,0,0] neg_hi:[1,0,0]
    v_pk_fma_f16 v222, v218, v218, s44 neg_lo:[1,0,0] neg_hi:[1,0,0]
    v_pk_fma_f16 v223, v219, v219, s44 neg_lo:[1,0,0] neg_hi:[1,0,0]
    v_pk_mul_f16 v220, v220, v216
    v_pk_mul_f16 v221, v221, v217
    v_pk_mul_f16 v222, v222, v218
    v_pk_mul_f16 v223, v223, v219
    v_exp_f16 v216, v220
    v_exp_f16 v217, v221
    v_exp_f16 v218, v222
    v_exp_f16 v219, v223
    v_exp_f16_sdwa v216, v220 dst_sel:WORD_1 dst_unused:UNUSED_PRESERVE src0_sel:WORD_1
    v_exp_f16_sdwa v217, v221 dst_sel:WORD_1 dst_unused:UNUSED_PRESERVE src0_sel:WORD_1
    v_exp_f16_sdwa v218, v222 dst_sel:WORD_1 dst_unused:UNUSED_PRESERVE src0_sel:WORD_1
    v_exp_f16_sdwa v219, v223 dst_sel:WORD_1 dst_unused:UNUSED_PRESERVE src0_sel:WORD_1
    v_pk_add_f16 v216, v216, 1.0 op_sel_hi:[1,0]
    v_pk_add_f16 v217, v217, 1.0 op_sel_hi:[1,0]
    v_pk_add_f16 v218, v218, 1.0 op_sel_hi:[1,0]
    v_pk_add_f16 v219, v219, 1.0 op_sel_hi:[1,0]
    v_rcp_f16 v220, v216
    v_rcp_f16 v221, v217
    v_rcp_f16 v222, v218
    v_rcp_f16 v223, v219
    v_rcp_f16_sdwa v216, v216 dst_sel:DWORD dst_unused:UNUSED_PAD src0_sel:WORD_1
    v_rcp_f16_sdwa v217, v217 dst_sel:DWORD dst_unused:UNUSED_PAD src0_sel:WORD_1
    v_rcp_f16_sdwa v218, v218 dst_sel:DWORD dst_unused:UNUSED_PAD src0_sel:WORD_1
    v_rcp_f16_sdwa v219, v219 dst_sel:DWORD dst_unused:UNUSED_PAD src0_sel:WORD_1
    v_fma_mix_f32 v168, v168, v220, 0 op_sel_hi:[0,1,0]
    v_fma_mix_f32 v170, v170, v221, 0 op_sel_hi:[0,1,0]
    v_fma_mix_f32 v172, v172, v222, 0 op_sel_hi:[0,1,0]
    v_fma_mix_f32 v174, v174, v223, 0 op_sel_hi:[0,1,0]
    v_fma_mix_f32 v169, v169, v216, 0 op_sel_hi:[0,1,0]
    v_fma_mix_f32 v171, v171, v217, 0 op_sel_hi:[0,1,0]
    v_fma_mix_f32 v173, v173, v218, 0 op_sel_hi:[0,1,0]
    v_fma_mix_f32 v175, v175, v219, 0 op_sel_hi:[0,1,0]
    v_cvt_pk_bf16_f32 v175, v174, v175
    v_cvt_pk_bf16_f32 v174, v172, v173
    v_cvt_pk_bf16_f32 v173, v170, v171
    v_cvt_pk_bf16_f32 v172, v168, v169
    s_waitcnt vmcnt(3)
    s_barrier
    v_cvt_pk_f16_f32 v216, v176, v177
    v_cvt_pk_f16_f32 v217, v178, v179
    v_cvt_pk_f16_f32 v218, v180, v181
    v_cvt_pk_f16_f32 v219, v182, v183
    v_pk_fma_f16 v220, v216, v216, s44 neg_lo:[1,0,0] neg_hi:[1,0,0]
    v_pk_fma_f16 v221, v217, v217, s44 neg_lo:[1,0,0] neg_hi:[1,0,0]
    v_pk_fma_f16 v222, v218, v218, s44 neg_lo:[1,0,0] neg_hi:[1,0,0]
    v_pk_fma_f16 v223, v219, v219, s44 neg_lo:[1,0,0] neg_hi:[1,0,0]
    v_pk_mul_f16 v220, v220, v216
    v_pk_mul_f16 v221, v221, v217
    v_pk_mul_f16 v222, v222, v218
    v_pk_mul_f16 v223, v223, v219
    v_exp_f16 v216, v220
    v_exp_f16 v217, v221
    v_exp_f16 v218, v222
    v_exp_f16 v219, v223
    v_exp_f16_sdwa v216, v220 dst_sel:WORD_1 dst_unused:UNUSED_PRESERVE src0_sel:WORD_1
    v_exp_f16_sdwa v217, v221 dst_sel:WORD_1 dst_unused:UNUSED_PRESERVE src0_sel:WORD_1
    v_exp_f16_sdwa v218, v222 dst_sel:WORD_1 dst_unused:UNUSED_PRESERVE src0_sel:WORD_1
    v_exp_f16_sdwa v219, v223 dst_sel:WORD_1 dst_unused:UNUSED_PRESERVE src0_sel:WORD_1
    v_pk_add_f16 v216, v216, 1.0 op_sel_hi:[1,0]
    v_pk_add_f16 v217, v217, 1.0 op_sel_hi:[1,0]
    v_pk_add_f16 v218, v218, 1.0 op_sel_hi:[1,0]
    v_pk_add_f16 v219, v219, 1.0 op_sel_hi:[1,0]
    v_rcp_f16 v220, v216
    v_rcp_f16 v221, v217
    v_rcp_f16 v222, v218
    v_rcp_f16 v223, v219
    v_rcp_f16_sdwa v216, v216 dst_sel:DWORD dst_unused:UNUSED_PAD src0_sel:WORD_1
    v_rcp_f16_sdwa v217, v217 dst_sel:DWORD dst_unused:UNUSED_PAD src0_sel:WORD_1
    v_rcp_f16_sdwa v218, v218 dst_sel:DWORD dst_unused:UNUSED_PAD src0_sel:WORD_1
    v_rcp_f16_sdwa v219, v219 dst_sel:DWORD dst_unused:UNUSED_PAD src0_sel:WORD_1
    v_fma_mix_f32 v176, v176, v220, 0 op_sel_hi:[0,1,0]
    v_fma_mix_f32 v178, v178, v221, 0 op_sel_hi:[0,1,0]
    v_fma_mix_f32 v180, v180, v222, 0 op_sel_hi:[0,1,0]
    v_fma_mix_f32 v182, v182, v223, 0 op_sel_hi:[0,1,0]
    v_fma_mix_f32 v177, v177, v216, 0 op_sel_hi:[0,1,0]
    v_fma_mix_f32 v179, v179, v217, 0 op_sel_hi:[0,1,0]
    v_fma_mix_f32 v181, v181, v218, 0 op_sel_hi:[0,1,0]
    v_fma_mix_f32 v183, v183, v219, 0 op_sel_hi:[0,1,0]
    v_cvt_pk_bf16_f32 v183, v182, v183
    v_cvt_pk_bf16_f32 v182, v180, v181
    v_cvt_pk_bf16_f32 v181, v178, v179
    v_cvt_pk_bf16_f32 v180, v176, v177
    v_cvt_pk_f16_f32 v216, v184, v185
    v_cvt_pk_f16_f32 v217, v186, v187
    v_cvt_pk_f16_f32 v218, v188, v189
    v_cvt_pk_f16_f32 v219, v190, v191
    v_pk_fma_f16 v220, v216, v216, s44 neg_lo:[1,0,0] neg_hi:[1,0,0]
    v_pk_fma_f16 v221, v217, v217, s44 neg_lo:[1,0,0] neg_hi:[1,0,0]
    v_pk_fma_f16 v222, v218, v218, s44 neg_lo:[1,0,0] neg_hi:[1,0,0]
    v_pk_fma_f16 v223, v219, v219, s44 neg_lo:[1,0,0] neg_hi:[1,0,0]
    v_pk_mul_f16 v220, v220, v216
    v_pk_mul_f16 v221, v221, v217
    v_pk_mul_f16 v222, v222, v218
    v_pk_mul_f16 v223, v223, v219
    v_exp_f16 v216, v220
    v_exp_f16 v217, v221
    v_exp_f16 v218, v222
    v_exp_f16 v219, v223
    v_exp_f16_sdwa v216, v220 dst_sel:WORD_1 dst_unused:UNUSED_PRESERVE src0_sel:WORD_1
    v_exp_f16_sdwa v217, v221 dst_sel:WORD_1 dst_unused:UNUSED_PRESERVE src0_sel:WORD_1
    v_exp_f16_sdwa v218, v222 dst_sel:WORD_1 dst_unused:UNUSED_PRESERVE src0_sel:WORD_1
    v_exp_f16_sdwa v219, v223 dst_sel:WORD_1 dst_unused:UNUSED_PRESERVE src0_sel:WORD_1
    v_pk_add_f16 v216, v216, 1.0 op_sel_hi:[1,0]
    v_pk_add_f16 v217, v217, 1.0 op_sel_hi:[1,0]
    v_pk_add_f16 v218, v218, 1.0 op_sel_hi:[1,0]
    v_pk_add_f16 v219, v219, 1.0 op_sel_hi:[1,0]
    v_rcp_f16 v220, v216
    v_rcp_f16 v221, v217
    v_rcp_f16 v222, v218
    v_rcp_f16 v223, v219
    v_rcp_f16_sdwa v216, v216 dst_sel:DWORD dst_unused:UNUSED_PAD src0_sel:WORD_1
    v_rcp_f16_sdwa v217, v217 dst_sel:DWORD dst_unused:UNUSED_PAD src0_sel:WORD_1
    v_rcp_f16_sdwa v218, v218 dst_sel:DWORD dst_unused:UNUSED_PAD src0_sel:WORD_1
    v_rcp_f16_sdwa v219, v219 dst_sel:DWORD dst_unused:UNUSED_PAD src0_sel:WORD_1
    v_fma_mix_f32 v184, v184, v220, 0 op_sel_hi:[0,1,0]
    v_fma_mix_f32 v186, v186, v221, 0 op_sel_hi:[0,1,0]
    v_fma_mix_f32 v188, v188, v222, 0 op_sel_hi:[0,1,0]
    v_fma_mix_f32 v190, v190, v223, 0 op_sel_hi:[0,1,0]
    v_fma_mix_f32 v185, v185, v216, 0 op_sel_hi:[0,1,0]
    v_fma_mix_f32 v187, v187, v217, 0 op_sel_hi:[0,1,0]
    v_fma_mix_f32 v189, v189, v218, 0 op_sel_hi:[0,1,0]
    v_fma_mix_f32 v191, v191, v219, 0 op_sel_hi:[0,1,0]
    v_cvt_pk_bf16_f32 v191, v190, v191
    v_cvt_pk_bf16_f32 v190, v188, v189
    v_cvt_pk_bf16_f32 v189, v186, v187
    v_cvt_pk_bf16_f32 v188, v184, v185
    v_cvt_pk_f16_f32 v216, v192, v193
    v_cvt_pk_f16_f32 v217, v194, v195
    v_cvt_pk_f16_f32 v218, v196, v197
    v_cvt_pk_f16_f32 v219, v198, v199
    v_pk_fma_f16 v220, v216, v216, s44 neg_lo:[1,0,0] neg_hi:[1,0,0]
    v_pk_fma_f16 v221, v217, v217, s44 neg_lo:[1,0,0] neg_hi:[1,0,0]
    v_pk_fma_f16 v222, v218, v218, s44 neg_lo:[1,0,0] neg_hi:[1,0,0]
    v_pk_fma_f16 v223, v219, v219, s44 neg_lo:[1,0,0] neg_hi:[1,0,0]
    v_pk_mul_f16 v220, v220, v216
    v_pk_mul_f16 v221, v221, v217
    v_pk_mul_f16 v222, v222, v218
    v_pk_mul_f16 v223, v223, v219
    v_exp_f16 v216, v220
    v_exp_f16 v217, v221
    v_exp_f16 v218, v222
    v_exp_f16 v219, v223
    v_exp_f16_sdwa v216, v220 dst_sel:WORD_1 dst_unused:UNUSED_PRESERVE src0_sel:WORD_1
    v_exp_f16_sdwa v217, v221 dst_sel:WORD_1 dst_unused:UNUSED_PRESERVE src0_sel:WORD_1
    v_exp_f16_sdwa v218, v222 dst_sel:WORD_1 dst_unused:UNUSED_PRESERVE src0_sel:WORD_1
    v_exp_f16_sdwa v219, v223 dst_sel:WORD_1 dst_unused:UNUSED_PRESERVE src0_sel:WORD_1
    v_pk_add_f16 v216, v216, 1.0 op_sel_hi:[1,0]
    v_pk_add_f16 v217, v217, 1.0 op_sel_hi:[1,0]
    v_pk_add_f16 v218, v218, 1.0 op_sel_hi:[1,0]
    v_pk_add_f16 v219, v219, 1.0 op_sel_hi:[1,0]
    v_rcp_f16 v220, v216
    v_rcp_f16 v221, v217
    v_rcp_f16 v222, v218
    v_rcp_f16 v223, v219
    v_rcp_f16_sdwa v216, v216 dst_sel:DWORD dst_unused:UNUSED_PAD src0_sel:WORD_1
    v_rcp_f16_sdwa v217, v217 dst_sel:DWORD dst_unused:UNUSED_PAD src0_sel:WORD_1
    v_rcp_f16_sdwa v218, v218 dst_sel:DWORD dst_unused:UNUSED_PAD src0_sel:WORD_1
    v_rcp_f16_sdwa v219, v219 dst_sel:DWORD dst_unused:UNUSED_PAD src0_sel:WORD_1
    v_fma_mix_f32 v192, v192, v220, 0 op_sel_hi:[0,1,0]
    v_fma_mix_f32 v194, v194, v221, 0 op_sel_hi:[0,1,0]
    v_fma_mix_f32 v196, v196, v222, 0 op_sel_hi:[0,1,0]
    v_fma_mix_f32 v198, v198, v223, 0 op_sel_hi:[0,1,0]
    v_fma_mix_f32 v193, v193, v216, 0 op_sel_hi:[0,1,0]
    v_fma_mix_f32 v195, v195, v217, 0 op_sel_hi:[0,1,0]
    v_fma_mix_f32 v197, v197, v218, 0 op_sel_hi:[0,1,0]
    v_fma_mix_f32 v199, v199, v219, 0 op_sel_hi:[0,1,0]
    v_cvt_pk_bf16_f32 v199, v198, v199
    v_cvt_pk_bf16_f32 v198, v196, v197
    v_cvt_pk_bf16_f32 v197, v194, v195
    v_cvt_pk_bf16_f32 v196, v192, v193
    v_dot2_f32_bf16 v224, v156, v156, 0
    v_dot2_f32_bf16 v225, v158, v158, 0
    v_dot2_f32_bf16 v226, v180, v180, 0
    v_dot2_f32_bf16 v227, v182, v182, 0
    v_add_u32 v3, s34, v7
    ds_read_b64_tr_b16 v[200:201], v3 offset:0
    ds_read_b64_tr_b16 v[202:203], v3 offset:512
    v_dot2c_f32_bf16 v224, v157, v157
    v_dot2c_f32_bf16 v225, v159, v159
    v_dot2c_f32_bf16 v226, v181, v181
    v_dot2c_f32_bf16 v227, v183, v183
    ds_read_b64_tr_b16 v[204:205], v3 offset:4096
    ds_read_b64_tr_b16 v[206:207], v3 offset:4608
    v_dot2c_f32_bf16 v224, v164, v164
    v_dot2c_f32_bf16 v225, v166, v166
    v_dot2c_f32_bf16 v226, v188, v188
    v_dot2c_f32_bf16 v227, v190, v190
    ds_read_b64_tr_b16 v[208:209], v3 offset:8192
    ds_read_b64_tr_b16 v[210:211], v3 offset:8704
    v_dot2c_f32_bf16 v224, v165, v165
    v_dot2c_f32_bf16 v225, v167, v167
    v_dot2c_f32_bf16 v226, v189, v189
    v_dot2c_f32_bf16 v227, v191, v191
    ds_read_b64_tr_b16 v[212:213], v3 offset:12288
    ds_read_b64_tr_b16 v[214:215], v3 offset:12800
    v_dot2c_f32_bf16 v224, v172, v172
    v_dot2c_f32_bf16 v225, v174, v174
    v_dot2c_f32_bf16 v226, v196, v196
    v_dot2c_f32_bf16 v227, v198, v198
    v_dot2c_f32_bf16 v224, v173, v173
    v_dot2c_f32_bf16 v225, v175, v175
    v_dot2c_f32_bf16 v226, v197, v197
    v_dot2c_f32_bf16 v227, v199, v199
    s_add_u32 s37, s42, 1
    v_permlane16_swap_b32 v224, v225
    s_cmp_eq_u32 s37, s53
    v_permlane16_swap_b32 v226, v227
    v_add_f32 v224, v224, v225
    v_add_f32 v226, v226, v227
    s_cselect_b32 s37, s52, s37
    s_nop 0
    v_permlane32_swap_b32 v224, v226
    v_add_f32 v224, v224, v226
    s_set_gpr_idx_on s42, gpr_idx(SRC0,DST)
    s_mov_b32 s42, s37
    v_add_f32 v232, v232, v224
    s_set_gpr_idx_off
    s_cmp_lg_u32 s32, s33
    s_cbranch_scc1 K1_regB
K1_outB:
    s_cmp_eq_u32 s32, 34
    s_cbranch_scc1 K1_pretailB
.p2align 6
K1_preB:
    s_setprio 3
    s_waitcnt lgkmcnt(0)
    v_mfma_f32_16x16x32_bf16 v[152:155], v[8:11], v[200:203], 0
    ds_read_b64_tr_b16 v[216:217], v3 offset:16384
    v_mfma_f32_16x16x32_bf16 v[152:155], v[12:15], v[204:207], v[152:155]
    ds_read_b64_tr_b16 v[218:219], v3 offset:16896
    v_mfma_f32_16x16x32_bf16 v[152:155], v[16:19], v[208:211], v[152:155]
    ds_read_b64_tr_b16 v[220:221], v3 offset:20480
    v_mfma_f32_16x16x32_bf16 v[152:155], v[20:23], v[212:215], v[152:155]
    ds_read_b64_tr_b16 v[222:223], v3 offset:20992
    v_mfma_f32_16x16x32_bf16 v[160:163], v[56:59], v[200:203], 0
    ds_read_b64_tr_b16 v[224:225], v3 offset:24576
    v_mfma_f32_16x16x32_bf16 v[160:163], v[60:63], v[204:207], v[160:163]
    ds_read_b64_tr_b16 v[226:227], v3 offset:25088
    v_mfma_f32_16x16x32_bf16 v[160:163], v[64:67], v[208:211], v[160:163]
    ds_read_b64_tr_b16 v[228:229], v3 offset:28672
    v_mfma_f32_16x16x32_bf16 v[160:163], v[68:71], v[212:215], v[160:163]
    ds_read_b64_tr_b16 v[230:231], v3 offset:29184
    v_mfma_f32_16x16x32_bf16 v[168:171], v[104:107], v[200:203], 0
    buffer_store_dwordx4 v[156:159], v4, s[16:19], s47 offen offset:0
    v_mfma_f32_16x16x32_bf16 v[168:171], v[108:111], v[204:207], v[168:171]
    s_mov_b32 s57, s35
    v_mfma_f32_16x16x32_bf16 v[168:171], v[112:115], v[208:211], v[168:171]
    s_mov_b32 s40, s49
    v_mfma_f32_16x16x32_bf16 v[168:171], v[116:119], v[212:215], v[168:171]
    s_add_u32 s3, s35, 49152
    s_waitcnt lgkmcnt(0)
    v_mfma_f32_16x16x32_bf16 v[152:155], v[24:27], v[216:219], v[152:155]
    ds_read_b64_tr_b16 v[200:201], v3 offset:32768
    v_mfma_f32_16x16x32_bf16 v[152:155], v[28:31], v[220:223], v[152:155]
    ds_read_b64_tr_b16 v[202:203], v3 offset:33280
    v_mfma_f32_16x16x32_bf16 v[152:155], v[32:35], v[224:227], v[152:155]
    ds_read_b64_tr_b16 v[204:205], v3 offset:36864
    v_mfma_f32_16x16x32_bf16 v[152:155], v[36:39], v[228:231], v[152:155]
    ds_read_b64_tr_b16 v[206:207], v3 offset:37376
    v_mfma_f32_16x16x32_bf16 v[160:163], v[72:75], v[216:219], v[160:163]
    ds_read_b64_tr_b16 v[208:209], v3 offset:40960
    v_mfma_f32_16x16x32_bf16 v[160:163], v[76:79], v[220:223], v[160:163]
    ds_read_b64_tr_b16 v[210:211], v3 offset:41472
    v_mfma_f32_16x16x32_bf16 v[160:163], v[80:83], v[224:227], v[160:163]
    ds_read_b64_tr_b16 v[212:213], v3 offset:45056
    v_mfma_f32_16x16x32_bf16 v[160:163], v[84:87], v[228:231], v[160:163]
    ds_read_b64_tr_b16 v[214:215], v3 offset:45568
    v_mfma_f32_16x16x32_bf16 v[168:171], v[120:123], v[216:219], v[168:171]
    buffer_store_dwordx4 v[164:167], v4, s[16:19], s47 offen offset:1024
    v_mfma_f32_16x16x32_bf16 v[168:171], v[124:127], v[220:223], v[168:171]
    s_cmp_ge_u32 s3, 147456
    v_mfma_f32_16x16x32_bf16 v[168:171], v[128:131], v[224:227], v[168:171]
    s_cselect_b32 s3, s46, s3
    v_mfma_f32_16x16x32_bf16 v[168:171], v[132:135], v[228:231], v[168:171]
    v_xor_b32 v3, 32, v3
    s_waitcnt lgkmcnt(0)
    v_mfma_f32_16x16x32_bf16 v[152:155], v[40:43], v[200:203], v[152:155]
    ds_read_b64_tr_b16 v[216:217], v3 offset:0
    v_mfma_f32_16x16x32_bf16 v[152:155], v[44:47], v[204:207], v[152:155]
    ds_read_b64_tr_b16 v[218:219], v3 offset:512
    v_mfma_f32_16x16x32_bf16 v[152:155], v[48:51], v[208:211], v[152:155]
    ds_read_b64_tr_b16 v[220:221], v3 offset:4096
    v_mfma_f32_16x16x32_bf16 v[152:155], v[52:55], v[212:215], v[152:155]
    ds_read_b64_tr_b16 v[222:223], v3 offset:4608
    v_mfma_f32_16x16x32_bf16 v[160:163], v[88:91], v[200:203], v[160:163]
    ds_read_b64_tr_b16 v[224:225], v3 offset:8192
    v_mfma_f32_16x16x32_bf16 v[160:163], v[92:95], v[204:207], v[160:163]
    ds_read_b64_tr_b16 v[226:227], v3 offset:8704
    v_mfma_f32_16x16x32_bf16 v[160:163], v[96:99], v[208:211], v[160:163]
    ds_read_b64_tr_b16 v[228:229], v3 offset:12288
    v_mfma_f32_16x16x32_bf16 v[160:163], v[100:103], v[212:215], v[160:163]
    ds_read_b64_tr_b16 v[230:231], v3 offset:12800
    v_mfma_f32_16x16x32_bf16 v[168:171], v[136:139], v[200:203], v[168:171]
    s_add_u32 m0, s57, 0
    v_mfma_f32_16x16x32_bf16 v[168:171], v[140:143], v[204:207], v[168:171]
    buffer_store_dwordx4 v[172:175], v4, s[16:19], s47 offen offset:2048
    v_mfma_f32_16x16x32_bf16 v[168:171], v[144:147], v[208:211], v[168:171]
    s_add_u32 s58, s40, 384
    v_mfma_f32_16x16x32_bf16 v[168:171], v[148:151], v[212:215], v[168:171]
    buffer_load_dwordx4 v2, s[8:11], s58 offen nt lds
    s_waitcnt lgkmcnt(0)
    v_mfma_f32_16x16x32_bf16 v[156:159], v[8:11], v[216:219], 0
    ds_read_b64_tr_b16 v[200:201], v3 offset:16384
    v_mfma_f32_16x16x32_bf16 v[156:159], v[12:15], v[220:223], v[156:159]
    ds_read_b64_tr_b16 v[202:203], v3 offset:16896
    v_mfma_f32_16x16x32_bf16 v[156:159], v[16:19], v[224:227], v[156:159]
    ds_read_b64_tr_b16 v[204:205], v3 offset:20480
    v_mfma_f32_16x16x32_bf16 v[156:159], v[20:23], v[228:231], v[156:159]
    ds_read_b64_tr_b16 v[206:207], v3 offset:20992
    v_mfma_f32_16x16x32_bf16 v[164:167], v[56:59], v[216:219], 0
    ds_read_b64_tr_b16 v[208:209], v3 offset:24576
    v_mfma_f32_16x16x32_bf16 v[164:167], v[60:63], v[220:223], v[164:167]
    ds_read_b64_tr_b16 v[210:211], v3 offset:25088
    v_mfma_f32_16x16x32_bf16 v[164:167], v[64:67], v[224:227], v[164:167]
    ds_read_b64_tr_b16 v[212:213], v3 offset:28672
    v_mfma_f32_16x16x32_bf16 v[164:167], v[68:71], v[228:231], v[164:167]
    ds_read_b64_tr_b16 v[214:215], v3 offset:29184
    v_mfma_f32_16x16x32_bf16 v[172:175], v[104:107], v[216:219], 0
    s_add_u32 m0, m0, 1024
    v_mfma_f32_16x16x32_bf16 v[172:175], v[108:111], v[220:223], v[172:175]
    s_add_u32 s58, s58, 6144
    v_mfma_f32_16x16x32_bf16 v[172:175], v[112:115], v[224:227], v[172:175]
    buffer_load_dwordx4 v2, s[8:11], s58 offen nt lds
    v_mfma_f32_16x16x32_bf16 v[172:175], v[116:119], v[228:231], v[172:175]
    s_add_u32 m0, s57, 2048
    s_waitcnt lgkmcnt(0)
    v_mfma_f32_16x16x32_bf16 v[156:159], v[24:27], v[200:203], v[156:159]
    ds_read_b64_tr_b16 v[216:217], v3 offset:32768
    v_mfma_f32_16x16x32_bf16 v[156:159], v[28:31], v[204:207], v[156:159]
    ds_read_b64_tr_b16 v[218:219], v3 offset:33280
    v_mfma_f32_16x16x32_bf16 v[156:159], v[32:35], v[208:211], v[156:159]
    ds_read_b64_tr_b16 v[220:221], v3 offset:36864
    v_mfma_f32_16x16x32_bf16 v[156:159], v[36:39], v[212:215], v[156:159]
    ds_read_b64_tr_b16 v[222:223], v3 offset:37376
    v_mfma_f32_16x16x32_bf16 v[164:167], v[72:75], v[200:203], v[164:167]
    ds_read_b64_tr_b16 v[224:225], v3 offset:40960
    v_mfma_f32_16x16x32_bf16 v[164:167], v[76:79], v[204:207], v[164:167]
    ds_read_b64_tr_b16 v[226:227], v3 offset:41472
    v_mfma_f32_16x16x32_bf16 v[164:167], v[80:83], v[208:211], v[164:167]
    ds_read_b64_tr_b16 v[228:229], v3 offset:45056
    v_mfma_f32_16x16x32_bf16 v[164:167], v[84:87], v[212:215], v[164:167]
    ds_read_b64_tr_b16 v[230:231], v3 offset:45568
    v_mfma_f32_16x16x32_bf16 v[172:175], v[120:123], v[200:203], v[172:175]
    s_add_u32 s58, s40, 512
    v_mfma_f32_16x16x32_bf16 v[172:175], v[124:127], v[204:207], v[172:175]
    buffer_load_dwordx4 v2, s[8:11], s58 offen nt lds
    v_mfma_f32_16x16x32_bf16 v[172:175], v[128:131], v[208:211], v[172:175]
    s_add_u32 m0, m0, 1024
    v_mfma_f32_16x16x32_bf16 v[172:175], v[132:135], v[212:215], v[172:175]
    s_nop 0
    v_xor_b32 v3, 96, v3
    s_waitcnt lgkmcnt(0)
    v_mfma_f32_16x16x32_bf16 v[156:159], v[40:43], v[216:219], v[156:159]
    ds_read_b64_tr_b16 v[200:201], v3 offset:0
    v_mfma_f32_16x16x32_bf16 v[156:159], v[44:47], v[220:223], v[156:159]
    ds_read_b64_tr_b16 v[202:203], v3 offset:512
    v_mfma_f32_16x16x32_bf16 v[156:159], v[48:51], v[224:227], v[156:159]
    ds_read_b64_tr_b16 v[204:205], v3 offset:4096
    v_mfma_f32_16x16x32_bf16 v[156:159], v[52:55], v[228:231], v[156:159]
    ds_read_b64_tr_b16 v[206:207], v3 offset:4608
    v_mfma_f32_16x16x32_bf16 v[164:167], v[88:91], v[216:219], v[164:167]
    ds_read_b64_tr_b16 v[208:209], v3 offset:8192
    v_mfma_f32_16x16x32_bf16 v[164:167], v[92:95], v[220:223], v[164:167]
    ds_read_b64_tr_b16 v[210:211], v3 offset:8704
    v_mfma_f32_16x16x32_bf16 v[164:167], v[96:99], v[224:227], v[164:167]
    ds_read_b64_tr_b16 v[212:213], v3 offset:12288
    v_mfma_f32_16x16x32_bf16 v[164:167], v[100:103], v[228:231], v[164:167]
    ds_read_b64_tr_b16 v[214:215], v3 offset:12800
    v_mfma_f32_16x16x32_bf16 v[172:175], v[136:139], v[216:219], v[172:175]
    s_add_u32 s58, s58, 6144
    v_mfma_f32_16x16x32_bf16 v[172:175], v[140:143], v[220:223], v[172:175]
    buffer_load_dwordx4 v2, s[8:11], s58 offen nt lds
    v_mfma_f32_16x16x32_bf16 v[172:175], v[144:147], v[224:227], v[172:175]
    s_add_u32 m0, s57, 4096
    v_mfma_f32_16x16x32_bf16 v[172:175], v[148:151], v[228:231], v[172:175]
    s_add_u32 s58, s40, 640
    s_waitcnt lgkmcnt(0)
    v_mfma_f32_16x16x32_bf16 v[176:179], v[8:11], v[200:203], 0
    ds_read_b64_tr_b16 v[216:217], v3 offset:16384
    v_mfma_f32_16x16x32_bf16 v[176:179], v[12:15], v[204:207], v[176:179]
    ds_read_b64_tr_b16 v[218:219], v3 offset:16896
    v_mfma_f32_16x16x32_bf16 v[176:179], v[16:19], v[208:211], v[176:179]
    ds_read_b64_tr_b16 v[220:221], v3 offset:20480
    v_mfma_f32_16x16x32_bf16 v[176:179], v[20:23], v[212:215], v[176:179]
    ds_read_b64_tr_b16 v[222:223], v3 offset:20992
    v_mfma_f32_16x16x32_bf16 v[184:187], v[56:59], v[200:203], 0
    ds_read_b64_tr_b16 v[224:225], v3 offset:24576
    v_mfma_f32_16x16x32_bf16 v[184:187], v[60:63], v[204:207], v[184:187]
    ds_read_b64_tr_b16 v[226:227], v3 offset:25088
    v_mfma_f32_16x16x32_bf16 v[184:187], v[64:67], v[208:211], v[184:187]
    ds_read_b64_tr_b16 v[228:229], v3 offset:28672
    v_mfma_f32_16x16x32_bf16 v[184:187], v[68:71], v[212:215], v[184:187]
    ds_read_b64_tr_b16 v[230:231], v3 offset:29184
    v_mfma_f32_16x16x32_bf16 v[192:195], v[104:107], v[200:203], 0
    buffer_load_dwordx4 v2, s[8:11], s58 offen nt lds
    v_mfma_f32_16x16x32_bf16 v[192:195], v[108:111], v[204:207], v[192:195]
    s_add_u32 m0, m0, 1024
    v_mfma_f32_16x16x32_bf16 v[192:195], v[112:115], v[208:211], v[192:195]
    s_add_u32 s58, s58, 6144
    v_mfma_f32_16x16x32_bf16 v[192:195], v[116:119], v[212:215], v[192:195]
    buffer_load_dwordx4 v2, s[8:11], s58 offen nt lds
    s_waitcnt lgkmcnt(0)
    v_mfma_f32_16x16x32_bf16 v[176:179], v[24:27], v[216:219], v[176:179]
    ds_read_b64_tr_b16 v[200:201], v3 offset:32768
    v_mfma_f32_16x16x32_bf16 v[176:179], v[28:31], v[220:223], v[176:179]
    ds_read_b64_tr_b16 v[202:203], v3 offset:33280
    v_mfma_f32_16x16x32_bf16 v[176:179], v[32:35], v[224:227], v[176:179]
    ds_read_b64_tr_b16 v[204:205], v3 offset:36864
    v_mfma_f32_16x16x32_bf16 v[176:179], v[36:39], v[228:231], v[176:179]
    ds_read_b64_tr_b16 v[206:207], v3 offset:37376
    v_mfma_f32_16x16x32_bf16 v[184:187], v[72:75], v[216:219], v[184:187]
    ds_read_b64_tr_b16 v[208:209], v3 offset:40960
    v_mfma_f32_16x16x32_bf16 v[184:187], v[76:79], v[220:223], v[184:187]
    ds_read_b64_tr_b16 v[210:211], v3 offset:41472
    v_mfma_f32_16x16x32_bf16 v[184:187], v[80:83], v[224:227], v[184:187]
    ds_read_b64_tr_b16 v[212:213], v3 offset:45056
    v_mfma_f32_16x16x32_bf16 v[184:187], v[84:87], v[228:231], v[184:187]
    ds_read_b64_tr_b16 v[214:215], v3 offset:45568
    v_mfma_f32_16x16x32_bf16 v[192:195], v[120:123], v[216:219], v[192:195]
    s_add_u32 s34, s34, 49152
    v_mfma_f32_16x16x32_bf16 v[192:195], v[124:127], v[220:223], v[192:195]
    buffer_store_dwordx4 v[180:183], v4, s[16:19], s48 offen offset:0 nt
    v_mfma_f32_16x16x32_bf16 v[192:195], v[128:131], v[224:227], v[192:195]
    s_cmp_eq_u32 s34, 147456
    v_mfma_f32_16x16x32_bf16 v[192:195], v[132:135], v[228:231], v[192:195]
    v_xor_b32 v3, 32, v3
    s_waitcnt lgkmcnt(0)
    v_mfma_f32_16x16x32_bf16 v[176:179], v[40:43], v[200:203], v[176:179]
    ds_read_b64_tr_b16 v[216:217], v3 offset:0
    v_mfma_f32_16x16x32_bf16 v[176:179], v[44:47], v[204:207], v[176:179]
    ds_read_b64_tr_b16 v[218:219], v3 offset:512
    v_mfma_f32_16x16x32_bf16 v[176:179], v[48:51], v[208:211], v[176:179]
    ds_read_b64_tr_b16 v[220:221], v3 offset:4096
    v_mfma_f32_16x16x32_bf16 v[176:179], v[52:55], v[212:215], v[176:179]
    ds_read_b64_tr_b16 v[222:223], v3 offset:4608
    v_mfma_f32_16x16x32_bf16 v[184:187], v[88:91], v[200:203], v[184:187]
    ds_read_b64_tr_b16 v[224:225], v3 offset:8192
    v_mfma_f32_16x16x32_bf16 v[184:187], v[92:95], v[204:207], v[184:187]
    ds_read_b64_tr_b16 v[226:227], v3 offset:8704
    v_mfma_f32_16x16x32_bf16 v[184:187], v[96:99], v[208:211], v[184:187]
    ds_read_b64_tr_b16 v[228:229], v3 offset:12288
    v_mfma_f32_16x16x32_bf16 v[184:187], v[100:103], v[212:215], v[184:187]
    ds_read_b64_tr_b16 v[230:231], v3 offset:12800
    v_mfma_f32_16x16x32_bf16 v[192:195], v[136:139], v[200:203], v[192:195]
    buffer_store_dwordx4 v[188:191], v4, s[16:19], s48 offen offset:1024 nt
    v_mfma_f32_16x16x32_bf16 v[192:195], v[140:143], v[204:207], v[192:195]
    s_cselect_b32 s34, 0, s34
    v_mfma_f32_16x16x32_bf16 v[192:195], v[144:147], v[208:211], v[192:195]
    buffer_store_dwordx4 v[196:199], v4, s[16:19], s48 offen offset:2048 nt
    v_mfma_f32_16x16x32_bf16 v[192:195], v[148:151], v[212:215], v[192:195]
    s_add_u32 s32, s32, 1
    s_waitcnt lgkmcnt(0)
    v_mfma_f32_16x16x32_bf16 v[180:183], v[8:11], v[216:219], 0
    ds_read_b64_tr_b16 v[200:201], v3 offset:16384
    v_mfma_f32_16x16x32_bf16 v[180:183], v[12:15], v[220:223], v[180:183]
    ds_read_b64_tr_b16 v[202:203], v3 offset:16896
    v_mfma_f32_16x16x32_bf16 v[180:183], v[16:19], v[224:227], v[180:183]
    ds_read_b64_tr_b16 v[204:205], v3 offset:20480
    v_mfma_f32_16x16x32_bf16 v[180:183], v[20:23], v[228:231], v[180:183]
    ds_read_b64_tr_b16 v[206:207], v3 offset:20992
    v_mfma_f32_16x16x32_bf16 v[188:191], v[56:59], v[216:219], 0
    ds_read_b64_tr_b16 v[208:209], v3 offset:24576
    v_mfma_f32_16x16x32_bf16 v[188:191], v[60:63], v[220:223], v[188:191]
    ds_read_b64_tr_b16 v[210:211], v3 offset:25088
    v_mfma_f32_16x16x32_bf16 v[188:191], v[64:67], v[224:227], v[188:191]
    ds_read_b64_tr_b16 v[212:213], v3 offset:28672
    v_mfma_f32_16x16x32_bf16 v[188:191], v[68:71], v[228:231], v[188:191]
    ds_read_b64_tr_b16 v[214:215], v3 offset:29184
    v_mfma_f32_16x16x32_bf16 v[196:199], v[104:107], v[216:219], 0
    s_mul_i32 s47, s42, 24576
    v_mfma_f32_16x16x32_bf16 v[196:199], v[108:111], v[220:223], v[196:199]
    s_add_u32 s47, s47, s39
    v_mfma_f32_16x16x32_bf16 v[196:199], v[112:115], v[224:227], v[196:199]
    s_cmp_eq_u32 s42, s85
    v_mfma_f32_16x16x32_bf16 v[196:199], v[116:119], v[228:231], v[196:199]
    s_cselect_b32 s16, s26, s24
    s_waitcnt lgkmcnt(0)
    v_mfma_f32_16x16x32_bf16 v[180:183], v[24:27], v[200:203], v[180:183]
    ds_read_b64_tr_b16 v[216:217], v3 offset:32768
    v_mfma_f32_16x16x32_bf16 v[180:183], v[28:31], v[204:207], v[180:183]
    ds_read_b64_tr_b16 v[218:219], v3 offset:33280
    v_mfma_f32_16x16x32_bf16 v[180:183], v[32:35], v[208:211], v[180:183]
    ds_read_b64_tr_b16 v[220:221], v3 offset:36864
    v_mfma_f32_16x16x32_bf16 v[180:183], v[36:39], v[212:215], v[180:183]
    ds_read_b64_tr_b16 v[222:223], v3 offset:37376
    v_mfma_f32_16x16x32_bf16 v[188:191], v[72:75], v[200:203], v[188:191]
    ds_read_b64_tr_b16 v[224:225], v3 offset:40960
    v_mfma_f32_16x16x32_bf16 v[188:191], v[76:79], v[204:207], v[188:191]
    ds_read_b64_tr_b16 v[226:227], v3 offset:41472
    v_mfma_f32_16x16x32_bf16 v[188:191], v[80:83], v[208:211], v[188:191]
    ds_read_b64_tr_b16 v[228:229], v3 offset:45056
    v_mfma_f32_16x16x32_bf16 v[188:191], v[84:87], v[212:215], v[188:191]
    ds_read_b64_tr_b16 v[230:231], v3 offset:45568
    v_mfma_f32_16x16x32_bf16 v[196:199], v[120:123], v[200:203], v[196:199]
    s_cselect_b32 s17, s27, s25
    v_mfma_f32_16x16x32_bf16 v[196:199], v[124:127], v[204:207], v[196:199]
    s_cselect_b32 s47, s59, s47
    v_mfma_f32_16x16x32_bf16 v[196:199], v[128:131], v[208:211], v[196:199]
    s_mov_b32 s37, 113246208
    v_mfma_f32_16x16x32_bf16 v[196:199], v[132:135], v[212:215], v[196:199]
    s_cselect_b32 s18, s37, 446693376
    s_waitcnt lgkmcnt(0)
    v_mfma_f32_16x16x32_bf16 v[180:183], v[40:43], v[216:219], v[180:183]
    s_add_u32 s48, s47, 12288
    v_mfma_f32_16x16x32_bf16 v[180:183], v[44:47], v[220:223], v[180:183]
    v_mfma_f32_16x16x32_bf16 v[180:183], v[48:51], v[224:227], v[180:183]
    v_mfma_f32_16x16x32_bf16 v[180:183], v[52:55], v[228:231], v[180:183]
    v_mfma_f32_16x16x32_bf16 v[188:191], v[88:91], v[216:219], v[188:191]
    v_mfma_f32_16x16x32_bf16 v[188:191], v[92:95], v[220:223], v[188:191]
    v_mfma_f32_16x16x32_bf16 v[188:191], v[96:99], v[224:227], v[188:191]
    v_mfma_f32_16x16x32_bf16 v[188:191], v[100:103], v[228:231], v[188:191]
    v_mfma_f32_16x16x32_bf16 v[196:199], v[136:139], v[216:219], v[196:199]
    v_mfma_f32_16x16x32_bf16 v[196:199], v[140:143], v[220:223], v[196:199]
    v_mfma_f32_16x16x32_bf16 v[196:199], v[144:147], v[224:227], v[196:199]
    v_mfma_f32_16x16x32_bf16 v[196:199], v[148:151], v[228:231], v[196:199]
    s_setprio 0
    v_cvt_pk_f16_f32 v216, v152, v153
    v_cvt_pk_f16_f32 v217, v154, v155
    v_cvt_pk_f16_f32 v218, v156, v157
    v_cvt_pk_f16_f32 v219, v158, v159
    v_pk_fma_f16 v220, v216, v216, s44 neg_lo:[1,0,0] neg_hi:[1,0,0]
    v_pk_fma_f16 v221, v217, v217, s44 neg_lo:[1,0,0] neg_hi:[1,0,0]
    v_pk_fma_f16 v222, v218, v218, s44 neg_lo:[1,0,0] neg_hi:[1,0,0]
    v_pk_fma_f16 v223, v219, v219, s44 neg_lo:[1,0,0] neg_hi:[1,0,0]
    v_pk_mul_f16 v220, v220, v216
    v_pk_mul_f16 v221, v221, v217
    v_pk_mul_f16 v222, v222, v218
    v_pk_mul_f16 v223, v223, v219
    v_exp_f16 v216, v220
    v_exp_f16 v217, v221
    v_exp_f16 v218, v222
    v_exp_f16 v219, v223
    v_exp_f16_sdwa v216, v220 dst_sel:WORD_1 dst_unused:UNUSED_PRESERVE src0_sel:WORD_1
    v_exp_f16_sdwa v217, v221 dst_sel:WORD_1 dst_unused:UNUSED_PRESERVE src0_sel:WORD_1
    v_exp_f16_sdwa v218, v222 dst_sel:WORD_1 dst_unused:UNUSED_PRESERVE src0_sel:WORD_1
    v_exp_f16_sdwa v219, v223 dst_sel:WORD_1 dst_unused:UNUSED_PRESERVE src0_sel:WORD_1
    v_pk_add_f16 v216, v216, 1.0 op_sel_hi:[1,0]
    v_pk_add_f16 v217, v217, 1.0 op_sel_hi:[1,0]
    v_pk_add_f16 v218, v218, 1.0 op_sel_hi:[1,0]
    v_pk_add_f16 v219, v219, 1.0 op_sel_hi:[1,0]
    v_rcp_f16 v220, v216
    v_rcp_f16 v221, v217
    v_rcp_f16 v222, v218
    v_rcp_f16 v223, v219
    v_rcp_f16_sdwa v216, v216 dst_sel:DWORD dst_unused:UNUSED_PAD src0_sel:WORD_1
    v_rcp_f16_sdwa v217, v217 dst_sel:DWORD dst_unused:UNUSED_PAD src0_sel:WORD_1
    v_rcp_f16_sdwa v218, v218 dst_sel:DWORD dst_unused:UNUSED_PAD src0_sel:WORD_1
    v_rcp_f16_sdwa v219, v219 dst_sel:DWORD dst_unused:UNUSED_PAD src0_sel:WORD_1
    v_fma_mix_f32 v152, v152, v220, 0 op_sel_hi:[0,1,0]
    v_fma_mix_f32 v154, v154, v221, 0 op_sel_hi:[0,1,0]
    v_fma_mix_f32 v156, v156, v222, 0 op_sel_hi:[0,1,0]
    v_fma_mix_f32 v158, v158, v223, 0 op_sel_hi:[0,1,0]
    v_fma_mix_f32 v153, v153, v216, 0 op_sel_hi:[0,1,0]
    v_fma_mix_f32 v155, v155, v217, 0 op_sel_hi:[0,1,0]
    v_fma_mix_f32 v157, v157, v218, 0 op_sel_hi:[0,1,0]
    v_fma_mix_f32 v159, v159, v219, 0 op_sel_hi:[0,1,0]
    v_cvt_pk_bf16_f32 v159, v158, v159
    v_cvt_pk_bf16_f32 v158, v156, v157
    v_cvt_pk_bf16_f32 v157, v154, v155
    v_cvt_pk_bf16_f32 v156, v152, v153
    v_cvt_pk_f16_f32 v216, v160, v161
    v_cvt_pk_f16_f32 v217, v162, v163
    v_cvt_pk_f16_f32 v218, v164, v165
    v_cvt_pk_f16_f32 v219, v166, v167
    v_pk_fma_f16 v220, v216, v216, s44 neg_lo:[1,0,0] neg_hi:[1,0,0]
    v_pk_fma_f16 v221, v217, v217, s44 neg_lo:[1,0,0] neg_hi:[1,0,0]
    v_pk_fma_f16 v222, v218, v218, s44 neg_lo:[1,0,0] neg_hi:[1,0,0]
    v_pk_fma_f16 v223, v219, v219, s44 neg_lo:[1,0,0] neg_hi:[1,0,0]
    v_pk_mul_f16 v220, v220, v216
    v_pk_mul_f16 v221, v221, v217
    v_pk_mul_f16 v222, v222, v218
    v_pk_mul_f16 v223, v223, v219
    v_exp_f16 v216, v220
    v_exp_f16 v217, v221
    v_exp_f16 v218, v222
    v_exp_f16 v219, v223
    v_exp_f16_sdwa v216, v220 dst_sel:WORD_1 dst_unused:UNUSED_PRESERVE src0_sel:WORD_1
    v_exp_f16_sdwa v217, v221 dst_sel:WORD_1 dst_unused:UNUSED_PRESERVE src0_sel:WORD_1
    v_exp_f16_sdwa v218, v222 dst_sel:WORD_1 dst_unused:UNUSED_PRESERVE src0_sel:WORD_1
    v_exp_f16_sdwa v219, v223 dst_sel:WORD_1 dst_unused:UNUSED_PRESERVE src0_sel:WORD_1
    v_pk_add_f16 v216, v216, 1.0 op_sel_hi:[1,0]
    v_pk_add_f16 v217, v217, 1.0 op_sel_hi:[1,0]
    v_pk_add_f16 v218, v218, 1.0 op_sel_hi:[1,0]
    v_pk_add_f16 v219, v219, 1.0 op_sel_hi:[1,0]
    v_rcp_f16 v220, v216
    v_rcp_f16 v221, v217
    v_rcp_f16 v222, v218
    v_rcp_f16 v223, v219
    v_rcp_f16_sdwa v216, v216 dst_sel:DWORD dst_unused:UNUSED_PAD src0_sel:WORD_1
    v_rcp_f16_sdwa v217, v217 dst_sel:DWORD dst_unused:UNUSED_PAD src0_sel:WORD_1
    v_rcp_f16_sdwa v218, v218 dst_sel:DWORD dst_unused:UNUSED_PAD src0_sel:WORD_1
    v_rcp_f16_sdwa v219, v219 dst_sel:DWORD dst_unused:UNUSED_PAD src0_sel:WORD_1
    v_fma_mix_f32 v160, v160, v220, 0 op_sel_hi:[0,1,0]
    v_fma_mix_f32 v162, v162, v221, 0 op_sel_hi:[0,1,0]
    v_fma_mix_f32 v164, v164, v222, 0 op_sel_hi:[0,1,0]
    v_fma_mix_f32 v166, v166, v223, 0 op_sel_hi:[0,1,0]
    v_fma_mix_f32 v161, v161, v216, 0 op_sel_hi:[0,1,0]
    v_fma_mix_f32 v163, v163, v217, 0 op_sel_hi:[0,1,0]
    v_fma_mix_f32 v165, v165, v218, 0 op_sel_hi:[0,1,0]
    v_fma_mix_f32 v167, v167, v219, 0 op_sel_hi:[0,1,0]
    v_cvt_pk_bf16_f32 v167, v166, v167
    v_cvt_pk_bf16_f32 v166, v164, v165
    v_cvt_pk_bf16_f32 v165, v162, v163
    v_cvt_pk_bf16_f32 v164, v160, v161
    s_setprio 1
    s_nop 0
    v_cvt_pk_f16_f32 v216, v168, v169
    v_cvt_pk_f16_f32 v217, v170, v171
    v_cvt_pk_f16_f32 v218, v172, v173
    v_cvt_pk_f16_f32 v219, v174, v175
    v_pk_fma_f16 v220, v216, v216, s44 neg_lo:[1,0,0] neg_hi:[1,0,0]
    v_pk_fma_f16 v221, v217, v217, s44 neg_lo:[1,0,0] neg_hi:[1,0,0]
    v_pk_fma_f16 v222, v218, v218, s44 neg_lo:[1,0,0] neg_hi:[1,0,0]
    v_pk_fma_f16 v223, v219, v219, s44 neg_lo:[1,0,0] neg_hi:[1,0,0]
    v_pk_mul_f16 v220, v220, v216
    v_pk_mul_f16 v221, v221, v217
    v_pk_mul_f16 v222, v222, v218
    v_pk_mul_f16 v223, v223, v219
    v_exp_f16 v216, v220
    v_exp_f16 v217, v221
    v_exp_f16 v218, v222
    v_exp_f16 v219, v223
    v_exp_f16_sdwa v216, v220 dst_sel:WORD_1 dst_unused:UNUSED_PRESERVE src0_sel:WORD_1
    v_exp_f16_sdwa v217, v221 dst_sel:WORD_1 dst_unused:UNUSED_PRESERVE src0_sel:WORD_1
    v_exp_f16_sdwa v218, v222 dst_sel:WORD_1 dst_unused:UNUSED_PRESERVE src0_sel:WORD_1
    v_exp_f16_sdwa v219, v223 dst_sel:WORD_1 dst_unused:UNUSED_PRESERVE src0_sel:WORD_1
    v_pk_add_f16 v216, v216, 1.0 op_sel_hi:[1,0]
    v_pk_add_f16 v217, v217, 1.0 op_sel_hi:[1,0]
    v_pk_add_f16 v218, v218, 1.0 op_sel_hi:[1,0]
    v_pk_add_f16 v219, v219, 1.0 op_sel_hi:[1,0]
    v_rcp_f16 v220, v216
    v_rcp_f16 v221, v217
    v_rcp_f16 v222, v218
    v_rcp_f16 v223, v219
    v_rcp_f16_sdwa v216, v216 dst_sel:DWORD dst_unused:UNUSED_PAD src0_sel:WORD_1
    v_rcp_f16_sdwa v217, v217 dst_sel:DWORD dst_unused:UNUSED_PAD src0_sel:WORD_1
    v_rcp_f16_sdwa v218, v218 dst_sel:DWORD dst_unused:UNUSED_PAD src0_sel:WORD_1
    v_rcp_f16_sdwa v219, v219 dst_sel:DWORD dst_unused:UNUSED_PAD src0_sel:WORD_1
    v_fma_mix_f32 v168, v168, v220, 0 op_sel_hi:[0,1,0]
    v_fma_mix_f32 v170, v170, v221, 0 op_sel_hi:[0,1,0]
    v_fma_mix_f32 v172, v172, v222, 0 op_sel_hi:[0,1,0]
    v_fma_mix_f32 v174, v174, v223, 0 op_sel_hi:[0,1,0]
    v_fma_mix_f32 v169, v169, v216, 0 op_sel_hi:[0,1,0]
    v_fma_mix_f32 v171, v171, v217, 0 op_sel_hi:[0,1,0]
    v_fma_mix_f32 v173, v173, v218, 0 op_sel_hi:[0,1,0]
    v_fma_mix_f32 v175, v175, v219, 0 op_sel_hi:[0,1,0]
    v_cvt_pk_bf16_f32 v175, v174, v175
    v_cvt_pk_bf16_f32 v174, v172, v173
    v_cvt_pk_bf16_f32 v173, v170, v171
    v_cvt_pk_bf16_f32 v172, v168, v169
    s_barrier
    s_nop 0
    v_cvt_pk_f16_f32 v216, v176, v177
    v_cvt_pk_f16_f32 v217, v178, v179
    v_cvt_pk_f16_f32 v218, v180, v181
    v_cvt_pk_f16_f32 v219, v182, v183
    v_pk_fma_f16 v220, v216, v216, s44 neg_lo:[1,0,0] neg_hi:[1,0,0]
    v_pk_fma_f16 v221, v217, v217, s44 neg_lo:[1,0,0] neg_hi:[1,0,0]
    v_pk_fma_f16 v222, v218, v218, s44 neg_lo:[1,0,0] neg_hi:[1,0,0]
    v_pk_fma_f16 v223, v219, v219, s44 neg_lo:[1,0,0] neg_hi:[1,0,0]
    v_pk_mul_f16 v220, v220, v216
    v_pk_mul_f16 v221, v221, v217
    v_pk_mul_f16 v222, v222, v218
    v_pk_mul_f16 v223, v223, v219
    v_exp_f16 v216, v220
    v_exp_f16 v217, v221
    v_exp_f16 v218, v222
    v_exp_f16 v219, v223
    v_exp_f16_sdwa v216, v220 dst_sel:WORD_1 dst_unused:UNUSED_PRESERVE src0_sel:WORD_1
    v_exp_f16_sdwa v217, v221 dst_sel:WORD_1 dst_unused:UNUSED_PRESERVE src0_sel:WORD_1
    v_exp_f16_sdwa v218, v222 dst_sel:WORD_1 dst_unused:UNUSED_PRESERVE src0_sel:WORD_1
    v_exp_f16_sdwa v219, v223 dst_sel:WORD_1 dst_unused:UNUSED_PRESERVE src0_sel:WORD_1
    v_pk_add_f16 v216, v216, 1.0 op_sel_hi:[1,0]
    v_pk_add_f16 v217, v217, 1.0 op_sel_hi:[1,0]
    v_pk_add_f16 v218, v218, 1.0 op_sel_hi:[1,0]
    v_pk_add_f16 v219, v219, 1.0 op_sel_hi:[1,0]
    v_rcp_f16 v220, v216
    v_rcp_f16 v221, v217
    v_rcp_f16 v222, v218
    v_rcp_f16 v223, v219
    v_rcp_f16_sdwa v216, v216 dst_sel:DWORD dst_unused:UNUSED_PAD src0_sel:WORD_1
    v_rcp_f16_sdwa v217, v217 dst_sel:DWORD dst_unused:UNUSED_PAD src0_sel:WORD_1
    v_rcp_f16_sdwa v218, v218 dst_sel:DWORD dst_unused:UNUSED_PAD src0_sel:WORD_1
    v_rcp_f16_sdwa v219, v219 dst_sel:DWORD dst_unused:UNUSED_PAD src0_sel:WORD_1
    v_fma_mix_f32 v176, v176, v220, 0 op_sel_hi:[0,1,0]
    v_fma_mix_f32 v178, v178, v221, 0 op_sel_hi:[0,1,0]
    v_fma_mix_f32 v180, v180, v222, 0 op_sel_hi:[0,1,0]
    v_fma_mix_f32 v182, v182, v223, 0 op_sel_hi:[0,1,0]
    v_fma_mix_f32 v177, v177, v216, 0 op_sel_hi:[0,1,0]
    v_fma_mix_f32 v179, v179, v217, 0 op_sel_hi:[0,1,0]
    v_fma_mix_f32 v181, v181, v218, 0 op_sel_hi:[0,1,0]
    v_fma_mix_f32 v183, v183, v219, 0 op_sel_hi:[0,1,0]
    v_cvt_pk_bf16_f32 v183, v182, v183
    v_cvt_pk_bf16_f32 v182, v180, v181
    v_cvt_pk_bf16_f32 v181, v178, v179
    v_cvt_pk_bf16_f32 v180, v176, v177
    v_cvt_pk_f16_f32 v216, v184, v185
    v_cvt_pk_f16_f32 v217, v186, v187
    v_cvt_pk_f16_f32 v218, v188, v189
    v_cvt_pk_f16_f32 v219, v190, v191
    v_pk_fma_f16 v220, v216, v216, s44 neg_lo:[1,0,0] neg_hi:[1,0,0]
    v_pk_fma_f16 v221, v217, v217, s44 neg_lo:[1,0,0] neg_hi:[1,0,0]
    v_pk_fma_f16 v222, v218, v218, s44 neg_lo:[1,0,0] neg_hi:[1,0,0]
    v_pk_fma_f16 v223, v219, v219, s44 neg_lo:[1,0,0] neg_hi:[1,0,0]
    v_pk_mul_f16 v220, v220, v216
    v_pk_mul_f16 v221, v221, v217
    v_pk_mul_f16 v222, v222, v218
    v_pk_mul_f16 v223, v223, v219
    v_exp_f16 v216, v220
    v_exp_f16 v217, v221
    v_exp_f16 v218, v222
    v_exp_f16 v219, v223
    v_exp_f16_sdwa v216, v220 dst_sel:WORD_1 dst_unused:UNUSED_PRESERVE src0_sel:WORD_1
    v_exp_f16_sdwa v217, v221 dst_sel:WORD_1 dst_unused:UNUSED_PRESERVE src0_sel:WORD_1
    v_exp_f16_sdwa v218, v222 dst_sel:WORD_1 dst_unused:UNUSED_PRESERVE src0_sel:WORD_1
    v_exp_f16_sdwa v219, v223 dst_sel:WORD_1 dst_unused:UNUSED_PRESERVE src0_sel:WORD_1
    v_pk_add_f16 v216, v216, 1.0 op_sel_hi:[1,0]
    v_pk_add_f16 v217, v217, 1.0 op_sel_hi:[1,0]
    v_pk_add_f16 v218, v218, 1.0 op_sel_hi:[1,0]
    v_pk_add_f16 v219, v219, 1.0 op_sel_hi:[1,0]
    v_rcp_f16 v220, v216
    v_rcp_f16 v221, v217
    v_rcp_f16 v222, v218
    v_rcp_f16 v223, v219
    v_rcp_f16_sdwa v216, v216 dst_sel:DWORD dst_unused:UNUSED_PAD src0_sel:WORD_1
    v_rcp_f16_sdwa v217, v217 dst_sel:DWORD dst_unused:UNUSED_PAD src0_sel:WORD_1
    v_rcp_f16_sdwa v218, v218 dst_sel:DWORD dst_unused:UNUSED_PAD src0_sel:WORD_1
    v_rcp_f16_sdwa v219, v219 dst_sel:DWORD dst_unused:UNUSED_PAD src0_sel:WORD_1
    v_fma_mix_f32 v184, v184, v220, 0 op_sel_hi:[0,1,0]
    v_fma_mix_f32 v186, v186, v221, 0 op_sel_hi:[0,1,0]
    v_fma_mix_f32 v188, v188, v222, 0 op_sel_hi:[0,1,0]
    v_fma_mix_f32 v190, v190, v223, 0 op_sel_hi:[0,1,0]
    v_fma_mix_f32 v185, v185, v216, 0 op_sel_hi:[0,1,0]
    v_fma_mix_f32 v187, v187, v217, 0 op_sel_hi:[0,1,0]
    v_fma_mix_f32 v189, v189, v218, 0 op_sel_hi:[0,1,0]
    v_fma_mix_f32 v191, v191, v219, 0 op_sel_hi:[0,1,0]
    v_cvt_pk_bf16_f32 v191, v190, v191
    v_cvt_pk_bf16_f32 v190, v188, v189
    v_cvt_pk_bf16_f32 v189, v186, v187
    v_cvt_pk_bf16_f32 v188, v184, v185
    v_cvt_pk_f16_f32 v216, v192, v193
    v_cvt_pk_f16_f32 v217, v194, v195
    v_cvt_pk_f16_f32 v218, v196, v197
    v_cvt_pk_f16_f32 v219, v198, v199
    v_pk_fma_f16 v220, v216, v216, s44 neg_lo:[1,0,0] neg_hi:[1,0,0]
    v_pk_fma_f16 v221, v217, v217, s44 neg_lo:[1,0,0] neg_hi:[1,0,0]
    v_pk_fma_f16 v222, v218, v218, s44 neg_lo:[1,0,0] neg_hi:[1,0,0]
    v_pk_fma_f16 v223, v219, v219, s44 neg_lo:[1,0,0] neg_hi:[1,0,0]
    v_pk_mul_f16 v220, v220, v216
    v_pk_mul_f16 v221, v221, v217
    v_pk_mul_f16 v222, v222, v218
    v_pk_mul_f16 v223, v223, v219
    v_exp_f16 v216, v220
    v_exp_f16 v217, v221
    v_exp_f16 v218, v222
    v_exp_f16 v219, v223
    v_exp_f16_sdwa v216, v220 dst_sel:WORD_1 dst_unused:UNUSED_PRESERVE src0_sel:WORD_1
    v_exp_f16_sdwa v217, v221 dst_sel:WORD_1 dst_unused:UNUSED_PRESERVE src0_sel:WORD_1
    v_exp_f16_sdwa v218, v222 dst_sel:WORD_1 dst_unused:UNUSED_PRESERVE src0_sel:WORD_1
    v_exp_f16_sdwa v219, v223 dst_sel:WORD_1 dst_unused:UNUSED_PRESERVE src0_sel:WORD_1
    v_pk_add_f16 v216, v216, 1.0 op_sel_hi:[1,0]
    v_pk_add_f16 v217, v217, 1.0 op_sel_hi:[1,0]
    v_pk_add_f16 v218, v218, 1.0 op_sel_hi:[1,0]
    v_pk_add_f16 v219, v219, 1.0 op_sel_hi:[1,0]
    v_rcp_f16 v220, v216
    v_rcp_f16 v221, v217
    v_rcp_f16 v222, v218
    v_rcp_f16 v223, v219
    v_rcp_f16_sdwa v216, v216 dst_sel:DWORD dst_unused:UNUSED_PAD src0_sel:WORD_1
    v_rcp_f16_sdwa v217, v217 dst_sel:DWORD dst_unused:UNUSED_PAD src0_sel:WORD_1
    v_rcp_f16_sdwa v218, v218 dst_sel:DWORD dst_unused:UNUSED_PAD src0_sel:WORD_1
    v_rcp_f16_sdwa v219, v219 dst_sel:DWORD dst_unused:UNUSED_PAD src0_sel:WORD_1
    v_fma_mix_f32 v192, v192, v220, 0 op_sel_hi:[0,1,0]
    v_fma_mix_f32 v194, v194, v221, 0 op_sel_hi:[0,1,0]
    v_fma_mix_f32 v196, v196, v222, 0 op_sel_hi:[0,1,0]
    v_fma_mix_f32 v198, v198, v223, 0 op_sel_hi:[0,1,0]
    v_fma_mix_f32 v193, v193, v216, 0 op_sel_hi:[0,1,0]
    v_fma_mix_f32 v195, v195, v217, 0 op_sel_hi:[0,1,0]
    v_fma_mix_f32 v197, v197, v218, 0 op_sel_hi:[0,1,0]
    v_fma_mix_f32 v199, v199, v219, 0 op_sel_hi:[0,1,0]
    v_cvt_pk_bf16_f32 v199, v198, v199
    v_cvt_pk_bf16_f32 v198, v196, v197
    v_cvt_pk_bf16_f32 v197, v194, v195
    v_cvt_pk_bf16_f32 v196, v192, v193
    v_dot2_f32_bf16 v224, v156, v156, 0
    v_dot2_f32_bf16 v225, v158, v158, 0
    v_dot2_f32_bf16 v226, v180, v180, 0
    v_dot2_f32_bf16 v227, v182, v182, 0
    v_add_u32 v3, s34, v7
    ds_read_b64_tr_b16 v[200:201], v3 offset:0
    ds_read_b64_tr_b16 v[202:203], v3 offset:512
    v_dot2c_f32_bf16 v224, v157, v157
    v_dot2c_f32_bf16 v225, v159, v159
    v_dot2c_f32_bf16 v226, v181, v181
    v_dot2c_f32_bf16 v227, v183, v183
    ds_read_b64_tr_b16 v[204:205], v3 offset:4096
    ds_read_b64_tr_b16 v[206:207], v3 offset:4608
    v_dot2c_f32_bf16 v224, v164, v164
    v_dot2c_f32_bf16 v225, v166, v166
    v_dot2c_f32_bf16 v226, v188, v188
    v_dot2c_f32_bf16 v227, v190, v190
    ds_read_b64_tr_b16 v[208:209], v3 offset:8192
    ds_read_b64_tr_b16 v[210:211], v3 offset:8704
    v_dot2c_f32_bf16 v224, v165, v165
    v_dot2c_f32_bf16 v225, v167, v167
    v_dot2c_f32_bf16 v226, v189, v189
    v_dot2c_f32_bf16 v227, v191, v191
    ds_read_b64_tr_b16 v[212:213], v3 offset:12288
    ds_read_b64_tr_b16 v[214:215], v3 offset:12800
    v_dot2c_f32_bf16 v224, v172, v172
    v_dot2c_f32_bf16 v225, v174, v174
    v_dot2c_f32_bf16 v226, v196, v196
    v_dot2c_f32_bf16 v227, v198, v198
    v_dot2c_f32_bf16 v224, v173, v173
    v_dot2c_f32_bf16 v225, v175, v175
    v_dot2c_f32_bf16 v226, v197, v197
    v_dot2c_f32_bf16 v227, v199, v199
    s_add_u32 s37, s42, 1
    v_permlane16_swap_b32 v224, v225
    s_cmp_eq_u32 s37, s53
    v_permlane16_swap_b32 v226, v227
    v_add_f32 v224, v224, v225
    v_add_f32 v226, v226, v227
    s_cselect_b32 s37, s52, s37
    s_nop 0
    v_permlane32_swap_b32 v224, v226
    v_add_f32 v224, v224, v226
    s_set_gpr_idx_on s42, gpr_idx(SRC0,DST)
    s_mov_b32 s42, s37
    v_add_f32 v232, v232, v224
    s_set_gpr_idx_off
.p2align 6
K1_lastB:
    s_setprio 3
    s_waitcnt lgkmcnt(0)
    v_mfma_f32_16x16x32_bf16 v[152:155], v[8:11], v[200:203], 0
    ds_read_b64_tr_b16 v[216:217], v3 offset:16384
    v_mfma_f32_16x16x32_bf16 v[152:155], v[12:15], v[204:207], v[152:155]
    ds_read_b64_tr_b16 v[218:219], v3 offset:16896
    v_mfma_f32_16x16x32_bf16 v[152:155], v[16:19], v[208:211], v[152:155]
    ds_read_b64_tr_b16 v[220:221], v3 offset:20480
    v_mfma_f32_16x16x32_bf16 v[152:155], v[20:23], v[212:215], v[152:155]
    ds_read_b64_tr_b16 v[222:223], v3 offset:20992
    v_mfma_f32_16x16x32_bf16 v[160:163], v[56:59], v[200:203], 0
    ds_read_b64_tr_b16 v[224:225], v3 offset:24576
    v_mfma_f32_16x16x32_bf16 v[160:163], v[60:63], v[204:207], v[160:163]
    ds_read_b64_tr_b16 v[226:227], v3 offset:25088
    v_mfma_f32_16x16x32_bf16 v[160:163], v[64:67], v[208:211], v[160:163]
    ds_read_b64_tr_b16 v[228:229], v3 offset:28672
    v_mfma_f32_16x16x32_bf16 v[160:163], v[68:71], v[212:215], v[160:163]
    ds_read_b64_tr_b16 v[230:231], v3 offset:29184
    v_mfma_f32_16x16x32_bf16 v[168:171], v[104:107], v[200:203], 0
    buffer_store_dwordx4 v[156:159], v4, s[16:19], s47 offen offset:0
    v_mfma_f32_16x16x32_bf16 v[168:171], v[108:111], v[204:207], v[168:171]
    s_add_u32 m0, s3, 0
    v_mfma_f32_16x16x32_bf16 v[168:171], v[112:115], v[208:211], v[168:171]
    s_add_u32 s58, s40, 256
    v_mfma_f32_16x16x32_bf16 v[168:171], v[116:119], v[212:215], v[168:171]
    buffer_load_dwordx4 v2, s[8:11], s58 offen nt lds
    s_waitcnt lgkmcnt(0)
    v_mfma_f32_16x16x32_bf16 v[152:155], v[24:27], v[216:219], v[152:155]
    ds_read_b64_tr_b16 v[200:201], v3 offset:32768
    v_mfma_f32_16x16x32_bf16 v[152:155], v[28:31], v[220:223], v[152:155]
    ds_read_b64_tr_b16 v[202:203], v3 offset:33280
    v_mfma_f32_16x16x32_bf16 v[152:155], v[32:35], v[224:227], v[152:155]
    ds_read_b64_tr_b16 v[204:205], v3 offset:36864
    v_mfma_f32_16x16x32_bf16 v[152:155], v[36:39], v[228:231], v[152:155]
    ds_read_b64_tr_b16 v[206:207], v3 offset:37376
    v_mfma_f32_16x16x32_bf16 v[160:163], v[72:75], v[216:219], v[160:163]
    ds_read_b64_tr_b16 v[208:209], v3 offset:40960
    v_mfma_f32_16x16x32_bf16 v[160:163], v[76:79], v[220:223], v[160:163]
    ds_read_b64_tr_b16 v[210:211], v3 offset:41472
    v_mfma_f32_16x16x32_bf16 v[160:163], v[80:83], v[224:227], v[160:163]
    ds_read_b64_tr_b16 v[212:213], v3 offset:45056
    v_mfma_f32_16x16x32_bf16 v[160:163], v[84:87], v[228:231], v[160:163]
    ds_read_b64_tr_b16 v[214:215], v3 offset:45568
    v_mfma_f32_16x16x32_bf16 v[168:171], v[120:123], v[216:219], v[168:171]
    buffer_store_dwordx4 v[164:167], v4, s[16:19], s47 offen offset:1024
    v_mfma_f32_16x16x32_bf16 v[168:171], v[124:127], v[220:223], v[168:171]
    s_add_u32 m0, m0, 1024
    v_mfma_f32_16x16x32_bf16 v[168:171], v[128:131], v[224:227], v[168:171]
    s_add_u32 s58, s58, 6144
    v_mfma_f32_16x16x32_bf16 v[168:171], v[132:135], v[228:231], v[168:171]
    v_xor_b32 v3, 32, v3
    s_waitcnt lgkmcnt(0)
    v_mfma_f32_16x16x32_bf16 v[152:155], v[40:43], v[200:203], v[152:155]
    ds_read_b64_tr_b16 v[216:217], v3 offset:0
    v_mfma_f32_16x16x32_bf16 v[152:155], v[44:47], v[204:207], v[152:155]
    ds_read_b64_tr_b16 v[218:219], v3 offset:512
    v_mfma_f32_16x16x32_bf16 v[152:155], v[48:51], v[208:211], v[152:155]
    ds_read_b64_tr_b16 v[220:221], v3 offset:4096
    v_mfma_f32_16x16x32_bf16 v[152:155], v[52:55], v[212:215], v[152:155]
    ds_read_b64_tr_b16 v[222:223], v3 offset:4608
    v_mfma_f32_16x16x32_bf16 v[160:163], v[88:91], v[200:203], v[160:163]
    ds_read_b64_tr_b16 v[224:225], v3 offset:8192
    v_mfma_f32_16x16x32_bf16 v[160:163], v[92:95], v[204:207], v[160:163]
    ds_read_b64_tr_b16 v[226:227], v3 offset:8704
    v_mfma_f32_16x16x32_bf16 v[160:163], v[96:99], v[208:211], v[160:163]
    ds_read_b64_tr_b16 v[228:229], v3 offset:12288
    v_mfma_f32_16x16x32_bf16 v[160:163], v[100:103], v[212:215], v[160:163]
    ds_read_b64_tr_b16 v[230:231], v3 offset:12800
    v_mfma_f32_16x16x32_bf16 v[168:171], v[136:139], v[200:203], v[168:171]
    buffer_load_dwordx4 v2, s[8:11], s58 offen nt lds
    v_mfma_f32_16x16x32_bf16 v[168:171], v[140:143], v[204:207], v[168:171]
    buffer_store_dwordx4 v[172:175], v4, s[16:19], s47 offen offset:2048
    v_mfma_f32_16x16x32_bf16 v[168:171], v[144:147], v[208:211], v[168:171]
    s_add_u32 m0, s3, 2048
    v_mfma_f32_16x16x32_bf16 v[168:171], v[148:151], v[212:215], v[168:171]
    s_add_u32 s58, s40, 128
    s_waitcnt lgkmcnt(0)
    v_mfma_f32_16x16x32_bf16 v[156:159], v[8:11], v[216:219], 0
    ds_read_b64_tr_b16 v[200:201], v3 offset:16384
    v_mfma_f32_16x16x32_bf16 v[156:159], v[12:15], v[220:223], v[156:159]
    ds_read_b64_tr_b16 v[202:203], v3 offset:16896
    v_mfma_f32_16x16x32_bf16 v[156:159], v[16:19], v[224:227], v[156:159]
    ds_read_b64_tr_b16 v[204:205], v3 offset:20480
    v_mfma_f32_16x16x32_bf16 v[156:159], v[20:23], v[228:231], v[156:159]
    ds_read_b64_tr_b16 v[206:207], v3 offset:20992
    v_mfma_f32_16x16x32_bf16 v[164:167], v[56:59], v[216:219], 0
    ds_read_b64_tr_b16 v[208:209], v3 offset:24576
    v_mfma_f32_16x16x32_bf16 v[164:167], v[60:63], v[220:223], v[164:167]
    ds_read_b64_tr_b16 v[210:211], v3 offset:25088
    v_mfma_f32_16x16x32_bf16 v[164:167], v[64:67], v[224:227], v[164:167]
    ds_read_b64_tr_b16 v[212:213], v3 offset:28672
    v_mfma_f32_16x16x32_bf16 v[164:167], v[68:71], v[228:231], v[164:167]
    ds_read_b64_tr_b16 v[214:215], v3 offset:29184
    v_mfma_f32_16x16x32_bf16 v[172:175], v[104:107], v[216:219], 0
    buffer_load_dwordx4 v2, s[8:11], s58 offen nt lds
    v_mfma_f32_16x16x32_bf16 v[172:175], v[108:111], v[220:223], v[172:175]
    s_add_u32 m0, m0, 1024
    v_mfma_f32_16x16x32_bf16 v[172:175], v[112:115], v[224:227], v[172:175]
    s_add_u32 s58, s58, 6144
    v_mfma_f32_16x16x32_bf16 v[172:175], v[116:119], v[228:231], v[172:175]
    buffer_load_dwordx4 v2, s[8:11], s58 offen nt lds
    s_waitcnt lgkmcnt(0)
    v_mfma_f32_16x16x32_bf16 v[156:159], v[24:27], v[200:203], v[156:159]
    ds_read_b64_tr_b16 v[216:217], v3 offset:32768
    v_mfma_f32_16x16x32_bf16 v[156:159], v[28:31], v[204:207], v[156:159]
    ds_read_b64_tr_b16 v[218:219], v3 offset:33280
    v_mfma_f32_16x16x32_bf16 v[156:159], v[32:35], v[208:211], v[156:159]
    ds_read_b64_tr_b16 v[220:221], v3 offset:36864
    v_mfma_f32_16x16x32_bf16 v[156:159], v[36:39], v[212:215], v[156:159]
    ds_read_b64_tr_b16 v[222:223], v3 offset:37376
    v_mfma_f32_16x16x32_bf16 v[164:167], v[72:75], v[200:203], v[164:167]
    ds_read_b64_tr_b16 v[224:225], v3 offset:40960
    v_mfma_f32_16x16x32_bf16 v[164:167], v[76:79], v[204:207], v[164:167]
    ds_read_b64_tr_b16 v[226:227], v3 offset:41472
    v_mfma_f32_16x16x32_bf16 v[164:167], v[80:83], v[208:211], v[164:167]
    ds_read_b64_tr_b16 v[228:229], v3 offset:45056
    v_mfma_f32_16x16x32_bf16 v[164:167], v[84:87], v[212:215], v[164:167]
    ds_read_b64_tr_b16 v[230:231], v3 offset:45568
    v_mfma_f32_16x16x32_bf16 v[172:175], v[120:123], v[200:203], v[172:175]
    s_add_u32 m0, s3, 4096
    v_mfma_f32_16x16x32_bf16 v[172:175], v[124:127], v[204:207], v[172:175]
    s_add_u32 s58, s40, 0
    v_mfma_f32_16x16x32_bf16 v[172:175], v[128:131], v[208:211], v[172:175]
    buffer_load_dwordx4 v2, s[8:11], s58 offen nt lds
    v_mfma_f32_16x16x32_bf16 v[172:175], v[132:135], v[212:215], v[172:175]
    s_nop 0
    v_xor_b32 v3, 96, v3
    s_waitcnt lgkmcnt(0)
    v_mfma_f32_16x16x32_bf16 v[156:159], v[40:43], v[216:219], v[156:159]
    ds_read_b64_tr_b16 v[200:201], v3 offset:0
    v_mfma_f32_16x16x32_bf16 v[156:159], v[44:47], v[220:223], v[156:159]
    ds_read_b64_tr_b16 v[202:203], v3 offset:512
    v_mfma_f32_16x16x32_bf16 v[156:159], v[48:51], v[224:227], v[156:159]
    ds_read_b64_tr_b16 v[204:205], v3 offset:4096
    v_mfma_f32_16x16x32_bf16 v[156:159], v[52:55], v[228:231], v[156:159]
    ds_read_b64_tr_b16 v[206:207], v3 offset:4608
    v_mfma_f32_16x16x32_bf16 v[164:167], v[88:91], v[216:219], v[164:167]
    ds_read_b64_tr_b16 v[208:209], v3 offset:8192
    v_mfma_f32_16x16x32_bf16 v[164:167], v[92:95], v[220:223], v[164:167]
    ds_read_b64_tr_b16 v[210:211], v3 offset:8704
    v_mfma_f32_16x16x32_bf16 v[164:167], v[96:99], v[224:227], v[164:167]
    ds_read_b64_tr_b16 v[212:213], v3 offset:12288
    v_mfma_f32_16x16x32_bf16 v[164:167], v[100:103], v[228:231], v[164:167]
    ds_read_b64_tr_b16 v[214:215], v3 offset:12800
    v_mfma_f32_16x16x32_bf16 v[172:175], v[136:139], v[216:219], v[172:175]
    s_add_u32 m0, m0, 1024
    v_mfma_f32_16x16x32_bf16 v[172:175], v[140:143], v[220:223], v[172:175]
    s_add_u32 s58, s58, 6144
    v_mfma_f32_16x16x32_bf16 v[172:175], v[144:147], v[224:227], v[172:175]
    buffer_load_dwordx4 v2, s[8:11], s58 offen nt lds
    v_mfma_f32_16x16x32_bf16 v[172:175], v[148:151], v[228:231], v[172:175]
    s_add_u32 s34, s34, 49152
    s_waitcnt lgkmcnt(0)
    v_mfma_f32_16x16x32_bf16 v[176:179], v[8:11], v[200:203], 0
    ds_read_b64_tr_b16 v[216:217], v3 offset:16384
    v_mfma_f32_16x16x32_bf16 v[176:179], v[12:15], v[204:207], v[176:179]
    ds_read_b64_tr_b16 v[218:219], v3 offset:16896
    v_mfma_f32_16x16x32_bf16 v[176:179], v[16:19], v[208:211], v[176:179]
    ds_read_b64_tr_b16 v[220:221], v3 offset:20480
    v_mfma_f32_16x16x32_bf16 v[176:179], v[20:23], v[212:215], v[176:179]
    ds_read_b64_tr_b16 v[222:223], v3 offset:20992
    v_mfma_f32_16x16x32_bf16 v[184:187], v[56:59], v[200:203], 0
    ds_read_b64_tr_b16 v[224:225], v3 offset:24576
    v_mfma_f32_16x16x32_bf16 v[184:187], v[60:63], v[204:207], v[184:187]
    ds_read_b64_tr_b16 v[226:227], v3 offset:25088
    v_mfma_f32_16x16x32_bf16 v[184:187], v[64:67], v[208:211], v[184:187]
    ds_read_b64_tr_b16 v[228:229], v3 offset:28672
    v_mfma_f32_16x16x32_bf16 v[184:187], v[68:71], v[212:215], v[184:187]
    ds_read_b64_tr_b16 v[230:231], v3 offset:29184
    v_mfma_f32_16x16x32_bf16 v[192:195], v[104:107], v[200:203], 0
    buffer_store_dwordx4 v[180:183], v4, s[16:19], s48 offen offset:0 nt
    v_mfma_f32_16x16x32_bf16 v[192:195], v[108:111], v[204:207], v[192:195]
    s_cmp_eq_u32 s34, 147456
    v_mfma_f32_16x16x32_bf16 v[192:195], v[112:115], v[208:211], v[192:195]
    buffer_store_dwordx4 v[188:191], v4, s[16:19], s48 offen offset:1024 nt
    v_mfma_f32_16x16x32_bf16 v[192:195], v[116:119], v[212:215], v[192:195]
    s_cselect_b32 s34, 0, s34
    s_waitcnt lgkmcnt(0)
    v_mfma_f32_16x16x32_bf16 v[176:179], v[24:27], v[216:219], v[176:179]
    ds_read_b64_tr_b16 v[200:201], v3 offset:32768
    v_mfma_f32_16x16x32_bf16 v[176:179], v[28:31], v[220:223], v[176:179]
    ds_read_b64_tr_b16 v[202:203], v3 offset:33280
    v_mfma_f32_16x16x32_bf16 v[176:179], v[32:35], v[224:227], v[176:179]
    ds_read_b64_tr_b16 v[204:205], v3 offset:36864
    v_mfma_f32_16x16x32_bf16 v[176:179], v[36:39], v[228:231], v[176:179]
    ds_read_b64_tr_b16 v[206:207], v3 offset:37376
    v_mfma_f32_16x16x32_bf16 v[184:187], v[72:75], v[216:219], v[184:187]
    ds_read_b64_tr_b16 v[208:209], v3 offset:40960
    v_mfma_f32_16x16x32_bf16 v[184:187], v[76:79], v[220:223], v[184:187]
    ds_read_b64_tr_b16 v[210:211], v3 offset:41472
    v_mfma_f32_16x16x32_bf16 v[184:187], v[80:83], v[224:227], v[184:187]
    ds_read_b64_tr_b16 v[212:213], v3 offset:45056
    v_mfma_f32_16x16x32_bf16 v[184:187], v[84:87], v[228:231], v[184:187]
    ds_read_b64_tr_b16 v[214:215], v3 offset:45568
    v_mfma_f32_16x16x32_bf16 v[192:195], v[120:123], v[216:219], v[192:195]
    buffer_store_dwordx4 v[196:199], v4, s[16:19], s48 offen offset:2048 nt
    v_mfma_f32_16x16x32_bf16 v[192:195], v[124:127], v[220:223], v[192:195]
    s_add_u32 s32, s32, 1
    v_mfma_f32_16x16x32_bf16 v[192:195], v[128:131], v[224:227], v[192:195]
    s_mul_i32 s47, s42, 24576
    v_mfma_f32_16x16x32_bf16 v[192:195], v[132:135], v[228:231], v[192:195]
    v_xor_b32 v3, 32, v3
    s_waitcnt lgkmcnt(0)
    v_mfma_f32_16x16x32_bf16 v[176:179], v[40:43], v[200:203], v[176:179]
    ds_read_b64_tr_b16 v[216:217], v3 offset:0
    v_mfma_f32_16x16x32_bf16 v[176:179], v[44:47], v[204:207], v[176:179]
    ds_read_b64_tr_b16 v[218:219], v3 offset:512
    v_mfma_f32_16x16x32_bf16 v[176:179], v[48:51], v[208:211], v[176:179]
    ds_read_b64_tr_b16 v[220:221], v3 offset:4096
    v_mfma_f32_16x16x32_bf16 v[176:179], v[52:55], v[212:215], v[176:179]
    ds_read_b64_tr_b16 v[222:223], v3 offset:4608
    v_mfma_f32_16x16x32_bf16 v[184:187], v[88:91], v[200:203], v[184:187]
    ds_read_b64_tr_b16 v[224:225], v3 offset:8192
    v_mfma_f32_16x16x32_bf16 v[184:187], v[92:95], v[204:207], v[184:187]
    ds_read_b64_tr_b16 v[226:227], v3 offset:8704
    v_mfma_f32_16x16x32_bf16 v[184:187], v[96:99], v[208:211], v[184:187]
    ds_read_b64_tr_b16 v[228:229], v3 offset:12288
    v_mfma_f32_16x16x32_bf16 v[184:187], v[100:103], v[212:215], v[184:187]
    ds_read_b64_tr_b16 v[230:231], v3 offset:12800
    v_mfma_f32_16x16x32_bf16 v[192:195], v[136:139], v[200:203], v[192:195]
    s_add_u32 s47, s47, s39
    v_mfma_f32_16x16x32_bf16 v[192:195], v[140:143], v[204:207], v[192:195]
    s_cmp_eq_u32 s42, s85
    v_mfma_f32_16x16x32_bf16 v[192:195], v[144:147], v[208:211], v[192:195]
    s_cselect_b32 s16, s26, s24
    v_mfma_f32_16x16x32_bf16 v[192:195], v[148:151], v[212:215], v[192:195]
    s_cselect_b32 s17, s27, s25
    s_waitcnt lgkmcnt(0)
    v_mfma_f32_16x16x32_bf16 v[180:183], v[8:11], v[216:219], 0
    ds_read_b64_tr_b16 v[200:201], v3 offset:16384
    v_mfma_f32_16x16x32_bf16 v[180:183], v[12:15], v[220:223], v[180:183]
    ds_read_b64_tr_b16 v[202:203], v3 offset:16896
    v_mfma_f32_16x16x32_bf16 v[180:183], v[16:19], v[224:227], v[180:183]
    ds_read_b64_tr_b16 v[204:205], v3 offset:20480
    v_mfma_f32_16x16x32_bf16 v[180:183], v[20:23], v[228:231], v[180:183]
    ds_read_b64_tr_b16 v[206:207], v3 offset:20992
    v_mfma_f32_16x16x32_bf16 v[188:191], v[56:59], v[216:219], 0
    ds_read_b64_tr_b16 v[208:209], v3 offset:24576
    v_mfma_f32_16x16x32_bf16 v[188:191], v[60:63], v[220:223], v[188:191]
    ds_read_b64_tr_b16 v[210:211], v3 offset:25088
    v_mfma_f32_16x16x32_bf16 v[188:191], v[64:67], v[224:227], v[188:191]
    ds_read_b64_tr_b16 v[212:213], v3 offset:28672
    v_mfma_f32_16x16x32_bf16 v[188:191], v[68:71], v[228:231], v[188:191]
    ds_read_b64_tr_b16 v[214:215], v3 offset:29184
    v_mfma_f32_16x16x32_bf16 v[196:199], v[104:107], v[216:219], 0
    s_cselect_b32 s47, s59, s47
    v_mfma_f32_16x16x32_bf16 v[196:199], v[108:111], v[220:223], v[196:199]
    s_mov_b32 s37, 113246208
    v_mfma_f32_16x16x32_bf16 v[196:199], v[112:115], v[224:227], v[196:199]
    s_cselect_b32 s18, s37, 446693376
    v_mfma_f32_16x16x32_bf16 v[196:199], v[116:119], v[228:231], v[196:199]
    s_add_u32 s48, s47, 12288
    s_waitcnt lgkmcnt(0)
    v_mfma_f32_16x16x32_bf16 v[180:183], v[24:27], v[200:203], v[180:183]
    ds_read_b64_tr_b16 v[216:217], v3 offset:32768
    v_mfma_f32_16x16x32_bf16 v[180:183], v[28:31], v[204:207], v[180:183]
    ds_read_b64_tr_b16 v[218:219], v3 offset:33280
    v_mfma_f32_16x16x32_bf16 v[180:183], v[32:35], v[208:211], v[180:183]
    ds_read_b64_tr_b16 v[220:221], v3 offset:36864
    v_mfma_f32_16x16x32_bf16 v[180:183], v[36:39], v[212:215], v[180:183]
    ds_read_b64_tr_b16 v[222:223], v3 offset:37376
    v_mfma_f32_16x16x32_bf16 v[188:191], v[72:75], v[200:203], v[188:191]
    ds_read_b64_tr_b16 v[224:225], v3 offset:40960
    v_mfma_f32_16x16x32_bf16 v[188:191], v[76:79], v[204:207], v[188:191]
    ds_read_b64_tr_b16 v[226:227], v3 offset:41472
    v_mfma_f32_16x16x32_bf16 v[188:191], v[80:83], v[208:211], v[188:191]
    ds_read_b64_tr_b16 v[228:229], v3 offset:45056
    v_mfma_f32_16x16x32_bf16 v[188:191], v[84:87], v[212:215], v[188:191]
    ds_read_b64_tr_b16 v[230:231], v3 offset:45568
    v_mfma_f32_16x16x32_bf16 v[196:199], v[120:123], v[200:203], v[196:199]
    v_mfma_f32_16x16x32_bf16 v[196:199], v[124:127], v[204:207], v[196:199]
    v_mfma_f32_16x16x32_bf16 v[196:199], v[128:131], v[208:211], v[196:199]
    v_mfma_f32_16x16x32_bf16 v[196:199], v[132:135], v[212:215], v[196:199]
    s_waitcnt lgkmcnt(0)
    v_mfma_f32_16x16x32_bf16 v[180:183], v[40:43], v[216:219], v[180:183]
    v_mfma_f32_16x16x32_bf16 v[180:183], v[44:47], v[220:223], v[180:183]
    v_mfma_f32_16x16x32_bf16 v[180:183], v[48:51], v[224:227], v[180:183]
    v_mfma_f32_16x16x32_bf16 v[180:183], v[52:55], v[228:231], v[180:183]
    v_mfma_f32_16x16x32_bf16 v[188:191], v[88:91], v[216:219], v[188:191]
    v_mfma_f32_16x16x32_bf16 v[188:191], v[92:95], v[220:223], v[188:191]
    v_mfma_f32_16x16x32_bf16 v[188:191], v[96:99], v[224:227], v[188:191]
    v_mfma_f32_16x16x32_bf16 v[188:191], v[100:103], v[228:231], v[188:191]
    v_mfma_f32_16x16x32_bf16 v[196:199], v[136:139], v[216:219], v[196:199]
    v_mfma_f32_16x16x32_bf16 v[196:199], v[140:143], v[220:223], v[196:199]
    v_mfma_f32_16x16x32_bf16 v[196:199], v[144:147], v[224:227], v[196:199]
    v_mfma_f32_16x16x32_bf16 v[196:199], v[148:151], v[228:231], v[196:199]
    s_setprio 0
    v_and_b32 v213, 15, v0
    v_lshlrev_b32 v212, 7, v213
    v_bfe_u32 v213, v0, 1, 2
    v_bfe_u32 v214, v0, 4, 2
    v_xor_b32_e64 v213, v213, v214
    v_lshl_add_u32 v212, v213, 4, v212
    v_add_u32 v213, s3, v212
    v_add_u32 v212, s57, v212
    v_cvt_pk_f16_f32 v216, v152, v153
    v_cvt_pk_f16_f32 v217, v154, v155
    v_cvt_pk_f16_f32 v218, v156, v157
    v_cvt_pk_f16_f32 v219, v158, v159
    v_pk_fma_f16 v220, v216, v216, s44 neg_lo:[1,0,0] neg_hi:[1,0,0]
    v_pk_fma_f16 v221, v217, v217, s44 neg_lo:[1,0,0] neg_hi:[1,0,0]
    v_pk_fma_f16 v222, v218, v218, s44 neg_lo:[1,0,0] neg_hi:[1,0,0]
    v_pk_fma_f16 v223, v219, v219, s44 neg_lo:[1,0,0] neg_hi:[1,0,0]
    v_pk_mul_f16 v220, v220, v216
    v_pk_mul_f16 v221, v221, v217
    v_pk_mul_f16 v222, v222, v218
    v_pk_mul_f16 v223, v223, v219
    v_exp_f16 v216, v220
    v_exp_f16 v217, v221
    v_exp_f16 v218, v222
    v_exp_f16 v219, v223
    v_exp_f16_sdwa v216, v220 dst_sel:WORD_1 dst_unused:UNUSED_PRESERVE src0_sel:WORD_1
    v_exp_f16_sdwa v217, v221 dst_sel:WORD_1 dst_unused:UNUSED_PRESERVE src0_sel:WORD_1
    v_exp_f16_sdwa v218, v222 dst_sel:WORD_1 dst_unused:UNUSED_PRESERVE src0_sel:WORD_1
    v_exp_f16_sdwa v219, v223 dst_sel:WORD_1 dst_unused:UNUSED_PRESERVE src0_sel:WORD_1
    v_pk_add_f16 v216, v216, 1.0 op_sel_hi:[1,0]
    v_pk_add_f16 v217, v217, 1.0 op_sel_hi:[1,0]
    v_pk_add_f16 v218, v218, 1.0 op_sel_hi:[1,0]
    v_pk_add_f16 v219, v219, 1.0 op_sel_hi:[1,0]
    v_rcp_f16 v220, v216
    v_rcp_f16 v221, v217
    v_rcp_f16 v222, v218
    v_rcp_f16 v223, v219
    v_rcp_f16_sdwa v216, v216 dst_sel:DWORD dst_unused:UNUSED_PAD src0_sel:WORD_1
    v_rcp_f16_sdwa v217, v217 dst_sel:DWORD dst_unused:UNUSED_PAD src0_sel:WORD_1
    v_rcp_f16_sdwa v218, v218 dst_sel:DWORD dst_unused:UNUSED_PAD src0_sel:WORD_1
    v_rcp_f16_sdwa v219, v219 dst_sel:DWORD dst_unused:UNUSED_PAD src0_sel:WORD_1
    v_fma_mix_f32 v152, v152, v220, 0 op_sel_hi:[0,1,0]
    v_fma_mix_f32 v154, v154, v221, 0 op_sel_hi:[0,1,0]
    v_fma_mix_f32 v156, v156, v222, 0 op_sel_hi:[0,1,0]
    v_fma_mix_f32 v158, v158, v223, 0 op_sel_hi:[0,1,0]
    v_fma_mix_f32 v153, v153, v216, 0 op_sel_hi:[0,1,0]
    v_fma_mix_f32 v155, v155, v217, 0 op_sel_hi:[0,1,0]
    v_fma_mix_f32 v157, v157, v218, 0 op_sel_hi:[0,1,0]
    v_fma_mix_f32 v159, v159, v219, 0 op_sel_hi:[0,1,0]
    v_cvt_pk_bf16_f32 v159, v158, v159
    v_cvt_pk_bf16_f32 v158, v156, v157
    v_cvt_pk_bf16_f32 v157, v154, v155
    v_cvt_pk_bf16_f32 v156, v152, v153
    buffer_store_dwordx4 v[156:159], v4, s[16:19], s47 offen offset:0
    s_waitcnt vmcnt(13)
    ds_read_b128 v[32:35], v212 offset:0
    ds_read_b128 v[36:39], v212 offset:64
    s_waitcnt lgkmcnt(0)
    s_add_u32 m0, s57, 0
    s_add_u32 s58, s40, 12672
    buffer_load_dwordx4 v2, s[8:11], s58 offen nt lds
    s_add_u32 m0, m0, 1024
    s_add_u32 s58, s58, 6144
    buffer_load_dwordx4 v2, s[8:11], s58 offen nt lds
    s_nop 0
    v_cvt_pk_f16_f32 v216, v160, v161
    v_cvt_pk_f16_f32 v217, v162, v163
    v_cvt_pk_f16_f32 v218, v164, v165
    v_cvt_pk_f16_f32 v219, v166, v167
    v_pk_fma_f16 v220, v216, v216, s44 neg_lo:[1,0,0] neg_hi:[1,0,0]
    v_pk_fma_f16 v221, v217, v217, s44 neg_lo:[1,0,0] neg_hi:[1,0,0]
    v_pk_fma_f16 v222, v218, v218, s44 neg_lo:[1,0,0] neg_hi:[1,0,0]
    v_pk_fma_f16 v223, v219, v219, s44 neg_lo:[1,0,0] neg_hi:[1,0,0]
    v_pk_mul_f16 v220, v220, v216
    v_pk_mul_f16 v221, v221, v217
    v_pk_mul_f16 v222, v222, v218
    v_pk_mul_f16 v223, v223, v219
    v_exp_f16 v216, v220
    v_exp_f16 v217, v221
    v_exp_f16 v218, v222
    v_exp_f16 v219, v223
    v_exp_f16_sdwa v216, v220 dst_sel:WORD_1 dst_unused:UNUSED_PRESERVE src0_sel:WORD_1
    v_exp_f16_sdwa v217, v221 dst_sel:WORD_1 dst_unused:UNUSED_PRESERVE src0_sel:WORD_1
    v_exp_f16_sdwa v218, v222 dst_sel:WORD_1 dst_unused:UNUSED_PRESERVE src0_sel:WORD_1
    v_exp_f16_sdwa v219, v223 dst_sel:WORD_1 dst_unused:UNUSED_PRESERVE src0_sel:WORD_1
    v_pk_add_f16 v216, v216, 1.0 op_sel_hi:[1,0]
    v_pk_add_f16 v217, v217, 1.0 op_sel_hi:[1,0]
    v_pk_add_f16 v218, v218, 1.0 op_sel_hi:[1,0]
    v_pk_add_f16 v219, v219, 1.0 op_sel_hi:[1,0]
    v_rcp_f16 v220, v216
    v_rcp_f16 v221, v217
    v_rcp_f16 v222, v218
    v_rcp_f16 v223, v219
    v_rcp_f16_sdwa v216, v216 dst_sel:DWORD dst_unused:UNUSED_PAD src0_sel:WORD_1
    v_rcp_f16_sdwa v217, v217 dst_sel:DWORD dst_unused:UNUSED_PAD src0_sel:WORD_1
    v_rcp_f16_sdwa v218, v218 dst_sel:DWORD dst_unused:UNUSED_PAD src0_sel:WORD_1
    v_rcp_f16_sdwa v219, v219 dst_sel:DWORD dst_unused:UNUSED_PAD src0_sel:WORD_1
    v_fma_mix_f32 v160, v160, v220, 0 op_sel_hi:[0,1,0]
    v_fma_mix_f32 v162, v162, v221, 0 op_sel_hi:[0,1,0]
    v_fma_mix_f32 v164, v164, v222, 0 op_sel_hi:[0,1,0]
    v_fma_mix_f32 v166, v166, v223, 0 op_sel_hi:[0,1,0]
    v_fma_mix_f32 v161, v161, v216, 0 op_sel_hi:[0,1,0]
    v_fma_mix_f32 v163, v163, v217, 0 op_sel_hi:[0,1,0]
    v_fma_mix_f32 v165, v165, v218, 0 op_sel_hi:[0,1,0]
    v_fma_mix_f32 v167, v167, v219, 0 op_sel_hi:[0,1,0]
    v_cvt_pk_bf16_f32 v167, v166, v167
    v_cvt_pk_bf16_f32 v166, v164, v165
    v_cvt_pk_bf16_f32 v165, v162, v163
    v_cvt_pk_bf16_f32 v164, v160, v161
    buffer_store_dwordx4 v[164:167], v4, s[16:19], s47 offen offset:1024
    s_waitcnt vmcnt(16)
    ds_read_b128 v[40:43], v212 offset:2048
    ds_read_b128 v[44:47], v212 offset:2112
    s_waitcnt lgkmcnt(0)
    s_add_u32 m0, s57, 2048
    s_add_u32 s58, s40, 12800
    buffer_load_dwordx4 v2, s[8:11], s58 offen nt lds
    s_add_u32 m0, m0, 1024
    s_add_u32 s58, s58, 6144
    buffer_load_dwordx4 v2, s[8:11], s58 offen nt lds
    s_setprio 1
    s_nop 0
    v_cvt_pk_f16_f32 v216, v168, v169
    v_cvt_pk_f16_f32 v217, v170, v171
    v_cvt_pk_f16_f32 v218, v172, v173
    v_cvt_pk_f16_f32 v219, v174, v175
    v_pk_fma_f16 v220, v216, v216, s44 neg_lo:[1,0,0] neg_hi:[1,0,0]
    v_pk_fma_f16 v221, v217, v217, s44 neg_lo:[1,0,0] neg_hi:[1,0,0]
    v_pk_fma_f16 v222, v218, v218, s44 neg_lo:[1,0,0] neg_hi:[1,0,0]
    v_pk_fma_f16 v223, v219, v219, s44 neg_lo:[1,0,0] neg_hi:[1,0,0]
    v_pk_mul_f16 v220, v220, v216
    v_pk_mul_f16 v221, v221, v217
    v_pk_mul_f16 v222, v222, v218
    v_pk_mul_f16 v223, v223, v219
    v_exp_f16 v216, v220
    v_exp_f16 v217, v221
    v_exp_f16 v218, v222
    v_exp_f16 v219, v223
    v_exp_f16_sdwa v216, v220 dst_sel:WORD_1 dst_unused:UNUSED_PRESERVE src0_sel:WORD_1
    v_exp_f16_sdwa v217, v221 dst_sel:WORD_1 dst_unused:UNUSED_PRESERVE src0_sel:WORD_1
    v_exp_f16_sdwa v218, v222 dst_sel:WORD_1 dst_unused:UNUSED_PRESERVE src0_sel:WORD_1
    v_exp_f16_sdwa v219, v223 dst_sel:WORD_1 dst_unused:UNUSED_PRESERVE src0_sel:WORD_1
    v_pk_add_f16 v216, v216, 1.0 op_sel_hi:[1,0]
    v_pk_add_f16 v217, v217, 1.0 op_sel_hi:[1,0]
    v_pk_add_f16 v218, v218, 1.0 op_sel_hi:[1,0]
    v_pk_add_f16 v219, v219, 1.0 op_sel_hi:[1,0]
    v_rcp_f16 v220, v216
    v_rcp_f16 v221, v217
    v_rcp_f16 v222, v218
    v_rcp_f16 v223, v219
    v_rcp_f16_sdwa v216, v216 dst_sel:DWORD dst_unused:UNUSED_PAD src0_sel:WORD_1
    v_rcp_f16_sdwa v217, v217 dst_sel:DWORD dst_unused:UNUSED_PAD src0_sel:WORD_1
    v_rcp_f16_sdwa v218, v218 dst_sel:DWORD dst_unused:UNUSED_PAD src0_sel:WORD_1
    v_rcp_f16_sdwa v219, v219 dst_sel:DWORD dst_unused:UNUSED_PAD src0_sel:WORD_1
    v_fma_mix_f32 v168, v168, v220, 0 op_sel_hi:[0,1,0]
    v_fma_mix_f32 v170, v170, v221, 0 op_sel_hi:[0,1,0]
    v_fma_mix_f32 v172, v172, v222, 0 op_sel_hi:[0,1,0]
    v_fma_mix_f32 v174, v174, v223, 0 op_sel_hi:[0,1,0]
    v_fma_mix_f32 v169, v169, v216, 0 op_sel_hi:[0,1,0]
    v_fma_mix_f32 v171, v171, v217, 0 op_sel_hi:[0,1,0]
    v_fma_mix_f32 v173, v173, v218, 0 op_sel_hi:[0,1,0]
    v_fma_mix_f32 v175, v175, v219, 0 op_sel_hi:[0,1,0]
    v_cvt_pk_bf16_f32 v175, v174, v175
    v_cvt_pk_bf16_f32 v174, v172, v173
    v_cvt_pk_bf16_f32 v173, v170, v171
    v_cvt_pk_bf16_f32 v172, v168, v169
    buffer_store_dwordx4 v[172:175], v4, s[16:19], s47 offen offset:2048
    s_waitcnt vmcnt(19)
    ds_read_b128 v[48:51], v212 offset:4096
    ds_read_b128 v[52:55], v212 offset:4160
    s_waitcnt lgkmcnt(0)
    s_add_u32 m0, s57, 4096
    s_add_u32 s58, s40, 12928
    buffer_load_dwordx4 v2, s[8:11], s58 offen nt lds
    s_add_u32 m0, m0, 1024
    s_add_u32 s58, s58, 6144
    buffer_load_dwordx4 v2, s[8:11], s58 offen nt lds
    v_cvt_pk_f16_f32 v216, v176, v177
    v_cvt_pk_f16_f32 v217, v178, v179
    v_cvt_pk_f16_f32 v218, v180, v181
    v_cvt_pk_f16_f32 v219, v182, v183
    v_pk_fma_f16 v220, v216, v216, s44 neg_lo:[1,0,0] neg_hi:[1,0,0]
    v_pk_fma_f16 v221, v217, v217, s44 neg_lo:[1,0,0] neg_hi:[1,0,0]
    v_pk_fma_f16 v222, v218, v218, s44 neg_lo:[1,0,0] neg_hi:[1,0,0]
    v_pk_fma_f16 v223, v219, v219, s44 neg_lo:[1,0,0] neg_hi:[1,0,0]
    v_pk_mul_f16 v220, v220, v216
    v_pk_mul_f16 v221, v221, v217
    v_pk_mul_f16 v222, v222, v218
    v_pk_mul_f16 v223, v223, v219
    v_exp_f16 v216, v220
    v_exp_f16 v217, v221
    v_exp_f16 v218, v222
    v_exp_f16 v219, v223
    v_exp_f16_sdwa v216, v220 dst_sel:WORD_1 dst_unused:UNUSED_PRESERVE src0_sel:WORD_1
    v_exp_f16_sdwa v217, v221 dst_sel:WORD_1 dst_unused:UNUSED_PRESERVE src0_sel:WORD_1
    v_exp_f16_sdwa v218, v222 dst_sel:WORD_1 dst_unused:UNUSED_PRESERVE src0_sel:WORD_1
    v_exp_f16_sdwa v219, v223 dst_sel:WORD_1 dst_unused:UNUSED_PRESERVE src0_sel:WORD_1
    v_pk_add_f16 v216, v216, 1.0 op_sel_hi:[1,0]
    v_pk_add_f16 v217, v217, 1.0 op_sel_hi:[1,0]
    v_pk_add_f16 v218, v218, 1.0 op_sel_hi:[1,0]
    v_pk_add_f16 v219, v219, 1.0 op_sel_hi:[1,0]
    v_rcp_f16 v220, v216
    v_rcp_f16 v221, v217
    v_rcp_f16 v222, v218
    v_rcp_f16 v223, v219
    v_rcp_f16_sdwa v216, v216 dst_sel:DWORD dst_unused:UNUSED_PAD src0_sel:WORD_1
    v_rcp_f16_sdwa v217, v217 dst_sel:DWORD dst_unused:UNUSED_PAD src0_sel:WORD_1
    v_rcp_f16_sdwa v218, v218 dst_sel:DWORD dst_unused:UNUSED_PAD src0_sel:WORD_1
    v_rcp_f16_sdwa v219, v219 dst_sel:DWORD dst_unused:UNUSED_PAD src0_sel:WORD_1
    v_fma_mix_f32 v176, v176, v220, 0 op_sel_hi:[0,1,0]
    v_fma_mix_f32 v178, v178, v221, 0 op_sel_hi:[0,1,0]
    v_fma_mix_f32 v180, v180, v222, 0 op_sel_hi:[0,1,0]
    v_fma_mix_f32 v182, v182, v223, 0 op_sel_hi:[0,1,0]
    v_fma_mix_f32 v177, v177, v216, 0 op_sel_hi:[0,1,0]
    v_fma_mix_f32 v179, v179, v217, 0 op_sel_hi:[0,1,0]
    v_fma_mix_f32 v181, v181, v218, 0 op_sel_hi:[0,1,0]
    v_fma_mix_f32 v183, v183, v219, 0 op_sel_hi:[0,1,0]
    v_cvt_pk_bf16_f32 v183, v182, v183
    v_cvt_pk_bf16_f32 v182, v180, v181
    v_cvt_pk_bf16_f32 v181, v178, v179
    v_cvt_pk_bf16_f32 v180, v176, v177
    buffer_store_dwordx4 v[180:183], v4, s[16:19], s48 offen offset:0 nt
    s_waitcnt vmcnt(14)
    ds_read_b128 v[24:27], v213 offset:0
    ds_read_b128 v[28:31], v213 offset:64
    s_waitcnt lgkmcnt(0)
    s_add_u32 m0, s3, 0
    s_add_u32 s58, s40, 12544
    buffer_load_dwordx4 v2, s[8:11], s58 offen nt lds
    s_add_u32 m0, m0, 1024
    s_add_u32 s58, s58, 6144
    buffer_load_dwordx4 v2, s[8:11], s58 offen nt lds
    s_nop 0
    v_cvt_pk_f16_f32 v216, v184, v185
    v_cvt_pk_f16_f32 v217, v186, v187
    v_cvt_pk_f16_f32 v218, v188, v189
    v_cvt_pk_f16_f32 v219, v190, v191
    v_pk_fma_f16 v220, v216, v216, s44 neg_lo:[1,0,0] neg_hi:[1,0,0]
    v_pk_fma_f16 v221, v217, v217, s44 neg_lo:[1,0,0] neg_hi:[1,0,0]
    v_pk_fma_f16 v222, v218, v218, s44 neg_lo:[1,0,0] neg_hi:[1,0,0]
    v_pk_fma_f16 v223, v219, v219, s44 neg_lo:[1,0,0] neg_hi:[1,0,0]
    v_pk_mul_f16 v220, v220, v216
    v_pk_mul_f16 v221, v221, v217
    v_pk_mul_f16 v222, v222, v218
    v_pk_mul_f16 v223, v223, v219
    v_exp_f16 v216, v220
    v_exp_f16 v217, v221
    v_exp_f16 v218, v222
    v_exp_f16 v219, v223
    v_exp_f16_sdwa v216, v220 dst_sel:WORD_1 dst_unused:UNUSED_PRESERVE src0_sel:WORD_1
    v_exp_f16_sdwa v217, v221 dst_sel:WORD_1 dst_unused:UNUSED_PRESERVE src0_sel:WORD_1
    v_exp_f16_sdwa v218, v222 dst_sel:WORD_1 dst_unused:UNUSED_PRESERVE src0_sel:WORD_1
    v_exp_f16_sdwa v219, v223 dst_sel:WORD_1 dst_unused:UNUSED_PRESERVE src0_sel:WORD_1
    v_pk_add_f16 v216, v216, 1.0 op_sel_hi:[1,0]
    v_pk_add_f16 v217, v217, 1.0 op_sel_hi:[1,0]
    v_pk_add_f16 v218, v218, 1.0 op_sel_hi:[1,0]
    v_pk_add_f16 v219, v219, 1.0 op_sel_hi:[1,0]
    v_rcp_f16 v220, v216
    v_rcp_f16 v221, v217
    v_rcp_f16 v222, v218
    v_rcp_f16 v223, v219
    v_rcp_f16_sdwa v216, v216 dst_sel:DWORD dst_unused:UNUSED_PAD src0_sel:WORD_1
    v_rcp_f16_sdwa v217, v217 dst_sel:DWORD dst_unused:UNUSED_PAD src0_sel:WORD_1
    v_rcp_f16_sdwa v218, v218 dst_sel:DWORD dst_unused:UNUSED_PAD src0_sel:WORD_1
    v_rcp_f16_sdwa v219, v219 dst_sel:DWORD dst_unused:UNUSED_PAD src0_sel:WORD_1
    v_fma_mix_f32 v184, v184, v220, 0 op_sel_hi:[0,1,0]
    v_fma_mix_f32 v186, v186, v221, 0 op_sel_hi:[0,1,0]
    v_fma_mix_f32 v188, v188, v222, 0 op_sel_hi:[0,1,0]
    v_fma_mix_f32 v190, v190, v223, 0 op_sel_hi:[0,1,0]
    v_fma_mix_f32 v185, v185, v216, 0 op_sel_hi:[0,1,0]
    v_fma_mix_f32 v187, v187, v217, 0 op_sel_hi:[0,1,0]
    v_fma_mix_f32 v189, v189, v218, 0 op_sel_hi:[0,1,0]
    v_fma_mix_f32 v191, v191, v219, 0 op_sel_hi:[0,1,0]
    v_cvt_pk_bf16_f32 v191, v190, v191
    v_cvt_pk_bf16_f32 v190, v188, v189
    v_cvt_pk_bf16_f32 v189, v186, v187
    v_cvt_pk_bf16_f32 v188, v184, v185
    buffer_store_dwordx4 v[188:191], v4, s[16:19], s48 offen offset:1024 nt
    s_waitcnt vmcnt(15)
    ds_read_b128 v[16:19], v213 offset:2048
    ds_read_b128 v[20:23], v213 offset:2112
    s_waitcnt lgkmcnt(0)
    s_add_u32 m0, s3, 2048
    s_add_u32 s58, s40, 12416
    buffer_load_dwordx4 v2, s[8:11], s58 offen nt lds
    s_add_u32 m0, m0, 1024
    s_add_u32 s58, s58, 6144
    buffer_load_dwordx4 v2, s[8:11], s58 offen nt lds
    v_cvt_pk_f16_f32 v216, v192, v193
    v_cvt_pk_f16_f32 v217, v194, v195
    v_cvt_pk_f16_f32 v218, v196, v197
    v_cvt_pk_f16_f32 v219, v198, v199
    v_pk_fma_f16 v220, v216, v216, s44 neg_lo:[1,0,0] neg_hi:[1,0,0]
    v_pk_fma_f16 v221, v217, v217, s44 neg_lo:[1,0,0] neg_hi:[1,0,0]
    v_pk_fma_f16 v222, v218, v218, s44 neg_lo:[1,0,0] neg_hi:[1,0,0]
    v_pk_fma_f16 v223, v219, v219, s44 neg_lo:[1,0,0] neg_hi:[1,0,0]
    v_pk_mul_f16 v220, v220, v216
    v_pk_mul_f16 v221, v221, v217
    v_pk_mul_f16 v222, v222, v218
    v_pk_mul_f16 v223, v223, v219
    v_exp_f16 v216, v220
    v_exp_f16 v217, v221
    v_exp_f16 v218, v222
    v_exp_f16 v219, v223
    v_exp_f16_sdwa v216, v220 dst_sel:WORD_1 dst_unused:UNUSED_PRESERVE src0_sel:WORD_1
    v_exp_f16_sdwa v217, v221 dst_sel:WORD_1 dst_unused:UNUSED_PRESERVE src0_sel:WORD_1
    v_exp_f16_sdwa v218, v222 dst_sel:WORD_1 dst_unused:UNUSED_PRESERVE src0_sel:WORD_1
    v_exp_f16_sdwa v219, v223 dst_sel:WORD_1 dst_unused:UNUSED_PRESERVE src0_sel:WORD_1
    v_pk_add_f16 v216, v216, 1.0 op_sel_hi:[1,0]
    v_pk_add_f16 v217, v217, 1.0 op_sel_hi:[1,0]
    v_pk_add_f16 v218, v218, 1.0 op_sel_hi:[1,0]
    v_pk_add_f16 v219, v219, 1.0 op_sel_hi:[1,0]
    v_rcp_f16 v220, v216
    v_rcp_f16 v221, v217
    v_rcp_f16 v222, v218
    v_rcp_f16 v223, v219
    v_rcp_f16_sdwa v216, v216 dst_sel:DWORD dst_unused:UNUSED_PAD src0_sel:WORD_1
    v_rcp_f16_sdwa v217, v217 dst_sel:DWORD dst_unused:UNUSED_PAD src0_sel:WORD_1
    v_rcp_f16_sdwa v218, v218 dst_sel:DWORD dst_unused:UNUSED_PAD src0_sel:WORD_1
    v_rcp_f16_sdwa v219, v219 dst_sel:DWORD dst_unused:UNUSED_PAD src0_sel:WORD_1
    v_fma_mix_f32 v192, v192, v220, 0 op_sel_hi:[0,1,0]
    v_fma_mix_f32 v194, v194, v221, 0 op_sel_hi:[0,1,0]
    v_fma_mix_f32 v196, v196, v222, 0 op_sel_hi:[0,1,0]
    v_fma_mix_f32 v198, v198, v223, 0 op_sel_hi:[0,1,0]
    v_fma_mix_f32 v193, v193, v216, 0 op_sel_hi:[0,1,0]
    v_fma_mix_f32 v195, v195, v217, 0 op_sel_hi:[0,1,0]
    v_fma_mix_f32 v197, v197, v218, 0 op_sel_hi:[0,1,0]
    v_fma_mix_f32 v199, v199, v219, 0 op_sel_hi:[0,1,0]
    v_cvt_pk_bf16_f32 v199, v198, v199
    v_cvt_pk_bf16_f32 v198, v196, v197
    v_cvt_pk_bf16_f32 v197, v194, v195
    v_cvt_pk_bf16_f32 v196, v192, v193
    buffer_store_dwordx4 v[196:199], v4, s[16:19], s48 offen offset:2048 nt
    s_waitcnt vmcnt(16)
    ds_read_b128 v[8:11], v213 offset:4096
    ds_read_b128 v[12:15], v213 offset:4160
    s_waitcnt lgkmcnt(0)
    s_add_u32 m0, s3, 4096
    s_add_u32 s58, s40, 12288
    buffer_load_dwordx4 v2, s[8:11], s58 offen nt lds
    s_add_u32 m0, m0, 1024
    s_add_u32 s58, s58, 6144
    buffer_load_dwordx4 v2, s[8:11], s58 offen nt lds
    v_dot2_f32_bf16 v224, v156, v156, 0
    v_dot2_f32_bf16 v225, v158, v158, 0
    v_dot2_f32_bf16 v226, v180, v180, 0
    v_dot2_f32_bf16 v227, v182, v182, 0
    v_dot2c_f32_bf16 v224, v157, v157
    v_dot2c_f32_bf16 v225, v159, v159
    v_dot2c_f32_bf16 v226, v181, v181
    v_dot2c_f32_bf16 v227, v183, v183
    v_dot2c_f32_bf16 v224, v164, v164
    v_dot2c_f32_bf16 v225, v166, v166
    v_dot2c_f32_bf16 v226, v188, v188
    v_dot2c_f32_bf16 v227, v190, v190
    v_dot2c_f32_bf16 v224, v165, v165
    v_dot2c_f32_bf16 v225, v167, v167
    v_dot2c_f32_bf16 v226, v189, v189
    v_dot2c_f32_bf16 v227, v191, v191
    v_dot2c_f32_bf16 v224, v172, v172
    v_dot2c_f32_bf16 v225, v174, v174
    v_dot2c_f32_bf16 v226, v196, v196
    v_dot2c_f32_bf16 v227, v198, v198
    v_dot2c_f32_bf16 v224, v173, v173
    v_dot2c_f32_bf16 v225, v175, v175
    v_dot2c_f32_bf16 v226, v197, v197
    v_dot2c_f32_bf16 v227, v199, v199
    s_add_u32 s37, s42, 1
    v_permlane16_swap_b32 v224, v225
    s_cmp_eq_u32 s37, s53
    v_permlane16_swap_b32 v226, v227
    v_add_f32 v224, v224, v225
    v_add_f32 v226, v226, v227
    s_cselect_b32 s37, s52, s37
    s_nop 0
    v_permlane32_swap_b32 v224, v226
    v_add_f32 v224, v224, v226
    s_set_gpr_idx_on s42, gpr_idx(SRC0,DST)
    s_mov_b32 s42, s37
    v_add_f32 v232, v232, v224
    s_set_gpr_idx_off
    s_branch K1_sw
K1_pretailB:
.p2align 6
K1_tailB:
    s_setprio 3
    s_waitcnt lgkmcnt(0)
    v_mfma_f32_16x16x32_bf16 v[152:155], v[8:11], v[200:203], 0
    ds_read_b64_tr_b16 v[216:217], v3 offset:16384
    v_mfma_f32_16x16x32_bf16 v[152:155], v[12:15], v[204:207], v[152:155]
    ds_read_b64_tr_b16 v[218:219], v3 offset:16896
    v_mfma_f32_16x16x32_bf16 v[152:155], v[16:19], v[208:211], v[152:155]
    ds_read_b64_tr_b16 v[220:221], v3 offset:20480
    v_mfma_f32_16x16x32_bf16 v[152:155], v[20:23], v[212:215], v[152:155]
    ds_read_b64_tr_b16 v[222:223], v3 offset:20992
    v_mfma_f32_16x16x32_bf16 v[160:163], v[56:59], v[200:203], 0
    ds_read_b64_tr_b16 v[224:225], v3 offset:24576
    v_mfma_f32_16x16x32_bf16 v[160:163], v[60:63], v[204:207], v[160:163]
    ds_read_b64_tr_b16 v[226:227], v3 offset:25088
    v_mfma_f32_16x16x32_bf16 v[160:163], v[64:67], v[208:211], v[160:163]
    ds_read_b64_tr_b16 v[228:229], v3 offset:28672
    v_mfma_f32_16x16x32_bf16 v[160:163], v[68:71], v[212:215], v[160:163]
    ds_read_b64_tr_b16 v[230:231], v3 offset:29184
    v_mfma_f32_16x16x32_bf16 v[168:171], v[104:107], v[200:203], 0
    buffer_store_dwordx4 v[156:159], v4, s[16:19], s47 offen offset:0 nt
    v_mfma_f32_16x16x32_bf16 v[168:171], v[108:111], v[204:207], v[168:171]
    v_mfma_f32_16x16x32_bf16 v[168:171], v[112:115], v[208:211], v[168:171]
    v_mfma_f32_16x16x32_bf16 v[168:171], v[116:119], v[212:215], v[168:171]
    s_waitcnt lgkmcnt(0)
    v_mfma_f32_16x16x32_bf16 v[152:155], v[24:27], v[216:219], v[152:155]
    ds_read_b64_tr_b16 v[200:201], v3 offset:32768
    v_mfma_f32_16x16x32_bf16 v[152:155], v[28:31], v[220:223], v[152:155]
    ds_read_b64_tr_b16 v[202:203], v3 offset:33280
    v_mfma_f32_16x16x32_bf16 v[152:155], v[32:35], v[224:227], v[152:155]
    ds_read_b64_tr_b16 v[204:205], v3 offset:36864
    v_mfma_f32_16x16x32_bf16 v[152:155], v[36:39], v[228:231], v[152:155]
    ds_read_b64_tr_b16 v[206:207], v3 offset:37376
    v_mfma_f32_16x16x32_bf16 v[160:163], v[72:75], v[216:219], v[160:163]
    ds_read_b64_tr_b16 v[208:209], v3 offset:40960
    v_mfma_f32_16x16x32_bf16 v[160:163], v[76:79], v[220:223], v[160:163]
    ds_read_b64_tr_b16 v[210:211], v3 offset:41472
    v_mfma_f32_16x16x32_bf16 v[160:163], v[80:83], v[224:227], v[160:163]
    ds_read_b64_tr_b16 v[212:213], v3 offset:45056
    v_mfma_f32_16x16x32_bf16 v[160:163], v[84:87], v[228:231], v[160:163]
    ds_read_b64_tr_b16 v[214:215], v3 offset:45568
    v_mfma_f32_16x16x32_bf16 v[168:171], v[120:123], v[216:219], v[168:171]
    buffer_store_dwordx4 v[164:167], v4, s[16:19], s47 offen offset:1024 nt
    v_mfma_f32_16x16x32_bf16 v[168:171], v[124:127], v[220:223], v[168:171]
    v_mfma_f32_16x16x32_bf16 v[168:171], v[128:131], v[224:227], v[168:171]
    v_mfma_f32_16x16x32_bf16 v[168:171], v[132:135], v[228:231], v[168:171]
    v_xor_b32 v3, 32, v3
    s_waitcnt lgkmcnt(0)
    v_mfma_f32_16x16x32_bf16 v[152:155], v[40:43], v[200:203], v[152:155]
    ds_read_b64_tr_b16 v[216:217], v3 offset:0
    v_mfma_f32_16x16x32_bf16 v[152:155], v[44:47], v[204:207], v[152:155]
    ds_read_b64_tr_b16 v[218:219], v3 offset:512
    v_mfma_f32_16x16x32_bf16 v[152:155], v[48:51], v[208:211], v[152:155]
    ds_read_b64_tr_b16 v[220:221], v3 offset:4096
    v_mfma_f32_16x16x32_bf16 v[152:155], v[52:55], v[212:215], v[152:155]
    ds_read_b64_tr_b16 v[222:223], v3 offset:4608
    v_mfma_f32_16x16x32_bf16 v[160:163], v[88:91], v[200:203], v[160:163]
    ds_read_b64_tr_b16 v[224:225], v3 offset:8192
    v_mfma_f32_16x16x32_bf16 v[160:163], v[92:95], v[204:207], v[160:163]
    ds_read_b64_tr_b16 v[226:227], v3 offset:8704
    v_mfma_f32_16x16x32_bf16 v[160:163], v[96:99], v[208:211], v[160:163]
    ds_read_b64_tr_b16 v[228:229], v3 offset:12288
    v_mfma_f32_16x16x32_bf16 v[160:163], v[100:103], v[212:215], v[160:163]
    ds_read_b64_tr_b16 v[230:231], v3 offset:12800
    v_mfma_f32_16x16x32_bf16 v[168:171], v[136:139], v[200:203], v[168:171]
    v_mfma_f32_16x16x32_bf16 v[168:171], v[140:143], v[204:207], v[168:171]
    buffer_store_dwordx4 v[172:175], v4, s[16:19], s47 offen offset:2048 nt
    v_mfma_f32_16x16x32_bf16 v[168:171], v[144:147], v[208:211], v[168:171]
    v_mfma_f32_16x16x32_bf16 v[168:171], v[148:151], v[212:215], v[168:171]
    s_waitcnt lgkmcnt(0)
    v_mfma_f32_16x16x32_bf16 v[156:159], v[8:11], v[216:219], 0
    ds_read_b64_tr_b16 v[200:201], v3 offset:16384
    v_mfma_f32_16x16x32_bf16 v[156:159], v[12:15], v[220:223], v[156:159]
    ds_read_b64_tr_b16 v[202:203], v3 offset:16896
    v_mfma_f32_16x16x32_bf16 v[156:159], v[16:19], v[224:227], v[156:159]
    ds_read_b64_tr_b16 v[204:205], v3 offset:20480
    v_mfma_f32_16x16x32_bf16 v[156:159], v[20:23], v[228:231], v[156:159]
    ds_read_b64_tr_b16 v[206:207], v3 offset:20992
    v_mfma_f32_16x16x32_bf16 v[164:167], v[56:59], v[216:219], 0
    ds_read_b64_tr_b16 v[208:209], v3 offset:24576
    v_mfma_f32_16x16x32_bf16 v[164:167], v[60:63], v[220:223], v[164:167]
    ds_read_b64_tr_b16 v[210:211], v3 offset:25088
    v_mfma_f32_16x16x32_bf16 v[164:167], v[64:67], v[224:227], v[164:167]
    ds_read_b64_tr_b16 v[212:213], v3 offset:28672
    v_mfma_f32_16x16x32_bf16 v[164:167], v[68:71], v[228:231], v[164:167]
    ds_read_b64_tr_b16 v[214:215], v3 offset:29184
    v_mfma_f32_16x16x32_bf16 v[172:175], v[104:107], v[216:219], 0
    buffer_store_dwordx4 v[180:183], v4, s[16:19], s48 offen offset:0 nt
    v_mfma_f32_16x16x32_bf16 v[172:175], v[108:111], v[220:223], v[172:175]
    s_add_u32 s34, s34, 49152
    v_mfma_f32_16x16x32_bf16 v[172:175], v[112:115], v[224:227], v[172:175]
    buffer_store_dwordx4 v[188:191], v4, s[16:19], s48 offen offset:1024 nt
    v_mfma_f32_16x16x32_bf16 v[172:175], v[116:119], v[228:231], v[172:175]
    s_cmp_eq_u32 s34, 147456
    s_waitcnt lgkmcnt(0)
    v_mfma_f32_16x16x32_bf16 v[156:159], v[24:27], v[200:203], v[156:159]
    ds_read_b64_tr_b16 v[216:217], v3 offset:32768
    v_mfma_f32_16x16x32_bf16 v[156:159], v[28:31], v[204:207], v[156:159]
    ds_read_b64_tr_b16 v[218:219], v3 offset:33280
    v_mfma_f32_16x16x32_bf16 v[156:159], v[32:35], v[208:211], v[156:159]
    ds_read_b64_tr_b16 v[220:221], v3 offset:36864
    v_mfma_f32_16x16x32_bf16 v[156:159], v[36:39], v[212:215], v[156:159]
    ds_read_b64_tr_b16 v[222:223], v3 offset:37376
    v_mfma_f32_16x16x32_bf16 v[164:167], v[72:75], v[200:203], v[164:167]
    ds_read_b64_tr_b16 v[224:225], v3 offset:40960
    v_mfma_f32_16x16x32_bf16 v[164:167], v[76:79], v[204:207], v[164:167]
    ds_read_b64_tr_b16 v[226:227], v3 offset:41472
    v_mfma_f32_16x16x32_bf16 v[164:167], v[80:83], v[208:211], v[164:167]
    ds_read_b64_tr_b16 v[228:229], v3 offset:45056
    v_mfma_f32_16x16x32_bf16 v[164:167], v[84:87], v[212:215], v[164:167]
    ds_read_b64_tr_b16 v[230:231], v3 offset:45568
    v_mfma_f32_16x16x32_bf16 v[172:175], v[120:123], v[200:203], v[172:175]
    buffer_store_dwordx4 v[196:199], v4, s[16:19], s48 offen offset:2048 nt
    v_mfma_f32_16x16x32_bf16 v[172:175], v[124:127], v[204:207], v[172:175]
    s_cselect_b32 s34, 0, s34
    v_mfma_f32_16x16x32_bf16 v[172:175], v[128:131], v[208:211], v[172:175]
    s_add_u32 s32, s32, 1
    v_mfma_f32_16x16x32_bf16 v[172:175], v[132:135], v[212:215], v[172:175]
    s_nop 0
    v_xor_b32 v3, 96, v3
    s_waitcnt lgkmcnt(0)
    v_mfma_f32_16x16x32_bf16 v[156:159], v[40:43], v[216:219], v[156:159]
    ds_read_b64_tr_b16 v[200:201], v3 offset:0
    v_mfma_f32_16x16x32_bf16 v[156:159], v[44:47], v[220:223], v[156:159]
    ds_read_b64_tr_b16 v[202:203], v3 offset:512
    v_mfma_f32_16x16x32_bf16 v[156:159], v[48:51], v[224:227], v[156:159]
    ds_read_b64_tr_b16 v[204:205], v3 offset:4096
    v_mfma_f32_16x16x32_bf16 v[156:159], v[52:55], v[228:231], v[156:159]
    ds_read_b64_tr_b16 v[206:207], v3 offset:4608
    v_mfma_f32_16x16x32_bf16 v[164:167], v[88:91], v[216:219], v[164:167]
    ds_read_b64_tr_b16 v[208:209], v3 offset:8192
    v_mfma_f32_16x16x32_bf16 v[164:167], v[92:95], v[220:223], v[164:167]
    ds_read_b64_tr_b16 v[210:211], v3 offset:8704
    v_mfma_f32_16x16x32_bf16 v[164:167], v[96:99], v[224:227], v[164:167]
    ds_read_b64_tr_b16 v[212:213], v3 offset:12288
    v_mfma_f32_16x16x32_bf16 v[164:167], v[100:103], v[228:231], v[164:167]
    ds_read_b64_tr_b16 v[214:215], v3 offset:12800
    v_mfma_f32_16x16x32_bf16 v[172:175], v[136:139], v[216:219], v[172:175]
    s_mul_i32 s47, s42, 24576
    v_mfma_f32_16x16x32_bf16 v[172:175], v[140:143], v[220:223], v[172:175]
    s_add_u32 s47, s47, s39
    v_mfma_f32_16x16x32_bf16 v[172:175], v[144:147], v[224:227], v[172:175]
    s_cmp_eq_u32 s42, s85
    v_mfma_f32_16x16x32_bf16 v[172:175], v[148:151], v[228:231], v[172:175]
    s_cselect_b32 s16, s26, s24
    s_waitcnt lgkmcnt(0)
    v_mfma_f32_16x16x32_bf16 v[176:179], v[8:11], v[200:203], 0
    ds_read_b64_tr_b16 v[216:217], v3 offset:16384
    v_mfma_f32_16x16x32_bf16 v[176:179], v[12:15], v[204:207], v[176:179]
    ds_read_b64_tr_b16 v[218:219], v3 offset:16896
    v_mfma_f32_16x16x32_bf16 v[176:179], v[16:19], v[208:211], v[176:179]
    ds_read_b64_tr_b16 v[220:221], v3 offset:20480
    v_mfma_f32_16x16x32_bf16 v[176:179], v[20:23], v[212:215], v[176:179]
    ds_read_b64_tr_b16 v[222:223], v3 offset:20992
    v_mfma_f32_16x16x32_bf16 v[184:187], v[56:59], v[200:203], 0
    ds_read_b64_tr_b16 v[224:225], v3 offset:24576
    v_mfma_f32_16x16x32_bf16 v[184:187], v[60:63], v[204:207], v[184:187]
    ds_read_b64_tr_b16 v[226:227], v3 offset:25088
    v_mfma_f32_16x16x32_bf16 v[184:187], v[64:67], v[208:211], v[184:187]
    ds_read_b64_tr_b16 v[228:229], v3 offset:28672
    v_mfma_f32_16x16x32_bf16 v[184:187], v[68:71], v[212:215], v[184:187]
    ds_read_b64_tr_b16 v[230:231], v3 offset:29184
    v_mfma_f32_16x16x32_bf16 v[192:195], v[104:107], v[200:203], 0
    s_cselect_b32 s17, s27, s25
    v_mfma_f32_16x16x32_bf16 v[192:195], v[108:111], v[204:207], v[192:195]
    s_cselect_b32 s47, s59, s47
    v_mfma_f32_16x16x32_bf16 v[192:195], v[112:115], v[208:211], v[192:195]
    s_mov_b32 s37, 113246208
    v_mfma_f32_16x16x32_bf16 v[192:195], v[116:119], v[212:215], v[192:195]
    s_cselect_b32 s18, s37, 446693376
    s_waitcnt lgkmcnt(0)
    v_mfma_f32_16x16x32_bf16 v[176:179], v[24:27], v[216:219], v[176:179]
    ds_read_b64_tr_b16 v[200:201], v3 offset:32768
    v_mfma_f32_16x16x32_bf16 v[176:179], v[28:31], v[220:223], v[176:179]
    ds_read_b64_tr_b16 v[202:203], v3 offset:33280
    v_mfma_f32_16x16x32_bf16 v[176:179], v[32:35], v[224:227], v[176:179]
    ds_read_b64_tr_b16 v[204:205], v3 offset:36864
    v_mfma_f32_16x16x32_bf16 v[176:179], v[36:39], v[228:231], v[176:179]
    ds_read_b64_tr_b16 v[206:207], v3 offset:37376
    v_mfma_f32_16x16x32_bf16 v[184:187], v[72:75], v[216:219], v[184:187]
    ds_read_b64_tr_b16 v[208:209], v3 offset:40960
    v_mfma_f32_16x16x32_bf16 v[184:187], v[76:79], v[220:223], v[184:187]
    ds_read_b64_tr_b16 v[210:211], v3 offset:41472
    v_mfma_f32_16x16x32_bf16 v[184:187], v[80:83], v[224:227], v[184:187]
    ds_read_b64_tr_b16 v[212:213], v3 offset:45056
    v_mfma_f32_16x16x32_bf16 v[184:187], v[84:87], v[228:231], v[184:187]
    ds_read_b64_tr_b16 v[214:215], v3 offset:45568
    v_mfma_f32_16x16x32_bf16 v[192:195], v[120:123], v[216:219], v[192:195]
    s_add_u32 s48, s47, 12288
    v_mfma_f32_16x16x32_bf16 v[192:195], v[124:127], v[220:223], v[192:195]
    v_mfma_f32_16x16x32_bf16 v[192:195], v[128:131], v[224:227], v[192:195]
    v_mfma_f32_16x16x32_bf16 v[192:195], v[132:135], v[228:231], v[192:195]
    v_xor_b32 v3, 32, v3
    s_waitcnt lgkmcnt(0)
    v_mfma_f32_16x16x32_bf16 v[176:179], v[40:43], v[200:203], v[176:179]
    ds_read_b64_tr_b16 v[216:217], v3 offset:0
    v_mfma_f32_16x16x32_bf16 v[176:179], v[44:47], v[204:207], v[176:179]
    ds_read_b64_tr_b16 v[218:219], v3 offset:512
    v_mfma_f32_16x16x32_bf16 v[176:179], v[48:51], v[208:211], v[176:179]
    ds_read_b64_tr_b16 v[220:221], v3 offset:4096
    v_mfma_f32_16x16x32_bf16 v[176:179], v[52:55], v[212:215], v[176:179]
    ds_read_b64_tr_b16 v[222:223], v3 offset:4608
    v_mfma_f32_16x16x32_bf16 v[184:187], v[88:91], v[200:203], v[184:187]
    ds_read_b64_tr_b16 v[224:225], v3 offset:8192
    v_mfma_f32_16x16x32_bf16 v[184:187], v[92:95], v[204:207], v[184:187]
    ds_read_b64_tr_b16 v[226:227], v3 offset:8704
    v_mfma_f32_16x16x32_bf16 v[184:187], v[96:99], v[208:211], v[184:187]
    ds_read_b64_tr_b16 v[228:229], v3 offset:12288
    v_mfma_f32_16x16x32_bf16 v[184:187], v[100:103], v[212:215], v[184:187]
    ds_read_b64_tr_b16 v[230:231], v3 offset:12800
    v_mfma_f32_16x16x32_bf16 v[192:195], v[136:139], v[200:203], v[192:195]
    v_mfma_f32_16x16x32_bf16 v[192:195], v[140:143], v[204:207], v[192:195]
    v_mfma_f32_16x16x32_bf16 v[192:195], v[144:147], v[208:211], v[192:195]
    v_mfma_f32_16x16x32_bf16 v[192:195], v[148:151], v[212:215], v[192:195]
    s_waitcnt lgkmcnt(0)
    v_mfma_f32_16x16x32_bf16 v[180:183], v[8:11], v[216:219], 0
    ds_read_b64_tr_b16 v[200:201], v3 offset:16384
    v_mfma_f32_16x16x32_bf16 v[180:183], v[12:15], v[220:223], v[180:183]
    ds_read_b64_tr_b16 v[202:203], v3 offset:16896
    v_mfma_f32_16x16x32_bf16 v[180:183], v[16:19], v[224:227], v[180:183]
    ds_read_b64_tr_b16 v[204:205], v3 offset:20480
    v_mfma_f32_16x16x32_bf16 v[180:183], v[20:23], v[228:231], v[180:183]
    ds_read_b64_tr_b16 v[206:207], v3 offset:20992
    v_mfma_f32_16x16x32_bf16 v[188:191], v[56:59], v[216:219], 0
    ds_read_b64_tr_b16 v[208:209], v3 offset:24576
    v_mfma_f32_16x16x32_bf16 v[188:191], v[60:63], v[220:223], v[188:191]
    ds_read_b64_tr_b16 v[210:211], v3 offset:25088
    v_mfma_f32_16x16x32_bf16 v[188:191], v[64:67], v[224:227], v[188:191]
    ds_read_b64_tr_b16 v[212:213], v3 offset:28672
    v_mfma_f32_16x16x32_bf16 v[188:191], v[68:71], v[228:231], v[188:191]
    ds_read_b64_tr_b16 v[214:215], v3 offset:29184
    v_mfma_f32_16x16x32_bf16 v[196:199], v[104:107], v[216:219], 0
    v_mfma_f32_16x16x32_bf16 v[196:199], v[108:111], v[220:223], v[196:199]
    v_mfma_f32_16x16x32_bf16 v[196:199], v[112:115], v[224:227], v[196:199]
    v_mfma_f32_16x16x32_bf16 v[196:199], v[116:119], v[228:231], v[196:199]
    s_waitcnt lgkmcnt(0)
    v_mfma_f32_16x16x32_bf16 v[180:183], v[24:27], v[200:203], v[180:183]
    ds_read_b64_tr_b16 v[216:217], v3 offset:32768
    v_mfma_f32_16x16x32_bf16 v[180:183], v[28:31], v[204:207], v[180:183]
    ds_read_b64_tr_b16 v[218:219], v3 offset:33280
    v_mfma_f32_16x16x32_bf16 v[180:183], v[32:35], v[208:211], v[180:183]
    ds_read_b64_tr_b16 v[220:221], v3 offset:36864
    v_mfma_f32_16x16x32_bf16 v[180:183], v[36:39], v[212:215], v[180:183]
    ds_read_b64_tr_b16 v[222:223], v3 offset:37376
    v_mfma_f32_16x16x32_bf16 v[188:191], v[72:75], v[200:203], v[188:191]
    ds_read_b64_tr_b16 v[224:225], v3 offset:40960
    v_mfma_f32_16x16x32_bf16 v[188:191], v[76:79], v[204:207], v[188:191]
    ds_read_b64_tr_b16 v[226:227], v3 offset:41472
    v_mfma_f32_16x16x32_bf16 v[188:191], v[80:83], v[208:211], v[188:191]
    ds_read_b64_tr_b16 v[228:229], v3 offset:45056
    v_mfma_f32_16x16x32_bf16 v[188:191], v[84:87], v[212:215], v[188:191]
    ds_read_b64_tr_b16 v[230:231], v3 offset:45568
    v_mfma_f32_16x16x32_bf16 v[196:199], v[120:123], v[200:203], v[196:199]
    v_mfma_f32_16x16x32_bf16 v[196:199], v[124:127], v[204:207], v[196:199]
    v_mfma_f32_16x16x32_bf16 v[196:199], v[128:131], v[208:211], v[196:199]
    v_mfma_f32_16x16x32_bf16 v[196:199], v[132:135], v[212:215], v[196:199]
    s_waitcnt lgkmcnt(0)
    v_mfma_f32_16x16x32_bf16 v[180:183], v[40:43], v[216:219], v[180:183]
    v_mfma_f32_16x16x32_bf16 v[180:183], v[44:47], v[220:223], v[180:183]
    v_mfma_f32_16x16x32_bf16 v[180:183], v[48:51], v[224:227], v[180:183]
    v_mfma_f32_16x16x32_bf16 v[180:183], v[52:55], v[228:231], v[180:183]
    v_mfma_f32_16x16x32_bf16 v[188:191], v[88:91], v[216:219], v[188:191]
    v_mfma_f32_16x16x32_bf16 v[188:191], v[92:95], v[220:223], v[188:191]
    v_mfma_f32_16x16x32_bf16 v[188:191], v[96:99], v[224:227], v[188:191]
    v_mfma_f32_16x16x32_bf16 v[188:191], v[100:103], v[228:231], v[188:191]
    v_mfma_f32_16x16x32_bf16 v[196:199], v[136:139], v[216:219], v[196:199]
    v_mfma_f32_16x16x32_bf16 v[196:199], v[140:143], v[220:223], v[196:199]
    v_mfma_f32_16x16x32_bf16 v[196:199], v[144:147], v[224:227], v[196:199]
    v_mfma_f32_16x16x32_bf16 v[196:199], v[148:151], v[228:231], v[196:199]
    s_setprio 0
    v_cvt_pk_f16_f32 v216, v152, v153
    v_cvt_pk_f16_f32 v217, v154, v155
    v_cvt_pk_f16_f32 v218, v156, v157
    v_cvt_pk_f16_f32 v219, v158, v159
    v_pk_fma_f16 v220, v216, v216, s44 neg_lo:[1,0,0] neg_hi:[1,0,0]
    v_pk_fma_f16 v221, v217, v217, s44 neg_lo:[1,0,0] neg_hi:[1,0,0]
    v_pk_fma_f16 v222, v218, v218, s44 neg_lo:[1,0,0] neg_hi:[1,0,0]
    v_pk_fma_f16 v223, v219, v219, s44 neg_lo:[1,0,0] neg_hi:[1,0,0]
    v_pk_mul_f16 v220, v220, v216
    v_pk_mul_f16 v221, v221, v217
    v_pk_mul_f16 v222, v222, v218
    v_pk_mul_f16 v223, v223, v219
    v_exp_f16 v216, v220
    v_exp_f16 v217, v221
    v_exp_f16 v218, v222
    v_exp_f16 v219, v223
    v_exp_f16_sdwa v216, v220 dst_sel:WORD_1 dst_unused:UNUSED_PRESERVE src0_sel:WORD_1
    v_exp_f16_sdwa v217, v221 dst_sel:WORD_1 dst_unused:UNUSED_PRESERVE src0_sel:WORD_1
    v_exp_f16_sdwa v218, v222 dst_sel:WORD_1 dst_unused:UNUSED_PRESERVE src0_sel:WORD_1
    v_exp_f16_sdwa v219, v223 dst_sel:WORD_1 dst_unused:UNUSED_PRESERVE src0_sel:WORD_1
    v_pk_add_f16 v216, v216, 1.0 op_sel_hi:[1,0]
    v_pk_add_f16 v217, v217, 1.0 op_sel_hi:[1,0]
    v_pk_add_f16 v218, v218, 1.0 op_sel_hi:[1,0]
    v_pk_add_f16 v219, v219, 1.0 op_sel_hi:[1,0]
    v_rcp_f16 v220, v216
    v_rcp_f16 v221, v217
    v_rcp_f16 v222, v218
    v_rcp_f16 v223, v219
    v_rcp_f16_sdwa v216, v216 dst_sel:DWORD dst_unused:UNUSED_PAD src0_sel:WORD_1
    v_rcp_f16_sdwa v217, v217 dst_sel:DWORD dst_unused:UNUSED_PAD src0_sel:WORD_1
    v_rcp_f16_sdwa v218, v218 dst_sel:DWORD dst_unused:UNUSED_PAD src0_sel:WORD_1
    v_rcp_f16_sdwa v219, v219 dst_sel:DWORD dst_unused:UNUSED_PAD src0_sel:WORD_1
    v_fma_mix_f32 v152, v152, v220, 0 op_sel_hi:[0,1,0]
    v_fma_mix_f32 v154, v154, v221, 0 op_sel_hi:[0,1,0]
    v_fma_mix_f32 v156, v156, v222, 0 op_sel_hi:[0,1,0]
    v_fma_mix_f32 v158, v158, v223, 0 op_sel_hi:[0,1,0]
    v_fma_mix_f32 v153, v153, v216, 0 op_sel_hi:[0,1,0]
    v_fma_mix_f32 v155, v155, v217, 0 op_sel_hi:[0,1,0]
    v_fma_mix_f32 v157, v157, v218, 0 op_sel_hi:[0,1,0]
    v_fma_mix_f32 v159, v159, v219, 0 op_sel_hi:[0,1,0]
    v_cvt_pk_bf16_f32 v159, v158, v159
    v_cvt_pk_bf16_f32 v158, v156, v157
    v_cvt_pk_bf16_f32 v157, v154, v155
    v_cvt_pk_bf16_f32 v156, v152, v153
    v_cvt_pk_f16_f32 v216, v160, v161
    v_cvt_pk_f16_f32 v217, v162, v163
    v_cvt_pk_f16_f32 v218, v164, v165
    v_cvt_pk_f16_f32 v219, v166, v167
    v_pk_fma_f16 v220, v216, v216, s44 neg_lo:[1,0,0] neg_hi:[1,0,0]
    v_pk_fma_f16 v221, v217, v217, s44 neg_lo:[1,0,0] neg_hi:[1,0,0]
    v_pk_fma_f16 v222, v218, v218, s44 neg_lo:[1,0,0] neg_hi:[1,0,0]
    v_pk_fma_f16 v223, v219, v219, s44 neg_lo:[1,0,0] neg_hi:[1,0,0]
    v_pk_mul_f16 v220, v220, v216
    v_pk_mul_f16 v221, v221, v217
    v_pk_mul_f16 v222, v222, v218
    v_pk_mul_f16 v223, v223, v219
    v_exp_f16 v216, v220
    v_exp_f16 v217, v221
    v_exp_f16 v218, v222
    v_exp_f16 v219, v223
    v_exp_f16_sdwa v216, v220 dst_sel:WORD_1 dst_unused:UNUSED_PRESERVE src0_sel:WORD_1
    v_exp_f16_sdwa v217, v221 dst_sel:WORD_1 dst_unused:UNUSED_PRESERVE src0_sel:WORD_1
    v_exp_f16_sdwa v218, v222 dst_sel:WORD_1 dst_unused:UNUSED_PRESERVE src0_sel:WORD_1
    v_exp_f16_sdwa v219, v223 dst_sel:WORD_1 dst_unused:UNUSED_PRESERVE src0_sel:WORD_1
    v_pk_add_f16 v216, v216, 1.0 op_sel_hi:[1,0]
    v_pk_add_f16 v217, v217, 1.0 op_sel_hi:[1,0]
    v_pk_add_f16 v218, v218, 1.0 op_sel_hi:[1,0]
    v_pk_add_f16 v219, v219, 1.0 op_sel_hi:[1,0]
    v_rcp_f16 v220, v216
    v_rcp_f16 v221, v217
    v_rcp_f16 v222, v218
    v_rcp_f16 v223, v219
    v_rcp_f16_sdwa v216, v216 dst_sel:DWORD dst_unused:UNUSED_PAD src0_sel:WORD_1
    v_rcp_f16_sdwa v217, v217 dst_sel:DWORD dst_unused:UNUSED_PAD src0_sel:WORD_1
    v_rcp_f16_sdwa v218, v218 dst_sel:DWORD dst_unused:UNUSED_PAD src0_sel:WORD_1
    v_rcp_f16_sdwa v219, v219 dst_sel:DWORD dst_unused:UNUSED_PAD src0_sel:WORD_1
    v_fma_mix_f32 v160, v160, v220, 0 op_sel_hi:[0,1,0]
    v_fma_mix_f32 v162, v162, v221, 0 op_sel_hi:[0,1,0]
    v_fma_mix_f32 v164, v164, v222, 0 op_sel_hi:[0,1,0]
    v_fma_mix_f32 v166, v166, v223, 0 op_sel_hi:[0,1,0]
    v_fma_mix_f32 v161, v161, v216, 0 op_sel_hi:[0,1,0]
    v_fma_mix_f32 v163, v163, v217, 0 op_sel_hi:[0,1,0]
    v_fma_mix_f32 v165, v165, v218, 0 op_sel_hi:[0,1,0]
    v_fma_mix_f32 v167, v167, v219, 0 op_sel_hi:[0,1,0]
    v_cvt_pk_bf16_f32 v167, v166, v167
    v_cvt_pk_bf16_f32 v166, v164, v165
    v_cvt_pk_bf16_f32 v165, v162, v163
    v_cvt_pk_bf16_f32 v164, v160, v161
    s_setprio 1
    s_nop 0
    v_cvt_pk_f16_f32 v216, v168, v169
    v_cvt_pk_f16_f32 v217, v170, v171
    v_cvt_pk_f16_f32 v218, v172, v173
    v_cvt_pk_f16_f32 v219, v174, v175
    v_pk_fma_f16 v220, v216, v216, s44 neg_lo:[1,0,0] neg_hi:[1,0,0]
    v_pk_fma_f16 v221, v217, v217, s44 neg_lo:[1,0,0] neg_hi:[1,0,0]
    v_pk_fma_f16 v222, v218, v218, s44 neg_lo:[1,0,0] neg_hi:[1,0,0]
    v_pk_fma_f16 v223, v219, v219, s44 neg_lo:[1,0,0] neg_hi:[1,0,0]
    v_pk_mul_f16 v220, v220, v216
    v_pk_mul_f16 v221, v221, v217
    v_pk_mul_f16 v222, v222, v218
    v_pk_mul_f16 v223, v223, v219
    v_exp_f16 v216, v220
    v_exp_f16 v217, v221
    v_exp_f16 v218, v222
    v_exp_f16 v219, v223
    v_exp_f16_sdwa v216, v220 dst_sel:WORD_1 dst_unused:UNUSED_PRESERVE src0_sel:WORD_1
    v_exp_f16_sdwa v217, v221 dst_sel:WORD_1 dst_unused:UNUSED_PRESERVE src0_sel:WORD_1
    v_exp_f16_sdwa v218, v222 dst_sel:WORD_1 dst_unused:UNUSED_PRESERVE src0_sel:WORD_1
    v_exp_f16_sdwa v219, v223 dst_sel:WORD_1 dst_unused:UNUSED_PRESERVE src0_sel:WORD_1
    v_pk_add_f16 v216, v216, 1.0 op_sel_hi:[1,0]
    v_pk_add_f16 v217, v217, 1.0 op_sel_hi:[1,0]
    v_pk_add_f16 v218, v218, 1.0 op_sel_hi:[1,0]
    v_pk_add_f16 v219, v219, 1.0 op_sel_hi:[1,0]
    v_rcp_f16 v220, v216
    v_rcp_f16 v221, v217
    v_rcp_f16 v222, v218
    v_rcp_f16 v223, v219
    v_rcp_f16_sdwa v216, v216 dst_sel:DWORD dst_unused:UNUSED_PAD src0_sel:WORD_1
    v_rcp_f16_sdwa v217, v217 dst_sel:DWORD dst_unused:UNUSED_PAD src0_sel:WORD_1
    v_rcp_f16_sdwa v218, v218 dst_sel:DWORD dst_unused:UNUSED_PAD src0_sel:WORD_1
    v_rcp_f16_sdwa v219, v219 dst_sel:DWORD dst_unused:UNUSED_PAD src0_sel:WORD_1
    v_fma_mix_f32 v168, v168, v220, 0 op_sel_hi:[0,1,0]
    v_fma_mix_f32 v170, v170, v221, 0 op_sel_hi:[0,1,0]
    v_fma_mix_f32 v172, v172, v222, 0 op_sel_hi:[0,1,0]
    v_fma_mix_f32 v174, v174, v223, 0 op_sel_hi:[0,1,0]
    v_fma_mix_f32 v169, v169, v216, 0 op_sel_hi:[0,1,0]
    v_fma_mix_f32 v171, v171, v217, 0 op_sel_hi:[0,1,0]
    v_fma_mix_f32 v173, v173, v218, 0 op_sel_hi:[0,1,0]
    v_fma_mix_f32 v175, v175, v219, 0 op_sel_hi:[0,1,0]
    v_cvt_pk_bf16_f32 v175, v174, v175
    v_cvt_pk_bf16_f32 v174, v172, v173
    v_cvt_pk_bf16_f32 v173, v170, v171
    v_cvt_pk_bf16_f32 v172, v168, v169
    s_cmp_eq_u32 s32, 36
    s_cbranch_scc1 K1_nogb
    s_barrier
    s_nop 0
K1_nogb:
    v_cvt_pk_f16_f32 v216, v176, v177
    v_cvt_pk_f16_f32 v217, v178, v179
    v_cvt_pk_f16_f32 v218, v180, v181
    v_cvt_pk_f16_f32 v219, v182, v183
    v_pk_fma_f16 v220, v216, v216, s44 neg_lo:[1,0,0] neg_hi:[1,0,0]
    v_pk_fma_f16 v221, v217, v217, s44 neg_lo:[1,0,0] neg_hi:[1,0,0]
    v_pk_fma_f16 v222, v218, v218, s44 neg_lo:[1,0,0] neg_hi:[1,0,0]
    v_pk_fma_f16 v223, v219, v219, s44 neg_lo:[1,0,0] neg_hi:[1,0,0]
    v_pk_mul_f16 v220, v220, v216
    v_pk_mul_f16 v221, v221, v217
    v_pk_mul_f16 v222, v222, v218
    v_pk_mul_f16 v223, v223, v219
    v_exp_f16 v216, v220
    v_exp_f16 v217, v221
    v_exp_f16 v218, v222
    v_exp_f16 v219, v223
    v_exp_f16_sdwa v216, v220 dst_sel:WORD_1 dst_unused:UNUSED_PRESERVE src0_sel:WORD_1
    v_exp_f16_sdwa v217, v221 dst_sel:WORD_1 dst_unused:UNUSED_PRESERVE src0_sel:WORD_1
    v_exp_f16_sdwa v218, v222 dst_sel:WORD_1 dst_unused:UNUSED_PRESERVE src0_sel:WORD_1
    v_exp_f16_sdwa v219, v223 dst_sel:WORD_1 dst_unused:UNUSED_PRESERVE src0_sel:WORD_1
    v_pk_add_f16 v216, v216, 1.0 op_sel_hi:[1,0]
    v_pk_add_f16 v217, v217, 1.0 op_sel_hi:[1,0]
    v_pk_add_f16 v218, v218, 1.0 op_sel_hi:[1,0]
    v_pk_add_f16 v219, v219, 1.0 op_sel_hi:[1,0]
    v_rcp_f16 v220, v216
    v_rcp_f16 v221, v217
    v_rcp_f16 v222, v218
    v_rcp_f16 v223, v219
    v_rcp_f16_sdwa v216, v216 dst_sel:DWORD dst_unused:UNUSED_PAD src0_sel:WORD_1
    v_rcp_f16_sdwa v217, v217 dst_sel:DWORD dst_unused:UNUSED_PAD src0_sel:WORD_1
    v_rcp_f16_sdwa v218, v218 dst_sel:DWORD dst_unused:UNUSED_PAD src0_sel:WORD_1
    v_rcp_f16_sdwa v219, v219 dst_sel:DWORD dst_unused:UNUSED_PAD src0_sel:WORD_1
    v_fma_mix_f32 v176, v176, v220, 0 op_sel_hi:[0,1,0]
    v_fma_mix_f32 v178, v178, v221, 0 op_sel_hi:[0,1,0]
    v_fma_mix_f32 v180, v180, v222, 0 op_sel_hi:[0,1,0]
    v_fma_mix_f32 v182, v182, v223, 0 op_sel_hi:[0,1,0]
    v_fma_mix_f32 v177, v177, v216, 0 op_sel_hi:[0,1,0]
    v_fma_mix_f32 v179, v179, v217, 0 op_sel_hi:[0,1,0]
    v_fma_mix_f32 v181, v181, v218, 0 op_sel_hi:[0,1,0]
    v_fma_mix_f32 v183, v183, v219, 0 op_sel_hi:[0,1,0]
    v_cvt_pk_bf16_f32 v183, v182, v183
    v_cvt_pk_bf16_f32 v182, v180, v181
    v_cvt_pk_bf16_f32 v181, v178, v179
    v_cvt_pk_bf16_f32 v180, v176, v177
    v_cvt_pk_f16_f32 v216, v184, v185
    v_cvt_pk_f16_f32 v217, v186, v187
    v_cvt_pk_f16_f32 v218, v188, v189
    v_cvt_pk_f16_f32 v219, v190, v191
    v_pk_fma_f16 v220, v216, v216, s44 neg_lo:[1,0,0] neg_hi:[1,0,0]
    v_pk_fma_f16 v221, v217, v217, s44 neg_lo:[1,0,0] neg_hi:[1,0,0]
    v_pk_fma_f16 v222, v218, v218, s44 neg_lo:[1,0,0] neg_hi:[1,0,0]
    v_pk_fma_f16 v223, v219, v219, s44 neg_lo:[1,0,0] neg_hi:[1,0,0]
    v_pk_mul_f16 v220, v220, v216
    v_pk_mul_f16 v221, v221, v217
    v_pk_mul_f16 v222, v222, v218
    v_pk_mul_f16 v223, v223, v219
    v_exp_f16 v216, v220
    v_exp_f16 v217, v221
    v_exp_f16 v218, v222
    v_exp_f16 v219, v223
    v_exp_f16_sdwa v216, v220 dst_sel:WORD_1 dst_unused:UNUSED_PRESERVE src0_sel:WORD_1
    v_exp_f16_sdwa v217, v221 dst_sel:WORD_1 dst_unused:UNUSED_PRESERVE src0_sel:WORD_1
    v_exp_f16_sdwa v218, v222 dst_sel:WORD_1 dst_unused:UNUSED_PRESERVE src0_sel:WORD_1
    v_exp_f16_sdwa v219, v223 dst_sel:WORD_1 dst_unused:UNUSED_PRESERVE src0_sel:WORD_1
    v_pk_add_f16 v216, v216, 1.0 op_sel_hi:[1,0]
    v_pk_add_f16 v217, v217, 1.0 op_sel_hi:[1,0]
    v_pk_add_f16 v218, v218, 1.0 op_sel_hi:[1,0]
    v_pk_add_f16 v219, v219, 1.0 op_sel_hi:[1,0]
    v_rcp_f16 v220, v216
    v_rcp_f16 v221, v217
    v_rcp_f16 v222, v218
    v_rcp_f16 v223, v219
    v_rcp_f16_sdwa v216, v216 dst_sel:DWORD dst_unused:UNUSED_PAD src0_sel:WORD_1
    v_rcp_f16_sdwa v217, v217 dst_sel:DWORD dst_unused:UNUSED_PAD src0_sel:WORD_1
    v_rcp_f16_sdwa v218, v218 dst_sel:DWORD dst_unused:UNUSED_PAD src0_sel:WORD_1
    v_rcp_f16_sdwa v219, v219 dst_sel:DWORD dst_unused:UNUSED_PAD src0_sel:WORD_1
    v_fma_mix_f32 v184, v184, v220, 0 op_sel_hi:[0,1,0]
    v_fma_mix_f32 v186, v186, v221, 0 op_sel_hi:[0,1,0]
    v_fma_mix_f32 v188, v188, v222, 0 op_sel_hi:[0,1,0]
    v_fma_mix_f32 v190, v190, v223, 0 op_sel_hi:[0,1,0]
    v_fma_mix_f32 v185, v185, v216, 0 op_sel_hi:[0,1,0]
    v_fma_mix_f32 v187, v187, v217, 0 op_sel_hi:[0,1,0]
    v_fma_mix_f32 v189, v189, v218, 0 op_sel_hi:[0,1,0]
    v_fma_mix_f32 v191, v191, v219, 0 op_sel_hi:[0,1,0]
    v_cvt_pk_bf16_f32 v191, v190, v191
    v_cvt_pk_bf16_f32 v190, v188, v189
    v_cvt_pk_bf16_f32 v189, v186, v187
    v_cvt_pk_bf16_f32 v188, v184, v185
    v_cvt_pk_f16_f32 v216, v192, v193
    v_cvt_pk_f16_f32 v217, v194, v195
    v_cvt_pk_f16_f32 v218, v196, v197
    v_cvt_pk_f16_f32 v219, v198, v199
    v_pk_fma_f16 v220, v216, v216, s44 neg_lo:[1,0,0] neg_hi:[1,0,0]
    v_pk_fma_f16 v221, v217, v217, s44 neg_lo:[1,0,0] neg_hi:[1,0,0]
    v_pk_fma_f16 v222, v218, v218, s44 neg_lo:[1,0,0] neg_hi:[1,0,0]
    v_pk_fma_f16 v223, v219, v219, s44 neg_lo:[1,0,0] neg_hi:[1,0,0]
    v_pk_mul_f16 v220, v220, v216
    v_pk_mul_f16 v221, v221, v217
    v_pk_mul_f16 v222, v222, v218
    v_pk_mul_f16 v223, v223, v219
    v_exp_f16 v216, v220
    v_exp_f16 v217, v221
    v_exp_f16 v218, v222
    v_exp_f16 v219, v223
    v_exp_f16_sdwa v216, v220 dst_sel:WORD_1 dst_unused:UNUSED_PRESERVE src0_sel:WORD_1
    v_exp_f16_sdwa v217, v221 dst_sel:WORD_1 dst_unused:UNUSED_PRESERVE src0_sel:WORD_1
    v_exp_f16_sdwa v218, v222 dst_sel:WORD_1 dst_unused:UNUSED_PRESERVE src0_sel:WORD_1
    v_exp_f16_sdwa v219, v223 dst_sel:WORD_1 dst_unused:UNUSED_PRESERVE src0_sel:WORD_1
    v_pk_add_f16 v216, v216, 1.0 op_sel_hi:[1,0]
    v_pk_add_f16 v217, v217, 1.0 op_sel_hi:[1,0]
    v_pk_add_f16 v218, v218, 1.0 op_sel_hi:[1,0]
    v_pk_add_f16 v219, v219, 1.0 op_sel_hi:[1,0]
    v_rcp_f16 v220, v216
    v_rcp_f16 v221, v217
    v_rcp_f16 v222, v218
    v_rcp_f16 v223, v219
    v_rcp_f16_sdwa v216, v216 dst_sel:DWORD dst_unused:UNUSED_PAD src0_sel:WORD_1
    v_rcp_f16_sdwa v217, v217 dst_sel:DWORD dst_unused:UNUSED_PAD src0_sel:WORD_1
    v_rcp_f16_sdwa v218, v218 dst_sel:DWORD dst_unused:UNUSED_PAD src0_sel:WORD_1
    v_rcp_f16_sdwa v219, v219 dst_sel:DWORD dst_unused:UNUSED_PAD src0_sel:WORD_1
    v_fma_mix_f32 v192, v192, v220, 0 op_sel_hi:[0,1,0]
    v_fma_mix_f32 v194, v194, v221, 0 op_sel_hi:[0,1,0]
    v_fma_mix_f32 v196, v196, v222, 0 op_sel_hi:[0,1,0]
    v_fma_mix_f32 v198, v198, v223, 0 op_sel_hi:[0,1,0]
    v_fma_mix_f32 v193, v193, v216, 0 op_sel_hi:[0,1,0]
    v_fma_mix_f32 v195, v195, v217, 0 op_sel_hi:[0,1,0]
    v_fma_mix_f32 v197, v197, v218, 0 op_sel_hi:[0,1,0]
    v_fma_mix_f32 v199, v199, v219, 0 op_sel_hi:[0,1,0]
    v_cvt_pk_bf16_f32 v199, v198, v199
    v_cvt_pk_bf16_f32 v198, v196, v197
    v_cvt_pk_bf16_f32 v197, v194, v195
    v_cvt_pk_bf16_f32 v196, v192, v193
    v_dot2_f32_bf16 v224, v156, v156, 0
    v_dot2_f32_bf16 v225, v158, v158, 0
    v_dot2_f32_bf16 v226, v180, v180, 0
    v_dot2_f32_bf16 v227, v182, v182, 0
    v_add_u32 v3, s34, v7
    ds_read_b64_tr_b16 v[200:201], v3 offset:0
    ds_read_b64_tr_b16 v[202:203], v3 offset:512
    v_dot2c_f32_bf16 v224, v157, v157
    v_dot2c_f32_bf16 v225, v159, v159
    v_dot2c_f32_bf16 v226, v181, v181
    v_dot2c_f32_bf16 v227, v183, v183
    ds_read_b64_tr_b16 v[204:205], v3 offset:4096
    ds_read_b64_tr_b16 v[206:207], v3 offset:4608
    v_dot2c_f32_bf16 v224, v164, v164
    v_dot2c_f32_bf16 v225, v166, v166
    v_dot2c_f32_bf16 v226, v188, v188
    v_dot2c_f32_bf16 v227, v190, v190
    ds_read_b64_tr_b16 v[208:209], v3 offset:8192
    ds_read_b64_tr_b16 v[210:211], v3 offset:8704
    v_dot2c_f32_bf16 v224, v165, v165
    v_dot2c_f32_bf16 v225, v167, v167
    v_dot2c_f32_bf16 v226, v189, v189
    v_dot2c_f32_bf16 v227, v191, v191
    ds_read_b64_tr_b16 v[212:213], v3 offset:12288
    ds_read_b64_tr_b16 v[214:215], v3 offset:12800
    v_dot2c_f32_bf16 v224, v172, v172
    v_dot2c_f32_bf16 v225, v174, v174
    v_dot2c_f32_bf16 v226, v196, v196
    v_dot2c_f32_bf16 v227, v198, v198
    v_dot2c_f32_bf16 v224, v173, v173
    v_dot2c_f32_bf16 v225, v175, v175
    v_dot2c_f32_bf16 v226, v197, v197
    v_dot2c_f32_bf16 v227, v199, v199
    s_add_u32 s37, s42, 1
    v_permlane16_swap_b32 v224, v225
    s_cmp_eq_u32 s37, s53
    v_permlane16_swap_b32 v226, v227
    v_add_f32 v224, v224, v225
    v_add_f32 v226, v226, v227
    s_cselect_b32 s37, s52, s37
    s_nop 0
    v_permlane32_swap_b32 v224, v226
    v_add_f32 v224, v224, v226
    s_set_gpr_idx_on s42, gpr_idx(SRC0,DST)
    s_mov_b32 s42, s37
    v_add_f32 v232, v232, v224
    s_set_gpr_idx_off
    s_cmp_lg_u32 s32, 36
    s_cbranch_scc1 K1_tailB
    s_branch K1_fin
K1_sw:
    s_setprio 0
    s_mov_b64 vcc, -1
    s_mov_b32 s33, 34
    s_mov_b32 s52, s83
    s_mov_b32 s53, s84
    s_add_u32 s42, s52, s56
    s_mov_b32 s39, s82
    s_mov_b32 s85, s86
    s_and_b32 s43, s2, 7
    s_lshl_b32 s43, s43, 2
    s_waitcnt lgkmcnt(0)
    v_mov_b32 v214, 0
    buffer_load_dword v215, v214, s[20:23], s43 offen offset:64 sc0 sc1
    s_branch K1_ln
K1_fin:
    s_setprio 0
    buffer_store_dwordx4 v[156:159], v4, s[16:19], s47 offen offset:0 nt
    buffer_store_dwordx4 v[164:167], v4, s[16:19], s47 offen offset:1024 nt
    buffer_store_dwordx4 v[172:175], v4, s[16:19], s47 offen offset:2048 nt
    buffer_store_dwordx4 v[180:183], v4, s[16:19], s48 offen offset:0 nt
    buffer_store_dwordx4 v[188:191], v4, s[16:19], s48 offen offset:1024 nt
    buffer_store_dwordx4 v[196:199], v4, s[16:19], s48 offen offset:2048 nt
    s_and_b32 s36, s2, 7
    s_waitcnt lgkmcnt(0)
    s_barrier
    v_and_b32 v1, 63, v0
    v_lshlrev_b32 v1, 2, v1
    v_add_u32 v1, s46, v1
    ds_write_b32 v1, v232 offset:0
    ds_write_b32 v1, v233 offset:256
    ds_write_b32 v1, v234 offset:512
    ds_write_b32 v1, v235 offset:768
    ds_write_b32 v1, v236 offset:1024
    ds_write_b32 v1, v237 offset:1280
    ds_write_b32 v1, v238 offset:1536
    ds_write_b32 v1, v239 offset:1792
    ds_write_b32 v1, v240 offset:2048
    ds_write_b32 v1, v241 offset:2304
    ds_write_b32 v1, v242 offset:2560
    ds_write_b32 v1, v243 offset:2816
    ds_write_b32 v1, v244 offset:3072
    ds_write_b32 v1, v245 offset:3328
    ds_write_b32 v1, v246 offset:3584
    ds_write_b32 v1, v247 offset:3840
    ds_write_b32 v1, v248 offset:4096
    ds_write_b32 v1, v249 offset:4352
    ds_write_b32 v1, v250 offset:4608
    ds_write_b32 v1, v251 offset:4864
    ds_write_b32 v1, v252 offset:5120
    ds_write_b32 v1, v253 offset:5376
    ds_write_b32 v1, v254 offset:5632
    ds_write_b32 v1, v255 offset:5888
    v_lshlrev_b32 v1, 2, v0
    s_waitcnt lgkmcnt(0)
    s_barrier
    ds_read_b32 v8, v1 offset:0
    ds_read_b32 v9, v1 offset:6144
    ds_read_b32 v10, v1 offset:12288
    ds_read_b32 v11, v1 offset:18432
    ds_read_b32 v12, v1 offset:24576
    ds_read_b32 v13, v1 offset:30720
    ds_read_b32 v14, v1 offset:36864
    ds_read_b32 v15, v1 offset:43008
    ds_read_b32 v16, v1 offset:2048
    ds_read_b32 v17, v1 offset:8192
    ds_read_b32 v18, v1 offset:14336
    ds_read_b32 v19, v1 offset:20480
    ds_read_b32 v20, v1 offset:26624
    ds_read_b32 v21, v1 offset:32768
    ds_read_b32 v22, v1 offset:38912
    ds_read_b32 v23, v1 offset:45056
    ds_read_b32 v24, v1 offset:4096
    ds_read_b32 v25, v1 offset:10240
    ds_read_b32 v26, v1 offset:16384
    ds_read_b32 v27, v1 offset:22528
    ds_read_b32 v28, v1 offset:28672
    ds_read_b32 v29, v1 offset:34816
    ds_read_b32 v30, v1 offset:40960
    ds_read_b32 v31, v1 offset:47104
    s_add_u32 s60, s24, 449056768
    s_addc_u32 s61, s25, 0
    s_mov_b32 s62, 49152
    s_mov_b32 s63, 0x00020000
    s_mul_i32 s36, s36, 6144
    s_add_u32 s37, s36, 4096
    s_waitcnt lgkmcnt(0)
    v_add_f32 v8, v8, v12
    v_add_f32 v9, v9, v13
    v_add_f32 v10, v10, v14
    v_add_f32 v11, v11, v15
    v_add_f32 v16, v16, v20
    v_add_f32 v17, v17, v21
    v_add_f32 v18, v18, v22
    v_add_f32 v19, v19, v23
    v_add_f32 v24, v24, v28
    v_add_f32 v25, v25, v29
    v_add_f32 v26, v26, v30
    v_add_f32 v27, v27, v31
    v_add_f32 v8, v8, v10
    v_add_f32 v9, v9, v11
    v_add_f32 v16, v16, v18
    v_add_f32 v17, v17, v19
    v_add_f32 v24, v24, v26
    v_add_f32 v25, v25, v27
    v_add_f32 v8, v8, v9
    v_add_f32 v16, v16, v17
    v_add_f32 v24, v24, v25
    buffer_atomic_add_f32 v8, v1, s[60:63], s36 offen
    buffer_atomic_add_f32 v16, v1, s[60:63], s36 offen offset:2048
    buffer_atomic_add_f32 v24, v1, s[60:63], s37 offen
    s_waitcnt vmcnt(0)
    s_barrier
    s_mov_b32 s48, s20
    s_mov_b32 s49, s21
    s_mov_b32 s50, s22
    s_mov_b32 s51, 0x00020000
    s_cmp_lg_u32 s30, 0
    s_cbranch_scc1 K1_tk
    v_lshlrev_b32 v2, 8, v0
    v_mov_b32 v3, 1
    buffer_atomic_add v3, v2, s[48:51], 0 offen offset:128 sc0
    s_nop 0
    v_mov_b32 v2, 147456
    s_waitcnt vmcnt(0)
    v_readfirstlane_b32 s2, v3
    s_nop 1
    v_mov_b32 v3, s2
    ds_write_b32 v2, v3
    s_waitcnt lgkmcnt(0)
K1_tk:
    s_barrier
    v_mov_b32 v2, 147456
    ds_read_b32 v3, v2
    s_waitcnt lgkmcnt(0)
    v_readfirstlane_b32 s2, v3
    s_nop 3
    s_cmp_ge_u32 s2, 24
    s_cbranch_scc1 K1_end
    s_load_dwordx4 s[4:7], s[0:1], 24
    s_load_dwordx2 s[8:9], s[0:1], 40
    s_load_dwordx2 s[10:11], s[0:1], 64
    v_lshrrev_b32 v1, 6, v0
    v_and_b32 v2, 63, v0
    v_readfirstlane_b32 s3, v1
    v_mul_u32_u24 v5, 12, v0
    s_lshr_b32 s30, s2, 2
    s_and_b32 s32, s2, 3
    s_lshl_b32 s31, s30, 3
    s_add_u32 s31, s31, s3
    s_mul_i32 s33, s32, 192
    s_mul_i32 s34, s31, 24576
    s_add_u32 s33, s33, s34
    v_lshrrev_b32 v3, 4, v2
    v_and_b32 v4, 1, v3
    v_lshlrev_b32 v4, 4, v4
    v_lshrrev_b32 v3, 1, v3
    v_lshl_add_u32 v3, v3, 3, v4
    v_mul_u32_u24 v7, 768, v3
    v_and_b32 v6, 15, v2
    v_mul_u32_u24 v4, 12, v6
    v_add_u32 v7, v4, v7
    s_lshl_b32 s35, s31, 6
    v_lshlrev_b32 v4, 1, v3
    s_waitcnt lgkmcnt(0)
    s_add_u32 s24, s10, 446693376
    s_addc_u32 s25, s11, 0
    s_mov_b32 s26, 6291456
    s_mov_b32 s27, 0x00020000
    s_mov_b32 s12, s4
    s_mov_b32 s13, s5
    s_mov_b32 s14, 1179648
    s_mov_b32 s15, 0x00020000
    s_mov_b32 s16, s6
    s_mov_b32 s17, s7
    s_mov_b32 s18, 3072
    s_mov_b32 s19, 0x00020000
    s_mov_b32 s20, s8
    s_mov_b32 s21, s9
    s_mov_b32 s22, 3072
    s_mov_b32 s23, 0x00020000
    buffer_load_dwordx3 v[64:66], v7, s[12:15], s33 offen offset:0
    buffer_load_dwordx3 v[68:70], v7, s[12:15], s33 offen offset:768
    buffer_load_dwordx3 v[72:74], v7, s[12:15], s33 offen offset:1536
    buffer_load_dwordx3 v[76:78], v7, s[12:15], s33 offen offset:2304
    s_add_u32 s33, s33, 3072
    buffer_load_dwordx3 v[80:82], v7, s[12:15], s33 offen offset:0
    buffer_load_dwordx3 v[84:86], v7, s[12:15], s33 offen offset:768
    buffer_load_dwordx3 v[88:90], v7, s[12:15], s33 offen offset:1536
    buffer_load_dwordx3 v[92:94], v7, s[12:15], s33 offen offset:2304
    buffer_load_dwordx4 v[16:19], v4, s[16:19], s35 offen
    buffer_load_dwordx4 v[12:15], v4, s[20:23], s35 offen
    s_waitcnt vmcnt(0)
    v_lshlrev_b32_e64 v96, 16, v64
    v_and_b32 v97, 0xffff0000, v64
    v_lshlrev_b32_e64 v98, 16, v65
    v_and_b32 v99, 0xffff0000, v65
    v_lshlrev_b32_e64 v100, 16, v66
    v_and_b32 v101, 0xffff0000, v66
    v_lshlrev_b32_e64 v102, 16, v68
    v_and_b32 v103, 0xffff0000, v68
    v_lshlrev_b32_e64 v104, 16, v69
    v_and_b32 v105, 0xffff0000, v69
    v_lshlrev_b32_e64 v106, 16, v70
    v_and_b32 v107, 0xffff0000, v70
    v_lshlrev_b32_e64 v108, 16, v72
    v_and_b32 v109, 0xffff0000, v72
    v_lshlrev_b32_e64 v110, 16, v73
    v_and_b32 v111, 0xffff0000, v73
    v_lshlrev_b32_e64 v112, 16, v74
    v_and_b32 v113, 0xffff0000, v74
    v_lshlrev_b32_e64 v114, 16, v76
    v_and_b32 v115, 0xffff0000, v76
    v_lshlrev_b32_e64 v116, 16, v77
    v_and_b32 v117, 0xffff0000, v77
    v_lshlrev_b32_e64 v118, 16, v78
    v_and_b32 v119, 0xffff0000, v78
    v_lshlrev_b32_e64 v120, 16, v80
    v_and_b32 v121, 0xffff0000, v80
    v_lshlrev_b32_e64 v122, 16, v81
    v_and_b32 v123, 0xffff0000, v81
    v_lshlrev_b32_e64 v124, 16, v82
    v_and_b32 v125, 0xffff0000, v82
    v_lshlrev_b32_e64 v126, 16, v84
    v_and_b32 v127, 0xffff0000, v84
    v_lshlrev_b32_e64 v128, 16, v85
    v_and_b32 v129, 0xffff0000, v85
    v_lshlrev_b32_e64 v130, 16, v86
    v_and_b32 v131, 0xffff0000, v86
    v_lshlrev_b32_e64 v132, 16, v88
    v_and_b32 v133, 0xffff0000, v88
    v_lshlrev_b32_e64 v134, 16, v89
    v_and_b32 v135, 0xffff0000, v89
    v_lshlrev_b32_e64 v136, 16, v90
    v_and_b32 v137, 0xffff0000, v90
    v_lshlrev_b32_e64 v138, 16, v92
    v_and_b32 v139, 0xffff0000, v92
    v_lshlrev_b32_e64 v140, 16, v93
    v_and_b32 v141, 0xffff0000, v93
    v_lshlrev_b32_e64 v142, 16, v94
    v_and_b32 v143, 0xffff0000, v94
    v_lshlrev_b32 v41, 16, v12
    v_mul_f32 v24, v41, v96
    v_mul_f32 v25, v41, v97
    v_mul_f32 v26, v41, v98
    v_mul_f32 v27, v41, v99
    v_mul_f32 v28, v41, v100
    v_mul_f32_e64 v29, v41, v101
    v_and_b32 v41, 0xffff0000, v12
    v_fmac_f32 v24, v41, v102
    v_fmac_f32 v25, v41, v103
    v_fmac_f32 v26, v41, v104
    v_fmac_f32 v27, v41, v105
    v_fmac_f32 v28, v41, v106
    v_fmac_f32 v29, v41, v107
    v_lshlrev_b32_e64 v41, 16, v13
    v_fmac_f32 v24, v41, v108
    v_fmac_f32 v25, v41, v109
    v_fmac_f32 v26, v41, v110
    v_fmac_f32 v27, v41, v111
    v_fmac_f32 v28, v41, v112
    v_fmac_f32 v29, v41, v113
    v_and_b32 v41, 0xffff0000, v13
    v_fmac_f32 v24, v41, v114
    v_fmac_f32 v25, v41, v115
    v_fmac_f32 v26, v41, v116
    v_fmac_f32 v27, v41, v117
    v_fmac_f32 v28, v41, v118
    v_fmac_f32 v29, v41, v119
    v_lshlrev_b32_e64 v41, 16, v14
    v_fmac_f32 v24, v41, v120
    v_fmac_f32 v25, v41, v121
    v_fmac_f32 v26, v41, v122
    v_fmac_f32 v27, v41, v123
    v_fmac_f32 v28, v41, v124
    v_fmac_f32 v29, v41, v125
    v_and_b32 v41, 0xffff0000, v14
    v_fmac_f32 v24, v41, v126
    v_fmac_f32 v25, v41, v127
    v_fmac_f32 v26, v41, v128
    v_fmac_f32 v27, v41, v129
    v_fmac_f32 v28, v41, v130
    v_fmac_f32 v29, v41, v131
    v_lshlrev_b32_e64 v41, 16, v15
    v_fmac_f32 v24, v41, v132
    v_fmac_f32 v25, v41, v133
    v_fmac_f32 v26, v41, v134
    v_fmac_f32 v27, v41, v135
    v_fmac_f32 v28, v41, v136
    v_fmac_f32 v29, v41, v137
    v_and_b32 v41, 0xffff0000, v15
    v_fmac_f32 v24, v41, v138
    v_fmac_f32 v25, v41, v139
    v_fmac_f32 v26, v41, v140
    v_fmac_f32 v27, v41, v141
    v_fmac_f32 v28, v41, v142
    v_fmac_f32 v29, v41, v143
    v_mul_u32_u24 v43, 24, v0
    ds_write_b64 v43, v[24:25] offset:6400
    ds_write_b64 v43, v[26:27] offset:6408
    ds_write_b64 v43, v[28:29] offset:6416
    s_waitcnt lgkmcnt(0)
    s_barrier
    s_cmp_ge_u32 s3, 2
    s_cbranch_scc1 K2_nb
    v_lshlrev_b32 v43, 2, v0
    ds_read_b32 v144, v43 offset:6400
    ds_read_b32 v145, v43 offset:6784
    ds_read_b32 v146, v43 offset:7168
    ds_read_b32 v147, v43 offset:7552
    ds_read_b32 v148, v43 offset:7936
    ds_read_b32 v149, v43 offset:8320
    ds_read_b32 v150, v43 offset:8704
    ds_read_b32 v151, v43 offset:9088
    ds_read_b32 v152, v43 offset:9472
    ds_read_b32 v153, v43 offset:9856
    ds_read_b32 v154, v43 offset:10240
    ds_read_b32 v155, v43 offset:10624
    ds_read_b32 v156, v43 offset:11008
    ds_read_b32 v157, v43 offset:11392
    ds_read_b32 v158, v43 offset:11776
    ds_read_b32 v159, v43 offset:12160
    ds_read_b32 v160, v43 offset:12544
    ds_read_b32 v161, v43 offset:12928
    ds_read_b32 v162, v43 offset:13312
    ds_read_b32 v163, v43 offset:13696
    ds_read_b32 v164, v43 offset:14080
    ds_read_b32 v165, v43 offset:14464
    ds_read_b32 v166, v43 offset:14848
    ds_read_b32 v167, v43 offset:15232
    ds_read_b32 v168, v43 offset:15616
    ds_read_b32 v169, v43 offset:16000
    ds_read_b32 v170, v43 offset:16384
    ds_read_b32 v171, v43 offset:16768
    ds_read_b32 v172, v43 offset:17152
    ds_read_b32 v173, v43 offset:17536
    ds_read_b32 v174, v43 offset:17920
    ds_read_b32 v175, v43 offset:18304
    s_waitcnt lgkmcnt(0)
    v_add_f32 v144, v144, v160
    v_add_f32 v145, v145, v161
    v_add_f32 v146, v146, v162
    v_add_f32 v147, v147, v163
    v_add_f32 v148, v148, v164
    v_add_f32 v149, v149, v165
    v_add_f32 v150, v150, v166
    v_add_f32 v151, v151, v167
    v_add_f32 v152, v152, v168
    v_add_f32 v153, v153, v169
    v_add_f32 v154, v154, v170
    v_add_f32 v155, v155, v171
    v_add_f32 v156, v156, v172
    v_add_f32 v157, v157, v173
    v_add_f32 v158, v158, v174
    v_add_f32 v159, v159, v175
    v_add_f32 v144, v144, v152
    v_add_f32 v145, v145, v153
    v_add_f32 v146, v146, v154
    v_add_f32 v147, v147, v155
    v_add_f32 v148, v148, v156
    v_add_f32 v149, v149, v157
    v_add_f32 v150, v150, v158
    v_add_f32 v151, v151, v159
    v_add_f32 v144, v144, v148
    v_add_f32 v145, v145, v149
    v_add_f32 v146, v146, v150
    v_add_f32 v147, v147, v151
    v_add_f32 v144, v144, v146
    v_add_f32 v145, v145, v147
    v_add_f32 v144, v144, v145
    s_mul_i32 s39, s30, 1536
    s_mul_i32 s38, s32, 384
    s_add_u32 s38, s38, s39
    s_add_u32 s38, s38, 0
    v_cmp_gt_u32 vcc, 96, v0
    s_and_saveexec_b64 s[40:41], vcc
    buffer_store_dword v144, v43, s[24:27], s38 offen
    s_mov_b64 exec, s[40:41]
K2_nb:
    v_mov_b32 v8, 0
    s_cmp_lg_u32 s3, 0
    s_cbranch_scc1 K2_seen
    s_mov_b32 s45, 0x100000
K2_poll:
    s_sub_u32 s45, s45, 1
    s_cbranch_scc1 K2_seen
    buffer_load_dword v9, v8, s[48:51], 0 offen offset:128 sc0 sc1
    s_waitcnt vmcnt(0)
    v_readfirstlane_b32 s44, v9
    s_nop 3
    s_cmp_lt_u32 s44, 256
    s_cbranch_scc1 K2_poll
K2_seen:
    s_barrier
    s_mov_b32 s34, 2363392
    buffer_load_dwordx3 v[32:34], v5, s[24:27], s34 offen sc0 sc1
    s_add_u32 s34, s34, 6144
    buffer_load_dwordx3 v[36:38], v5, s[24:27], s34 offen sc0 sc1
    s_add_u32 s34, s34, 6144
    buffer_load_dwordx3 v[40:42], v5, s[24:27], s34 offen sc0 sc1
    s_add_u32 s34, s34, 6144
    buffer_load_dwordx3 v[44:46], v5, s[24:27], s34 offen sc0 sc1
    s_add_u32 s34, s34, 6144
    buffer_load_dwordx3 v[48:50], v5, s[24:27], s34 offen sc0 sc1
    s_add_u32 s34, s34, 6144
    buffer_load_dwordx3 v[52:54], v5, s[24:27], s34 offen sc0 sc1
    s_add_u32 s34, s34, 6144
    buffer_load_dwordx3 v[56:58], v5, s[24:27], s34 offen sc0 sc1
    s_add_u32 s34, s34, 6144
    buffer_load_dwordx3 v[60:62], v5, s[24:27], s34 offen sc0 sc1
    s_waitcnt vmcnt(0)
    v_add_f32 v32, v32, v48
    v_add_f32 v33, v33, v49
    v_add_f32 v34, v34, v50
    v_add_f32 v36, v36, v52
    v_add_f32 v37, v37, v53
    v_add_f32 v38, v38, v54
    v_add_f32 v40, v40, v56
    v_add_f32 v41, v41, v57
    v_add_f32 v42, v42, v58
    v_add_f32 v44, v44, v60
    v_add_f32 v45, v45, v61
    v_add_f32 v46, v46, v62
    v_add_f32 v32, v32, v40
    v_add_f32 v33, v33, v41
    v_add_f32 v34, v34, v42
    v_add_f32 v36, v36, v44
    v_add_f32 v37, v37, v45
    v_add_f32 v38, v38, v46
    v_add_f32 v32, v32, v36
    v_add_f32 v33, v33, v37
    v_add_f32 v34, v34, v38
    s_mov_b32 s36, 0x4091cb7a
    v_mov_b32 v20, 0x358637bd
    v_fma_f32 v32, v32, s36, v20
    v_fma_f32 v33, v33, s36, v20
    v_fma_f32 v34, v34, s36, v20
    v_sqrt_f32 v32, v32
    v_sqrt_f32 v33, v33
    v_sqrt_f32 v34, v34
    s_nop 0
    ds_write_b32 v5, v32 offset:0
    ds_write_b32 v5, v33 offset:4
    ds_write_b32 v5, v34 offset:8
    v_add_f32 v21, v32, v33
    v_add_f32_e64 v21, v21, v34
    s_nop 1
    v_add_f32_dpp v21, v21, v21 row_shr:1 row_mask:0xf bank_mask:0xf bound_ctrl:0
    s_nop 1
    s_nop 0
    v_add_f32_dpp v21, v21, v21 row_shr:2 row_mask:0xf bank_mask:0xf bound_ctrl:0
    s_nop 1
    s_nop 0
    v_add_f32_dpp v21, v21, v21 row_shr:4 row_mask:0xf bank_mask:0xf bound_ctrl:0
    s_nop 1
    s_nop 0
    v_add_f32_dpp v21, v21, v21 row_shr:8 row_mask:0xf bank_mask:0xf bound_ctrl:0
    s_nop 1
    s_nop 0
    v_readlane_b32 s40, v21, 15
    v_readlane_b32 s41, v21, 31
    v_readlane_b32 s42, v21, 47
    v_readlane_b32 s43, v21, 63
    s_nop 1
    v_mov_b32 v22, s40
    v_add_f32 v22, s41, v22
    v_add_f32 v22, s42, v22
    v_add_f32 v22, s43, v22
    s_lshl_b32 s37, s3, 2
    v_mov_b32 v23, s37
    ds_write_b32 v23, v22 offset:6144
    s_waitcnt lgkmcnt(0)
    s_barrier
    v_mov_b32 v23, 0
    ds_read_b128 v[24:27], v23 offset:6144
    ds_read_b128 v[28:31], v23 offset:6160
    s_lshl_b32 s37, s31, 7
    v_lshlrev_b32 v4, 2, v3
    v_add_u32 v4, s37, v4
    ds_read_b128 v[32:35], v4
    ds_read_b128 v[36:39], v4 offset:16
    s_waitcnt lgkmcnt(0)
    v_add_f32 v24, v24, v28
    v_add_f32 v25, v25, v29
    v_add_f32 v26, v26, v30
    v_add_f32 v27, v27, v31
    v_add_f32 v24, v24, v26
    v_add_f32 v25, v25, v27
    v_add_f32_e64 v24, v24, v25
    v_mul_f32 v24, 0x3a2aaaab, v24
    v_add_f32 v24, 0x358637bd, v24
    v_rcp_f32 v24, v24
    s_mov_b32 s36, 0x40089ba4
    v_lshlrev_b32 v40, 16, v16
    v_mul_f32_e64 v32, v32, v24
    v_fma_f32 v32, v32, v40, 1.0
    v_mul_f32_e64 v32, s36, v32
    v_and_b32 v40, 0xffff0000, v16
    v_mul_f32_e64 v33, v33, v24
    v_fma_f32 v33, v33, v40, 1.0
    v_mul_f32 v33, s36, v33
    v_lshlrev_b32 v40, 16, v17
    v_mul_f32_e64 v34, v34, v24
    v_fma_f32 v34, v34, v40, 1.0
    v_mul_f32_e64 v34, s36, v34
    v_and_b32 v40, 0xffff0000, v17
    v_mul_f32_e64 v35, v35, v24
    v_fma_f32 v35, v35, v40, 1.0
    v_mul_f32 v35, s36, v35
    v_lshlrev_b32 v40, 16, v18
    v_mul_f32_e64 v36, v36, v24
    v_fma_f32 v36, v36, v40, 1.0
    v_mul_f32_e64 v36, s36, v36
    v_and_b32 v40, 0xffff0000, v18
    v_mul_f32_e64 v37, v37, v24
    v_fma_f32 v37, v37, v40, 1.0
    v_mul_f32 v37, s36, v37
    v_lshlrev_b32 v40, 16, v19
    v_mul_f32_e64 v38, v38, v24
    v_fma_f32 v38, v38, v40, 1.0
    v_mul_f32_e64 v38, s36, v38
    v_and_b32 v40, 0xffff0000, v19
    v_mul_f32_e64 v39, v39, v24
    v_fma_f32 v39, v39, v40, 1.0
    v_mul_f32 v39, s36, v39
    s_sub_u32 s44, 47, s31
    s_and_b32 s45, s44, 1
    s_andn2_b32 s44, s44, 1
    s_sub_u32 s44, 47, s44
    s_mul_i32 s33, s44, 24
    s_mul_i32 s45, s45, 3
    s_add_u32 s33, s33, s45
    s_mul_i32 s46, s32, 6
    s_add_u32 s33, s33, s46
    s_lshl_b32 s33, s33, 10
    s_add_u32 s33, s33, 1179648
    s_sub_u32 s34, s33, 24576
    v_lshlrev_b32 v43, 4, v2
    v_mul_f32 v44, v96, v32
    v_mul_f32 v45, v102, v33
    v_mul_f32 v46, v108, v34
    v_mul_f32 v47, v114, v35
    v_mul_f32 v48, v120, v36
    v_mul_f32 v49, v126, v37
    v_mul_f32 v50, v132, v38
    v_mul_f32 v51, v138, v39
    v_cvt_pk_bf16_f32 v64, v44, v45
    v_cvt_pk_bf16_f32 v65, v46, v47
    v_cvt_pk_bf16_f32 v66, v48, v49
    v_cvt_pk_bf16_f32 v67, v50, v51
    buffer_store_dwordx4 v[64:67], v43, s[24:27], s33 offen offset:0
    v_mul_f32 v52, v97, v32
    v_mul_f32 v53, v103, v33
    v_mul_f32 v54, v109, v34
    v_mul_f32 v55, v115, v35
    v_mul_f32 v56, v121, v36
    v_mul_f32 v57, v127, v37
    v_mul_f32 v58, v133, v38
    v_mul_f32 v59, v139, v39
    v_cvt_pk_bf16_f32 v68, v52, v53
    v_cvt_pk_bf16_f32 v69, v54, v55
    v_cvt_pk_bf16_f32 v70, v56, v57
    v_cvt_pk_bf16_f32 v71, v58, v59
    buffer_store_dwordx4 v[68:71], v43, s[24:27], s33 offen offset:1024
    v_mul_f32 v44, v98, v32
    v_mul_f32 v45, v104, v33
    v_mul_f32 v46, v110, v34
    v_mul_f32 v47, v116, v35
    v_mul_f32 v48, v122, v36
    v_mul_f32 v49, v128, v37
    v_mul_f32 v50, v134, v38
    v_mul_f32 v51, v140, v39
    v_cvt_pk_bf16_f32 v72, v44, v45
    v_cvt_pk_bf16_f32 v73, v46, v47
    v_cvt_pk_bf16_f32 v74, v48, v49
    v_cvt_pk_bf16_f32 v75, v50, v51
    buffer_store_dwordx4 v[72:75], v43, s[24:27], s33 offen offset:2048
    v_mul_f32 v52, v99, v32
    v_mul_f32 v53, v105, v33
    v_mul_f32 v54, v111, v34
    v_mul_f32 v55, v117, v35
    v_mul_f32 v56, v123, v36
    v_mul_f32 v57, v129, v37
    v_mul_f32 v58, v135, v38
    v_mul_f32 v59, v141, v39
    v_cvt_pk_bf16_f32 v76, v52, v53
    v_cvt_pk_bf16_f32 v77, v54, v55
    v_cvt_pk_bf16_f32 v78, v56, v57
    v_cvt_pk_bf16_f32 v79, v58, v59
    buffer_store_dwordx4 v[76:79], v43, s[24:27], s34 offen offset:0
    v_mul_f32 v44, v100, v32
    v_mul_f32 v45, v106, v33
    v_mul_f32 v46, v112, v34
    v_mul_f32 v47, v118, v35
    v_mul_f32 v48, v124, v36
    v_mul_f32 v49, v130, v37
    v_mul_f32 v50, v136, v38
    v_mul_f32 v51, v142, v39
    v_cvt_pk_bf16_f32 v80, v44, v45
    v_cvt_pk_bf16_f32 v81, v46, v47
    v_cvt_pk_bf16_f32 v82, v48, v49
    v_cvt_pk_bf16_f32 v83, v50, v51
    buffer_store_dwordx4 v[80:83], v43, s[24:27], s34 offen offset:1024
    v_mul_f32 v52, v101, v32
    v_mul_f32 v53, v107, v33
    v_mul_f32 v54, v113, v34
    v_mul_f32 v55, v119, v35
    v_mul_f32 v56, v125, v36
    v_mul_f32 v57, v131, v37
    v_mul_f32 v58, v137, v38
    v_mul_f32 v59, v143, v39
    v_cvt_pk_bf16_f32 v84, v52, v53
    v_cvt_pk_bf16_f32 v85, v54, v55
    v_cvt_pk_bf16_f32 v86, v56, v57
    v_cvt_pk_bf16_f32 v87, v58, v59
    buffer_store_dwordx4 v[84:87], v43, s[24:27], s34 offen offset:2048
K2_end:
    s_endpgm
K1_end:
    s_endpgm
.globl gemm2_kernel
.p2align 8
.type gemm2_kernel,@function
gemm2_kernel:
    s_cmp_ge_u32 s2, 256
    s_cbranch_scc1 K3_end
    s_load_dwordx2 s[4:5], s[0:1], 0
    s_load_dwordx2 s[6:7], s[0:1], 48
    s_load_dwordx2 s[24:25], s[0:1], 64
    v_lshrrev_b32 v16, 6, v0
    v_and_b32 v17, 63, v0
    v_readfirstlane_b32 s30, v16
    v_lshlrev_b32 v1, 4, v17
    v_mov_b32 v254, v1
    v_add_u32 v2, 1024, v1
    v_add_u32 v3, 2048, v1
    v_and_b32 v18, 15, v17
    v_lshrrev_b32 v19, 4, v17
    v_mul_u32_u24 v20, 24, v18
    s_lshr_b32 s31, s30, 2
    s_and_b32 s32, s30, 3
    s_mov_b32 s11, 0x00020000
    s_mov_b32 s15, 0x00020000
    s_mov_b32 s23, 0x00020000
    s_mov_b32 s14, 442368
    s_mul_i32 s37, s2, 442368
    s_and_b32 s38, s30, 1
    s_mul_i32 s49, s38, 2048
    s_add_u32 s49, s49, 20480
    s_mul_i32 s38, s38, 6144
    s_waitcnt lgkmcnt(0)
    s_add_u32 s12, s6, s37
    s_addc_u32 s13, s7, 0
    s_add_u32 s20, s24, 447873024
    s_addc_u32 s21, s25, 0
    s_mov_b32 s22, 1179648
    s_add_u32 s16, s24, 446693376
    s_addc_u32 s17, s25, 0
    s_mov_b32 s18, 9216
    s_mov_b32 s19, 0x00020000
    s_mul_i32 s44, s32, 384
    buffer_load_dwordx3 v[24:26], v20, s[16:19], s44 offen
    buffer_load_dwordx3 v[28:30], v20, s[16:19], s44 offen offset:12
    s_add_u32 s44, s44, 1536
    buffer_load_dwordx3 v[32:34], v20, s[16:19], s44 offen
    buffer_load_dwordx3 v[36:38], v20, s[16:19], s44 offen offset:12
    s_add_u32 s44, s44, 1536
    buffer_load_dwordx3 v[40:42], v20, s[16:19], s44 offen
    buffer_load_dwordx3 v[44:46], v20, s[16:19], s44 offen offset:12
    s_add_u32 s44, s44, 1536
    buffer_load_dwordx3 v[48:50], v20, s[16:19], s44 offen
    buffer_load_dwordx3 v[52:54], v20, s[16:19], s44 offen offset:12
    s_add_u32 s44, s44, 1536
    buffer_load_dwordx3 v[56:58], v20, s[16:19], s44 offen
    buffer_load_dwordx3 v[60:62], v20, s[16:19], s44 offen offset:12
    s_add_u32 s44, s44, 1536
    buffer_load_dwordx3 v[64:66], v20, s[16:19], s44 offen
    buffer_load_dwordx3 v[68:70], v20, s[16:19], s44 offen offset:12
    s_cmp_lt_u32 s30, 4
    s_cbranch_scc1 K3_rw
    s_cmp_ge_u32 s30, 6
    s_cbranch_scc1 K3_rx
    s_add_u32 s35, s38, 73728
    s_mov_b32 s34, s35
    s_add_u32 s33, s38, 12288
    s_add_u32 s45, s33, 4096
    s_add_u32 s46, s34, 4096
    s_mov_b32 m0, s34
    s_nop 0
    buffer_load_dwordx4 v254, s[12:15], s33 offen offset:0 nt lds
    buffer_load_dwordx4 v254, s[12:15], s33 offen offset:1024 nt lds
    buffer_load_dwordx4 v254, s[12:15], s33 offen offset:2048 nt lds
    buffer_load_dwordx4 v254, s[12:15], s33 offen offset:3072 nt lds
    s_mov_b32 m0, s46
    s_nop 0
    buffer_load_dwordx4 v254, s[12:15], s45 offen offset:0 nt lds
    buffer_load_dwordx4 v254, s[12:15], s45 offen offset:1024 nt lds
    s_add_u32 s34, s34, 12288
    s_mov_b32 s33, s38
    s_add_u32 s45, s33, 4096
    s_add_u32 s46, s34, 4096
    s_mov_b32 m0, s34
    s_nop 0
    buffer_load_dwordx4 v254, s[12:15], s33 offen offset:0 nt lds
    buffer_load_dwordx4 v254, s[12:15], s33 offen offset:1024 nt lds
    buffer_load_dwordx4 v254, s[12:15], s33 offen offset:2048 nt lds
    buffer_load_dwordx4 v254, s[12:15], s33 offen offset:3072 nt lds
    s_mov_b32 m0, s46
    s_nop 0
    buffer_load_dwordx4 v254, s[12:15], s45 offen offset:0 nt lds
    buffer_load_dwordx4 v254, s[12:15], s45 offen offset:1024 nt lds
    s_mul_i32 s37, s2, 1744896
    s_add_u32 s8, s24, s37
    s_addc_u32 s9, s25, 0
    s_mov_b32 s10, 1744896
    s_add_u32 s36, s35, 73728
    s_add_u32 s34, s34, 12288
    s_add_u32 s33, s38, 1732608
    s_add_u32 s45, s33, 4096
    s_add_u32 s46, s34, 4096
    s_mov_b32 m0, s34
    s_nop 0
    buffer_load_dwordx4 v254, s[8:11], s33 offen offset:0 nt lds
    buffer_load_dwordx4 v254, s[8:11], s33 offen offset:1024 nt lds
    buffer_load_dwordx4 v254, s[8:11], s33 offen offset:2048 nt lds
    buffer_load_dwordx4 v254, s[8:11], s33 offen offset:3072 nt lds
    s_mov_b32 m0, s46
    s_nop 0
    buffer_load_dwordx4 v254, s[8:11], s45 offen offset:0 nt lds
    buffer_load_dwordx4 v254, s[8:11], s45 offen offset:1024 nt lds
    s_add_u32 s34, s34, 12288
    s_cmp_eq_u32 s34, s36
    s_cselect_b32 s34, s35, s34
    s_sub_u32 s33, s33, 12288
    s_cselect_b32 s10, 0, s10
    s_cselect_b32 s33, 0, s33
    s_add_u32 s45, s33, 4096
    s_add_u32 s46, s34, 4096
    s_mov_b32 m0, s34
    s_nop 0
    buffer_load_dwordx4 v254, s[8:11], s33 offen offset:0 nt lds
    buffer_load_dwordx4 v254, s[8:11], s33 offen offset:1024 nt lds
    buffer_load_dwordx4 v254, s[8:11], s33 offen offset:2048 nt lds
    buffer_load_dwordx4 v254, s[8:11], s33 offen offset:3072 nt lds
    s_mov_b32 m0, s46
    s_nop 0
    buffer_load_dwordx4 v254, s[8:11], s45 offen offset:0 nt lds
    buffer_load_dwordx4 v254, s[8:11], s45 offen offset:1024 nt lds
    s_add_u32 s34, s34, 12288
    s_cmp_eq_u32 s34, s36
    s_cselect_b32 s34, s35, s34
    s_sub_u32 s33, s33, 12288
    s_cselect_b32 s10, 0, s10
    s_cselect_b32 s33, 0, s33
    s_add_u32 s45, s33, 4096
    s_add_u32 s46, s34, 4096
    s_mov_b32 m0, s34
    s_nop 0
    buffer_load_dwordx4 v254, s[8:11], s33 offen offset:0 nt lds
    buffer_load_dwordx4 v254, s[8:11], s33 offen offset:1024 nt lds
    buffer_load_dwordx4 v254, s[8:11], s33 offen offset:2048 nt lds
    buffer_load_dwordx4 v254, s[8:11], s33 offen offset:3072 nt lds
    s_mov_b32 m0, s46
    s_nop 0
    buffer_load_dwordx4 v254, s[8:11], s45 offen offset:0 nt lds
    buffer_load_dwordx4 v254, s[8:11], s45 offen offset:1024 nt lds
    s_add_u32 s34, s34, 12288
    s_cmp_eq_u32 s34, s36
    s_cselect_b32 s34, s35, s34
    s_sub_u32 s33, s33, 12288
    s_cselect_b32 s10, 0, s10
    s_cselect_b32 s33, 0, s33
    s_add_u32 s45, s33, 4096
    s_add_u32 s46, s34, 4096
    s_branch K3_rdone
K3_rx:
    s_add_u32 s50, s49, 73728
    s_mov_b32 s48, s49
    s_add_u32 s47, s49, 1155072
    s_mov_b32 m0, s48
    s_nop 0
    buffer_load_dwordx4 v254, s[20:23], s47 offen offset:0 lds
    buffer_load_dwordx4 v254, s[20:23], s47 offen offset:1024 lds
    s_add_u32 s48, s48, 24576
    s_cmp_eq_u32 s48, s50
    s_cselect_b32 s48, s49, s48
    s_sub_u32 s47, s47, 24576
    s_cselect_b32 s44, 1179648, 0
    s_add_u32 s47, s47, s44
    s_mov_b32 m0, s48
    s_nop 0
    buffer_load_dwordx4 v254, s[20:23], s47 offen offset:0 lds
    buffer_load_dwordx4 v254, s[20:23], s47 offen offset:1024 lds
    s_add_u32 s48, s48, 24576
    s_cmp_eq_u32 s48, s50
    s_cselect_b32 s48, s49, s48
    s_sub_u32 s47, s47, 24576
    s_cselect_b32 s44, 1179648, 0
    s_add_u32 s47, s47, s44
    s_add_u32 s8, s4, s37
    s_addc_u32 s9, s5, 0
    s_mov_b32 s10, 442368
    s_nop 0
    v_mul_u32_u24 v20, 43691, v1
    v_lshrrev_b32 v20, 25, v20
    s_nop 0
    v_mul_u32_u24 v21, 864, v20
    v_sub_u32 v21, v1, v21
    s_nop 0
    v_add_u32 v22, 768, v21
    v_cmp_gt_i32 vcc, 0, v21
    s_nop 0
    v_mul_u32_u24 v20, 768, v20
    s_nop 0
    v_cndmask_b32 v21, v21, v22, vcc
    v_add_u32_e64 v1, v20, v21
    v_mul_u32_u24 v20, 43691, v2
    v_lshrrev_b32 v20, 25, v20
    s_nop 0
    v_mul_u32_u24 v21, 864, v20
    v_sub_u32 v21, v2, v21
    s_nop 0
    v_add_u32 v22, 768, v21
    v_cmp_gt_i32 vcc, 0, v21
    s_nop 0
    v_mul_u32_u24 v20, 768, v20
    s_nop 0
    v_cndmask_b32 v21, v21, v22, vcc
    v_add_u32_e64 v2, v20, v21
    v_mul_u32_u24 v20, 43691, v3
    v_lshrrev_b32 v20, 25, v20
    s_nop 0
    v_mul_u32_u24 v21, 864, v20
    v_sub_u32 v21, v3, v21
    s_nop 0
    v_add_u32 v22, 768, v21
    v_cmp_gt_i32 vcc, 0, v21
    s_nop 0
    v_mul_u32_u24 v20, 768, v20
    s_nop 0
    v_cndmask_b32 v21, v21, v22, vcc
    v_add_u32 v3, v20, v21
    s_add_u32 s34, s38, 147456
    s_add_u32 s33, s38, 430080
    s_add_u32 s45, s33, 3072
    s_branch K3_rdone
K3_rw:
    s_mov_b32 s8, s20
    s_mov_b32 s9, s21
    s_mov_b32 s10, s22
    s_mul_i32 s35, s32, 5120
    s_add_u32 s36, s35, 73728
    s_mov_b32 s34, s35
    s_add_u32 s33, s35, 1155072
    s_add_u32 s45, s33, 4096
    s_add_u32 s46, s34, 4096
    s_mov_b32 m0, s34
    s_nop 0
    buffer_load_dwordx4 v254, s[8:11], s33 offen offset:0 lds
    buffer_load_dwordx4 v254, s[8:11], s33 offen offset:1024 lds
    buffer_load_dwordx4 v254, s[8:11], s33 offen offset:2048 lds
    buffer_load_dwordx4 v254, s[8:11], s33 offen offset:3072 lds
    s_mov_b32 m0, s46
    s_nop 0
    buffer_load_dwordx4 v254, s[8:11], s45 offen offset:0 lds
    s_add_u32 s34, s34, 24576
    s_cmp_eq_u32 s34, s36
    s_cselect_b32 s34, s35, s34
    s_sub_u32 s33, s33, 24576
    s_cselect_b32 s44, 1179648, 0
    s_add_u32 s33, s33, s44
    s_add_u32 s45, s33, 4096
    s_add_u32 s46, s34, 4096
    s_mov_b32 m0, s34
    s_nop 0
    buffer_load_dwordx4 v254, s[8:11], s33 offen offset:0 lds
    buffer_load_dwordx4 v254, s[8:11], s33 offen offset:1024 lds
    buffer_load_dwordx4 v254, s[8:11], s33 offen offset:2048 lds
    buffer_load_dwordx4 v254, s[8:11], s33 offen offset:3072 lds
    s_mov_b32 m0, s46
    s_nop 0
    buffer_load_dwordx4 v254, s[8:11], s45 offen offset:0 lds
    s_add_u32 s34, s34, 24576
    s_cmp_eq_u32 s34, s36
    s_cselect_b32 s34, s35, s34
    s_sub_u32 s33, s33, 24576
    s_cselect_b32 s44, 1179648, 0
    s_add_u32 s33, s33, s44
    s_add_u32 s45, s33, 4096
    s_add_u32 s46, s34, 4096
K3_rdone:
    v_mul_u32_u24 v8, 3072, v19
    v_mul_u32_u24 v21, 12, v18
    s_mul_i32 s37, s31, 73728
    s_mul_i32 s38, s32, 192
    s_add_u32 s37, s37, s38
    v_add3_u32 v8, v8, v21, s37
    s_mul_i32 s37, s32, 6144
    v_lshl_add_u32 v9, v17, 4, s37
    v_and_b32 v21, 3, v18
    v_lshrrev_b32 v22, 2, v18
    v_and_b32 v23, 2, v19
    v_xor_b32 v23, v23, v21
    v_lshl_add_u32 v22, v23, 2, v22
    v_lshl_add_u32 v22, v21, 4, v22
    v_lshlrev_b32 v22, 4, v22
    v_and_b32 v23, 1, v19
    v_lshl_add_u32 v22, v23, 3, v22
    s_mul_i32 s37, s31, 6144
    s_add_u32 s37, s37, 73728
    v_add_u32 v10, s37, v22
    v_xor_b32_e64 v11, 64, v10
    s_lshl_b32 s37, s32, 2
    v_lshl_add_u32 v22, v21, 1, v19
    v_add_u32 v22, s37, v22
    v_and_b32_e64 v22, 15, v22
    v_mul_u32_u24 v22, 48, v22
    v_mul_u32_u24 v23, 768, v18
    v_add_u32 v22, 147456, v22
    v_add_u32_e64 v7, v22, v23
    v_lshrrev_b32 v22, 2, v18
    v_cmp_eq_u32 vcc, v22, v19
    v_mov_b32 v23, 0x3f80
    s_nop 0
    v_cndmask_b32 v23, 0, v23, vcc
    v_cmp_eq_u32 vcc, 0, v21
    s_nop 1
    v_cndmask_b32 v232, 0, v23, vcc
    v_lshlrev_b32 v236, 16, v232
    v_cmp_eq_u32 vcc, 1, v21
    s_nop 1
    v_cndmask_b32 v233, 0, v23, vcc
    v_lshlrev_b32 v237, 16, v233
    v_cmp_eq_u32 vcc, 2, v21
    s_nop 1
    v_cndmask_b32 v234, 0, v23, vcc
    v_lshlrev_b32 v238, 16, v234
    v_cmp_eq_u32 vcc, 3, v21
    s_nop 1
    v_cndmask_b32 v235, 0, v23, vcc
    v_lshlrev_b32 v239, 16, v235
    s_mov_b32 s39, 0
    s_mov_b32 s40, 0
    s_mov_b32 s41, 0
    s_mov_b32 s42, 294912
    v_mov_b32 v4, v9
    v_mov_b32 v5, v10
    v_mov_b32 v6, v11
    s_waitcnt vmcnt(18)
    s_sub_u32 s37, s30, 4
    s_cmp_lt_u32 s37, 2
    s_cbranch_scc1 K3_pw
    s_waitcnt vmcnt(2)
K3_pw:
    v_add_f32 v24, v24, v32
    v_add_f32 v25, v25, v33
    v_add_f32 v26, v26, v34
    v_add_f32 v28, v28, v36
    v_add_f32 v29, v29, v37
    v_add_f32 v30, v30, v38
    v_add_f32 v24, v24, v40
    v_add_f32 v25, v25, v41
    v_add_f32 v26, v26, v42
    v_add_f32 v28, v28, v44
    v_add_f32 v29, v29, v45
    v_add_f32 v30, v30, v46
    v_add_f32 v24, v24, v48
    v_add_f32 v25, v25, v49
    v_add_f32 v26, v26, v50
    v_add_f32 v28, v28, v52
    v_add_f32 v29, v29, v53
    v_add_f32 v30, v30, v54
    v_add_f32 v24, v24, v56
    v_add_f32 v25, v25, v57
    v_add_f32 v26, v26, v58
    v_add_f32 v28, v28, v60
    v_add_f32 v29, v29, v61
    v_add_f32 v30, v30, v62
    v_add_f32 v24, v24, v64
    v_add_f32 v25, v25, v65
    v_add_f32 v26, v26, v66
    v_add_f32 v28, v28, v68
    v_add_f32 v29, v29, v69
    v_add_f32 v30, v30, v70
    v_mov_b32 v12, v24
    v_mov_b32 v13, v25
    v_mov_b32 v14, v26
    v_mov_b32 v15, v28
    v_mov_b32 v252, v29
    v_mov_b32 v253, v30
    s_barrier
    s_cmp_ge_u32 s30, 6
    s_cbranch_scc1 K3_x_tile
    s_cmp_ge_u32 s30, 4
    s_cbranch_scc1 K3_h_tile
K3_w_tile:
    s_mov_b32 s43, 11
    s_mov_b32 m0, s34
    ds_read_b128 v[208:211], v4 offset:0
    ds_read_b128 v[212:215], v4 offset:1024
    ds_read_b128 v[216:219], v4 offset:2048
    ds_read_b128 v[220:223], v4 offset:3072
    ds_read_b128 v[224:227], v4 offset:4096
    ds_read_b128 v[228:231], v4 offset:5120
    buffer_load_dwordx4 v254, s[8:11], s33 offen offset:0 lds
    ds_read_b64_tr_b16 v[160:161], v5 offset:0
    ds_read_b64_tr_b16 v[162:163], v6 offset:0
    ds_read_b64_tr_b16 v[184:185], v5 offset:12288
    ds_read_b64_tr_b16 v[186:187], v6 offset:12288
    ds_read_b64_tr_b16 v[164:165], v5 offset:1024
    ds_read_b64_tr_b16 v[166:167], v6 offset:1024
    buffer_load_dwordx4 v254, s[8:11], s33 offen offset:1024 lds
    ds_read_b64_tr_b16 v[188:189], v5 offset:13312
    ds_read_b64_tr_b16 v[190:191], v6 offset:13312
    ds_read_b64_tr_b16 v[168:169], v5 offset:2048
    ds_read_b64_tr_b16 v[170:171], v6 offset:2048
    ds_read_b64_tr_b16 v[192:193], v5 offset:14336
    ds_read_b64_tr_b16 v[194:195], v6 offset:14336
    buffer_load_dwordx4 v254, s[8:11], s33 offen offset:2048 lds
    ds_read_b64_tr_b16 v[172:173], v5 offset:3072
    ds_read_b64_tr_b16 v[174:175], v6 offset:3072
    ds_read_b64_tr_b16 v[196:197], v5 offset:15360
    ds_read_b64_tr_b16 v[198:199], v6 offset:15360
    ds_read_b64_tr_b16 v[176:177], v5 offset:4096
    ds_read_b64_tr_b16 v[178:179], v6 offset:4096
    buffer_load_dwordx4 v254, s[8:11], s33 offen offset:3072 lds
    s_mov_b32 m0, s46
    ds_read_b64_tr_b16 v[200:201], v5 offset:16384
    ds_read_b64_tr_b16 v[202:203], v6 offset:16384
    ds_read_b64_tr_b16 v[180:181], v5 offset:5120
    ds_read_b64_tr_b16 v[182:183], v6 offset:5120
    ds_read_b64_tr_b16 v[204:205], v5 offset:17408
    ds_read_b64_tr_b16 v[206:207], v6 offset:17408
    buffer_load_dwordx4 v254, s[8:11], s45 offen offset:0 lds
    s_cmp_eq_u32 s41, 0
    s_cbranch_scc1 K3_w_noep
    s_nop 7
    s_mov_b32 s38, s42
    s_nop 0
    v_cvt_pk_bf16_f32 v240, v16, v20
    v_cvt_pk_bf16_f32 v241, v24, v28
    v_cvt_pk_bf16_f32 v242, v32, v36
    buffer_store_dwordx3 v[240:242], v8, s[12:15], s38 offen offset:0
    v_cvt_pk_bf16_f32 v244, v17, v21
    v_cvt_pk_bf16_f32 v245, v25, v29
    v_cvt_pk_bf16_f32 v246, v33, v37
    buffer_store_dwordx3 v[244:246], v8, s[12:15], s38 offen offset:768
    v_cvt_pk_bf16_f32 v248, v18, v22
    v_cvt_pk_bf16_f32 v249, v26, v30
    v_cvt_pk_bf16_f32 v250, v34, v38
    buffer_store_dwordx3 v[248:250], v8, s[12:15], s38 offen offset:1536
    v_cvt_pk_bf16_f32 v240, v19, v23
    v_cvt_pk_bf16_f32 v241, v27, v31
    v_cvt_pk_bf16_f32 v242, v35, v39
    buffer_store_dwordx3 v[240:242], v8, s[12:15], s38 offen offset:2304
    s_add_u32 s38, s38, 12288
    v_cvt_pk_bf16_f32 v244, v40, v44
    v_cvt_pk_bf16_f32 v245, v48, v52
    v_cvt_pk_bf16_f32 v246, v56, v60
    buffer_store_dwordx3 v[244:246], v8, s[12:15], s38 offen offset:0
    v_cvt_pk_bf16_f32 v248, v41, v45
    v_cvt_pk_bf16_f32 v249, v49, v53
    v_cvt_pk_bf16_f32 v250, v57, v61
    buffer_store_dwordx3 v[248:250], v8, s[12:15], s38 offen offset:768
    v_cvt_pk_bf16_f32 v240, v42, v46
    v_cvt_pk_bf16_f32 v241, v50, v54
    v_cvt_pk_bf16_f32 v242, v58, v62
    buffer_store_dwordx3 v[240:242], v8, s[12:15], s38 offen offset:1536
    v_cvt_pk_bf16_f32 v244, v43, v47
    v_cvt_pk_bf16_f32 v245, v51, v55
    v_cvt_pk_bf16_f32 v246, v59, v63
    buffer_store_dwordx3 v[244:246], v8, s[12:15], s38 offen offset:2304
    s_add_u32 s38, s38, 12288
    v_cvt_pk_bf16_f32 v248, v64, v68
    v_cvt_pk_bf16_f32 v249, v72, v76
    v_cvt_pk_bf16_f32 v250, v80, v84
    buffer_store_dwordx3 v[248:250], v8, s[12:15], s38 offen offset:0
    v_cvt_pk_bf16_f32 v240, v65, v69
    v_cvt_pk_bf16_f32 v241, v73, v77
    v_cvt_pk_bf16_f32 v242, v81, v85
    buffer_store_dwordx3 v[240:242], v8, s[12:15], s38 offen offset:768
    v_cvt_pk_bf16_f32 v244, v66, v70
    v_cvt_pk_bf16_f32 v245, v74, v78
    v_cvt_pk_bf16_f32 v246, v82, v86
    buffer_store_dwordx3 v[244:246], v8, s[12:15], s38 offen offset:1536
    v_cvt_pk_bf16_f32 v248, v67, v71
    v_cvt_pk_bf16_f32 v249, v75, v79
    v_cvt_pk_bf16_f32 v250, v83, v87
    buffer_store_dwordx3 v[248:250], v8, s[12:15], s38 offen offset:2304
    s_add_u32 s38, s38, 12288
    v_cvt_pk_bf16_f32 v240, v88, v92
    v_cvt_pk_bf16_f32 v241, v96, v100
    v_cvt_pk_bf16_f32 v242, v104, v108
    buffer_store_dwordx3 v[240:242], v8, s[12:15], s38 offen offset:0
    v_cvt_pk_bf16_f32 v244, v89, v93
    v_cvt_pk_bf16_f32 v245, v97, v101
    v_cvt_pk_bf16_f32 v246, v105, v109
    buffer_store_dwordx3 v[244:246], v8, s[12:15], s38 offen offset:768
    v_cvt_pk_bf16_f32 v248, v90, v94
    v_cvt_pk_bf16_f32 v249, v98, v102
    v_cvt_pk_bf16_f32 v250, v106, v110
    buffer_store_dwordx3 v[248:250], v8, s[12:15], s38 offen offset:1536
    v_cvt_pk_bf16_f32 v240, v91, v95
    v_cvt_pk_bf16_f32 v241, v99, v103
    v_cvt_pk_bf16_f32 v242, v107, v111
    buffer_store_dwordx3 v[240:242], v8, s[12:15], s38 offen offset:2304
    s_add_u32 s38, s38, 12288
    v_cvt_pk_bf16_f32 v244, v112, v116
    v_cvt_pk_bf16_f32 v245, v120, v124
    v_cvt_pk_bf16_f32 v246, v128, v132
    buffer_store_dwordx3 v[244:246], v8, s[12:15], s38 offen offset:0
    v_cvt_pk_bf16_f32 v248, v113, v117
    v_cvt_pk_bf16_f32 v249, v121, v125
    v_cvt_pk_bf16_f32 v250, v129, v133
    buffer_store_dwordx3 v[248:250], v8, s[12:15], s38 offen offset:768
    v_cvt_pk_bf16_f32 v240, v114, v118
    v_cvt_pk_bf16_f32 v241, v122, v126
    v_cvt_pk_bf16_f32 v242, v130, v134
    buffer_store_dwordx3 v[240:242], v8, s[12:15], s38 offen offset:1536
    v_cvt_pk_bf16_f32 v244, v115, v119
    v_cvt_pk_bf16_f32 v245, v123, v127
    v_cvt_pk_bf16_f32 v246, v131, v135
    buffer_store_dwordx3 v[244:246], v8, s[12:15], s38 offen offset:2304
    s_add_u32 s38, s38, 12288
    v_cvt_pk_bf16_f32 v248, v136, v140
    v_cvt_pk_bf16_f32 v249, v144, v148
    v_cvt_pk_bf16_f32 v250, v152, v156
    buffer_store_dwordx3 v[248:250], v8, s[12:15], s38 offen offset:0
    v_cvt_pk_bf16_f32 v240, v137, v141
    v_cvt_pk_bf16_f32 v241, v145, v149
    v_cvt_pk_bf16_f32 v242, v153, v157
    buffer_store_dwordx3 v[240:242], v8, s[12:15], s38 offen offset:768
    v_cvt_pk_bf16_f32 v244, v138, v142
    v_cvt_pk_bf16_f32 v245, v146, v150
    v_cvt_pk_bf16_f32 v246, v154, v158
    buffer_store_dwordx3 v[244:246], v8, s[12:15], s38 offen offset:1536
    v_cvt_pk_bf16_f32 v248, v139, v143
    v_cvt_pk_bf16_f32 v249, v147, v151
    v_cvt_pk_bf16_f32 v250, v155, v159
    buffer_store_dwordx3 v[248:250], v8, s[12:15], s38 offen offset:2304
    s_sub_u32 s42, s42, 147456
K3_w_noep:
    s_nop 1
    v_mov_b32 v240, v12
    v_mov_b32 v241, v12
    v_mov_b32 v242, v12
    v_mov_b32 v243, v12
    v_mov_b32 v244, v13
    v_mov_b32 v245, v13
    v_mov_b32 v246, v13
    v_mov_b32 v247, v13
    v_mov_b32 v248, v14
    v_mov_b32 v249, v14
    v_mov_b32 v250, v14
    v_mov_b32 v251, v14
    s_waitcnt lgkmcnt(15)
    s_setprio 1
    v_mfma_f32_16x16x32_bf16 v[16:19], v[160:163], v[208:211], v[240:243]
    v_mfma_f32_16x16x32_bf16 v[16:19], v[184:187], v[220:223], v[16:19]
    s_add_u32 s34, s34, 24576
    v_mfma_f32_16x16x32_bf16 v[20:23], v[160:163], v[212:215], v[244:247]
    v_mfma_f32_16x16x32_bf16 v[20:23], v[184:187], v[224:227], v[20:23]
    s_cmp_eq_u32 s34, s36
    v_mfma_f32_16x16x32_bf16 v[24:27], v[160:163], v[216:219], v[248:251]
    v_mfma_f32_16x16x32_bf16 v[24:27], v[184:187], v[228:231], v[24:27]
    s_cselect_b32 s34, s35, s34
    v_mfma_f32_16x16x32_bf16 v[40:43], v[164:167], v[208:211], v[240:243]
    v_mfma_f32_16x16x32_bf16 v[40:43], v[188:191], v[220:223], v[40:43]
    s_sub_u32 s33, s33, 24576
    v_mfma_f32_16x16x32_bf16 v[44:47], v[164:167], v[212:215], v[244:247]
    v_mfma_f32_16x16x32_bf16 v[44:47], v[188:191], v[224:227], v[44:47]
    s_cselect_b32 s44, 1179648, 0
    v_mfma_f32_16x16x32_bf16 v[48:51], v[164:167], v[216:219], v[248:251]
    v_mfma_f32_16x16x32_bf16 v[48:51], v[188:191], v[228:231], v[48:51]
    s_add_u32 s33, s33, s44
    s_waitcnt lgkmcnt(12)
    v_mfma_f32_16x16x32_bf16 v[64:67], v[168:171], v[208:211], v[240:243]
    v_mfma_f32_16x16x32_bf16 v[64:67], v[192:195], v[220:223], v[64:67]
    s_add_u32 s45, s33, 4096
    v_mfma_f32_16x16x32_bf16 v[68:71], v[168:171], v[212:215], v[244:247]
    v_mfma_f32_16x16x32_bf16 v[68:71], v[192:195], v[224:227], v[68:71]
    s_add_u32 s46, s34, 4096
    v_mfma_f32_16x16x32_bf16 v[72:75], v[168:171], v[216:219], v[248:251]
    v_mfma_f32_16x16x32_bf16 v[72:75], v[192:195], v[228:231], v[72:75]
    s_add_u32 s39, s39, 24576
    s_waitcnt lgkmcnt(8)
    v_mfma_f32_16x16x32_bf16 v[88:91], v[172:175], v[208:211], v[240:243]
    v_mfma_f32_16x16x32_bf16 v[88:91], v[196:199], v[220:223], v[88:91]
    s_cmp_eq_u32 s39, 73728
    v_mfma_f32_16x16x32_bf16 v[92:95], v[172:175], v[212:215], v[244:247]
    v_mfma_f32_16x16x32_bf16 v[92:95], v[196:199], v[224:227], v[92:95]
    s_cselect_b32 s39, 0, s39
    v_mfma_f32_16x16x32_bf16 v[96:99], v[172:175], v[216:219], v[248:251]
    v_mfma_f32_16x16x32_bf16 v[96:99], v[196:199], v[228:231], v[96:99]
    v_add_u32 v4, s39, v9
    s_waitcnt lgkmcnt(4)
    v_mfma_f32_16x16x32_bf16 v[112:115], v[176:179], v[208:211], v[240:243]
    v_mfma_f32_16x16x32_bf16 v[112:115], v[200:203], v[220:223], v[112:115]
    v_mfma_f32_16x16x32_bf16 v[116:119], v[176:179], v[212:215], v[244:247]
    v_mfma_f32_16x16x32_bf16 v[116:119], v[200:203], v[224:227], v[116:119]
    v_mfma_f32_16x16x32_bf16 v[120:123], v[176:179], v[216:219], v[248:251]
    v_mfma_f32_16x16x32_bf16 v[120:123], v[200:203], v[228:231], v[120:123]
    s_waitcnt lgkmcnt(0)
    v_mfma_f32_16x16x32_bf16 v[136:139], v[180:183], v[208:211], v[240:243]
    v_mfma_f32_16x16x32_bf16 v[136:139], v[204:207], v[220:223], v[136:139]
    v_mfma_f32_16x16x32_bf16 v[140:143], v[180:183], v[212:215], v[244:247]
    v_mfma_f32_16x16x32_bf16 v[140:143], v[204:207], v[224:227], v[140:143]
    s_waitcnt vmcnt(29)
    s_cmp_lg_u32 s41, 0
    s_cbranch_scc1 K3_vwf0
    s_waitcnt vmcnt(5)
K3_vwf0:
    v_mfma_f32_16x16x32_bf16 v[144:147], v[180:183], v[216:219], v[248:251]
    v_mfma_f32_16x16x32_bf16 v[144:147], v[204:207], v[228:231], v[144:147]
    s_barrier
    s_setprio 0
    s_mov_b32 m0, s34
    ds_read_b128 v[208:211], v4 offset:0
    buffer_load_dwordx4 v254, s[8:11], s33 offen offset:0 lds
    ds_read_b128 v[212:215], v4 offset:1024
    buffer_load_dwordx4 v254, s[8:11], s33 offen offset:1024 lds
    ds_read_b128 v[216:219], v4 offset:2048
    buffer_load_dwordx4 v254, s[8:11], s33 offen offset:2048 lds
    ds_read_b128 v[220:223], v4 offset:3072
    buffer_load_dwordx4 v254, s[8:11], s33 offen offset:3072 lds
    s_mov_b32 m0, s46
    ds_read_b128 v[224:227], v4 offset:4096
    buffer_load_dwordx4 v254, s[8:11], s45 offen offset:0 lds
    ds_read_b128 v[228:231], v4 offset:5120
    s_nop 1
    v_mov_b32 v240, v15
    v_mov_b32 v241, v15
    v_mov_b32 v242, v15
    v_mov_b32 v243, v15
    v_mov_b32 v244, v252
    v_mov_b32 v245, v252
    v_mov_b32 v246, v252
    v_mov_b32 v247, v252
    v_mov_b32 v248, v253
    v_mov_b32 v249, v253
    v_mov_b32 v250, v253
    v_mov_b32 v251, v253
    s_waitcnt lgkmcnt(0)
    s_setprio 1
    v_mfma_f32_16x16x32_bf16 v[28:31], v[160:163], v[208:211], v[240:243]
    v_mfma_f32_16x16x32_bf16 v[28:31], v[184:187], v[220:223], v[28:31]
    s_add_u32 s34, s34, 24576
    v_mfma_f32_16x16x32_bf16 v[32:35], v[160:163], v[212:215], v[244:247]
    v_mfma_f32_16x16x32_bf16 v[32:35], v[184:187], v[224:227], v[32:35]
    s_cmp_eq_u32 s34, s36
    v_mfma_f32_16x16x32_bf16 v[36:39], v[160:163], v[216:219], v[248:251]
    v_mfma_f32_16x16x32_bf16 v[36:39], v[184:187], v[228:231], v[36:39]
    s_cselect_b32 s34, s35, s34
    v_mfma_f32_16x16x32_bf16 v[52:55], v[164:167], v[208:211], v[240:243]
    v_mfma_f32_16x16x32_bf16 v[52:55], v[188:191], v[220:223], v[52:55]
    s_sub_u32 s33, s33, 24576
    v_mfma_f32_16x16x32_bf16 v[56:59], v[164:167], v[212:215], v[244:247]
    v_mfma_f32_16x16x32_bf16 v[56:59], v[188:191], v[224:227], v[56:59]
    s_cselect_b32 s44, 1179648, 0
    v_mfma_f32_16x16x32_bf16 v[60:63], v[164:167], v[216:219], v[248:251]
    v_mfma_f32_16x16x32_bf16 v[60:63], v[188:191], v[228:231], v[60:63]
    s_add_u32 s33, s33, s44
    v_mfma_f32_16x16x32_bf16 v[76:79], v[168:171], v[208:211], v[240:243]
    v_mfma_f32_16x16x32_bf16 v[76:79], v[192:195], v[220:223], v[76:79]
    s_add_u32 s45, s33, 4096
    v_mfma_f32_16x16x32_bf16 v[80:83], v[168:171], v[212:215], v[244:247]
    v_mfma_f32_16x16x32_bf16 v[80:83], v[192:195], v[224:227], v[80:83]
    s_add_u32 s46, s34, 4096
    v_mfma_f32_16x16x32_bf16 v[84:87], v[168:171], v[216:219], v[248:251]
    v_mfma_f32_16x16x32_bf16 v[84:87], v[192:195], v[228:231], v[84:87]
    s_add_u32 s39, s39, 24576
    v_mfma_f32_16x16x32_bf16 v[100:103], v[172:175], v[208:211], v[240:243]
    v_mfma_f32_16x16x32_bf16 v[100:103], v[196:199], v[220:223], v[100:103]
    s_cmp_eq_u32 s39, 73728
    v_mfma_f32_16x16x32_bf16 v[104:107], v[172:175], v[212:215], v[244:247]
    v_mfma_f32_16x16x32_bf16 v[104:107], v[196:199], v[224:227], v[104:107]
    s_cselect_b32 s39, 0, s39
    v_mfma_f32_16x16x32_bf16 v[108:111], v[172:175], v[216:219], v[248:251]
    v_mfma_f32_16x16x32_bf16 v[108:111], v[196:199], v[228:231], v[108:111]
    v_add_u32 v4, s39, v9
    v_mfma_f32_16x16x32_bf16 v[124:127], v[176:179], v[208:211], v[240:243]
    v_mfma_f32_16x16x32_bf16 v[124:127], v[200:203], v[220:223], v[124:127]
    s_add_u32 s40, s40, 24576
    v_mfma_f32_16x16x32_bf16 v[128:131], v[176:179], v[212:215], v[244:247]
    v_mfma_f32_16x16x32_bf16 v[128:131], v[200:203], v[224:227], v[128:131]
    s_cmp_eq_u32 s40, 73728
    v_mfma_f32_16x16x32_bf16 v[132:135], v[176:179], v[216:219], v[248:251]
    v_mfma_f32_16x16x32_bf16 v[132:135], v[200:203], v[228:231], v[132:135]
    s_cselect_b32 s40, 0, s40
    v_mfma_f32_16x16x32_bf16 v[148:151], v[180:183], v[208:211], v[240:243]
    v_mfma_f32_16x16x32_bf16 v[148:151], v[204:207], v[220:223], v[148:151]
    v_add_u32 v5, s40, v10
    v_mfma_f32_16x16x32_bf16 v[152:155], v[180:183], v[212:215], v[244:247]
    v_mfma_f32_16x16x32_bf16 v[152:155], v[204:207], v[224:227], v[152:155]
    v_add_u32 v6, s40, v11
    s_waitcnt vmcnt(29)
    s_cmp_lg_u32 s41, 0
    s_cbranch_scc1 K3_vwf1
    s_waitcnt vmcnt(5)
K3_vwf1:
    v_mfma_f32_16x16x32_bf16 v[156:159], v[180:183], v[216:219], v[248:251]
    v_mfma_f32_16x16x32_bf16 v[156:159], v[204:207], v[228:231], v[156:159]
    s_barrier
    s_setprio 0
    s_mov_b32 m0, s34
    ds_read_b128 v[208:211], v4 offset:0
    ds_read_b128 v[212:215], v4 offset:1024
    ds_read_b128 v[216:219], v4 offset:2048
    ds_read_b128 v[220:223], v4 offset:3072
    ds_read_b128 v[224:227], v4 offset:4096
    ds_read_b128 v[228:231], v4 offset:5120
    buffer_load_dwordx4 v254, s[8:11], s33 offen offset:0 lds
    ds_read_b64_tr_b16 v[160:161], v5 offset:0
    ds_read_b64_tr_b16 v[162:163], v6 offset:0
    ds_read_b64_tr_b16 v[184:185], v5 offset:12288
    ds_read_b64_tr_b16 v[186:187], v6 offset:12288
    ds_read_b64_tr_b16 v[164:165], v5 offset:1024
    ds_read_b64_tr_b16 v[166:167], v6 offset:1024
    buffer_load_dwordx4 v254, s[8:11], s33 offen offset:1024 lds
    ds_read_b64_tr_b16 v[188:189], v5 offset:13312
    ds_read_b64_tr_b16 v[190:191], v6 offset:13312
    ds_read_b64_tr_b16 v[168:169], v5 offset:2048
    ds_read_b64_tr_b16 v[170:171], v6 offset:2048
    ds_read_b64_tr_b16 v[192:193], v5 offset:14336
    ds_read_b64_tr_b16 v[194:195], v6 offset:14336
    buffer_load_dwordx4 v254, s[8:11], s33 offen offset:2048 lds
    ds_read_b64_tr_b16 v[172:173], v5 offset:3072
    ds_read_b64_tr_b16 v[174:175], v6 offset:3072
    ds_read_b64_tr_b16 v[196:197], v5 offset:15360
    ds_read_b64_tr_b16 v[198:199], v6 offset:15360
    ds_read_b64_tr_b16 v[176:177], v5 offset:4096
    ds_read_b64_tr_b16 v[178:179], v6 offset:4096
    buffer_load_dwordx4 v254, s[8:11], s33 offen offset:3072 lds
    s_mov_b32 m0, s46
    ds_read_b64_tr_b16 v[200:201], v5 offset:16384
    ds_read_b64_tr_b16 v[202:203], v6 offset:16384
    ds_read_b64_tr_b16 v[180:181], v5 offset:5120
    ds_read_b64_tr_b16 v[182:183], v6 offset:5120
    ds_read_b64_tr_b16 v[204:205], v5 offset:17408
    ds_read_b64_tr_b16 v[206:207], v6 offset:17408
    buffer_load_dwordx4 v254, s[8:11], s45 offen offset:0 lds
    s_waitcnt lgkmcnt(15)
    s_setprio 1
    v_mfma_f32_16x16x32_bf16 v[16:19], v[160:163], v[208:211], v[16:19]
    v_mfma_f32_16x16x32_bf16 v[16:19], v[184:187], v[220:223], v[16:19]
    s_add_u32 s34, s34, 24576
    v_mfma_f32_16x16x32_bf16 v[20:23], v[160:163], v[212:215], v[20:23]
    v_mfma_f32_16x16x32_bf16 v[20:23], v[184:187], v[224:227], v[20:23]
    s_cmp_eq_u32 s34, s36
    v_mfma_f32_16x16x32_bf16 v[24:27], v[160:163], v[216:219], v[24:27]
    v_mfma_f32_16x16x32_bf16 v[24:27], v[184:187], v[228:231], v[24:27]
    s_cselect_b32 s34, s35, s34
    v_mfma_f32_16x16x32_bf16 v[40:43], v[164:167], v[208:211], v[40:43]
    v_mfma_f32_16x16x32_bf16 v[40:43], v[188:191], v[220:223], v[40:43]
    s_sub_u32 s33, s33, 24576
    v_mfma_f32_16x16x32_bf16 v[44:47], v[164:167], v[212:215], v[44:47]
    v_mfma_f32_16x16x32_bf16 v[44:47], v[188:191], v[224:227], v[44:47]
    s_cselect_b32 s44, 1179648, 0
    v_mfma_f32_16x16x32_bf16 v[48:51], v[164:167], v[216:219], v[48:51]
    v_mfma_f32_16x16x32_bf16 v[48:51], v[188:191], v[228:231], v[48:51]
    s_add_u32 s33, s33, s44
    s_waitcnt lgkmcnt(12)
    v_mfma_f32_16x16x32_bf16 v[64:67], v[168:171], v[208:211], v[64:67]
    v_mfma_f32_16x16x32_bf16 v[64:67], v[192:195], v[220:223], v[64:67]
    s_add_u32 s45, s33, 4096
    v_mfma_f32_16x16x32_bf16 v[68:71], v[168:171], v[212:215], v[68:71]
    v_mfma_f32_16x16x32_bf16 v[68:71], v[192:195], v[224:227], v[68:71]
    s_add_u32 s46, s34, 4096
    v_mfma_f32_16x16x32_bf16 v[72:75], v[168:171], v[216:219], v[72:75]
    v_mfma_f32_16x16x32_bf16 v[72:75], v[192:195], v[228:231], v[72:75]
    s_add_u32 s39, s39, 24576
    s_waitcnt lgkmcnt(8)
    v_mfma_f32_16x16x32_bf16 v[88:91], v[172:175], v[208:211], v[88:91]
    v_mfma_f32_16x16x32_bf16 v[88:91], v[196:199], v[220:223], v[88:91]
    s_cmp_eq_u32 s39, 73728
    v_mfma_f32_16x16x32_bf16 v[92:95], v[172:175], v[212:215], v[92:95]
    v_mfma_f32_16x16x32_bf16 v[92:95], v[196:199], v[224:227], v[92:95]
    s_cselect_b32 s39, 0, s39
    v_mfma_f32_16x16x32_bf16 v[96:99], v[172:175], v[216:219], v[96:99]
    v_mfma_f32_16x16x32_bf16 v[96:99], v[196:199], v[228:231], v[96:99]
    v_add_u32 v4, s39, v9
    s_waitcnt lgkmcnt(4)
    v_mfma_f32_16x16x32_bf16 v[112:115], v[176:179], v[208:211], v[112:115]
    v_mfma_f32_16x16x32_bf16 v[112:115], v[200:203], v[220:223], v[112:115]
    s_sub_u32 s37, s43, 0
    v_mfma_f32_16x16x32_bf16 v[116:119], v[176:179], v[212:215], v[116:119]
    v_mfma_f32_16x16x32_bf16 v[116:119], v[200:203], v[224:227], v[116:119]
    s_sub_u32 s43, s43, 1
    v_mfma_f32_16x16x32_bf16 v[120:123], v[176:179], v[216:219], v[120:123]
    v_mfma_f32_16x16x32_bf16 v[120:123], v[200:203], v[228:231], v[120:123]
    s_waitcnt lgkmcnt(0)
    v_mfma_f32_16x16x32_bf16 v[136:139], v[180:183], v[208:211], v[136:139]
    v_mfma_f32_16x16x32_bf16 v[136:139], v[204:207], v[220:223], v[136:139]
    v_mfma_f32_16x16x32_bf16 v[140:143], v[180:183], v[212:215], v[140:143]
    v_mfma_f32_16x16x32_bf16 v[140:143], v[204:207], v[224:227], v[140:143]
    s_waitcnt vmcnt(5)
    v_mfma_f32_16x16x32_bf16 v[144:147], v[180:183], v[216:219], v[144:147]
    v_mfma_f32_16x16x32_bf16 v[144:147], v[204:207], v[228:231], v[144:147]
    s_barrier
    s_setprio 0
    s_cmp_lt_u32 s37, 6
    s_cbranch_scc0 K3_wf3_xr
    ds_read2_b32 v[240:241], v7 offset0:0 offset1:3
    ds_read2_b32 v[242:243], v7 offset0:6 offset1:9
    ds_read2_b32 v[244:245], v7 offset0:1 offset1:4
    ds_read2_b32 v[246:247], v7 offset0:7 offset1:10
    ds_read2_b32 v[248:249], v7 offset0:2 offset1:5
    ds_read2_b32 v[250:251], v7 offset0:8 offset1:11
K3_wf3_xr:
    s_mov_b32 m0, s34
    ds_read_b128 v[208:211], v4 offset:0
    buffer_load_dwordx4 v254, s[8:11], s33 offen offset:0 lds
    ds_read_b128 v[212:215], v4 offset:1024
    buffer_load_dwordx4 v254, s[8:11], s33 offen offset:1024 lds
    ds_read_b128 v[216:219], v4 offset:2048
    buffer_load_dwordx4 v254, s[8:11], s33 offen offset:2048 lds
    ds_read_b128 v[220:223], v4 offset:3072
    buffer_load_dwordx4 v254, s[8:11], s33 offen offset:3072 lds
    s_mov_b32 m0, s46
    ds_read_b128 v[224:227], v4 offset:4096
    buffer_load_dwordx4 v254, s[8:11], s45 offen offset:0 lds
    ds_read_b128 v[228:231], v4 offset:5120
    s_cmp_lt_u32 s37, 6
    s_cbranch_scc0 K3_wf3_xn
    s_cmp_lg_u32 s37, 0
    s_cbranch_scc1 K3_wf3_x1
    s_waitcnt lgkmcnt(0)
    s_setprio 1
    v_mfma_f32_16x16x32_bf16 v[16:19], v[240:243], v[232:235], v[16:19]
    v_mfma_f32_16x16x32_bf16 v[20:23], v[240:243], v[236:239], v[20:23]
    v_mfma_f32_16x16x32_bf16 v[24:27], v[244:247], v[232:235], v[24:27]
    v_mfma_f32_16x16x32_bf16 v[28:31], v[244:247], v[236:239], v[28:31]
    v_mfma_f32_16x16x32_bf16 v[32:35], v[248:251], v[232:235], v[32:35]
    v_mfma_f32_16x16x32_bf16 v[36:39], v[248:251], v[236:239], v[36:39]
    s_branch K3_wf3_xd
K3_wf3_x1:
    s_cmp_lg_u32 s37, 1
    s_cbranch_scc1 K3_wf3_x2
    s_waitcnt lgkmcnt(0)
    s_setprio 1
    v_mfma_f32_16x16x32_bf16 v[40:43], v[240:243], v[232:235], v[40:43]
    v_mfma_f32_16x16x32_bf16 v[44:47], v[240:243], v[236:239], v[44:47]
    v_mfma_f32_16x16x32_bf16 v[48:51], v[244:247], v[232:235], v[48:51]
    v_mfma_f32_16x16x32_bf16 v[52:55], v[244:247], v[236:239], v[52:55]
    v_mfma_f32_16x16x32_bf16 v[56:59], v[248:251], v[232:235], v[56:59]
    v_mfma_f32_16x16x32_bf16 v[60:63], v[248:251], v[236:239], v[60:63]
    s_branch K3_wf3_xd
K3_wf3_x2:
    s_cmp_lg_u32 s37, 2
    s_cbranch_scc1 K3_wf3_x3
    s_waitcnt lgkmcnt(0)
    s_setprio 1
    v_mfma_f32_16x16x32_bf16 v[64:67], v[240:243], v[232:235], v[64:67]
    v_mfma_f32_16x16x32_bf16 v[68:71], v[240:243], v[236:239], v[68:71]
    v_mfma_f32_16x16x32_bf16 v[72:75], v[244:247], v[232:235], v[72:75]
    v_mfma_f32_16x16x32_bf16 v[76:79], v[244:247], v[236:239], v[76:79]
    v_mfma_f32_16x16x32_bf16 v[80:83], v[248:251], v[232:235], v[80:83]
    v_mfma_f32_16x16x32_bf16 v[84:87], v[248:251], v[236:239], v[84:87]
    s_branch K3_wf3_xd
K3_wf3_x3:
    s_cmp_lg_u32 s37, 3
    s_cbranch_scc1 K3_wf3_x4
    s_waitcnt lgkmcnt(0)
    s_setprio 1
    v_mfma_f32_16x16x32_bf16 v[88:91], v[240:243], v[232:235], v[88:91]
    v_mfma_f32_16x16x32_bf16 v[92:95], v[240:243], v[236:239], v[92:95]
    v_mfma_f32_16x16x32_bf16 v[96:99], v[244:247], v[232:235], v[96:99]
    v_mfma_f32_16x16x32_bf16 v[100:103], v[244:247], v[236:239], v[100:103]
    v_mfma_f32_16x16x32_bf16 v[104:107], v[248:251], v[232:235], v[104:107]
    v_mfma_f32_16x16x32_bf16 v[108:111], v[248:251], v[236:239], v[108:111]
    s_branch K3_wf3_xd
K3_wf3_x4:
    s_cmp_lg_u32 s37, 4
    s_cbranch_scc1 K3_wf3_x5
    s_waitcnt lgkmcnt(0)
    s_setprio 1
    v_mfma_f32_16x16x32_bf16 v[112:115], v[240:243], v[232:235], v[112:115]
    v_mfma_f32_16x16x32_bf16 v[116:119], v[240:243], v[236:239], v[116:119]
    v_mfma_f32_16x16x32_bf16 v[120:123], v[244:247], v[232:235], v[120:123]
    v_mfma_f32_16x16x32_bf16 v[124:127], v[244:247], v[236:239], v[124:127]
    v_mfma_f32_16x16x32_bf16 v[128:131], v[248:251], v[232:235], v[128:131]
    v_mfma_f32_16x16x32_bf16 v[132:135], v[248:251], v[236:239], v[132:135]
    s_branch K3_wf3_xd
K3_wf3_x5:
    s_waitcnt lgkmcnt(0)
    s_setprio 1
    v_mfma_f32_16x16x32_bf16 v[136:139], v[240:243], v[232:235], v[136:139]
    v_mfma_f32_16x16x32_bf16 v[140:143], v[240:243], v[236:239], v[140:143]
    v_mfma_f32_16x16x32_bf16 v[144:147], v[244:247], v[232:235], v[144:147]
    v_mfma_f32_16x16x32_bf16 v[148:151], v[244:247], v[236:239], v[148:151]
    v_mfma_f32_16x16x32_bf16 v[152:155], v[248:251], v[232:235], v[152:155]
    v_mfma_f32_16x16x32_bf16 v[156:159], v[248:251], v[236:239], v[156:159]
    s_branch K3_wf3_xd
K3_wf3_xn:
    s_waitcnt lgkmcnt(0)
    s_setprio 1
K3_wf3_xd:
    v_mfma_f32_16x16x32_bf16 v[28:31], v[160:163], v[208:211], v[28:31]
    v_mfma_f32_16x16x32_bf16 v[28:31], v[184:187], v[220:223], v[28:31]
    s_add_u32 s34, s34, 24576
    v_mfma_f32_16x16x32_bf16 v[32:35], v[160:163], v[212:215], v[32:35]
    v_mfma_f32_16x16x32_bf16 v[32:35], v[184:187], v[224:227], v[32:35]
    s_cmp_eq_u32 s34, s36
    v_mfma_f32_16x16x32_bf16 v[36:39], v[160:163], v[216:219], v[36:39]
    v_mfma_f32_16x16x32_bf16 v[36:39], v[184:187], v[228:231], v[36:39]
    s_cselect_b32 s34, s35, s34
    v_mfma_f32_16x16x32_bf16 v[52:55], v[164:167], v[208:211], v[52:55]
    v_mfma_f32_16x16x32_bf16 v[52:55], v[188:191], v[220:223], v[52:55]
    s_sub_u32 s33, s33, 24576
    v_mfma_f32_16x16x32_bf16 v[56:59], v[164:167], v[212:215], v[56:59]
    v_mfma_f32_16x16x32_bf16 v[56:59], v[188:191], v[224:227], v[56:59]
    s_cselect_b32 s44, 1179648, 0
    v_mfma_f32_16x16x32_bf16 v[60:63], v[164:167], v[216:219], v[60:63]
    v_mfma_f32_16x16x32_bf16 v[60:63], v[188:191], v[228:231], v[60:63]
    s_add_u32 s33, s33, s44
    v_mfma_f32_16x16x32_bf16 v[76:79], v[168:171], v[208:211], v[76:79]
    v_mfma_f32_16x16x32_bf16 v[76:79], v[192:195], v[220:223], v[76:79]
    s_add_u32 s45, s33, 4096
    v_mfma_f32_16x16x32_bf16 v[80:83], v[168:171], v[212:215], v[80:83]
    v_mfma_f32_16x16x32_bf16 v[80:83], v[192:195], v[224:227], v[80:83]
    s_add_u32 s46, s34, 4096
    v_mfma_f32_16x16x32_bf16 v[84:87], v[168:171], v[216:219], v[84:87]
    v_mfma_f32_16x16x32_bf16 v[84:87], v[192:195], v[228:231], v[84:87]
    s_add_u32 s39, s39, 24576
    v_mfma_f32_16x16x32_bf16 v[100:103], v[172:175], v[208:211], v[100:103]
    v_mfma_f32_16x16x32_bf16 v[100:103], v[196:199], v[220:223], v[100:103]
    s_cmp_eq_u32 s39, 73728
    v_mfma_f32_16x16x32_bf16 v[104:107], v[172:175], v[212:215], v[104:107]
    v_mfma_f32_16x16x32_bf16 v[104:107], v[196:199], v[224:227], v[104:107]
    s_cselect_b32 s39, 0, s39
    v_mfma_f32_16x16x32_bf16 v[108:111], v[172:175], v[216:219], v[108:111]
    v_mfma_f32_16x16x32_bf16 v[108:111], v[196:199], v[228:231], v[108:111]
    v_add_u32 v4, s39, v9
    v_mfma_f32_16x16x32_bf16 v[124:127], v[176:179], v[208:211], v[124:127]
    v_mfma_f32_16x16x32_bf16 v[124:127], v[200:203], v[220:223], v[124:127]
    s_add_u32 s40, s40, 24576
    v_mfma_f32_16x16x32_bf16 v[128:131], v[176:179], v[212:215], v[128:131]
    v_mfma_f32_16x16x32_bf16 v[128:131], v[200:203], v[224:227], v[128:131]
    s_cmp_eq_u32 s40, 73728
    v_mfma_f32_16x16x32_bf16 v[132:135], v[176:179], v[216:219], v[132:135]
    v_mfma_f32_16x16x32_bf16 v[132:135], v[200:203], v[228:231], v[132:135]
    s_cselect_b32 s40, 0, s40
    v_mfma_f32_16x16x32_bf16 v[148:151], v[180:183], v[208:211], v[148:151]
    v_mfma_f32_16x16x32_bf16 v[148:151], v[204:207], v[220:223], v[148:151]
    v_add_u32 v5, s40, v10
    v_mfma_f32_16x16x32_bf16 v[152:155], v[180:183], v[212:215], v[152:155]
    v_mfma_f32_16x16x32_bf16 v[152:155], v[204:207], v[224:227], v[152:155]
    v_add_u32 v6, s40, v11
    s_waitcnt vmcnt(5)
    v_mfma_f32_16x16x32_bf16 v[156:159], v[180:183], v[216:219], v[156:159]
    v_mfma_f32_16x16x32_bf16 v[156:159], v[204:207], v[228:231], v[156:159]
    s_barrier
    s_setprio 0
.p2align 6
K3_w_loop:
    s_mov_b32 m0, s34
    ds_read_b128 v[208:211], v4 offset:0
    ds_read_b128 v[212:215], v4 offset:1024
    ds_read_b128 v[216:219], v4 offset:2048
    ds_read_b128 v[220:223], v4 offset:3072
    ds_read_b128 v[224:227], v4 offset:4096
    ds_read_b128 v[228:231], v4 offset:5120
    buffer_load_dwordx4 v254, s[8:11], s33 offen offset:0 lds
    ds_read_b64_tr_b16 v[160:161], v5 offset:0
    ds_read_b64_tr_b16 v[162:163], v6 offset:0
    ds_read_b64_tr_b16 v[184:185], v5 offset:12288
    ds_read_b64_tr_b16 v[186:187], v6 offset:12288
    ds_read_b64_tr_b16 v[164:165], v5 offset:1024
    ds_read_b64_tr_b16 v[166:167], v6 offset:1024
    buffer_load_dwordx4 v254, s[8:11], s33 offen offset:1024 lds
    ds_read_b64_tr_b16 v[188:189], v5 offset:13312
    ds_read_b64_tr_b16 v[190:191], v6 offset:13312
    ds_read_b64_tr_b16 v[168:169], v5 offset:2048
    ds_read_b64_tr_b16 v[170:171], v6 offset:2048
    ds_read_b64_tr_b16 v[192:193], v5 offset:14336
    ds_read_b64_tr_b16 v[194:195], v6 offset:14336
    buffer_load_dwordx4 v254, s[8:11], s33 offen offset:2048 lds
    ds_read_b64_tr_b16 v[172:173], v5 offset:3072
    ds_read_b64_tr_b16 v[174:175], v6 offset:3072
    ds_read_b64_tr_b16 v[196:197], v5 offset:15360
    ds_read_b64_tr_b16 v[198:199], v6 offset:15360
    ds_read_b64_tr_b16 v[176:177], v5 offset:4096
    ds_read_b64_tr_b16 v[178:179], v6 offset:4096
    buffer_load_dwordx4 v254, s[8:11], s33 offen offset:3072 lds
    s_mov_b32 m0, s46
    ds_read_b64_tr_b16 v[200:201], v5 offset:16384
    ds_read_b64_tr_b16 v[202:203], v6 offset:16384
    ds_read_b64_tr_b16 v[180:181], v5 offset:5120
    ds_read_b64_tr_b16 v[182:183], v6 offset:5120
    ds_read_b64_tr_b16 v[204:205], v5 offset:17408
    ds_read_b64_tr_b16 v[206:207], v6 offset:17408
    buffer_load_dwordx4 v254, s[8:11], s45 offen offset:0 lds
    s_waitcnt lgkmcnt(15)
    s_setprio 1
    v_mfma_f32_16x16x32_bf16 v[16:19], v[160:163], v[208:211], v[16:19]
    v_mfma_f32_16x16x32_bf16 v[16:19], v[184:187], v[220:223], v[16:19]
    s_add_u32 s34, s34, 24576
    v_mfma_f32_16x16x32_bf16 v[20:23], v[160:163], v[212:215], v[20:23]
    v_mfma_f32_16x16x32_bf16 v[20:23], v[184:187], v[224:227], v[20:23]
    s_cmp_eq_u32 s34, s36
    v_mfma_f32_16x16x32_bf16 v[24:27], v[160:163], v[216:219], v[24:27]
    v_mfma_f32_16x16x32_bf16 v[24:27], v[184:187], v[228:231], v[24:27]
    s_cselect_b32 s34, s35, s34
    v_mfma_f32_16x16x32_bf16 v[40:43], v[164:167], v[208:211], v[40:43]
    v_mfma_f32_16x16x32_bf16 v[40:43], v[188:191], v[220:223], v[40:43]
    s_sub_u32 s33, s33, 24576
    v_mfma_f32_16x16x32_bf16 v[44:47], v[164:167], v[212:215], v[44:47]
    v_mfma_f32_16x16x32_bf16 v[44:47], v[188:191], v[224:227], v[44:47]
    s_cselect_b32 s44, 1179648, 0
    v_mfma_f32_16x16x32_bf16 v[48:51], v[164:167], v[216:219], v[48:51]
    v_mfma_f32_16x16x32_bf16 v[48:51], v[188:191], v[228:231], v[48:51]
    s_add_u32 s33, s33, s44
    s_waitcnt lgkmcnt(12)
    v_mfma_f32_16x16x32_bf16 v[64:67], v[168:171], v[208:211], v[64:67]
    v_mfma_f32_16x16x32_bf16 v[64:67], v[192:195], v[220:223], v[64:67]
    s_add_u32 s45, s33, 4096
    v_mfma_f32_16x16x32_bf16 v[68:71], v[168:171], v[212:215], v[68:71]
    v_mfma_f32_16x16x32_bf16 v[68:71], v[192:195], v[224:227], v[68:71]
    s_add_u32 s46, s34, 4096
    v_mfma_f32_16x16x32_bf16 v[72:75], v[168:171], v[216:219], v[72:75]
    v_mfma_f32_16x16x32_bf16 v[72:75], v[192:195], v[228:231], v[72:75]
    s_add_u32 s39, s39, 24576
    s_waitcnt lgkmcnt(8)
    v_mfma_f32_16x16x32_bf16 v[88:91], v[172:175], v[208:211], v[88:91]
    v_mfma_f32_16x16x32_bf16 v[88:91], v[196:199], v[220:223], v[88:91]
    s_cmp_eq_u32 s39, 73728
    v_mfma_f32_16x16x32_bf16 v[92:95], v[172:175], v[212:215], v[92:95]
    v_mfma_f32_16x16x32_bf16 v[92:95], v[196:199], v[224:227], v[92:95]
    s_cselect_b32 s39, 0, s39
    v_mfma_f32_16x16x32_bf16 v[96:99], v[172:175], v[216:219], v[96:99]
    v_mfma_f32_16x16x32_bf16 v[96:99], v[196:199], v[228:231], v[96:99]
    v_add_u32 v4, s39, v9
    s_waitcnt lgkmcnt(4)
    v_mfma_f32_16x16x32_bf16 v[112:115], v[176:179], v[208:211], v[112:115]
    v_mfma_f32_16x16x32_bf16 v[112:115], v[200:203], v[220:223], v[112:115]
    v_mfma_f32_16x16x32_bf16 v[116:119], v[176:179], v[212:215], v[116:119]
    v_mfma_f32_16x16x32_bf16 v[116:119], v[200:203], v[224:227], v[116:119]
    v_mfma_f32_16x16x32_bf16 v[120:123], v[176:179], v[216:219], v[120:123]
    v_mfma_f32_16x16x32_bf16 v[120:123], v[200:203], v[228:231], v[120:123]
    s_waitcnt lgkmcnt(0)
    v_mfma_f32_16x16x32_bf16 v[136:139], v[180:183], v[208:211], v[136:139]
    v_mfma_f32_16x16x32_bf16 v[136:139], v[204:207], v[220:223], v[136:139]
    v_mfma_f32_16x16x32_bf16 v[140:143], v[180:183], v[212:215], v[140:143]
    v_mfma_f32_16x16x32_bf16 v[140:143], v[204:207], v[224:227], v[140:143]
    s_waitcnt vmcnt(5)
    v_mfma_f32_16x16x32_bf16 v[144:147], v[180:183], v[216:219], v[144:147]
    v_mfma_f32_16x16x32_bf16 v[144:147], v[204:207], v[228:231], v[144:147]
    s_barrier
    s_setprio 0
    s_mov_b32 m0, s34
    ds_read_b128 v[208:211], v4 offset:0
    buffer_load_dwordx4 v254, s[8:11], s33 offen offset:0 lds
    ds_read_b128 v[212:215], v4 offset:1024
    buffer_load_dwordx4 v254, s[8:11], s33 offen offset:1024 lds
    ds_read_b128 v[216:219], v4 offset:2048
    buffer_load_dwordx4 v254, s[8:11], s33 offen offset:2048 lds
    ds_read_b128 v[220:223], v4 offset:3072
    buffer_load_dwordx4 v254, s[8:11], s33 offen offset:3072 lds
    s_mov_b32 m0, s46
    ds_read_b128 v[224:227], v4 offset:4096
    buffer_load_dwordx4 v254, s[8:11], s45 offen offset:0 lds
    ds_read_b128 v[228:231], v4 offset:5120
    s_waitcnt lgkmcnt(0)
    s_setprio 1
    v_mfma_f32_16x16x32_bf16 v[28:31], v[160:163], v[208:211], v[28:31]
    v_mfma_f32_16x16x32_bf16 v[28:31], v[184:187], v[220:223], v[28:31]
    s_add_u32 s34, s34, 24576
    v_mfma_f32_16x16x32_bf16 v[32:35], v[160:163], v[212:215], v[32:35]
    v_mfma_f32_16x16x32_bf16 v[32:35], v[184:187], v[224:227], v[32:35]
    s_cmp_eq_u32 s34, s36
    v_mfma_f32_16x16x32_bf16 v[36:39], v[160:163], v[216:219], v[36:39]
    v_mfma_f32_16x16x32_bf16 v[36:39], v[184:187], v[228:231], v[36:39]
    s_cselect_b32 s34, s35, s34
    v_mfma_f32_16x16x32_bf16 v[52:55], v[164:167], v[208:211], v[52:55]
    v_mfma_f32_16x16x32_bf16 v[52:55], v[188:191], v[220:223], v[52:55]
    s_sub_u32 s33, s33, 24576
    v_mfma_f32_16x16x32_bf16 v[56:59], v[164:167], v[212:215], v[56:59]
    v_mfma_f32_16x16x32_bf16 v[56:59], v[188:191], v[224:227], v[56:59]
    s_cselect_b32 s44, 1179648, 0
    v_mfma_f32_16x16x32_bf16 v[60:63], v[164:167], v[216:219], v[60:63]
    v_mfma_f32_16x16x32_bf16 v[60:63], v[188:191], v[228:231], v[60:63]
    s_add_u32 s33, s33, s44
    v_mfma_f32_16x16x32_bf16 v[76:79], v[168:171], v[208:211], v[76:79]
    v_mfma_f32_16x16x32_bf16 v[76:79], v[192:195], v[220:223], v[76:79]
    s_add_u32 s45, s33, 4096
    v_mfma_f32_16x16x32_bf16 v[80:83], v[168:171], v[212:215], v[80:83]
    v_mfma_f32_16x16x32_bf16 v[80:83], v[192:195], v[224:227], v[80:83]
    s_add_u32 s46, s34, 4096
    v_mfma_f32_16x16x32_bf16 v[84:87], v[168:171], v[216:219], v[84:87]
    v_mfma_f32_16x16x32_bf16 v[84:87], v[192:195], v[228:231], v[84:87]
    s_add_u32 s39, s39, 24576
    v_mfma_f32_16x16x32_bf16 v[100:103], v[172:175], v[208:211], v[100:103]
    v_mfma_f32_16x16x32_bf16 v[100:103], v[196:199], v[220:223], v[100:103]
    s_cmp_eq_u32 s39, 73728
    v_mfma_f32_16x16x32_bf16 v[104:107], v[172:175], v[212:215], v[104:107]
    v_mfma_f32_16x16x32_bf16 v[104:107], v[196:199], v[224:227], v[104:107]
    s_cselect_b32 s39, 0, s39
    v_mfma_f32_16x16x32_bf16 v[108:111], v[172:175], v[216:219], v[108:111]
    v_mfma_f32_16x16x32_bf16 v[108:111], v[196:199], v[228:231], v[108:111]
    v_add_u32 v4, s39, v9
    v_mfma_f32_16x16x32_bf16 v[124:127], v[176:179], v[208:211], v[124:127]
    v_mfma_f32_16x16x32_bf16 v[124:127], v[200:203], v[220:223], v[124:127]
    s_add_u32 s40, s40, 24576
    v_mfma_f32_16x16x32_bf16 v[128:131], v[176:179], v[212:215], v[128:131]
    v_mfma_f32_16x16x32_bf16 v[128:131], v[200:203], v[224:227], v[128:131]
    s_cmp_eq_u32 s40, 73728
    v_mfma_f32_16x16x32_bf16 v[132:135], v[176:179], v[216:219], v[132:135]
    v_mfma_f32_16x16x32_bf16 v[132:135], v[200:203], v[228:231], v[132:135]
    s_cselect_b32 s40, 0, s40
    v_mfma_f32_16x16x32_bf16 v[148:151], v[180:183], v[208:211], v[148:151]
    v_mfma_f32_16x16x32_bf16 v[148:151], v[204:207], v[220:223], v[148:151]
    v_add_u32 v5, s40, v10
    v_mfma_f32_16x16x32_bf16 v[152:155], v[180:183], v[212:215], v[152:155]
    v_mfma_f32_16x16x32_bf16 v[152:155], v[204:207], v[224:227], v[152:155]
    v_add_u32 v6, s40, v11
    s_waitcnt vmcnt(5)
    v_mfma_f32_16x16x32_bf16 v[156:159], v[180:183], v[216:219], v[156:159]
    v_mfma_f32_16x16x32_bf16 v[156:159], v[204:207], v[228:231], v[156:159]
    s_barrier
    s_setprio 0
    s_mov_b32 m0, s34
    ds_read_b128 v[208:211], v4 offset:0
    ds_read_b128 v[212:215], v4 offset:1024
    ds_read_b128 v[216:219], v4 offset:2048
    ds_read_b128 v[220:223], v4 offset:3072
    ds_read_b128 v[224:227], v4 offset:4096
    ds_read_b128 v[228:231], v4 offset:5120
    buffer_load_dwordx4 v254, s[8:11], s33 offen offset:0 lds
    ds_read_b64_tr_b16 v[160:161], v5 offset:0
    ds_read_b64_tr_b16 v[162:163], v6 offset:0
    ds_read_b64_tr_b16 v[184:185], v5 offset:12288
    ds_read_b64_tr_b16 v[186:187], v6 offset:12288
    ds_read_b64_tr_b16 v[164:165], v5 offset:1024
    ds_read_b64_tr_b16 v[166:167], v6 offset:1024
    buffer_load_dwordx4 v254, s[8:11], s33 offen offset:1024 lds
    ds_read_b64_tr_b16 v[188:189], v5 offset:13312
    ds_read_b64_tr_b16 v[190:191], v6 offset:13312
    ds_read_b64_tr_b16 v[168:169], v5 offset:2048
    ds_read_b64_tr_b16 v[170:171], v6 offset:2048
    ds_read_b64_tr_b16 v[192:193], v5 offset:14336
    ds_read_b64_tr_b16 v[194:195], v6 offset:14336
    buffer_load_dwordx4 v254, s[8:11], s33 offen offset:2048 lds
    ds_read_b64_tr_b16 v[172:173], v5 offset:3072
    ds_read_b64_tr_b16 v[174:175], v6 offset:3072
    ds_read_b64_tr_b16 v[196:197], v5 offset:15360
    ds_read_b64_tr_b16 v[198:199], v6 offset:15360
    ds_read_b64_tr_b16 v[176:177], v5 offset:4096
    ds_read_b64_tr_b16 v[178:179], v6 offset:4096
    buffer_load_dwordx4 v254, s[8:11], s33 offen offset:3072 lds
    s_mov_b32 m0, s46
    ds_read_b64_tr_b16 v[200:201], v5 offset:16384
    ds_read_b64_tr_b16 v[202:203], v6 offset:16384
    ds_read_b64_tr_b16 v[180:181], v5 offset:5120
    ds_read_b64_tr_b16 v[182:183], v6 offset:5120
    ds_read_b64_tr_b16 v[204:205], v5 offset:17408
    ds_read_b64_tr_b16 v[206:207], v6 offset:17408
    buffer_load_dwordx4 v254, s[8:11], s45 offen offset:0 lds
    s_waitcnt lgkmcnt(15)
    s_setprio 1
    v_mfma_f32_16x16x32_bf16 v[16:19], v[160:163], v[208:211], v[16:19]
    v_mfma_f32_16x16x32_bf16 v[16:19], v[184:187], v[220:223], v[16:19]
    s_add_u32 s34, s34, 24576
    v_mfma_f32_16x16x32_bf16 v[20:23], v[160:163], v[212:215], v[20:23]
    v_mfma_f32_16x16x32_bf16 v[20:23], v[184:187], v[224:227], v[20:23]
    s_cmp_eq_u32 s34, s36
    v_mfma_f32_16x16x32_bf16 v[24:27], v[160:163], v[216:219], v[24:27]
    v_mfma_f32_16x16x32_bf16 v[24:27], v[184:187], v[228:231], v[24:27]
    s_cselect_b32 s34, s35, s34
    v_mfma_f32_16x16x32_bf16 v[40:43], v[164:167], v[208:211], v[40:43]
    v_mfma_f32_16x16x32_bf16 v[40:43], v[188:191], v[220:223], v[40:43]
    s_sub_u32 s33, s33, 24576
    v_mfma_f32_16x16x32_bf16 v[44:47], v[164:167], v[212:215], v[44:47]
    v_mfma_f32_16x16x32_bf16 v[44:47], v[188:191], v[224:227], v[44:47]
    s_cselect_b32 s44, 1179648, 0
    v_mfma_f32_16x16x32_bf16 v[48:51], v[164:167], v[216:219], v[48:51]
    v_mfma_f32_16x16x32_bf16 v[48:51], v[188:191], v[228:231], v[48:51]
    s_add_u32 s33, s33, s44
    s_waitcnt lgkmcnt(12)
    v_mfma_f32_16x16x32_bf16 v[64:67], v[168:171], v[208:211], v[64:67]
    v_mfma_f32_16x16x32_bf16 v[64:67], v[192:195], v[220:223], v[64:67]
    s_add_u32 s45, s33, 4096
    v_mfma_f32_16x16x32_bf16 v[68:71], v[168:171], v[212:215], v[68:71]
    v_mfma_f32_16x16x32_bf16 v[68:71], v[192:195], v[224:227], v[68:71]
    s_add_u32 s46, s34, 4096
    v_mfma_f32_16x16x32_bf16 v[72:75], v[168:171], v[216:219], v[72:75]
    v_mfma_f32_16x16x32_bf16 v[72:75], v[192:195], v[228:231], v[72:75]
    s_add_u32 s39, s39, 24576
    s_waitcnt lgkmcnt(8)
    v_mfma_f32_16x16x32_bf16 v[88:91], v[172:175], v[208:211], v[88:91]
    v_mfma_f32_16x16x32_bf16 v[88:91], v[196:199], v[220:223], v[88:91]
    s_cmp_eq_u32 s39, 73728
    v_mfma_f32_16x16x32_bf16 v[92:95], v[172:175], v[212:215], v[92:95]
    v_mfma_f32_16x16x32_bf16 v[92:95], v[196:199], v[224:227], v[92:95]
    s_cselect_b32 s39, 0, s39
    v_mfma_f32_16x16x32_bf16 v[96:99], v[172:175], v[216:219], v[96:99]
    v_mfma_f32_16x16x32_bf16 v[96:99], v[196:199], v[228:231], v[96:99]
    v_add_u32 v4, s39, v9
    s_waitcnt lgkmcnt(4)
    v_mfma_f32_16x16x32_bf16 v[112:115], v[176:179], v[208:211], v[112:115]
    v_mfma_f32_16x16x32_bf16 v[112:115], v[200:203], v[220:223], v[112:115]
    s_sub_u32 s37, s43, 0
    v_mfma_f32_16x16x32_bf16 v[116:119], v[176:179], v[212:215], v[116:119]
    v_mfma_f32_16x16x32_bf16 v[116:119], v[200:203], v[224:227], v[116:119]
    s_sub_u32 s43, s43, 1
    v_mfma_f32_16x16x32_bf16 v[120:123], v[176:179], v[216:219], v[120:123]
    v_mfma_f32_16x16x32_bf16 v[120:123], v[200:203], v[228:231], v[120:123]
    s_waitcnt lgkmcnt(0)
    v_mfma_f32_16x16x32_bf16 v[136:139], v[180:183], v[208:211], v[136:139]
    v_mfma_f32_16x16x32_bf16 v[136:139], v[204:207], v[220:223], v[136:139]
    v_mfma_f32_16x16x32_bf16 v[140:143], v[180:183], v[212:215], v[140:143]
    v_mfma_f32_16x16x32_bf16 v[140:143], v[204:207], v[224:227], v[140:143]
    s_waitcnt vmcnt(5)
    v_mfma_f32_16x16x32_bf16 v[144:147], v[180:183], v[216:219], v[144:147]
    v_mfma_f32_16x16x32_bf16 v[144:147], v[204:207], v[228:231], v[144:147]
    s_barrier
    s_setprio 0
    s_cmp_lt_u32 s37, 6
    s_cbranch_scc0 K3_wl3_xr
    ds_read2_b32 v[240:241], v7 offset0:0 offset1:3
    ds_read2_b32 v[242:243], v7 offset0:6 offset1:9
    ds_read2_b32 v[244:245], v7 offset0:1 offset1:4
    ds_read2_b32 v[246:247], v7 offset0:7 offset1:10
    ds_read2_b32 v[248:249], v7 offset0:2 offset1:5
    ds_read2_b32 v[250:251], v7 offset0:8 offset1:11
K3_wl3_xr:
    s_mov_b32 m0, s34
    ds_read_b128 v[208:211], v4 offset:0
    buffer_load_dwordx4 v254, s[8:11], s33 offen offset:0 lds
    ds_read_b128 v[212:215], v4 offset:1024
    buffer_load_dwordx4 v254, s[8:11], s33 offen offset:1024 lds
    ds_read_b128 v[216:219], v4 offset:2048
    buffer_load_dwordx4 v254, s[8:11], s33 offen offset:2048 lds
    ds_read_b128 v[220:223], v4 offset:3072
    buffer_load_dwordx4 v254, s[8:11], s33 offen offset:3072 lds
    s_mov_b32 m0, s46
    ds_read_b128 v[224:227], v4 offset:4096
    buffer_load_dwordx4 v254, s[8:11], s45 offen offset:0 lds
    ds_read_b128 v[228:231], v4 offset:5120
    s_cmp_lt_u32 s37, 6
    s_cbranch_scc0 K3_wl3_xn
    s_cmp_lg_u32 s37, 0
    s_cbranch_scc1 K3_wl3_x1
    s_waitcnt lgkmcnt(0)
    s_setprio 1
    v_mfma_f32_16x16x32_bf16 v[16:19], v[240:243], v[232:235], v[16:19]
    v_mfma_f32_16x16x32_bf16 v[20:23], v[240:243], v[236:239], v[20:23]
    v_mfma_f32_16x16x32_bf16 v[24:27], v[244:247], v[232:235], v[24:27]
    v_mfma_f32_16x16x32_bf16 v[28:31], v[244:247], v[236:239], v[28:31]
    v_mfma_f32_16x16x32_bf16 v[32:35], v[248:251], v[232:235], v[32:35]
    v_mfma_f32_16x16x32_bf16 v[36:39], v[248:251], v[236:239], v[36:39]
    s_branch K3_wl3_xd
K3_wl3_x1:
    s_cmp_lg_u32 s37, 1
    s_cbranch_scc1 K3_wl3_x2
    s_waitcnt lgkmcnt(0)
    s_setprio 1
    v_mfma_f32_16x16x32_bf16 v[40:43], v[240:243], v[232:235], v[40:43]
    v_mfma_f32_16x16x32_bf16 v[44:47], v[240:243], v[236:239], v[44:47]
    v_mfma_f32_16x16x32_bf16 v[48:51], v[244:247], v[232:235], v[48:51]
    v_mfma_f32_16x16x32_bf16 v[52:55], v[244:247], v[236:239], v[52:55]
    v_mfma_f32_16x16x32_bf16 v[56:59], v[248:251], v[232:235], v[56:59]
    v_mfma_f32_16x16x32_bf16 v[60:63], v[248:251], v[236:239], v[60:63]
    s_branch K3_wl3_xd
K3_wl3_x2:
    s_cmp_lg_u32 s37, 2
    s_cbranch_scc1 K3_wl3_x3
    s_waitcnt lgkmcnt(0)
    s_setprio 1
    v_mfma_f32_16x16x32_bf16 v[64:67], v[240:243], v[232:235], v[64:67]
    v_mfma_f32_16x16x32_bf16 v[68:71], v[240:243], v[236:239], v[68:71]
    v_mfma_f32_16x16x32_bf16 v[72:75], v[244:247], v[232:235], v[72:75]
    v_mfma_f32_16x16x32_bf16 v[76:79], v[244:247], v[236:239], v[76:79]
    v_mfma_f32_16x16x32_bf16 v[80:83], v[248:251], v[232:235], v[80:83]
    v_mfma_f32_16x16x32_bf16 v[84:87], v[248:251], v[236:239], v[84:87]
    s_branch K3_wl3_xd
K3_wl3_x3:
    s_cmp_lg_u32 s37, 3
    s_cbranch_scc1 K3_wl3_x4
    s_waitcnt lgkmcnt(0)
    s_setprio 1
    v_mfma_f32_16x16x32_bf16 v[88:91], v[240:243], v[232:235], v[88:91]
    v_mfma_f32_16x16x32_bf16 v[92:95], v[240:243], v[236:239], v[92:95]
    v_mfma_f32_16x16x32_bf16 v[96:99], v[244:247], v[232:235], v[96:99]
    v_mfma_f32_16x16x32_bf16 v[100:103], v[244:247], v[236:239], v[100:103]
    v_mfma_f32_16x16x32_bf16 v[104:107], v[248:251], v[232:235], v[104:107]
    v_mfma_f32_16x16x32_bf16 v[108:111], v[248:251], v[236:239], v[108:111]
    s_branch K3_wl3_xd
K3_wl3_x4:
    s_cmp_lg_u32 s37, 4
    s_cbranch_scc1 K3_wl3_x5
    s_waitcnt lgkmcnt(0)
    s_setprio 1
    v_mfma_f32_16x16x32_bf16 v[112:115], v[240:243], v[232:235], v[112:115]
    v_mfma_f32_16x16x32_bf16 v[116:119], v[240:243], v[236:239], v[116:119]
    v_mfma_f32_16x16x32_bf16 v[120:123], v[244:247], v[232:235], v[120:123]
    v_mfma_f32_16x16x32_bf16 v[124:127], v[244:247], v[236:239], v[124:127]
    v_mfma_f32_16x16x32_bf16 v[128:131], v[248:251], v[232:235], v[128:131]
    v_mfma_f32_16x16x32_bf16 v[132:135], v[248:251], v[236:239], v[132:135]
    s_branch K3_wl3_xd
K3_wl3_x5:
    s_waitcnt lgkmcnt(0)
    s_setprio 1
    v_mfma_f32_16x16x32_bf16 v[136:139], v[240:243], v[232:235], v[136:139]
    v_mfma_f32_16x16x32_bf16 v[140:143], v[240:243], v[236:239], v[140:143]
    v_mfma_f32_16x16x32_bf16 v[144:147], v[244:247], v[232:235], v[144:147]
    v_mfma_f32_16x16x32_bf16 v[148:151], v[244:247], v[236:239], v[148:151]
    v_mfma_f32_16x16x32_bf16 v[152:155], v[248:251], v[232:235], v[152:155]
    v_mfma_f32_16x16x32_bf16 v[156:159], v[248:251], v[236:239], v[156:159]
    s_branch K3_wl3_xd
K3_wl3_xn:
    s_waitcnt lgkmcnt(0)
    s_setprio 1
K3_wl3_xd:
    v_mfma_f32_16x16x32_bf16 v[28:31], v[160:163], v[208:211], v[28:31]
    v_mfma_f32_16x16x32_bf16 v[28:31], v[184:187], v[220:223], v[28:31]
    s_add_u32 s34, s34, 24576
    v_mfma_f32_16x16x32_bf16 v[32:35], v[160:163], v[212:215], v[32:35]
    v_mfma_f32_16x16x32_bf16 v[32:35], v[184:187], v[224:227], v[32:35]
    s_cmp_eq_u32 s34, s36
    v_mfma_f32_16x16x32_bf16 v[36:39], v[160:163], v[216:219], v[36:39]
    v_mfma_f32_16x16x32_bf16 v[36:39], v[184:187], v[228:231], v[36:39]
    s_cselect_b32 s34, s35, s34
    v_mfma_f32_16x16x32_bf16 v[52:55], v[164:167], v[208:211], v[52:55]
    v_mfma_f32_16x16x32_bf16 v[52:55], v[188:191], v[220:223], v[52:55]
    s_sub_u32 s33, s33, 24576
    v_mfma_f32_16x16x32_bf16 v[56:59], v[164:167], v[212:215], v[56:59]
    v_mfma_f32_16x16x32_bf16 v[56:59], v[188:191], v[224:227], v[56:59]
    s_cselect_b32 s44, 1179648, 0
    v_mfma_f32_16x16x32_bf16 v[60:63], v[164:167], v[216:219], v[60:63]
    v_mfma_f32_16x16x32_bf16 v[60:63], v[188:191], v[228:231], v[60:63]
    s_add_u32 s33, s33, s44
    v_mfma_f32_16x16x32_bf16 v[76:79], v[168:171], v[208:211], v[76:79]
    v_mfma_f32_16x16x32_bf16 v[76:79], v[192:195], v[220:223], v[76:79]
    s_add_u32 s45, s33, 4096
    v_mfma_f32_16x16x32_bf16 v[80:83], v[168:171], v[212:215], v[80:83]
    v_mfma_f32_16x16x32_bf16 v[80:83], v[192:195], v[224:227], v[80:83]
    s_add_u32 s46, s34, 4096
    v_mfma_f32_16x16x32_bf16 v[84:87], v[168:171], v[216:219], v[84:87]
    v_mfma_f32_16x16x32_bf16 v[84:87], v[192:195], v[228:231], v[84:87]
    s_add_u32 s39, s39, 24576
    v_mfma_f32_16x16x32_bf16 v[100:103], v[172:175], v[208:211], v[100:103]
    v_mfma_f32_16x16x32_bf16 v[100:103], v[196:199], v[220:223], v[100:103]
    s_cmp_eq_u32 s39, 73728
    v_mfma_f32_16x16x32_bf16 v[104:107], v[172:175], v[212:215], v[104:107]
    v_mfma_f32_16x16x32_bf16 v[104:107], v[196:199], v[224:227], v[104:107]
    s_cselect_b32 s39, 0, s39
    v_mfma_f32_16x16x32_bf16 v[108:111], v[172:175], v[216:219], v[108:111]
    v_mfma_f32_16x16x32_bf16 v[108:111], v[196:199], v[228:231], v[108:111]
    v_add_u32 v4, s39, v9
    v_mfma_f32_16x16x32_bf16 v[124:127], v[176:179], v[208:211], v[124:127]
    v_mfma_f32_16x16x32_bf16 v[124:127], v[200:203], v[220:223], v[124:127]
    s_add_u32 s40, s40, 24576
    v_mfma_f32_16x16x32_bf16 v[128:131], v[176:179], v[212:215], v[128:131]
    v_mfma_f32_16x16x32_bf16 v[128:131], v[200:203], v[224:227], v[128:131]
    s_cmp_eq_u32 s40, 73728
    v_mfma_f32_16x16x32_bf16 v[132:135], v[176:179], v[216:219], v[132:135]
    v_mfma_f32_16x16x32_bf16 v[132:135], v[200:203], v[228:231], v[132:135]
    s_cselect_b32 s40, 0, s40
    v_mfma_f32_16x16x32_bf16 v[148:151], v[180:183], v[208:211], v[148:151]
    v_mfma_f32_16x16x32_bf16 v[148:151], v[204:207], v[220:223], v[148:151]
    v_add_u32 v5, s40, v10
    v_mfma_f32_16x16x32_bf16 v[152:155], v[180:183], v[212:215], v[152:155]
    v_mfma_f32_16x16x32_bf16 v[152:155], v[204:207], v[224:227], v[152:155]
    v_add_u32 v6, s40, v11
    s_waitcnt vmcnt(5)
    v_mfma_f32_16x16x32_bf16 v[156:159], v[180:183], v[216:219], v[156:159]
    v_mfma_f32_16x16x32_bf16 v[156:159], v[204:207], v[228:231], v[156:159]
    s_barrier
    s_setprio 0
    s_cmp_lg_u32 s43, -1
    s_cbranch_scc1 K3_w_loop
    s_add_u32 s41, s41, 48
    s_cmp_lg_u32 s41, 144
    s_cbranch_scc1 K3_w_tile
    s_branch K3_fin
K3_h_tile:
    s_mov_b32 s43, 11
    s_mov_b32 m0, s34
    ds_read_b128 v[208:211], v4 offset:0
    ds_read_b128 v[212:215], v4 offset:1024
    ds_read_b128 v[216:219], v4 offset:2048
    ds_read_b128 v[220:223], v4 offset:3072
    ds_read_b128 v[224:227], v4 offset:4096
    buffer_load_dwordx4 v254, s[8:11], s33 offen offset:0 nt lds
    ds_read_b128 v[228:231], v4 offset:5120
    ds_read_b64_tr_b16 v[160:161], v5 offset:0
    ds_read_b64_tr_b16 v[162:163], v6 offset:0
    ds_read_b64_tr_b16 v[184:185], v5 offset:12288
    ds_read_b64_tr_b16 v[186:187], v6 offset:12288
    buffer_load_dwordx4 v254, s[8:11], s33 offen offset:1024 nt lds
    ds_read_b64_tr_b16 v[164:165], v5 offset:1024
    ds_read_b64_tr_b16 v[166:167], v6 offset:1024
    ds_read_b64_tr_b16 v[188:189], v5 offset:13312
    ds_read_b64_tr_b16 v[190:191], v6 offset:13312
    ds_read_b64_tr_b16 v[168:169], v5 offset:2048
    buffer_load_dwordx4 v254, s[8:11], s33 offen offset:2048 nt lds
    ds_read_b64_tr_b16 v[170:171], v6 offset:2048
    ds_read_b64_tr_b16 v[192:193], v5 offset:14336
    ds_read_b64_tr_b16 v[194:195], v6 offset:14336
    ds_read_b64_tr_b16 v[172:173], v5 offset:3072
    ds_read_b64_tr_b16 v[174:175], v6 offset:3072
    buffer_load_dwordx4 v254, s[8:11], s33 offen offset:3072 nt lds
    s_mov_b32 m0, s46
    ds_read_b64_tr_b16 v[196:197], v5 offset:15360
    ds_read_b64_tr_b16 v[198:199], v6 offset:15360
    ds_read_b64_tr_b16 v[176:177], v5 offset:4096
    ds_read_b64_tr_b16 v[178:179], v6 offset:4096
    ds_read_b64_tr_b16 v[200:201], v5 offset:16384
    buffer_load_dwordx4 v254, s[8:11], s45 offen offset:0 nt lds
    ds_read_b64_tr_b16 v[202:203], v6 offset:16384
    ds_read_b64_tr_b16 v[180:181], v5 offset:5120
    ds_read_b64_tr_b16 v[182:183], v6 offset:5120
    ds_read_b64_tr_b16 v[204:205], v5 offset:17408
    ds_read_b64_tr_b16 v[206:207], v6 offset:17408
    buffer_load_dwordx4 v254, s[8:11], s45 offen offset:1024 nt lds
    s_cmp_eq_u32 s41, 0
    s_cbranch_scc1 K3_h_noep
    s_nop 7
    s_mov_b32 s38, s42
    v_cvt_pk_bf16_f32 v240, v16, v20
    v_cvt_pk_bf16_f32 v241, v24, v28
    v_cvt_pk_bf16_f32 v242, v32, v36
    buffer_store_dwordx3 v[240:242], v8, s[12:15], s38 offen offset:0
    v_cvt_pk_bf16_f32 v244, v17, v21
    v_cvt_pk_bf16_f32 v245, v25, v29
    v_cvt_pk_bf16_f32 v246, v33, v37
    buffer_store_dwordx3 v[244:246], v8, s[12:15], s38 offen offset:768
    v_cvt_pk_bf16_f32 v248, v18, v22
    v_cvt_pk_bf16_f32 v249, v26, v30
    v_cvt_pk_bf16_f32 v250, v34, v38
    buffer_store_dwordx3 v[248:250], v8, s[12:15], s38 offen offset:1536
    v_cvt_pk_bf16_f32 v240, v19, v23
    v_cvt_pk_bf16_f32 v241, v27, v31
    v_cvt_pk_bf16_f32 v242, v35, v39
    buffer_store_dwordx3 v[240:242], v8, s[12:15], s38 offen offset:2304
    s_add_u32 s38, s38, 12288
    v_cvt_pk_bf16_f32 v244, v40, v44
    v_cvt_pk_bf16_f32 v245, v48, v52
    v_cvt_pk_bf16_f32 v246, v56, v60
    buffer_store_dwordx3 v[244:246], v8, s[12:15], s38 offen offset:0
    v_cvt_pk_bf16_f32 v248, v41, v45
    v_cvt_pk_bf16_f32 v249, v49, v53
    v_cvt_pk_bf16_f32 v250, v57, v61
    buffer_store_dwordx3 v[248:250], v8, s[12:15], s38 offen offset:768
    v_cvt_pk_bf16_f32 v240, v42, v46
    v_cvt_pk_bf16_f32 v241, v50, v54
    v_cvt_pk_bf16_f32 v242, v58, v62
    buffer_store_dwordx3 v[240:242], v8, s[12:15], s38 offen offset:1536
    v_cvt_pk_bf16_f32 v244, v43, v47
    v_cvt_pk_bf16_f32 v245, v51, v55
    v_cvt_pk_bf16_f32 v246, v59, v63
    buffer_store_dwordx3 v[244:246], v8, s[12:15], s38 offen offset:2304
    s_add_u32 s38, s38, 12288
    v_cvt_pk_bf16_f32 v248, v64, v68
    v_cvt_pk_bf16_f32 v249, v72, v76
    v_cvt_pk_bf16_f32 v250, v80, v84
    buffer_store_dwordx3 v[248:250], v8, s[12:15], s38 offen offset:0
    v_cvt_pk_bf16_f32 v240, v65, v69
    v_cvt_pk_bf16_f32 v241, v73, v77
    v_cvt_pk_bf16_f32 v242, v81, v85
    buffer_store_dwordx3 v[240:242], v8, s[12:15], s38 offen offset:768
    v_cvt_pk_bf16_f32 v244, v66, v70
    v_cvt_pk_bf16_f32 v245, v74, v78
    v_cvt_pk_bf16_f32 v246, v82, v86
    buffer_store_dwordx3 v[244:246], v8, s[12:15], s38 offen offset:1536
    v_cvt_pk_bf16_f32 v248, v67, v71
    v_cvt_pk_bf16_f32 v249, v75, v79
    v_cvt_pk_bf16_f32 v250, v83, v87
    buffer_store_dwordx3 v[248:250], v8, s[12:15], s38 offen offset:2304
    s_add_u32 s38, s38, 12288
    v_cvt_pk_bf16_f32 v240, v88, v92
    v_cvt_pk_bf16_f32 v241, v96, v100
    v_cvt_pk_bf16_f32 v242, v104, v108
    buffer_store_dwordx3 v[240:242], v8, s[12:15], s38 offen offset:0
    v_cvt_pk_bf16_f32 v244, v89, v93
    v_cvt_pk_bf16_f32 v245, v97, v101
    v_cvt_pk_bf16_f32 v246, v105, v109
    buffer_store_dwordx3 v[244:246], v8, s[12:15], s38 offen offset:768
    v_cvt_pk_bf16_f32 v248, v90, v94
    v_cvt_pk_bf16_f32 v249, v98, v102
    v_cvt_pk_bf16_f32 v250, v106, v110
    buffer_store_dwordx3 v[248:250], v8, s[12:15], s38 offen offset:1536
    v_cvt_pk_bf16_f32 v240, v91, v95
    v_cvt_pk_bf16_f32 v241, v99, v103
    v_cvt_pk_bf16_f32 v242, v107, v111
    buffer_store_dwordx3 v[240:242], v8, s[12:15], s38 offen offset:2304
    s_add_u32 s38, s38, 12288
    v_cvt_pk_bf16_f32 v244, v112, v116
    v_cvt_pk_bf16_f32 v245, v120, v124
    v_cvt_pk_bf16_f32 v246, v128, v132
    buffer_store_dwordx3 v[244:246], v8, s[12:15], s38 offen offset:0
    v_cvt_pk_bf16_f32 v248, v113, v117
    v_cvt_pk_bf16_f32 v249, v121, v125
    v_cvt_pk_bf16_f32 v250, v129, v133
    buffer_store_dwordx3 v[248:250], v8, s[12:15], s38 offen offset:768
    v_cvt_pk_bf16_f32 v240, v114, v118
    v_cvt_pk_bf16_f32 v241, v122, v126
    v_cvt_pk_bf16_f32 v242, v130, v134
    buffer_store_dwordx3 v[240:242], v8, s[12:15], s38 offen offset:1536
    v_cvt_pk_bf16_f32 v244, v115, v119
    v_cvt_pk_bf16_f32 v245, v123, v127
    v_cvt_pk_bf16_f32 v246, v131, v135
    buffer_store_dwordx3 v[244:246], v8, s[12:15], s38 offen offset:2304
    s_add_u32 s38, s38, 12288
    v_cvt_pk_bf16_f32 v248, v136, v140
    v_cvt_pk_bf16_f32 v249, v144, v148
    v_cvt_pk_bf16_f32 v250, v152, v156
    buffer_store_dwordx3 v[248:250], v8, s[12:15], s38 offen offset:0
    v_cvt_pk_bf16_f32 v240, v137, v141
    v_cvt_pk_bf16_f32 v241, v145, v149
    v_cvt_pk_bf16_f32 v242, v153, v157
    buffer_store_dwordx3 v[240:242], v8, s[12:15], s38 offen offset:768
    v_cvt_pk_bf16_f32 v244, v138, v142
    v_cvt_pk_bf16_f32 v245, v146, v150
    v_cvt_pk_bf16_f32 v246, v154, v158
    buffer_store_dwordx3 v[244:246], v8, s[12:15], s38 offen offset:1536
    v_cvt_pk_bf16_f32 v248, v139, v143
    v_cvt_pk_bf16_f32 v249, v147, v151
    v_cvt_pk_bf16_f32 v250, v155, v159
    buffer_store_dwordx3 v[248:250], v8, s[12:15], s38 offen offset:2304
    s_sub_u32 s42, s42, 147456
K3_h_noep:
    s_nop 1
    v_mov_b32 v240, v12
    v_mov_b32 v241, v12
    v_mov_b32 v242, v12
    v_mov_b32 v243, v12
    v_mov_b32 v244, v13
    v_mov_b32 v245, v13
    v_mov_b32 v246, v13
    v_mov_b32 v247, v13
    v_mov_b32 v248, v14
    v_mov_b32 v249, v14
    v_mov_b32 v250, v14
    v_mov_b32 v251, v14
    s_waitcnt lgkmcnt(0)
    s_setprio 2
    s_barrier
    v_mfma_f32_16x16x32_bf16 v[16:19], v[160:163], v[208:211], v[240:243]
    v_mfma_f32_16x16x32_bf16 v[16:19], v[184:187], v[220:223], v[16:19]
    s_add_u32 s34, s34, 12288
    v_mfma_f32_16x16x32_bf16 v[20:23], v[160:163], v[212:215], v[244:247]
    v_mfma_f32_16x16x32_bf16 v[20:23], v[184:187], v[224:227], v[20:23]
    s_cmp_eq_u32 s34, s36
    v_mfma_f32_16x16x32_bf16 v[24:27], v[160:163], v[216:219], v[248:251]
    v_mfma_f32_16x16x32_bf16 v[24:27], v[184:187], v[228:231], v[24:27]
    s_cselect_b32 s34, s35, s34
    v_mfma_f32_16x16x32_bf16 v[40:43], v[164:167], v[208:211], v[240:243]
    v_mfma_f32_16x16x32_bf16 v[40:43], v[188:191], v[220:223], v[40:43]
    s_sub_u32 s33, s33, 12288
    v_mfma_f32_16x16x32_bf16 v[44:47], v[164:167], v[212:215], v[244:247]
    v_mfma_f32_16x16x32_bf16 v[44:47], v[188:191], v[224:227], v[44:47]
    s_cselect_b32 s10, 0, s10
    v_mfma_f32_16x16x32_bf16 v[48:51], v[164:167], v[216:219], v[248:251]
    v_mfma_f32_16x16x32_bf16 v[48:51], v[188:191], v[228:231], v[48:51]
    s_cselect_b32 s33, 0, s33
    v_mfma_f32_16x16x32_bf16 v[64:67], v[168:171], v[208:211], v[240:243]
    v_mfma_f32_16x16x32_bf16 v[64:67], v[192:195], v[220:223], v[64:67]
    s_add_u32 s45, s33, 4096
    v_mfma_f32_16x16x32_bf16 v[68:71], v[168:171], v[212:215], v[244:247]
    v_mfma_f32_16x16x32_bf16 v[68:71], v[192:195], v[224:227], v[68:71]
    s_add_u32 s46, s34, 4096
    v_mfma_f32_16x16x32_bf16 v[72:75], v[168:171], v[216:219], v[248:251]
    v_mfma_f32_16x16x32_bf16 v[72:75], v[192:195], v[228:231], v[72:75]
    s_add_u32 s39, s39, 24576
    v_mfma_f32_16x16x32_bf16 v[88:91], v[172:175], v[208:211], v[240:243]
    v_mfma_f32_16x16x32_bf16 v[88:91], v[196:199], v[220:223], v[88:91]
    s_cmp_eq_u32 s39, 73728
    v_mfma_f32_16x16x32_bf16 v[92:95], v[172:175], v[212:215], v[244:247]
    v_mfma_f32_16x16x32_bf16 v[92:95], v[196:199], v[224:227], v[92:95]
    s_cselect_b32 s39, 0, s39
    v_mfma_f32_16x16x32_bf16 v[96:99], v[172:175], v[216:219], v[248:251]
    v_mfma_f32_16x16x32_bf16 v[96:99], v[196:199], v[228:231], v[96:99]
    v_add_u32 v4, s39, v9
    v_mfma_f32_16x16x32_bf16 v[112:115], v[176:179], v[208:211], v[240:243]
    v_mfma_f32_16x16x32_bf16 v[112:115], v[200:203], v[220:223], v[112:115]
    v_mfma_f32_16x16x32_bf16 v[116:119], v[176:179], v[212:215], v[244:247]
    v_mfma_f32_16x16x32_bf16 v[116:119], v[200:203], v[224:227], v[116:119]
    v_mfma_f32_16x16x32_bf16 v[120:123], v[176:179], v[216:219], v[248:251]
    v_mfma_f32_16x16x32_bf16 v[120:123], v[200:203], v[228:231], v[120:123]
    v_mfma_f32_16x16x32_bf16 v[136:139], v[180:183], v[208:211], v[240:243]
    v_mfma_f32_16x16x32_bf16 v[136:139], v[204:207], v[220:223], v[136:139]
    v_mfma_f32_16x16x32_bf16 v[140:143], v[180:183], v[212:215], v[244:247]
    v_mfma_f32_16x16x32_bf16 v[140:143], v[204:207], v[224:227], v[140:143]
    v_mfma_f32_16x16x32_bf16 v[144:147], v[180:183], v[216:219], v[248:251]
    v_mfma_f32_16x16x32_bf16 v[144:147], v[204:207], v[228:231], v[144:147]
    s_setprio 0
    s_mov_b32 m0, s34
    ds_read_b128 v[208:211], v4 offset:0
    buffer_load_dwordx4 v254, s[8:11], s33 offen offset:0 nt lds
    ds_read_b128 v[212:215], v4 offset:1024
    buffer_load_dwordx4 v254, s[8:11], s33 offen offset:1024 nt lds
    ds_read_b128 v[216:219], v4 offset:2048
    buffer_load_dwordx4 v254, s[8:11], s33 offen offset:2048 nt lds
    ds_read_b128 v[220:223], v4 offset:3072
    buffer_load_dwordx4 v254, s[8:11], s33 offen offset:3072 nt lds
    s_mov_b32 m0, s46
    ds_read_b128 v[224:227], v4 offset:4096
    buffer_load_dwordx4 v254, s[8:11], s45 offen offset:0 nt lds
    ds_read_b128 v[228:231], v4 offset:5120
    buffer_load_dwordx4 v254, s[8:11], s45 offen offset:1024 nt lds
    s_nop 1
    v_mov_b32 v240, v15
    v_mov_b32 v241, v15
    v_mov_b32 v242, v15
    v_mov_b32 v243, v15
    v_mov_b32 v244, v252
    v_mov_b32 v245, v252
    v_mov_b32 v246, v252
    v_mov_b32 v247, v252
    v_mov_b32 v248, v253
    v_mov_b32 v249, v253
    v_mov_b32 v250, v253
    v_mov_b32 v251, v253
    s_waitcnt vmcnt(42)
    s_cmp_lg_u32 s41, 0
    s_cbranch_scc1 K3_vhf1
    s_waitcnt vmcnt(18)
K3_vhf1:
    s_waitcnt lgkmcnt(0)
    s_setprio 2
    s_barrier
    v_mfma_f32_16x16x32_bf16 v[28:31], v[160:163], v[208:211], v[240:243]
    v_mfma_f32_16x16x32_bf16 v[28:31], v[184:187], v[220:223], v[28:31]
    s_add_u32 s34, s34, 12288
    v_mfma_f32_16x16x32_bf16 v[32:35], v[160:163], v[212:215], v[244:247]
    v_mfma_f32_16x16x32_bf16 v[32:35], v[184:187], v[224:227], v[32:35]
    s_cmp_eq_u32 s34, s36
    v_mfma_f32_16x16x32_bf16 v[36:39], v[160:163], v[216:219], v[248:251]
    v_mfma_f32_16x16x32_bf16 v[36:39], v[184:187], v[228:231], v[36:39]
    s_cselect_b32 s34, s35, s34
    v_mfma_f32_16x16x32_bf16 v[52:55], v[164:167], v[208:211], v[240:243]
    v_mfma_f32_16x16x32_bf16 v[52:55], v[188:191], v[220:223], v[52:55]
    s_sub_u32 s33, s33, 12288
    v_mfma_f32_16x16x32_bf16 v[56:59], v[164:167], v[212:215], v[244:247]
    v_mfma_f32_16x16x32_bf16 v[56:59], v[188:191], v[224:227], v[56:59]
    s_cselect_b32 s10, 0, s10
    v_mfma_f32_16x16x32_bf16 v[60:63], v[164:167], v[216:219], v[248:251]
    v_mfma_f32_16x16x32_bf16 v[60:63], v[188:191], v[228:231], v[60:63]
    s_cselect_b32 s33, 0, s33
    v_mfma_f32_16x16x32_bf16 v[76:79], v[168:171], v[208:211], v[240:243]
    v_mfma_f32_16x16x32_bf16 v[76:79], v[192:195], v[220:223], v[76:79]
    s_add_u32 s45, s33, 4096
    v_mfma_f32_16x16x32_bf16 v[80:83], v[168:171], v[212:215], v[244:247]
    v_mfma_f32_16x16x32_bf16 v[80:83], v[192:195], v[224:227], v[80:83]
    s_add_u32 s46, s34, 4096
    v_mfma_f32_16x16x32_bf16 v[84:87], v[168:171], v[216:219], v[248:251]
    v_mfma_f32_16x16x32_bf16 v[84:87], v[192:195], v[228:231], v[84:87]
    s_add_u32 s39, s39, 24576
    v_mfma_f32_16x16x32_bf16 v[100:103], v[172:175], v[208:211], v[240:243]
    v_mfma_f32_16x16x32_bf16 v[100:103], v[196:199], v[220:223], v[100:103]
    s_cmp_eq_u32 s39, 73728
    v_mfma_f32_16x16x32_bf16 v[104:107], v[172:175], v[212:215], v[244:247]
    v_mfma_f32_16x16x32_bf16 v[104:107], v[196:199], v[224:227], v[104:107]
    s_cselect_b32 s39, 0, s39
    v_mfma_f32_16x16x32_bf16 v[108:111], v[172:175], v[216:219], v[248:251]
    v_mfma_f32_16x16x32_bf16 v[108:111], v[196:199], v[228:231], v[108:111]
    v_add_u32 v4, s39, v9
    v_mfma_f32_16x16x32_bf16 v[124:127], v[176:179], v[208:211], v[240:243]
    v_mfma_f32_16x16x32_bf16 v[124:127], v[200:203], v[220:223], v[124:127]
    s_add_u32 s40, s40, 24576
    v_mfma_f32_16x16x32_bf16 v[128:131], v[176:179], v[212:215], v[244:247]
    v_mfma_f32_16x16x32_bf16 v[128:131], v[200:203], v[224:227], v[128:131]
    s_cmp_eq_u32 s40, 73728
    v_mfma_f32_16x16x32_bf16 v[132:135], v[176:179], v[216:219], v[248:251]
    v_mfma_f32_16x16x32_bf16 v[132:135], v[200:203], v[228:231], v[132:135]
    s_cselect_b32 s40, 0, s40
    v_mfma_f32_16x16x32_bf16 v[148:151], v[180:183], v[208:211], v[240:243]
    v_mfma_f32_16x16x32_bf16 v[148:151], v[204:207], v[220:223], v[148:151]
    v_add_u32 v5, s40, v10
    v_mfma_f32_16x16x32_bf16 v[152:155], v[180:183], v[212:215], v[244:247]
    v_mfma_f32_16x16x32_bf16 v[152:155], v[204:207], v[224:227], v[152:155]
    v_add_u32 v6, s40, v11
    v_mfma_f32_16x16x32_bf16 v[156:159], v[180:183], v[216:219], v[248:251]
    v_mfma_f32_16x16x32_bf16 v[156:159], v[204:207], v[228:231], v[156:159]
    s_setprio 0
    s_mov_b32 m0, s34
    ds_read_b128 v[208:211], v4 offset:0
    ds_read_b128 v[212:215], v4 offset:1024
    ds_read_b128 v[216:219], v4 offset:2048
    ds_read_b128 v[220:223], v4 offset:3072
    ds_read_b128 v[224:227], v4 offset:4096
    buffer_load_dwordx4 v254, s[8:11], s33 offen offset:0 nt lds
    ds_read_b128 v[228:231], v4 offset:5120
    ds_read_b64_tr_b16 v[160:161], v5 offset:0
    ds_read_b64_tr_b16 v[162:163], v6 offset:0
    ds_read_b64_tr_b16 v[184:185], v5 offset:12288
    ds_read_b64_tr_b16 v[186:187], v6 offset:12288
    buffer_load_dwordx4 v254, s[8:11], s33 offen offset:1024 nt lds
    ds_read_b64_tr_b16 v[164:165], v5 offset:1024
    ds_read_b64_tr_b16 v[166:167], v6 offset:1024
    ds_read_b64_tr_b16 v[188:189], v5 offset:13312
    ds_read_b64_tr_b16 v[190:191], v6 offset:13312
    ds_read_b64_tr_b16 v[168:169], v5 offset:2048
    buffer_load_dwordx4 v254, s[8:11], s33 offen offset:2048 nt lds
    ds_read_b64_tr_b16 v[170:171], v6 offset:2048
    ds_read_b64_tr_b16 v[192:193], v5 offset:14336
    ds_read_b64_tr_b16 v[194:195], v6 offset:14336
    ds_read_b64_tr_b16 v[172:173], v5 offset:3072
    ds_read_b64_tr_b16 v[174:175], v6 offset:3072
    buffer_load_dwordx4 v254, s[8:11], s33 offen offset:3072 nt lds
    s_mov_b32 m0, s46
    ds_read_b64_tr_b16 v[196:197], v5 offset:15360
    ds_read_b64_tr_b16 v[198:199], v6 offset:15360
    ds_read_b64_tr_b16 v[176:177], v5 offset:4096
    ds_read_b64_tr_b16 v[178:179], v6 offset:4096
    ds_read_b64_tr_b16 v[200:201], v5 offset:16384
    buffer_load_dwordx4 v254, s[8:11], s45 offen offset:0 nt lds
    ds_read_b64_tr_b16 v[202:203], v6 offset:16384
    ds_read_b64_tr_b16 v[180:181], v5 offset:5120
    ds_read_b64_tr_b16 v[182:183], v6 offset:5120
    ds_read_b64_tr_b16 v[204:205], v5 offset:17408
    ds_read_b64_tr_b16 v[206:207], v6 offset:17408
    buffer_load_dwordx4 v254, s[8:11], s45 offen offset:1024 nt lds
    s_waitcnt lgkmcnt(0)
    s_setprio 2
    s_barrier
    v_mfma_f32_16x16x32_bf16 v[16:19], v[160:163], v[208:211], v[16:19]
    v_mfma_f32_16x16x32_bf16 v[16:19], v[184:187], v[220:223], v[16:19]
    s_add_u32 s34, s34, 12288
    v_mfma_f32_16x16x32_bf16 v[20:23], v[160:163], v[212:215], v[20:23]
    v_mfma_f32_16x16x32_bf16 v[20:23], v[184:187], v[224:227], v[20:23]
    s_cmp_eq_u32 s34, s36
    v_mfma_f32_16x16x32_bf16 v[24:27], v[160:163], v[216:219], v[24:27]
    v_mfma_f32_16x16x32_bf16 v[24:27], v[184:187], v[228:231], v[24:27]
    s_cselect_b32 s34, s35, s34
    v_mfma_f32_16x16x32_bf16 v[40:43], v[164:167], v[208:211], v[40:43]
    v_mfma_f32_16x16x32_bf16 v[40:43], v[188:191], v[220:223], v[40:43]
    s_sub_u32 s33, s33, 12288
    v_mfma_f32_16x16x32_bf16 v[44:47], v[164:167], v[212:215], v[44:47]
    v_mfma_f32_16x16x32_bf16 v[44:47], v[188:191], v[224:227], v[44:47]
    s_cselect_b32 s10, 0, s10
    v_mfma_f32_16x16x32_bf16 v[48:51], v[164:167], v[216:219], v[48:51]
    v_mfma_f32_16x16x32_bf16 v[48:51], v[188:191], v[228:231], v[48:51]
    s_cselect_b32 s33, 0, s33
    v_mfma_f32_16x16x32_bf16 v[64:67], v[168:171], v[208:211], v[64:67]
    v_mfma_f32_16x16x32_bf16 v[64:67], v[192:195], v[220:223], v[64:67]
    s_add_u32 s45, s33, 4096
    v_mfma_f32_16x16x32_bf16 v[68:71], v[168:171], v[212:215], v[68:71]
    v_mfma_f32_16x16x32_bf16 v[68:71], v[192:195], v[224:227], v[68:71]
    s_add_u32 s46, s34, 4096
    v_mfma_f32_16x16x32_bf16 v[72:75], v[168:171], v[216:219], v[72:75]
    v_mfma_f32_16x16x32_bf16 v[72:75], v[192:195], v[228:231], v[72:75]
    s_add_u32 s39, s39, 24576
    v_mfma_f32_16x16x32_bf16 v[88:91], v[172:175], v[208:211], v[88:91]
    v_mfma_f32_16x16x32_bf16 v[88:91], v[196:199], v[220:223], v[88:91]
    s_cmp_eq_u32 s39, 73728
    v_mfma_f32_16x16x32_bf16 v[92:95], v[172:175], v[212:215], v[92:95]
    v_mfma_f32_16x16x32_bf16 v[92:95], v[196:199], v[224:227], v[92:95]
    s_cselect_b32 s39, 0, s39
    v_mfma_f32_16x16x32_bf16 v[96:99], v[172:175], v[216:219], v[96:99]
    v_mfma_f32_16x16x32_bf16 v[96:99], v[196:199], v[228:231], v[96:99]
    v_add_u32 v4, s39, v9
    v_mfma_f32_16x16x32_bf16 v[112:115], v[176:179], v[208:211], v[112:115]
    v_mfma_f32_16x16x32_bf16 v[112:115], v[200:203], v[220:223], v[112:115]
    s_sub_u32 s37, s43, 6
    v_mfma_f32_16x16x32_bf16 v[116:119], v[176:179], v[212:215], v[116:119]
    v_mfma_f32_16x16x32_bf16 v[116:119], v[200:203], v[224:227], v[116:119]
    s_sub_u32 s43, s43, 1
    v_mfma_f32_16x16x32_bf16 v[120:123], v[176:179], v[216:219], v[120:123]
    v_mfma_f32_16x16x32_bf16 v[120:123], v[200:203], v[228:231], v[120:123]
    v_mfma_f32_16x16x32_bf16 v[136:139], v[180:183], v[208:211], v[136:139]
    v_mfma_f32_16x16x32_bf16 v[136:139], v[204:207], v[220:223], v[136:139]
    v_mfma_f32_16x16x32_bf16 v[140:143], v[180:183], v[212:215], v[140:143]
    v_mfma_f32_16x16x32_bf16 v[140:143], v[204:207], v[224:227], v[140:143]
    v_mfma_f32_16x16x32_bf16 v[144:147], v[180:183], v[216:219], v[144:147]
    v_mfma_f32_16x16x32_bf16 v[144:147], v[204:207], v[228:231], v[144:147]
    s_setprio 0
    s_cmp_lt_u32 s37, 6
    s_cbranch_scc0 K3_hf3_xr
    ds_read2_b32 v[240:241], v7 offset0:0 offset1:3
    ds_read2_b32 v[242:243], v7 offset0:6 offset1:9
    ds_read2_b32 v[244:245], v7 offset0:1 offset1:4
    ds_read2_b32 v[246:247], v7 offset0:7 offset1:10
    ds_read2_b32 v[248:249], v7 offset0:2 offset1:5
    ds_read2_b32 v[250:251], v7 offset0:8 offset1:11
K3_hf3_xr:
    s_mov_b32 m0, s34
    ds_read_b128 v[208:211], v4 offset:0
    buffer_load_dwordx4 v254, s[8:11], s33 offen offset:0 nt lds
    ds_read_b128 v[212:215], v4 offset:1024
    buffer_load_dwordx4 v254, s[8:11], s33 offen offset:1024 nt lds
    ds_read_b128 v[216:219], v4 offset:2048
    buffer_load_dwordx4 v254, s[8:11], s33 offen offset:2048 nt lds
    ds_read_b128 v[220:223], v4 offset:3072
    buffer_load_dwordx4 v254, s[8:11], s33 offen offset:3072 nt lds
    s_mov_b32 m0, s46
    ds_read_b128 v[224:227], v4 offset:4096
    buffer_load_dwordx4 v254, s[8:11], s45 offen offset:0 nt lds
    ds_read_b128 v[228:231], v4 offset:5120
    buffer_load_dwordx4 v254, s[8:11], s45 offen offset:1024 nt lds
    s_cmp_lt_u32 s37, 6
    s_cbranch_scc0 K3_hf3_xn
    s_cmp_lg_u32 s37, 0
    s_cbranch_scc1 K3_hf3_x1
    s_waitcnt vmcnt(42)
    s_cmp_lg_u32 s41, 0
    s_cbranch_scc1 K3_vhf30
    s_waitcnt vmcnt(18)
K3_vhf30:
    s_waitcnt lgkmcnt(0)
    s_setprio 2
    s_barrier
    v_mfma_f32_16x16x32_bf16 v[16:19], v[240:243], v[232:235], v[16:19]
    v_mfma_f32_16x16x32_bf16 v[20:23], v[240:243], v[236:239], v[20:23]
    v_mfma_f32_16x16x32_bf16 v[24:27], v[244:247], v[232:235], v[24:27]
    v_mfma_f32_16x16x32_bf16 v[28:31], v[244:247], v[236:239], v[28:31]
    v_mfma_f32_16x16x32_bf16 v[32:35], v[248:251], v[232:235], v[32:35]
    v_mfma_f32_16x16x32_bf16 v[36:39], v[248:251], v[236:239], v[36:39]
    s_branch K3_hf3_xd
K3_hf3_x1:
    s_cmp_lg_u32 s37, 1
    s_cbranch_scc1 K3_hf3_x2
    s_waitcnt vmcnt(42)
    s_cmp_lg_u32 s41, 0
    s_cbranch_scc1 K3_vhf31
    s_waitcnt vmcnt(18)
K3_vhf31:
    s_waitcnt lgkmcnt(0)
    s_setprio 2
    s_barrier
    v_mfma_f32_16x16x32_bf16 v[40:43], v[240:243], v[232:235], v[40:43]
    v_mfma_f32_16x16x32_bf16 v[44:47], v[240:243], v[236:239], v[44:47]
    v_mfma_f32_16x16x32_bf16 v[48:51], v[244:247], v[232:235], v[48:51]
    v_mfma_f32_16x16x32_bf16 v[52:55], v[244:247], v[236:239], v[52:55]
    v_mfma_f32_16x16x32_bf16 v[56:59], v[248:251], v[232:235], v[56:59]
    v_mfma_f32_16x16x32_bf16 v[60:63], v[248:251], v[236:239], v[60:63]
    s_branch K3_hf3_xd
K3_hf3_x2:
    s_cmp_lg_u32 s37, 2
    s_cbranch_scc1 K3_hf3_x3
    s_waitcnt vmcnt(42)
    s_cmp_lg_u32 s41, 0
    s_cbranch_scc1 K3_vhf32
    s_waitcnt vmcnt(18)
K3_vhf32:
    s_waitcnt lgkmcnt(0)
    s_setprio 2
    s_barrier
    v_mfma_f32_16x16x32_bf16 v[64:67], v[240:243], v[232:235], v[64:67]
    v_mfma_f32_16x16x32_bf16 v[68:71], v[240:243], v[236:239], v[68:71]
    v_mfma_f32_16x16x32_bf16 v[72:75], v[244:247], v[232:235], v[72:75]
    v_mfma_f32_16x16x32_bf16 v[76:79], v[244:247], v[236:239], v[76:79]
    v_mfma_f32_16x16x32_bf16 v[80:83], v[248:251], v[232:235], v[80:83]
    v_mfma_f32_16x16x32_bf16 v[84:87], v[248:251], v[236:239], v[84:87]
    s_branch K3_hf3_xd
K3_hf3_x3:
    s_cmp_lg_u32 s37, 3
    s_cbranch_scc1 K3_hf3_x4
    s_waitcnt vmcnt(42)
    s_cmp_lg_u32 s41, 0
    s_cbranch_scc1 K3_vhf33
    s_waitcnt vmcnt(18)
K3_vhf33:
    s_waitcnt lgkmcnt(0)
    s_setprio 2
    s_barrier
    v_mfma_f32_16x16x32_bf16 v[88:91], v[240:243], v[232:235], v[88:91]
    v_mfma_f32_16x16x32_bf16 v[92:95], v[240:243], v[236:239], v[92:95]
    v_mfma_f32_16x16x32_bf16 v[96:99], v[244:247], v[232:235], v[96:99]
    v_mfma_f32_16x16x32_bf16 v[100:103], v[244:247], v[236:239], v[100:103]
    v_mfma_f32_16x16x32_bf16 v[104:107], v[248:251], v[232:235], v[104:107]
    v_mfma_f32_16x16x32_bf16 v[108:111], v[248:251], v[236:239], v[108:111]
    s_branch K3_hf3_xd
K3_hf3_x4:
    s_cmp_lg_u32 s37, 4
    s_cbranch_scc1 K3_hf3_x5
    s_waitcnt vmcnt(42)
    s_cmp_lg_u32 s41, 0
    s_cbranch_scc1 K3_vhf34
    s_waitcnt vmcnt(18)
K3_vhf34:
    s_waitcnt lgkmcnt(0)
    s_setprio 2
    s_barrier
    v_mfma_f32_16x16x32_bf16 v[112:115], v[240:243], v[232:235], v[112:115]
    v_mfma_f32_16x16x32_bf16 v[116:119], v[240:243], v[236:239], v[116:119]
    v_mfma_f32_16x16x32_bf16 v[120:123], v[244:247], v[232:235], v[120:123]
    v_mfma_f32_16x16x32_bf16 v[124:127], v[244:247], v[236:239], v[124:127]
    v_mfma_f32_16x16x32_bf16 v[128:131], v[248:251], v[232:235], v[128:131]
    v_mfma_f32_16x16x32_bf16 v[132:135], v[248:251], v[236:239], v[132:135]
    s_branch K3_hf3_xd
K3_hf3_x5:
    s_waitcnt vmcnt(42)
    s_cmp_lg_u32 s41, 0
    s_cbranch_scc1 K3_vhf35
    s_waitcnt vmcnt(18)
K3_vhf35:
    s_waitcnt lgkmcnt(0)
    s_setprio 2
    s_barrier
    v_mfma_f32_16x16x32_bf16 v[136:139], v[240:243], v[232:235], v[136:139]
    v_mfma_f32_16x16x32_bf16 v[140:143], v[240:243], v[236:239], v[140:143]
    v_mfma_f32_16x16x32_bf16 v[144:147], v[244:247], v[232:235], v[144:147]
    v_mfma_f32_16x16x32_bf16 v[148:151], v[244:247], v[236:239], v[148:151]
    v_mfma_f32_16x16x32_bf16 v[152:155], v[248:251], v[232:235], v[152:155]
    v_mfma_f32_16x16x32_bf16 v[156:159], v[248:251], v[236:239], v[156:159]
    s_branch K3_hf3_xd
K3_hf3_xn:
    s_waitcnt vmcnt(42)
    s_cmp_lg_u32 s41, 0
    s_cbranch_scc1 K3_vhf3
    s_waitcnt vmcnt(18)
K3_vhf3:
    s_waitcnt lgkmcnt(0)
    s_setprio 2
    s_barrier
K3_hf3_xd:
    v_mfma_f32_16x16x32_bf16 v[28:31], v[160:163], v[208:211], v[28:31]
    v_mfma_f32_16x16x32_bf16 v[28:31], v[184:187], v[220:223], v[28:31]
    s_add_u32 s34, s34, 12288
    v_mfma_f32_16x16x32_bf16 v[32:35], v[160:163], v[212:215], v[32:35]
    v_mfma_f32_16x16x32_bf16 v[32:35], v[184:187], v[224:227], v[32:35]
    s_cmp_eq_u32 s34, s36
    v_mfma_f32_16x16x32_bf16 v[36:39], v[160:163], v[216:219], v[36:39]
    v_mfma_f32_16x16x32_bf16 v[36:39], v[184:187], v[228:231], v[36:39]
    s_cselect_b32 s34, s35, s34
    v_mfma_f32_16x16x32_bf16 v[52:55], v[164:167], v[208:211], v[52:55]
    v_mfma_f32_16x16x32_bf16 v[52:55], v[188:191], v[220:223], v[52:55]
    s_sub_u32 s33, s33, 12288
    v_mfma_f32_16x16x32_bf16 v[56:59], v[164:167], v[212:215], v[56:59]
    v_mfma_f32_16x16x32_bf16 v[56:59], v[188:191], v[224:227], v[56:59]
    s_cselect_b32 s10, 0, s10
    v_mfma_f32_16x16x32_bf16 v[60:63], v[164:167], v[216:219], v[60:63]
    v_mfma_f32_16x16x32_bf16 v[60:63], v[188:191], v[228:231], v[60:63]
    s_cselect_b32 s33, 0, s33
    v_mfma_f32_16x16x32_bf16 v[76:79], v[168:171], v[208:211], v[76:79]
    v_mfma_f32_16x16x32_bf16 v[76:79], v[192:195], v[220:223], v[76:79]
    s_add_u32 s45, s33, 4096
    v_mfma_f32_16x16x32_bf16 v[80:83], v[168:171], v[212:215], v[80:83]
    v_mfma_f32_16x16x32_bf16 v[80:83], v[192:195], v[224:227], v[80:83]
    s_add_u32 s46, s34, 4096
    v_mfma_f32_16x16x32_bf16 v[84:87], v[168:171], v[216:219], v[84:87]
    v_mfma_f32_16x16x32_bf16 v[84:87], v[192:195], v[228:231], v[84:87]
    s_add_u32 s39, s39, 24576
    v_mfma_f32_16x16x32_bf16 v[100:103], v[172:175], v[208:211], v[100:103]
    v_mfma_f32_16x16x32_bf16 v[100:103], v[196:199], v[220:223], v[100:103]
    s_cmp_eq_u32 s39, 73728
    v_mfma_f32_16x16x32_bf16 v[104:107], v[172:175], v[212:215], v[104:107]
    v_mfma_f32_16x16x32_bf16 v[104:107], v[196:199], v[224:227], v[104:107]
    s_cselect_b32 s39, 0, s39
    v_mfma_f32_16x16x32_bf16 v[108:111], v[172:175], v[216:219], v[108:111]
    v_mfma_f32_16x16x32_bf16 v[108:111], v[196:199], v[228:231], v[108:111]
    v_add_u32 v4, s39, v9
    v_mfma_f32_16x16x32_bf16 v[124:127], v[176:179], v[208:211], v[124:127]
    v_mfma_f32_16x16x32_bf16 v[124:127], v[200:203], v[220:223], v[124:127]
    s_add_u32 s40, s40, 24576
    v_mfma_f32_16x16x32_bf16 v[128:131], v[176:179], v[212:215], v[128:131]
    v_mfma_f32_16x16x32_bf16 v[128:131], v[200:203], v[224:227], v[128:131]
    s_cmp_eq_u32 s40, 73728
    v_mfma_f32_16x16x32_bf16 v[132:135], v[176:179], v[216:219], v[132:135]
    v_mfma_f32_16x16x32_bf16 v[132:135], v[200:203], v[228:231], v[132:135]
    s_cselect_b32 s40, 0, s40
    v_mfma_f32_16x16x32_bf16 v[148:151], v[180:183], v[208:211], v[148:151]
    v_mfma_f32_16x16x32_bf16 v[148:151], v[204:207], v[220:223], v[148:151]
    v_add_u32 v5, s40, v10
    v_mfma_f32_16x16x32_bf16 v[152:155], v[180:183], v[212:215], v[152:155]
    v_mfma_f32_16x16x32_bf16 v[152:155], v[204:207], v[224:227], v[152:155]
    v_add_u32 v6, s40, v11
    v_mfma_f32_16x16x32_bf16 v[156:159], v[180:183], v[216:219], v[156:159]
    v_mfma_f32_16x16x32_bf16 v[156:159], v[204:207], v[228:231], v[156:159]
    s_setprio 0
.p2align 6
K3_h_loop:
    s_mov_b32 m0, s34
    ds_read_b128 v[208:211], v4 offset:0
    ds_read_b128 v[212:215], v4 offset:1024
    ds_read_b128 v[216:219], v4 offset:2048
    ds_read_b128 v[220:223], v4 offset:3072
    ds_read_b128 v[224:227], v4 offset:4096
    buffer_load_dwordx4 v254, s[8:11], s33 offen offset:0 nt lds
    ds_read_b128 v[228:231], v4 offset:5120
    ds_read_b64_tr_b16 v[160:161], v5 offset:0
    ds_read_b64_tr_b16 v[162:163], v6 offset:0
    ds_read_b64_tr_b16 v[184:185], v5 offset:12288
    ds_read_b64_tr_b16 v[186:187], v6 offset:12288
    buffer_load_dwordx4 v254, s[8:11], s33 offen offset:1024 nt lds
    ds_read_b64_tr_b16 v[164:165], v5 offset:1024
    ds_read_b64_tr_b16 v[166:167], v6 offset:1024
    ds_read_b64_tr_b16 v[188:189], v5 offset:13312
    ds_read_b64_tr_b16 v[190:191], v6 offset:13312
    ds_read_b64_tr_b16 v[168:169], v5 offset:2048
    buffer_load_dwordx4 v254, s[8:11], s33 offen offset:2048 nt lds
    ds_read_b64_tr_b16 v[170:171], v6 offset:2048
    ds_read_b64_tr_b16 v[192:193], v5 offset:14336
    ds_read_b64_tr_b16 v[194:195], v6 offset:14336
    ds_read_b64_tr_b16 v[172:173], v5 offset:3072
    ds_read_b64_tr_b16 v[174:175], v6 offset:3072
    buffer_load_dwordx4 v254, s[8:11], s33 offen offset:3072 nt lds
    s_mov_b32 m0, s46
    ds_read_b64_tr_b16 v[196:197], v5 offset:15360
    ds_read_b64_tr_b16 v[198:199], v6 offset:15360
    ds_read_b64_tr_b16 v[176:177], v5 offset:4096
    ds_read_b64_tr_b16 v[178:179], v6 offset:4096
    ds_read_b64_tr_b16 v[200:201], v5 offset:16384
    buffer_load_dwordx4 v254, s[8:11], s45 offen offset:0 nt lds
    ds_read_b64_tr_b16 v[202:203], v6 offset:16384
    ds_read_b64_tr_b16 v[180:181], v5 offset:5120
    ds_read_b64_tr_b16 v[182:183], v6 offset:5120
    ds_read_b64_tr_b16 v[204:205], v5 offset:17408
    ds_read_b64_tr_b16 v[206:207], v6 offset:17408
    buffer_load_dwordx4 v254, s[8:11], s45 offen offset:1024 nt lds
    s_waitcnt lgkmcnt(0)
    s_setprio 2
    s_barrier
    v_mfma_f32_16x16x32_bf16 v[16:19], v[160:163], v[208:211], v[16:19]
    v_mfma_f32_16x16x32_bf16 v[16:19], v[184:187], v[220:223], v[16:19]
    s_add_u32 s34, s34, 12288
    v_mfma_f32_16x16x32_bf16 v[20:23], v[160:163], v[212:215], v[20:23]
    v_mfma_f32_16x16x32_bf16 v[20:23], v[184:187], v[224:227], v[20:23]
    s_cmp_eq_u32 s34, s36
    v_mfma_f32_16x16x32_bf16 v[24:27], v[160:163], v[216:219], v[24:27]
    v_mfma_f32_16x16x32_bf16 v[24:27], v[184:187], v[228:231], v[24:27]
    s_cselect_b32 s34, s35, s34
    v_mfma_f32_16x16x32_bf16 v[40:43], v[164:167], v[208:211], v[40:43]
    v_mfma_f32_16x16x32_bf16 v[40:43], v[188:191], v[220:223], v[40:43]
    s_sub_u32 s33, s33, 12288
    v_mfma_f32_16x16x32_bf16 v[44:47], v[164:167], v[212:215], v[44:47]
    v_mfma_f32_16x16x32_bf16 v[44:47], v[188:191], v[224:227], v[44:47]
    s_cselect_b32 s10, 0, s10
    v_mfma_f32_16x16x32_bf16 v[48:51], v[164:167], v[216:219], v[48:51]
    v_mfma_f32_16x16x32_bf16 v[48:51], v[188:191], v[228:231], v[48:51]
    s_cselect_b32 s33, 0, s33
    v_mfma_f32_16x16x32_bf16 v[64:67], v[168:171], v[208:211], v[64:67]
    v_mfma_f32_16x16x32_bf16 v[64:67], v[192:195], v[220:223], v[64:67]
    s_add_u32 s45, s33, 4096
    v_mfma_f32_16x16x32_bf16 v[68:71], v[168:171], v[212:215], v[68:71]
    v_mfma_f32_16x16x32_bf16 v[68:71], v[192:195], v[224:227], v[68:71]
    s_add_u32 s46, s34, 4096
    v_mfma_f32_16x16x32_bf16 v[72:75], v[168:171], v[216:219], v[72:75]
    v_mfma_f32_16x16x32_bf16 v[72:75], v[192:195], v[228:231], v[72:75]
    s_add_u32 s39, s39, 24576
    v_mfma_f32_16x16x32_bf16 v[88:91], v[172:175], v[208:211], v[88:91]
    v_mfma_f32_16x16x32_bf16 v[88:91], v[196:199], v[220:223], v[88:91]
    s_cmp_eq_u32 s39, 73728
    v_mfma_f32_16x16x32_bf16 v[92:95], v[172:175], v[212:215], v[92:95]
    v_mfma_f32_16x16x32_bf16 v[92:95], v[196:199], v[224:227], v[92:95]
    s_cselect_b32 s39, 0, s39
    v_mfma_f32_16x16x32_bf16 v[96:99], v[172:175], v[216:219], v[96:99]
    v_mfma_f32_16x16x32_bf16 v[96:99], v[196:199], v[228:231], v[96:99]
    v_add_u32 v4, s39, v9
    v_mfma_f32_16x16x32_bf16 v[112:115], v[176:179], v[208:211], v[112:115]
    v_mfma_f32_16x16x32_bf16 v[112:115], v[200:203], v[220:223], v[112:115]
    v_mfma_f32_16x16x32_bf16 v[116:119], v[176:179], v[212:215], v[116:119]
    v_mfma_f32_16x16x32_bf16 v[116:119], v[200:203], v[224:227], v[116:119]
    v_mfma_f32_16x16x32_bf16 v[120:123], v[176:179], v[216:219], v[120:123]
    v_mfma_f32_16x16x32_bf16 v[120:123], v[200:203], v[228:231], v[120:123]
    v_mfma_f32_16x16x32_bf16 v[136:139], v[180:183], v[208:211], v[136:139]
    v_mfma_f32_16x16x32_bf16 v[136:139], v[204:207], v[220:223], v[136:139]
    v_mfma_f32_16x16x32_bf16 v[140:143], v[180:183], v[212:215], v[140:143]
    v_mfma_f32_16x16x32_bf16 v[140:143], v[204:207], v[224:227], v[140:143]
    v_mfma_f32_16x16x32_bf16 v[144:147], v[180:183], v[216:219], v[144:147]
    v_mfma_f32_16x16x32_bf16 v[144:147], v[204:207], v[228:231], v[144:147]
    s_setprio 0
    s_mov_b32 m0, s34
    ds_read_b128 v[208:211], v4 offset:0
    buffer_load_dwordx4 v254, s[8:11], s33 offen offset:0 nt lds
    ds_read_b128 v[212:215], v4 offset:1024
    buffer_load_dwordx4 v254, s[8:11], s33 offen offset:1024 nt lds
    ds_read_b128 v[216:219], v4 offset:2048
    buffer_load_dwordx4 v254, s[8:11], s33 offen offset:2048 nt lds
    ds_read_b128 v[220:223], v4 offset:3072
    buffer_load_dwordx4 v254, s[8:11], s33 offen offset:3072 nt lds
    s_mov_b32 m0, s46
    ds_read_b128 v[224:227], v4 offset:4096
    buffer_load_dwordx4 v254, s[8:11], s45 offen offset:0 nt lds
    ds_read_b128 v[228:231], v4 offset:5120
    buffer_load_dwordx4 v254, s[8:11], s45 offen offset:1024 nt lds
    s_waitcnt vmcnt(18)
    s_waitcnt lgkmcnt(0)
    s_setprio 2
    s_barrier
    v_mfma_f32_16x16x32_bf16 v[28:31], v[160:163], v[208:211], v[28:31]
    v_mfma_f32_16x16x32_bf16 v[28:31], v[184:187], v[220:223], v[28:31]
    s_add_u32 s34, s34, 12288
    v_mfma_f32_16x16x32_bf16 v[32:35], v[160:163], v[212:215], v[32:35]
    v_mfma_f32_16x16x32_bf16 v[32:35], v[184:187], v[224:227], v[32:35]
    s_cmp_eq_u32 s34, s36
    v_mfma_f32_16x16x32_bf16 v[36:39], v[160:163], v[216:219], v[36:39]
    v_mfma_f32_16x16x32_bf16 v[36:39], v[184:187], v[228:231], v[36:39]
    s_cselect_b32 s34, s35, s34
    v_mfma_f32_16x16x32_bf16 v[52:55], v[164:167], v[208:211], v[52:55]
    v_mfma_f32_16x16x32_bf16 v[52:55], v[188:191], v[220:223], v[52:55]
    s_sub_u32 s33, s33, 12288
    v_mfma_f32_16x16x32_bf16 v[56:59], v[164:167], v[212:215], v[56:59]
    v_mfma_f32_16x16x32_bf16 v[56:59], v[188:191], v[224:227], v[56:59]
    s_cselect_b32 s10, 0, s10
    v_mfma_f32_16x16x32_bf16 v[60:63], v[164:167], v[216:219], v[60:63]
    v_mfma_f32_16x16x32_bf16 v[60:63], v[188:191], v[228:231], v[60:63]
    s_cselect_b32 s33, 0, s33
    v_mfma_f32_16x16x32_bf16 v[76:79], v[168:171], v[208:211], v[76:79]
    v_mfma_f32_16x16x32_bf16 v[76:79], v[192:195], v[220:223], v[76:79]
    s_add_u32 s45, s33, 4096
    v_mfma_f32_16x16x32_bf16 v[80:83], v[168:171], v[212:215], v[80:83]
    v_mfma_f32_16x16x32_bf16 v[80:83], v[192:195], v[224:227], v[80:83]
    s_add_u32 s46, s34, 4096
    v_mfma_f32_16x16x32_bf16 v[84:87], v[168:171], v[216:219], v[84:87]
    v_mfma_f32_16x16x32_bf16 v[84:87], v[192:195], v[228:231], v[84:87]
    s_add_u32 s39, s39, 24576
    v_mfma_f32_16x16x32_bf16 v[100:103], v[172:175], v[208:211], v[100:103]
    v_mfma_f32_16x16x32_bf16 v[100:103], v[196:199], v[220:223], v[100:103]
    s_cmp_eq_u32 s39, 73728
    v_mfma_f32_16x16x32_bf16 v[104:107], v[172:175], v[212:215], v[104:107]
    v_mfma_f32_16x16x32_bf16 v[104:107], v[196:199], v[224:227], v[104:107]
    s_cselect_b32 s39, 0, s39
    v_mfma_f32_16x16x32_bf16 v[108:111], v[172:175], v[216:219], v[108:111]
    v_mfma_f32_16x16x32_bf16 v[108:111], v[196:199], v[228:231], v[108:111]
    v_add_u32 v4, s39, v9
    v_mfma_f32_16x16x32_bf16 v[124:127], v[176:179], v[208:211], v[124:127]
    v_mfma_f32_16x16x32_bf16 v[124:127], v[200:203], v[220:223], v[124:127]
    s_add_u32 s40, s40, 24576
    v_mfma_f32_16x16x32_bf16 v[128:131], v[176:179], v[212:215], v[128:131]
    v_mfma_f32_16x16x32_bf16 v[128:131], v[200:203], v[224:227], v[128:131]
    s_cmp_eq_u32 s40, 73728
    v_mfma_f32_16x16x32_bf16 v[132:135], v[176:179], v[216:219], v[132:135]
    v_mfma_f32_16x16x32_bf16 v[132:135], v[200:203], v[228:231], v[132:135]
    s_cselect_b32 s40, 0, s40
    v_mfma_f32_16x16x32_bf16 v[148:151], v[180:183], v[208:211], v[148:151]
    v_mfma_f32_16x16x32_bf16 v[148:151], v[204:207], v[220:223], v[148:151]
    v_add_u32 v5, s40, v10
    v_mfma_f32_16x16x32_bf16 v[152:155], v[180:183], v[212:215], v[152:155]
    v_mfma_f32_16x16x32_bf16 v[152:155], v[204:207], v[224:227], v[152:155]
    v_add_u32 v6, s40, v11
    v_mfma_f32_16x16x32_bf16 v[156:159], v[180:183], v[216:219], v[156:159]
    v_mfma_f32_16x16x32_bf16 v[156:159], v[204:207], v[228:231], v[156:159]
    s_setprio 0
    s_mov_b32 m0, s34
    ds_read_b128 v[208:211], v4 offset:0
    ds_read_b128 v[212:215], v4 offset:1024
    ds_read_b128 v[216:219], v4 offset:2048
    ds_read_b128 v[220:223], v4 offset:3072
    ds_read_b128 v[224:227], v4 offset:4096
    buffer_load_dwordx4 v254, s[8:11], s33 offen offset:0 nt lds
    ds_read_b128 v[228:231], v4 offset:5120
    ds_read_b64_tr_b16 v[160:161], v5 offset:0
    ds_read_b64_tr_b16 v[162:163], v6 offset:0
    ds_read_b64_tr_b16 v[184:185], v5 offset:12288
    ds_read_b64_tr_b16 v[186:187], v6 offset:12288
    buffer_load_dwordx4 v254, s[8:11], s33 offen offset:1024 nt lds
    ds_read_b64_tr_b16 v[164:165], v5 offset:1024
    ds_read_b64_tr_b16 v[166:167], v6 offset:1024
    ds_read_b64_tr_b16 v[188:189], v5 offset:13312
    ds_read_b64_tr_b16 v[190:191], v6 offset:13312
    ds_read_b64_tr_b16 v[168:169], v5 offset:2048
    buffer_load_dwordx4 v254, s[8:11], s33 offen offset:2048 nt lds
    ds_read_b64_tr_b16 v[170:171], v6 offset:2048
    ds_read_b64_tr_b16 v[192:193], v5 offset:14336
    ds_read_b64_tr_b16 v[194:195], v6 offset:14336
    ds_read_b64_tr_b16 v[172:173], v5 offset:3072
    ds_read_b64_tr_b16 v[174:175], v6 offset:3072
    buffer_load_dwordx4 v254, s[8:11], s33 offen offset:3072 nt lds
    s_mov_b32 m0, s46
    ds_read_b64_tr_b16 v[196:197], v5 offset:15360
    ds_read_b64_tr_b16 v[198:199], v6 offset:15360
    ds_read_b64_tr_b16 v[176:177], v5 offset:4096
    ds_read_b64_tr_b16 v[178:179], v6 offset:4096
    ds_read_b64_tr_b16 v[200:201], v5 offset:16384
    buffer_load_dwordx4 v254, s[8:11], s45 offen offset:0 nt lds
    ds_read_b64_tr_b16 v[202:203], v6 offset:16384
    ds_read_b64_tr_b16 v[180:181], v5 offset:5120
    ds_read_b64_tr_b16 v[182:183], v6 offset:5120
    ds_read_b64_tr_b16 v[204:205], v5 offset:17408
    ds_read_b64_tr_b16 v[206:207], v6 offset:17408
    buffer_load_dwordx4 v254, s[8:11], s45 offen offset:1024 nt lds
    s_waitcnt lgkmcnt(0)
    s_setprio 2
    s_barrier
    v_mfma_f32_16x16x32_bf16 v[16:19], v[160:163], v[208:211], v[16:19]
    v_mfma_f32_16x16x32_bf16 v[16:19], v[184:187], v[220:223], v[16:19]
    s_add_u32 s34, s34, 12288
    v_mfma_f32_16x16x32_bf16 v[20:23], v[160:163], v[212:215], v[20:23]
    v_mfma_f32_16x16x32_bf16 v[20:23], v[184:187], v[224:227], v[20:23]
    s_cmp_eq_u32 s34, s36
    v_mfma_f32_16x16x32_bf16 v[24:27], v[160:163], v[216:219], v[24:27]
    v_mfma_f32_16x16x32_bf16 v[24:27], v[184:187], v[228:231], v[24:27]
    s_cselect_b32 s34, s35, s34
    v_mfma_f32_16x16x32_bf16 v[40:43], v[164:167], v[208:211], v[40:43]
    v_mfma_f32_16x16x32_bf16 v[40:43], v[188:191], v[220:223], v[40:43]
    s_sub_u32 s33, s33, 12288
    v_mfma_f32_16x16x32_bf16 v[44:47], v[164:167], v[212:215], v[44:47]
    v_mfma_f32_16x16x32_bf16 v[44:47], v[188:191], v[224:227], v[44:47]
    s_cselect_b32 s10, 0, s10
    v_mfma_f32_16x16x32_bf16 v[48:51], v[164:167], v[216:219], v[48:51]
    v_mfma_f32_16x16x32_bf16 v[48:51], v[188:191], v[228:231], v[48:51]
    s_cselect_b32 s33, 0, s33
    v_mfma_f32_16x16x32_bf16 v[64:67], v[168:171], v[208:211], v[64:67]
    v_mfma_f32_16x16x32_bf16 v[64:67], v[192:195], v[220:223], v[64:67]
    s_add_u32 s45, s33, 4096
    v_mfma_f32_16x16x32_bf16 v[68:71], v[168:171], v[212:215], v[68:71]
    v_mfma_f32_16x16x32_bf16 v[68:71], v[192:195], v[224:227], v[68:71]
    s_add_u32 s46, s34, 4096
    v_mfma_f32_16x16x32_bf16 v[72:75], v[168:171], v[216:219], v[72:75]
    v_mfma_f32_16x16x32_bf16 v[72:75], v[192:195], v[228:231], v[72:75]
    s_add_u32 s39, s39, 24576
    v_mfma_f32_16x16x32_bf16 v[88:91], v[172:175], v[208:211], v[88:91]
    v_mfma_f32_16x16x32_bf16 v[88:91], v[196:199], v[220:223], v[88:91]
    s_cmp_eq_u32 s39, 73728
    v_mfma_f32_16x16x32_bf16 v[92:95], v[172:175], v[212:215], v[92:95]
    v_mfma_f32_16x16x32_bf16 v[92:95], v[196:199], v[224:227], v[92:95]
    s_cselect_b32 s39, 0, s39
    v_mfma_f32_16x16x32_bf16 v[96:99], v[172:175], v[216:219], v[96:99]
    v_mfma_f32_16x16x32_bf16 v[96:99], v[196:199], v[228:231], v[96:99]
    v_add_u32 v4, s39, v9
    v_mfma_f32_16x16x32_bf16 v[112:115], v[176:179], v[208:211], v[112:115]
    v_mfma_f32_16x16x32_bf16 v[112:115], v[200:203], v[220:223], v[112:115]
    s_sub_u32 s37, s43, 6
    v_mfma_f32_16x16x32_bf16 v[116:119], v[176:179], v[212:215], v[116:119]
    v_mfma_f32_16x16x32_bf16 v[116:119], v[200:203], v[224:227], v[116:119]
    s_sub_u32 s43, s43, 1
    v_mfma_f32_16x16x32_bf16 v[120:123], v[176:179], v[216:219], v[120:123]
    v_mfma_f32_16x16x32_bf16 v[120:123], v[200:203], v[228:231], v[120:123]
    v_mfma_f32_16x16x32_bf16 v[136:139], v[180:183], v[208:211], v[136:139]
    v_mfma_f32_16x16x32_bf16 v[136:139], v[204:207], v[220:223], v[136:139]
    v_mfma_f32_16x16x32_bf16 v[140:143], v[180:183], v[212:215], v[140:143]
    v_mfma_f32_16x16x32_bf16 v[140:143], v[204:207], v[224:227], v[140:143]
    v_mfma_f32_16x16x32_bf16 v[144:147], v[180:183], v[216:219], v[144:147]
    v_mfma_f32_16x16x32_bf16 v[144:147], v[204:207], v[228:231], v[144:147]
    s_setprio 0
    s_cmp_lt_u32 s37, 6
    s_cbranch_scc0 K3_hl3_xr
    ds_read2_b32 v[240:241], v7 offset0:0 offset1:3
    ds_read2_b32 v[242:243], v7 offset0:6 offset1:9
    ds_read2_b32 v[244:245], v7 offset0:1 offset1:4
    ds_read2_b32 v[246:247], v7 offset0:7 offset1:10
    ds_read2_b32 v[248:249], v7 offset0:2 offset1:5
    ds_read2_b32 v[250:251], v7 offset0:8 offset1:11
K3_hl3_xr:
    s_mov_b32 m0, s34
    ds_read_b128 v[208:211], v4 offset:0
    buffer_load_dwordx4 v254, s[8:11], s33 offen offset:0 nt lds
    ds_read_b128 v[212:215], v4 offset:1024
    buffer_load_dwordx4 v254, s[8:11], s33 offen offset:1024 nt lds
    ds_read_b128 v[216:219], v4 offset:2048
    buffer_load_dwordx4 v254, s[8:11], s33 offen offset:2048 nt lds
    ds_read_b128 v[220:223], v4 offset:3072
    buffer_load_dwordx4 v254, s[8:11], s33 offen offset:3072 nt lds
    s_mov_b32 m0, s46
    ds_read_b128 v[224:227], v4 offset:4096
    buffer_load_dwordx4 v254, s[8:11], s45 offen offset:0 nt lds
    ds_read_b128 v[228:231], v4 offset:5120
    buffer_load_dwordx4 v254, s[8:11], s45 offen offset:1024 nt lds
    s_cmp_lt_u32 s37, 6
    s_cbranch_scc0 K3_hl3_xn
    s_cmp_lg_u32 s37, 0
    s_cbranch_scc1 K3_hl3_x1
    s_waitcnt vmcnt(18)
    s_waitcnt lgkmcnt(0)
    s_setprio 2
    s_barrier
    v_mfma_f32_16x16x32_bf16 v[16:19], v[240:243], v[232:235], v[16:19]
    v_mfma_f32_16x16x32_bf16 v[20:23], v[240:243], v[236:239], v[20:23]
    v_mfma_f32_16x16x32_bf16 v[24:27], v[244:247], v[232:235], v[24:27]
    v_mfma_f32_16x16x32_bf16 v[28:31], v[244:247], v[236:239], v[28:31]
    v_mfma_f32_16x16x32_bf16 v[32:35], v[248:251], v[232:235], v[32:35]
    v_mfma_f32_16x16x32_bf16 v[36:39], v[248:251], v[236:239], v[36:39]
    s_branch K3_hl3_xd
K3_hl3_x1:
    s_cmp_lg_u32 s37, 1
    s_cbranch_scc1 K3_hl3_x2
    s_waitcnt vmcnt(18)
    s_waitcnt lgkmcnt(0)
    s_setprio 2
    s_barrier
    v_mfma_f32_16x16x32_bf16 v[40:43], v[240:243], v[232:235], v[40:43]
    v_mfma_f32_16x16x32_bf16 v[44:47], v[240:243], v[236:239], v[44:47]
    v_mfma_f32_16x16x32_bf16 v[48:51], v[244:247], v[232:235], v[48:51]
    v_mfma_f32_16x16x32_bf16 v[52:55], v[244:247], v[236:239], v[52:55]
    v_mfma_f32_16x16x32_bf16 v[56:59], v[248:251], v[232:235], v[56:59]
    v_mfma_f32_16x16x32_bf16 v[60:63], v[248:251], v[236:239], v[60:63]
    s_branch K3_hl3_xd
K3_hl3_x2:
    s_cmp_lg_u32 s37, 2
    s_cbranch_scc1 K3_hl3_x3
    s_waitcnt vmcnt(18)
    s_waitcnt lgkmcnt(0)
    s_setprio 2
    s_barrier
    v_mfma_f32_16x16x32_bf16 v[64:67], v[240:243], v[232:235], v[64:67]
    v_mfma_f32_16x16x32_bf16 v[68:71], v[240:243], v[236:239], v[68:71]
    v_mfma_f32_16x16x32_bf16 v[72:75], v[244:247], v[232:235], v[72:75]
    v_mfma_f32_16x16x32_bf16 v[76:79], v[244:247], v[236:239], v[76:79]
    v_mfma_f32_16x16x32_bf16 v[80:83], v[248:251], v[232:235], v[80:83]
    v_mfma_f32_16x16x32_bf16 v[84:87], v[248:251], v[236:239], v[84:87]
    s_branch K3_hl3_xd
K3_hl3_x3:
    s_cmp_lg_u32 s37, 3
    s_cbranch_scc1 K3_hl3_x4
    s_waitcnt vmcnt(18)
    s_waitcnt lgkmcnt(0)
    s_setprio 2
    s_barrier
    v_mfma_f32_16x16x32_bf16 v[88:91], v[240:243], v[232:235], v[88:91]
    v_mfma_f32_16x16x32_bf16 v[92:95], v[240:243], v[236:239], v[92:95]
    v_mfma_f32_16x16x32_bf16 v[96:99], v[244:247], v[232:235], v[96:99]
    v_mfma_f32_16x16x32_bf16 v[100:103], v[244:247], v[236:239], v[100:103]
    v_mfma_f32_16x16x32_bf16 v[104:107], v[248:251], v[232:235], v[104:107]
    v_mfma_f32_16x16x32_bf16 v[108:111], v[248:251], v[236:239], v[108:111]
    s_branch K3_hl3_xd
K3_hl3_x4:
    s_cmp_lg_u32 s37, 4
    s_cbranch_scc1 K3_hl3_x5
    s_waitcnt vmcnt(18)
    s_waitcnt lgkmcnt(0)
    s_setprio 2
    s_barrier
    v_mfma_f32_16x16x32_bf16 v[112:115], v[240:243], v[232:235], v[112:115]
    v_mfma_f32_16x16x32_bf16 v[116:119], v[240:243], v[236:239], v[116:119]
    v_mfma_f32_16x16x32_bf16 v[120:123], v[244:247], v[232:235], v[120:123]
    v_mfma_f32_16x16x32_bf16 v[124:127], v[244:247], v[236:239], v[124:127]
    v_mfma_f32_16x16x32_bf16 v[128:131], v[248:251], v[232:235], v[128:131]
    v_mfma_f32_16x16x32_bf16 v[132:135], v[248:251], v[236:239], v[132:135]
    s_branch K3_hl3_xd
K3_hl3_x5:
    s_waitcnt vmcnt(18)
    s_waitcnt lgkmcnt(0)
    s_setprio 2
    s_barrier
    v_mfma_f32_16x16x32_bf16 v[136:139], v[240:243], v[232:235], v[136:139]
    v_mfma_f32_16x16x32_bf16 v[140:143], v[240:243], v[236:239], v[140:143]
    v_mfma_f32_16x16x32_bf16 v[144:147], v[244:247], v[232:235], v[144:147]
    v_mfma_f32_16x16x32_bf16 v[148:151], v[244:247], v[236:239], v[148:151]
    v_mfma_f32_16x16x32_bf16 v[152:155], v[248:251], v[232:235], v[152:155]
    v_mfma_f32_16x16x32_bf16 v[156:159], v[248:251], v[236:239], v[156:159]
    s_branch K3_hl3_xd
K3_hl3_xn:
    s_waitcnt vmcnt(18)
    s_waitcnt lgkmcnt(0)
    s_setprio 2
    s_barrier
K3_hl3_xd:
    v_mfma_f32_16x16x32_bf16 v[28:31], v[160:163], v[208:211], v[28:31]
    v_mfma_f32_16x16x32_bf16 v[28:31], v[184:187], v[220:223], v[28:31]
    s_add_u32 s34, s34, 12288
    v_mfma_f32_16x16x32_bf16 v[32:35], v[160:163], v[212:215], v[32:35]
    v_mfma_f32_16x16x32_bf16 v[32:35], v[184:187], v[224:227], v[32:35]
    s_cmp_eq_u32 s34, s36
    v_mfma_f32_16x16x32_bf16 v[36:39], v[160:163], v[216:219], v[36:39]
    v_mfma_f32_16x16x32_bf16 v[36:39], v[184:187], v[228:231], v[36:39]
    s_cselect_b32 s34, s35, s34
    v_mfma_f32_16x16x32_bf16 v[52:55], v[164:167], v[208:211], v[52:55]
    v_mfma_f32_16x16x32_bf16 v[52:55], v[188:191], v[220:223], v[52:55]
    s_sub_u32 s33, s33, 12288
    v_mfma_f32_16x16x32_bf16 v[56:59], v[164:167], v[212:215], v[56:59]
    v_mfma_f32_16x16x32_bf16 v[56:59], v[188:191], v[224:227], v[56:59]
    s_cselect_b32 s10, 0, s10
    v_mfma_f32_16x16x32_bf16 v[60:63], v[164:167], v[216:219], v[60:63]
    v_mfma_f32_16x16x32_bf16 v[60:63], v[188:191], v[228:231], v[60:63]
    s_cselect_b32 s33, 0, s33
    v_mfma_f32_16x16x32_bf16 v[76:79], v[168:171], v[208:211], v[76:79]
    v_mfma_f32_16x16x32_bf16 v[76:79], v[192:195], v[220:223], v[76:79]
    s_add_u32 s45, s33, 4096
    v_mfma_f32_16x16x32_bf16 v[80:83], v[168:171], v[212:215], v[80:83]
    v_mfma_f32_16x16x32_bf16 v[80:83], v[192:195], v[224:227], v[80:83]
    s_add_u32 s46, s34, 4096
    v_mfma_f32_16x16x32_bf16 v[84:87], v[168:171], v[216:219], v[84:87]
    v_mfma_f32_16x16x32_bf16 v[84:87], v[192:195], v[228:231], v[84:87]
    s_add_u32 s39, s39, 24576
    v_mfma_f32_16x16x32_bf16 v[100:103], v[172:175], v[208:211], v[100:103]
    v_mfma_f32_16x16x32_bf16 v[100:103], v[196:199], v[220:223], v[100:103]
    s_cmp_eq_u32 s39, 73728
    v_mfma_f32_16x16x32_bf16 v[104:107], v[172:175], v[212:215], v[104:107]
    v_mfma_f32_16x16x32_bf16 v[104:107], v[196:199], v[224:227], v[104:107]
    s_cselect_b32 s39, 0, s39
    v_mfma_f32_16x16x32_bf16 v[108:111], v[172:175], v[216:219], v[108:111]
    v_mfma_f32_16x16x32_bf16 v[108:111], v[196:199], v[228:231], v[108:111]
    v_add_u32 v4, s39, v9
    v_mfma_f32_16x16x32_bf16 v[124:127], v[176:179], v[208:211], v[124:127]
    v_mfma_f32_16x16x32_bf16 v[124:127], v[200:203], v[220:223], v[124:127]
    s_add_u32 s40, s40, 24576
    v_mfma_f32_16x16x32_bf16 v[128:131], v[176:179], v[212:215], v[128:131]
    v_mfma_f32_16x16x32_bf16 v[128:131], v[200:203], v[224:227], v[128:131]
    s_cmp_eq_u32 s40, 73728
    v_mfma_f32_16x16x32_bf16 v[132:135], v[176:179], v[216:219], v[132:135]
    v_mfma_f32_16x16x32_bf16 v[132:135], v[200:203], v[228:231], v[132:135]
    s_cselect_b32 s40, 0, s40
    v_mfma_f32_16x16x32_bf16 v[148:151], v[180:183], v[208:211], v[148:151]
    v_mfma_f32_16x16x32_bf16 v[148:151], v[204:207], v[220:223], v[148:151]
    v_add_u32 v5, s40, v10
    v_mfma_f32_16x16x32_bf16 v[152:155], v[180:183], v[212:215], v[152:155]
    v_mfma_f32_16x16x32_bf16 v[152:155], v[204:207], v[224:227], v[152:155]
    v_add_u32 v6, s40, v11
    v_mfma_f32_16x16x32_bf16 v[156:159], v[180:183], v[216:219], v[156:159]
    v_mfma_f32_16x16x32_bf16 v[156:159], v[204:207], v[228:231], v[156:159]
    s_setprio 0
    s_cmp_lg_u32 s43, -1
    s_cbranch_scc1 K3_h_loop
    s_add_u32 s41, s41, 48
    s_cmp_lg_u32 s41, 144
    s_cbranch_scc1 K3_h_tile
    s_branch K3_fin
K3_x_tile:
    s_mov_b32 s43, 11
    s_mov_b32 m0, s48
    ds_read_b128 v[208:211], v4 offset:0
    ds_read_b128 v[212:215], v4 offset:1024
    ds_read_b128 v[216:219], v4 offset:2048
    buffer_load_dwordx4 v254, s[20:23], s47 offen offset:0 lds
    ds_read_b128 v[220:223], v4 offset:3072
    ds_read_b128 v[224:227], v4 offset:4096
    ds_read_b128 v[228:231], v4 offset:5120
    buffer_load_dwordx4 v254, s[20:23], s47 offen offset:1024 lds
    s_add_u32 m0, s34, 0
    ds_read_b64_tr_b16 v[160:161], v5 offset:0
    ds_read_b64_tr_b16 v[162:163], v6 offset:0
    ds_read_b64_tr_b16 v[184:185], v5 offset:12288
    buffer_load_dwordx4 v1, s[8:11], s33 offen nt lds
    s_add_u32 m0, s34, 1024
    ds_read_b64_tr_b16 v[186:187], v6 offset:12288
    ds_read_b64_tr_b16 v[164:165], v5 offset:1024
    ds_read_b64_tr_b16 v[166:167], v6 offset:1024
    buffer_load_dwordx4 v2, s[8:11], s33 offen nt lds
    s_add_u32 m0, s34, 2048
    ds_read_b64_tr_b16 v[188:189], v5 offset:13312
    ds_read_b64_tr_b16 v[190:191], v6 offset:13312
    ds_read_b64_tr_b16 v[168:169], v5 offset:2048
    buffer_load_dwordx4 v3, s[8:11], s33 offen nt lds
    s_add_u32 m0, s34, 3072
    ds_read_b64_tr_b16 v[170:171], v6 offset:2048
    ds_read_b64_tr_b16 v[192:193], v5 offset:14336
    ds_read_b64_tr_b16 v[194:195], v6 offset:14336
    buffer_load_dwordx4 v1, s[8:11], s45 offen nt lds
    s_add_u32 m0, s34, 4096
    ds_read_b64_tr_b16 v[172:173], v5 offset:3072
    ds_read_b64_tr_b16 v[174:175], v6 offset:3072
    ds_read_b64_tr_b16 v[196:197], v5 offset:15360
    buffer_load_dwordx4 v2, s[8:11], s45 offen nt lds
    s_add_u32 m0, s34, 5120
    ds_read_b64_tr_b16 v[198:199], v6 offset:15360
    ds_read_b64_tr_b16 v[176:177], v5 offset:4096
    ds_read_b64_tr_b16 v[178:179], v6 offset:4096
    buffer_load_dwordx4 v3, s[8:11], s45 offen nt lds
    ds_read_b64_tr_b16 v[200:201], v5 offset:16384
    ds_read_b64_tr_b16 v[202:203], v6 offset:16384
    ds_read_b64_tr_b16 v[180:181], v5 offset:5120
    ds_read_b64_tr_b16 v[182:183], v6 offset:5120
    ds_read_b64_tr_b16 v[204:205], v5 offset:17408
    ds_read_b64_tr_b16 v[206:207], v6 offset:17408
    s_cmp_eq_u32 s41, 0
    s_cbranch_scc1 K3_x_noep
    s_nop 7
    s_mov_b32 s38, s42
    v_cvt_pk_bf16_f32 v240, v16, v20
    v_cvt_pk_bf16_f32 v241, v24, v28
    v_cvt_pk_bf16_f32 v242, v32, v36
    buffer_store_dwordx3 v[240:242], v8, s[12:15], s38 offen offset:0
    v_cvt_pk_bf16_f32 v244, v17, v21
    v_cvt_pk_bf16_f32 v245, v25, v29
    v_cvt_pk_bf16_f32 v246, v33, v37
    buffer_store_dwordx3 v[244:246], v8, s[12:15], s38 offen offset:768
    v_cvt_pk_bf16_f32 v248, v18, v22
    v_cvt_pk_bf16_f32 v249, v26, v30
    v_cvt_pk_bf16_f32 v250, v34, v38
    buffer_store_dwordx3 v[248:250], v8, s[12:15], s38 offen offset:1536
    v_cvt_pk_bf16_f32 v240, v19, v23
    v_cvt_pk_bf16_f32 v241, v27, v31
    v_cvt_pk_bf16_f32 v242, v35, v39
    buffer_store_dwordx3 v[240:242], v8, s[12:15], s38 offen offset:2304
    s_add_u32 s38, s38, 12288
    v_cvt_pk_bf16_f32 v244, v40, v44
    v_cvt_pk_bf16_f32 v245, v48, v52
    v_cvt_pk_bf16_f32 v246, v56, v60
    buffer_store_dwordx3 v[244:246], v8, s[12:15], s38 offen offset:0
    v_cvt_pk_bf16_f32 v248, v41, v45
    v_cvt_pk_bf16_f32 v249, v49, v53
    v_cvt_pk_bf16_f32 v250, v57, v61
    buffer_store_dwordx3 v[248:250], v8, s[12:15], s38 offen offset:768
    v_cvt_pk_bf16_f32 v240, v42, v46
    v_cvt_pk_bf16_f32 v241, v50, v54
    v_cvt_pk_bf16_f32 v242, v58, v62
    buffer_store_dwordx3 v[240:242], v8, s[12:15], s38 offen offset:1536
    v_cvt_pk_bf16_f32 v244, v43, v47
    v_cvt_pk_bf16_f32 v245, v51, v55
    v_cvt_pk_bf16_f32 v246, v59, v63
    buffer_store_dwordx3 v[244:246], v8, s[12:15], s38 offen offset:2304
    s_add_u32 s38, s38, 12288
    v_cvt_pk_bf16_f32 v248, v64, v68
    v_cvt_pk_bf16_f32 v249, v72, v76
    v_cvt_pk_bf16_f32 v250, v80, v84
    buffer_store_dwordx3 v[248:250], v8, s[12:15], s38 offen offset:0
    v_cvt_pk_bf16_f32 v240, v65, v69
    v_cvt_pk_bf16_f32 v241, v73, v77
    v_cvt_pk_bf16_f32 v242, v81, v85
    buffer_store_dwordx3 v[240:242], v8, s[12:15], s38 offen offset:768
    v_cvt_pk_bf16_f32 v244, v66, v70
    v_cvt_pk_bf16_f32 v245, v74, v78
    v_cvt_pk_bf16_f32 v246, v82, v86
    buffer_store_dwordx3 v[244:246], v8, s[12:15], s38 offen offset:1536
    v_cvt_pk_bf16_f32 v248, v67, v71
    v_cvt_pk_bf16_f32 v249, v75, v79
    v_cvt_pk_bf16_f32 v250, v83, v87
    buffer_store_dwordx3 v[248:250], v8, s[12:15], s38 offen offset:2304
    s_add_u32 s38, s38, 12288
    v_cvt_pk_bf16_f32 v240, v88, v92
    v_cvt_pk_bf16_f32 v241, v96, v100
    v_cvt_pk_bf16_f32 v242, v104, v108
    buffer_store_dwordx3 v[240:242], v8, s[12:15], s38 offen offset:0
    v_cvt_pk_bf16_f32 v244, v89, v93
    v_cvt_pk_bf16_f32 v245, v97, v101
    v_cvt_pk_bf16_f32 v246, v105, v109
    buffer_store_dwordx3 v[244:246], v8, s[12:15], s38 offen offset:768
    v_cvt_pk_bf16_f32 v248, v90, v94
    v_cvt_pk_bf16_f32 v249, v98, v102
    v_cvt_pk_bf16_f32 v250, v106, v110
    buffer_store_dwordx3 v[248:250], v8, s[12:15], s38 offen offset:1536
    v_cvt_pk_bf16_f32 v240, v91, v95
    v_cvt_pk_bf16_f32 v241, v99, v103
    v_cvt_pk_bf16_f32 v242, v107, v111
    buffer_store_dwordx3 v[240:242], v8, s[12:15], s38 offen offset:2304
    s_add_u32 s38, s38, 12288
    v_cvt_pk_bf16_f32 v244, v112, v116
    v_cvt_pk_bf16_f32 v245, v120, v124
    v_cvt_pk_bf16_f32 v246, v128, v132
    buffer_store_dwordx3 v[244:246], v8, s[12:15], s38 offen offset:0
    v_cvt_pk_bf16_f32 v248, v113, v117
    v_cvt_pk_bf16_f32 v249, v121, v125
    v_cvt_pk_bf16_f32 v250, v129, v133
    buffer_store_dwordx3 v[248:250], v8, s[12:15], s38 offen offset:768
    v_cvt_pk_bf16_f32 v240, v114, v118
    v_cvt_pk_bf16_f32 v241, v122, v126
    v_cvt_pk_bf16_f32 v242, v130, v134
    buffer_store_dwordx3 v[240:242], v8, s[12:15], s38 offen offset:1536
    v_cvt_pk_bf16_f32 v244, v115, v119
    v_cvt_pk_bf16_f32 v245, v123, v127
    v_cvt_pk_bf16_f32 v246, v131, v135
    buffer_store_dwordx3 v[244:246], v8, s[12:15], s38 offen offset:2304
    s_add_u32 s38, s38, 12288
    v_cvt_pk_bf16_f32 v248, v136, v140
    v_cvt_pk_bf16_f32 v249, v144, v148
    v_cvt_pk_bf16_f32 v250, v152, v156
    buffer_store_dwordx3 v[248:250], v8, s[12:15], s38 offen offset:0
    v_cvt_pk_bf16_f32 v240, v137, v141
    v_cvt_pk_bf16_f32 v241, v145, v149
    v_cvt_pk_bf16_f32 v242, v153, v157
    buffer_store_dwordx3 v[240:242], v8, s[12:15], s38 offen offset:768
    v_cvt_pk_bf16_f32 v244, v138, v142
    v_cvt_pk_bf16_f32 v245, v146, v150
    v_cvt_pk_bf16_f32 v246, v154, v158
    buffer_store_dwordx3 v[244:246], v8, s[12:15], s38 offen offset:1536
    v_cvt_pk_bf16_f32 v248, v139, v143
    v_cvt_pk_bf16_f32 v249, v147, v151
    v_cvt_pk_bf16_f32 v250, v155, v159
    buffer_store_dwordx3 v[248:250], v8, s[12:15], s38 offen offset:2304
    s_sub_u32 s42, s42, 147456
K3_x_noep:
    s_nop 1
    v_mov_b32 v240, v12
    v_mov_b32 v241, v12
    v_mov_b32 v242, v12
    v_mov_b32 v243, v12
    v_mov_b32 v244, v13
    v_mov_b32 v245, v13
    v_mov_b32 v246, v13
    v_mov_b32 v247, v13
    v_mov_b32 v248, v14
    v_mov_b32 v249, v14
    v_mov_b32 v250, v14
    v_mov_b32 v251, v14
    s_waitcnt vmcnt(32)
    s_cmp_lg_u32 s41, 0
    s_cbranch_scc1 K3_vxf0
    s_waitcnt vmcnt(8)
K3_vxf0:
    s_waitcnt lgkmcnt(0)
    s_setprio 2
    s_barrier
    v_mfma_f32_16x16x32_bf16 v[16:19], v[160:163], v[208:211], v[240:243]
    v_mfma_f32_16x16x32_bf16 v[16:19], v[184:187], v[220:223], v[16:19]
    s_add_u32 s48, s48, 24576
    v_mfma_f32_16x16x32_bf16 v[20:23], v[160:163], v[212:215], v[244:247]
    v_mfma_f32_16x16x32_bf16 v[20:23], v[184:187], v[224:227], v[20:23]
    s_cmp_eq_u32 s48, s50
    v_mfma_f32_16x16x32_bf16 v[24:27], v[160:163], v[216:219], v[248:251]
    v_mfma_f32_16x16x32_bf16 v[24:27], v[184:187], v[228:231], v[24:27]
    s_cselect_b32 s48, s49, s48
    v_mfma_f32_16x16x32_bf16 v[40:43], v[164:167], v[208:211], v[240:243]
    v_mfma_f32_16x16x32_bf16 v[40:43], v[188:191], v[220:223], v[40:43]
    s_sub_u32 s47, s47, 24576
    v_mfma_f32_16x16x32_bf16 v[44:47], v[164:167], v[212:215], v[244:247]
    v_mfma_f32_16x16x32_bf16 v[44:47], v[188:191], v[224:227], v[44:47]
    s_cselect_b32 s44, 1179648, 0
    v_mfma_f32_16x16x32_bf16 v[48:51], v[164:167], v[216:219], v[248:251]
    v_mfma_f32_16x16x32_bf16 v[48:51], v[188:191], v[228:231], v[48:51]
    s_add_u32 s47, s47, s44
    v_mfma_f32_16x16x32_bf16 v[64:67], v[168:171], v[208:211], v[240:243]
    v_mfma_f32_16x16x32_bf16 v[64:67], v[192:195], v[220:223], v[64:67]
    s_sub_u32 s33, s33, 12288
    v_mfma_f32_16x16x32_bf16 v[68:71], v[168:171], v[212:215], v[244:247]
    v_mfma_f32_16x16x32_bf16 v[68:71], v[192:195], v[224:227], v[68:71]
    s_cselect_b32 s10, 0, s10
    v_mfma_f32_16x16x32_bf16 v[72:75], v[168:171], v[216:219], v[248:251]
    v_mfma_f32_16x16x32_bf16 v[72:75], v[192:195], v[228:231], v[72:75]
    s_cselect_b32 s33, 0, s33
    v_mfma_f32_16x16x32_bf16 v[88:91], v[172:175], v[208:211], v[240:243]
    v_mfma_f32_16x16x32_bf16 v[88:91], v[196:199], v[220:223], v[88:91]
    s_add_u32 s45, s33, 3072
    v_mfma_f32_16x16x32_bf16 v[92:95], v[172:175], v[212:215], v[244:247]
    v_mfma_f32_16x16x32_bf16 v[92:95], v[196:199], v[224:227], v[92:95]
    s_add_u32 s39, s39, 24576
    v_mfma_f32_16x16x32_bf16 v[96:99], v[172:175], v[216:219], v[248:251]
    v_mfma_f32_16x16x32_bf16 v[96:99], v[196:199], v[228:231], v[96:99]
    s_cmp_eq_u32 s39, 73728
    v_mfma_f32_16x16x32_bf16 v[112:115], v[176:179], v[208:211], v[240:243]
    v_mfma_f32_16x16x32_bf16 v[112:115], v[200:203], v[220:223], v[112:115]
    s_cselect_b32 s39, 0, s39
    v_mfma_f32_16x16x32_bf16 v[116:119], v[176:179], v[212:215], v[244:247]
    v_mfma_f32_16x16x32_bf16 v[116:119], v[200:203], v[224:227], v[116:119]
    v_add_u32 v4, s39, v9
    v_mfma_f32_16x16x32_bf16 v[120:123], v[176:179], v[216:219], v[248:251]
    v_mfma_f32_16x16x32_bf16 v[120:123], v[200:203], v[228:231], v[120:123]
    v_mfma_f32_16x16x32_bf16 v[136:139], v[180:183], v[208:211], v[240:243]
    v_mfma_f32_16x16x32_bf16 v[136:139], v[204:207], v[220:223], v[136:139]
    v_mfma_f32_16x16x32_bf16 v[140:143], v[180:183], v[212:215], v[244:247]
    v_mfma_f32_16x16x32_bf16 v[140:143], v[204:207], v[224:227], v[140:143]
    v_mfma_f32_16x16x32_bf16 v[144:147], v[180:183], v[216:219], v[248:251]
    v_mfma_f32_16x16x32_bf16 v[144:147], v[204:207], v[228:231], v[144:147]
    s_setprio 0
    s_mov_b32 m0, s48
    ds_read_b128 v[208:211], v4 offset:0
    buffer_load_dwordx4 v254, s[20:23], s47 offen offset:0 lds
    ds_read_b128 v[212:215], v4 offset:1024
    buffer_load_dwordx4 v254, s[20:23], s47 offen offset:1024 lds
    ds_read_b128 v[216:219], v4 offset:2048
    ds_read_b128 v[220:223], v4 offset:3072
    ds_read_b128 v[224:227], v4 offset:4096
    ds_read_b128 v[228:231], v4 offset:5120
    s_nop 1
    v_mov_b32 v240, v15
    v_mov_b32 v241, v15
    v_mov_b32 v242, v15
    v_mov_b32 v243, v15
    v_mov_b32 v244, v252
    v_mov_b32 v245, v252
    v_mov_b32 v246, v252
    v_mov_b32 v247, v252
    v_mov_b32 v248, v253
    v_mov_b32 v249, v253
    v_mov_b32 v250, v253
    v_mov_b32 v251, v253
    s_waitcnt vmcnt(32)
    s_cmp_lg_u32 s41, 0
    s_cbranch_scc1 K3_vxf1
    s_waitcnt vmcnt(8)
K3_vxf1:
    s_waitcnt lgkmcnt(0)
    s_setprio 2
    s_barrier
    v_mfma_f32_16x16x32_bf16 v[28:31], v[160:163], v[208:211], v[240:243]
    v_mfma_f32_16x16x32_bf16 v[28:31], v[184:187], v[220:223], v[28:31]
    s_add_u32 s48, s48, 24576
    v_mfma_f32_16x16x32_bf16 v[32:35], v[160:163], v[212:215], v[244:247]
    v_mfma_f32_16x16x32_bf16 v[32:35], v[184:187], v[224:227], v[32:35]
    s_cmp_eq_u32 s48, s50
    v_mfma_f32_16x16x32_bf16 v[36:39], v[160:163], v[216:219], v[248:251]
    v_mfma_f32_16x16x32_bf16 v[36:39], v[184:187], v[228:231], v[36:39]
    s_cselect_b32 s48, s49, s48
    v_mfma_f32_16x16x32_bf16 v[52:55], v[164:167], v[208:211], v[240:243]
    v_mfma_f32_16x16x32_bf16 v[52:55], v[188:191], v[220:223], v[52:55]
    s_sub_u32 s47, s47, 24576
    v_mfma_f32_16x16x32_bf16 v[56:59], v[164:167], v[212:215], v[244:247]
    v_mfma_f32_16x16x32_bf16 v[56:59], v[188:191], v[224:227], v[56:59]
    s_cselect_b32 s44, 1179648, 0
    v_mfma_f32_16x16x32_bf16 v[60:63], v[164:167], v[216:219], v[248:251]
    v_mfma_f32_16x16x32_bf16 v[60:63], v[188:191], v[228:231], v[60:63]
    s_add_u32 s47, s47, s44
    v_mfma_f32_16x16x32_bf16 v[76:79], v[168:171], v[208:211], v[240:243]
    v_mfma_f32_16x16x32_bf16 v[76:79], v[192:195], v[220:223], v[76:79]
    s_add_u32 s39, s39, 24576
    v_mfma_f32_16x16x32_bf16 v[80:83], v[168:171], v[212:215], v[244:247]
    v_mfma_f32_16x16x32_bf16 v[80:83], v[192:195], v[224:227], v[80:83]
    s_cmp_eq_u32 s39, 73728
    v_mfma_f32_16x16x32_bf16 v[84:87], v[168:171], v[216:219], v[248:251]
    v_mfma_f32_16x16x32_bf16 v[84:87], v[192:195], v[228:231], v[84:87]
    s_cselect_b32 s39, 0, s39
    v_mfma_f32_16x16x32_bf16 v[100:103], v[172:175], v[208:211], v[240:243]
    v_mfma_f32_16x16x32_bf16 v[100:103], v[196:199], v[220:223], v[100:103]
    v_add_u32 v4, s39, v9
    v_mfma_f32_16x16x32_bf16 v[104:107], v[172:175], v[212:215], v[244:247]
    v_mfma_f32_16x16x32_bf16 v[104:107], v[196:199], v[224:227], v[104:107]
    s_add_u32 s40, s40, 24576
    v_mfma_f32_16x16x32_bf16 v[108:111], v[172:175], v[216:219], v[248:251]
    v_mfma_f32_16x16x32_bf16 v[108:111], v[196:199], v[228:231], v[108:111]
    s_cmp_eq_u32 s40, 73728
    v_mfma_f32_16x16x32_bf16 v[124:127], v[176:179], v[208:211], v[240:243]
    v_mfma_f32_16x16x32_bf16 v[124:127], v[200:203], v[220:223], v[124:127]
    s_cselect_b32 s40, 0, s40
    v_mfma_f32_16x16x32_bf16 v[128:131], v[176:179], v[212:215], v[244:247]
    v_mfma_f32_16x16x32_bf16 v[128:131], v[200:203], v[224:227], v[128:131]
    v_add_u32 v5, s40, v10
    v_mfma_f32_16x16x32_bf16 v[132:135], v[176:179], v[216:219], v[248:251]
    v_mfma_f32_16x16x32_bf16 v[132:135], v[200:203], v[228:231], v[132:135]
    v_add_u32 v6, s40, v11
    v_mfma_f32_16x16x32_bf16 v[148:151], v[180:183], v[208:211], v[240:243]
    v_mfma_f32_16x16x32_bf16 v[148:151], v[204:207], v[220:223], v[148:151]
    v_mfma_f32_16x16x32_bf16 v[152:155], v[180:183], v[212:215], v[244:247]
    v_mfma_f32_16x16x32_bf16 v[152:155], v[204:207], v[224:227], v[152:155]
    v_mfma_f32_16x16x32_bf16 v[156:159], v[180:183], v[216:219], v[248:251]
    v_mfma_f32_16x16x32_bf16 v[156:159], v[204:207], v[228:231], v[156:159]
    s_setprio 0
    s_mov_b32 m0, s48
    ds_read_b128 v[208:211], v4 offset:0
    ds_read_b128 v[212:215], v4 offset:1024
    ds_read_b128 v[216:219], v4 offset:2048
    ds_read_b128 v[220:223], v4 offset:3072
    ds_read_b128 v[224:227], v4 offset:4096
    ds_read_b128 v[228:231], v4 offset:5120
    ds_read_b64_tr_b16 v[160:161], v5 offset:0
    ds_read_b64_tr_b16 v[162:163], v6 offset:0
    ds_read_b64_tr_b16 v[184:185], v5 offset:12288
    ds_read_b64_tr_b16 v[186:187], v6 offset:12288
    ds_read_b64_tr_b16 v[164:165], v5 offset:1024
    ds_read_b64_tr_b16 v[166:167], v6 offset:1024
    ds_read_b64_tr_b16 v[188:189], v5 offset:13312
    ds_read_b64_tr_b16 v[190:191], v6 offset:13312
    ds_read_b64_tr_b16 v[168:169], v5 offset:2048
    buffer_load_dwordx4 v254, s[20:23], s47 offen offset:0 lds
    ds_read_b64_tr_b16 v[170:171], v6 offset:2048
    ds_read_b64_tr_b16 v[192:193], v5 offset:14336
    ds_read_b64_tr_b16 v[194:195], v6 offset:14336
    ds_read_b64_tr_b16 v[172:173], v5 offset:3072
    ds_read_b64_tr_b16 v[174:175], v6 offset:3072
    ds_read_b64_tr_b16 v[196:197], v5 offset:15360
    ds_read_b64_tr_b16 v[198:199], v6 offset:15360
    ds_read_b64_tr_b16 v[176:177], v5 offset:4096
    ds_read_b64_tr_b16 v[178:179], v6 offset:4096
    ds_read_b64_tr_b16 v[200:201], v5 offset:16384
    ds_read_b64_tr_b16 v[202:203], v6 offset:16384
    ds_read_b64_tr_b16 v[180:181], v5 offset:5120
    ds_read_b64_tr_b16 v[182:183], v6 offset:5120
    ds_read_b64_tr_b16 v[204:205], v5 offset:17408
    ds_read_b64_tr_b16 v[206:207], v6 offset:17408
    buffer_load_dwordx4 v254, s[20:23], s47 offen offset:1024 lds
    s_waitcnt vmcnt(2)
    s_waitcnt lgkmcnt(0)
    s_setprio 2
    s_barrier
    v_mfma_f32_16x16x32_bf16 v[16:19], v[160:163], v[208:211], v[16:19]
    v_mfma_f32_16x16x32_bf16 v[16:19], v[184:187], v[220:223], v[16:19]
    s_add_u32 s48, s48, 24576
    v_mfma_f32_16x16x32_bf16 v[20:23], v[160:163], v[212:215], v[20:23]
    v_mfma_f32_16x16x32_bf16 v[20:23], v[184:187], v[224:227], v[20:23]
    s_cmp_eq_u32 s48, s50
    v_mfma_f32_16x16x32_bf16 v[24:27], v[160:163], v[216:219], v[24:27]
    v_mfma_f32_16x16x32_bf16 v[24:27], v[184:187], v[228:231], v[24:27]
    s_cselect_b32 s48, s49, s48
    v_mfma_f32_16x16x32_bf16 v[40:43], v[164:167], v[208:211], v[40:43]
    v_mfma_f32_16x16x32_bf16 v[40:43], v[188:191], v[220:223], v[40:43]
    s_sub_u32 s47, s47, 24576
    v_mfma_f32_16x16x32_bf16 v[44:47], v[164:167], v[212:215], v[44:47]
    v_mfma_f32_16x16x32_bf16 v[44:47], v[188:191], v[224:227], v[44:47]
    s_cselect_b32 s44, 1179648, 0
    v_mfma_f32_16x16x32_bf16 v[48:51], v[164:167], v[216:219], v[48:51]
    v_mfma_f32_16x16x32_bf16 v[48:51], v[188:191], v[228:231], v[48:51]
    s_add_u32 s47, s47, s44
    v_mfma_f32_16x16x32_bf16 v[64:67], v[168:171], v[208:211], v[64:67]
    v_mfma_f32_16x16x32_bf16 v[64:67], v[192:195], v[220:223], v[64:67]
    s_add_u32 s39, s39, 24576
    v_mfma_f32_16x16x32_bf16 v[68:71], v[168:171], v[212:215], v[68:71]
    v_mfma_f32_16x16x32_bf16 v[68:71], v[192:195], v[224:227], v[68:71]
    s_cmp_eq_u32 s39, 73728
    v_mfma_f32_16x16x32_bf16 v[72:75], v[168:171], v[216:219], v[72:75]
    v_mfma_f32_16x16x32_bf16 v[72:75], v[192:195], v[228:231], v[72:75]
    s_cselect_b32 s39, 0, s39
    v_mfma_f32_16x16x32_bf16 v[88:91], v[172:175], v[208:211], v[88:91]
    v_mfma_f32_16x16x32_bf16 v[88:91], v[196:199], v[220:223], v[88:91]
    v_add_u32 v4, s39, v9
    v_mfma_f32_16x16x32_bf16 v[92:95], v[172:175], v[212:215], v[92:95]
    v_mfma_f32_16x16x32_bf16 v[92:95], v[196:199], v[224:227], v[92:95]
    s_sub_u32 s37, s43, 6
    v_mfma_f32_16x16x32_bf16 v[96:99], v[172:175], v[216:219], v[96:99]
    v_mfma_f32_16x16x32_bf16 v[96:99], v[196:199], v[228:231], v[96:99]
    s_sub_u32 s43, s43, 1
    v_mfma_f32_16x16x32_bf16 v[112:115], v[176:179], v[208:211], v[112:115]
    v_mfma_f32_16x16x32_bf16 v[112:115], v[200:203], v[220:223], v[112:115]
    v_mfma_f32_16x16x32_bf16 v[116:119], v[176:179], v[212:215], v[116:119]
    v_mfma_f32_16x16x32_bf16 v[116:119], v[200:203], v[224:227], v[116:119]
    v_mfma_f32_16x16x32_bf16 v[120:123], v[176:179], v[216:219], v[120:123]
    v_mfma_f32_16x16x32_bf16 v[120:123], v[200:203], v[228:231], v[120:123]
    v_mfma_f32_16x16x32_bf16 v[136:139], v[180:183], v[208:211], v[136:139]
    v_mfma_f32_16x16x32_bf16 v[136:139], v[204:207], v[220:223], v[136:139]
    v_mfma_f32_16x16x32_bf16 v[140:143], v[180:183], v[212:215], v[140:143]
    v_mfma_f32_16x16x32_bf16 v[140:143], v[204:207], v[224:227], v[140:143]
    v_mfma_f32_16x16x32_bf16 v[144:147], v[180:183], v[216:219], v[144:147]
    v_mfma_f32_16x16x32_bf16 v[144:147], v[204:207], v[228:231], v[144:147]
    s_setprio 0
    s_cmp_lt_u32 s37, 6
    s_cbranch_scc0 K3_xf3_xr
    ds_read2_b32 v[240:241], v7 offset0:0 offset1:3
    ds_read2_b32 v[242:243], v7 offset0:6 offset1:9
    ds_read2_b32 v[244:245], v7 offset0:1 offset1:4
    ds_read2_b32 v[246:247], v7 offset0:7 offset1:10
    ds_read2_b32 v[248:249], v7 offset0:2 offset1:5
    ds_read2_b32 v[250:251], v7 offset0:8 offset1:11
K3_xf3_xr:
    s_mov_b32 m0, s48
    ds_read_b128 v[208:211], v4 offset:0
    buffer_load_dwordx4 v254, s[20:23], s47 offen offset:0 lds
    ds_read_b128 v[212:215], v4 offset:1024
    buffer_load_dwordx4 v254, s[20:23], s47 offen offset:1024 lds
    ds_read_b128 v[216:219], v4 offset:2048
    ds_read_b128 v[220:223], v4 offset:3072
    ds_read_b128 v[224:227], v4 offset:4096
    ds_read_b128 v[228:231], v4 offset:5120
    s_cmp_lt_u32 s37, 6
    s_cbranch_scc0 K3_xf3_xn
    s_cmp_lg_u32 s37, 0
    s_cbranch_scc1 K3_xf3_x1
    s_waitcnt vmcnt(2)
    s_waitcnt lgkmcnt(0)
    s_setprio 2
    s_barrier
    v_mfma_f32_16x16x32_bf16 v[16:19], v[240:243], v[232:235], v[16:19]
    v_mfma_f32_16x16x32_bf16 v[20:23], v[240:243], v[236:239], v[20:23]
    v_mfma_f32_16x16x32_bf16 v[24:27], v[244:247], v[232:235], v[24:27]
    v_mfma_f32_16x16x32_bf16 v[28:31], v[244:247], v[236:239], v[28:31]
    v_mfma_f32_16x16x32_bf16 v[32:35], v[248:251], v[232:235], v[32:35]
    v_mfma_f32_16x16x32_bf16 v[36:39], v[248:251], v[236:239], v[36:39]
    s_branch K3_xf3_xd
K3_xf3_x1:
    s_cmp_lg_u32 s37, 1
    s_cbranch_scc1 K3_xf3_x2
    s_waitcnt vmcnt(2)
    s_waitcnt lgkmcnt(0)
    s_setprio 2
    s_barrier
    v_mfma_f32_16x16x32_bf16 v[40:43], v[240:243], v[232:235], v[40:43]
    v_mfma_f32_16x16x32_bf16 v[44:47], v[240:243], v[236:239], v[44:47]
    v_mfma_f32_16x16x32_bf16 v[48:51], v[244:247], v[232:235], v[48:51]
    v_mfma_f32_16x16x32_bf16 v[52:55], v[244:247], v[236:239], v[52:55]
    v_mfma_f32_16x16x32_bf16 v[56:59], v[248:251], v[232:235], v[56:59]
    v_mfma_f32_16x16x32_bf16 v[60:63], v[248:251], v[236:239], v[60:63]
    s_branch K3_xf3_xd
K3_xf3_x2:
    s_cmp_lg_u32 s37, 2
    s_cbranch_scc1 K3_xf3_x3
    s_waitcnt vmcnt(2)
    s_waitcnt lgkmcnt(0)
    s_setprio 2
    s_barrier
    v_mfma_f32_16x16x32_bf16 v[64:67], v[240:243], v[232:235], v[64:67]
    v_mfma_f32_16x16x32_bf16 v[68:71], v[240:243], v[236:239], v[68:71]
    v_mfma_f32_16x16x32_bf16 v[72:75], v[244:247], v[232:235], v[72:75]
    v_mfma_f32_16x16x32_bf16 v[76:79], v[244:247], v[236:239], v[76:79]
    v_mfma_f32_16x16x32_bf16 v[80:83], v[248:251], v[232:235], v[80:83]
    v_mfma_f32_16x16x32_bf16 v[84:87], v[248:251], v[236:239], v[84:87]
    s_branch K3_xf3_xd
K3_xf3_x3:
    s_cmp_lg_u32 s37, 3
    s_cbranch_scc1 K3_xf3_x4
    s_waitcnt vmcnt(2)
    s_waitcnt lgkmcnt(0)
    s_setprio 2
    s_barrier
    v_mfma_f32_16x16x32_bf16 v[88:91], v[240:243], v[232:235], v[88:91]
    v_mfma_f32_16x16x32_bf16 v[92:95], v[240:243], v[236:239], v[92:95]
    v_mfma_f32_16x16x32_bf16 v[96:99], v[244:247], v[232:235], v[96:99]
    v_mfma_f32_16x16x32_bf16 v[100:103], v[244:247], v[236:239], v[100:103]
    v_mfma_f32_16x16x32_bf16 v[104:107], v[248:251], v[232:235], v[104:107]
    v_mfma_f32_16x16x32_bf16 v[108:111], v[248:251], v[236:239], v[108:111]
    s_branch K3_xf3_xd
K3_xf3_x4:
    s_cmp_lg_u32 s37, 4
    s_cbranch_scc1 K3_xf3_x5
    s_waitcnt vmcnt(2)
    s_waitcnt lgkmcnt(0)
    s_setprio 2
    s_barrier
    v_mfma_f32_16x16x32_bf16 v[112:115], v[240:243], v[232:235], v[112:115]
    v_mfma_f32_16x16x32_bf16 v[116:119], v[240:243], v[236:239], v[116:119]
    v_mfma_f32_16x16x32_bf16 v[120:123], v[244:247], v[232:235], v[120:123]
    v_mfma_f32_16x16x32_bf16 v[124:127], v[244:247], v[236:239], v[124:127]
    v_mfma_f32_16x16x32_bf16 v[128:131], v[248:251], v[232:235], v[128:131]
    v_mfma_f32_16x16x32_bf16 v[132:135], v[248:251], v[236:239], v[132:135]
    s_branch K3_xf3_xd
K3_xf3_x5:
    s_waitcnt vmcnt(2)
    s_waitcnt lgkmcnt(0)
    s_setprio 2
    s_barrier
    v_mfma_f32_16x16x32_bf16 v[136:139], v[240:243], v[232:235], v[136:139]
    v_mfma_f32_16x16x32_bf16 v[140:143], v[240:243], v[236:239], v[140:143]
    v_mfma_f32_16x16x32_bf16 v[144:147], v[244:247], v[232:235], v[144:147]
    v_mfma_f32_16x16x32_bf16 v[148:151], v[244:247], v[236:239], v[148:151]
    v_mfma_f32_16x16x32_bf16 v[152:155], v[248:251], v[232:235], v[152:155]
    v_mfma_f32_16x16x32_bf16 v[156:159], v[248:251], v[236:239], v[156:159]
    s_branch K3_xf3_xd
K3_xf3_xn:
    s_waitcnt vmcnt(2)
    s_waitcnt lgkmcnt(0)
    s_setprio 2
    s_barrier
K3_xf3_xd:
    v_mfma_f32_16x16x32_bf16 v[28:31], v[160:163], v[208:211], v[28:31]
    v_mfma_f32_16x16x32_bf16 v[28:31], v[184:187], v[220:223], v[28:31]
    s_add_u32 s48, s48, 24576
    v_mfma_f32_16x16x32_bf16 v[32:35], v[160:163], v[212:215], v[32:35]
    v_mfma_f32_16x16x32_bf16 v[32:35], v[184:187], v[224:227], v[32:35]
    s_cmp_eq_u32 s48, s50
    v_mfma_f32_16x16x32_bf16 v[36:39], v[160:163], v[216:219], v[36:39]
    v_mfma_f32_16x16x32_bf16 v[36:39], v[184:187], v[228:231], v[36:39]
    s_cselect_b32 s48, s49, s48
    v_mfma_f32_16x16x32_bf16 v[52:55], v[164:167], v[208:211], v[52:55]
    v_mfma_f32_16x16x32_bf16 v[52:55], v[188:191], v[220:223], v[52:55]
    s_sub_u32 s47, s47, 24576
    v_mfma_f32_16x16x32_bf16 v[56:59], v[164:167], v[212:215], v[56:59]
    v_mfma_f32_16x16x32_bf16 v[56:59], v[188:191], v[224:227], v[56:59]
    s_cselect_b32 s44, 1179648, 0
    v_mfma_f32_16x16x32_bf16 v[60:63], v[164:167], v[216:219], v[60:63]
    v_mfma_f32_16x16x32_bf16 v[60:63], v[188:191], v[228:231], v[60:63]
    s_add_u32 s47, s47, s44
    v_mfma_f32_16x16x32_bf16 v[76:79], v[168:171], v[208:211], v[76:79]
    v_mfma_f32_16x16x32_bf16 v[76:79], v[192:195], v[220:223], v[76:79]
    s_add_u32 s39, s39, 24576
    v_mfma_f32_16x16x32_bf16 v[80:83], v[168:171], v[212:215], v[80:83]
    v_mfma_f32_16x16x32_bf16 v[80:83], v[192:195], v[224:227], v[80:83]
    s_cmp_eq_u32 s39, 73728
    v_mfma_f32_16x16x32_bf16 v[84:87], v[168:171], v[216:219], v[84:87]
    v_mfma_f32_16x16x32_bf16 v[84:87], v[192:195], v[228:231], v[84:87]
    s_cselect_b32 s39, 0, s39
    v_mfma_f32_16x16x32_bf16 v[100:103], v[172:175], v[208:211], v[100:103]
    v_mfma_f32_16x16x32_bf16 v[100:103], v[196:199], v[220:223], v[100:103]
    v_add_u32 v4, s39, v9
    v_mfma_f32_16x16x32_bf16 v[104:107], v[172:175], v[212:215], v[104:107]
    v_mfma_f32_16x16x32_bf16 v[104:107], v[196:199], v[224:227], v[104:107]
    s_add_u32 s40, s40, 24576
    v_mfma_f32_16x16x32_bf16 v[108:111], v[172:175], v[216:219], v[108:111]
    v_mfma_f32_16x16x32_bf16 v[108:111], v[196:199], v[228:231], v[108:111]
    s_cmp_eq_u32 s40, 73728
    v_mfma_f32_16x16x32_bf16 v[124:127], v[176:179], v[208:211], v[124:127]
    v_mfma_f32_16x16x32_bf16 v[124:127], v[200:203], v[220:223], v[124:127]
    s_cselect_b32 s40, 0, s40
    v_mfma_f32_16x16x32_bf16 v[128:131], v[176:179], v[212:215], v[128:131]
    v_mfma_f32_16x16x32_bf16 v[128:131], v[200:203], v[224:227], v[128:131]
    v_add_u32 v5, s40, v10
    v_mfma_f32_16x16x32_bf16 v[132:135], v[176:179], v[216:219], v[132:135]
    v_mfma_f32_16x16x32_bf16 v[132:135], v[200:203], v[228:231], v[132:135]
    v_add_u32 v6, s40, v11
    v_mfma_f32_16x16x32_bf16 v[148:151], v[180:183], v[208:211], v[148:151]
    v_mfma_f32_16x16x32_bf16 v[148:151], v[204:207], v[220:223], v[148:151]
    v_mfma_f32_16x16x32_bf16 v[152:155], v[180:183], v[212:215], v[152:155]
    v_mfma_f32_16x16x32_bf16 v[152:155], v[204:207], v[224:227], v[152:155]
    v_mfma_f32_16x16x32_bf16 v[156:159], v[180:183], v[216:219], v[156:159]
    v_mfma_f32_16x16x32_bf16 v[156:159], v[204:207], v[228:231], v[156:159]
    s_setprio 0
.p2align 6
K3_x_loop:
    s_mov_b32 m0, s48
    ds_read_b128 v[208:211], v4 offset:0
    ds_read_b128 v[212:215], v4 offset:1024
    ds_read_b128 v[216:219], v4 offset:2048
    buffer_load_dwordx4 v254, s[20:23], s47 offen offset:0 lds
    ds_read_b128 v[220:223], v4 offset:3072
    ds_read_b128 v[224:227], v4 offset:4096
    ds_read_b128 v[228:231], v4 offset:5120
    buffer_load_dwordx4 v254, s[20:23], s47 offen offset:1024 lds
    s_add_u32 m0, s34, 0
    ds_read_b64_tr_b16 v[160:161], v5 offset:0
    ds_read_b64_tr_b16 v[162:163], v6 offset:0
    ds_read_b64_tr_b16 v[184:185], v5 offset:12288
    buffer_load_dwordx4 v1, s[8:11], s33 offen nt lds
    s_add_u32 m0, s34, 1024
    ds_read_b64_tr_b16 v[186:187], v6 offset:12288
    ds_read_b64_tr_b16 v[164:165], v5 offset:1024
    ds_read_b64_tr_b16 v[166:167], v6 offset:1024
    buffer_load_dwordx4 v2, s[8:11], s33 offen nt lds
    s_add_u32 m0, s34, 2048
    ds_read_b64_tr_b16 v[188:189], v5 offset:13312
    ds_read_b64_tr_b16 v[190:191], v6 offset:13312
    ds_read_b64_tr_b16 v[168:169], v5 offset:2048
    buffer_load_dwordx4 v3, s[8:11], s33 offen nt lds
    s_add_u32 m0, s34, 3072
    ds_read_b64_tr_b16 v[170:171], v6 offset:2048
    ds_read_b64_tr_b16 v[192:193], v5 offset:14336
    ds_read_b64_tr_b16 v[194:195], v6 offset:14336
    buffer_load_dwordx4 v1, s[8:11], s45 offen nt lds
    s_add_u32 m0, s34, 4096
    ds_read_b64_tr_b16 v[172:173], v5 offset:3072
    ds_read_b64_tr_b16 v[174:175], v6 offset:3072
    ds_read_b64_tr_b16 v[196:197], v5 offset:15360
    buffer_load_dwordx4 v2, s[8:11], s45 offen nt lds
    s_add_u32 m0, s34, 5120
    ds_read_b64_tr_b16 v[198:199], v6 offset:15360
    ds_read_b64_tr_b16 v[176:177], v5 offset:4096
    ds_read_b64_tr_b16 v[178:179], v6 offset:4096
    buffer_load_dwordx4 v3, s[8:11], s45 offen nt lds
    ds_read_b64_tr_b16 v[200:201], v5 offset:16384
    ds_read_b64_tr_b16 v[202:203], v6 offset:16384
    ds_read_b64_tr_b16 v[180:181], v5 offset:5120
    ds_read_b64_tr_b16 v[182:183], v6 offset:5120
    ds_read_b64_tr_b16 v[204:205], v5 offset:17408
    ds_read_b64_tr_b16 v[206:207], v6 offset:17408
    s_waitcnt vmcnt(8)
    s_waitcnt lgkmcnt(0)
    s_setprio 2
    s_barrier
    v_mfma_f32_16x16x32_bf16 v[16:19], v[160:163], v[208:211], v[16:19]
    v_mfma_f32_16x16x32_bf16 v[16:19], v[184:187], v[220:223], v[16:19]
    s_add_u32 s48, s48, 24576
    v_mfma_f32_16x16x32_bf16 v[20:23], v[160:163], v[212:215], v[20:23]
    v_mfma_f32_16x16x32_bf16 v[20:23], v[184:187], v[224:227], v[20:23]
    s_cmp_eq_u32 s48, s50
    v_mfma_f32_16x16x32_bf16 v[24:27], v[160:163], v[216:219], v[24:27]
    v_mfma_f32_16x16x32_bf16 v[24:27], v[184:187], v[228:231], v[24:27]
    s_cselect_b32 s48, s49, s48
    v_mfma_f32_16x16x32_bf16 v[40:43], v[164:167], v[208:211], v[40:43]
    v_mfma_f32_16x16x32_bf16 v[40:43], v[188:191], v[220:223], v[40:43]
    s_sub_u32 s47, s47, 24576
    v_mfma_f32_16x16x32_bf16 v[44:47], v[164:167], v[212:215], v[44:47]
    v_mfma_f32_16x16x32_bf16 v[44:47], v[188:191], v[224:227], v[44:47]
    s_cselect_b32 s44, 1179648, 0
    v_mfma_f32_16x16x32_bf16 v[48:51], v[164:167], v[216:219], v[48:51]
    v_mfma_f32_16x16x32_bf16 v[48:51], v[188:191], v[228:231], v[48:51]
    s_add_u32 s47, s47, s44
    v_mfma_f32_16x16x32_bf16 v[64:67], v[168:171], v[208:211], v[64:67]
    v_mfma_f32_16x16x32_bf16 v[64:67], v[192:195], v[220:223], v[64:67]
    s_sub_u32 s33, s33, 12288
    v_mfma_f32_16x16x32_bf16 v[68:71], v[168:171], v[212:215], v[68:71]
    v_mfma_f32_16x16x32_bf16 v[68:71], v[192:195], v[224:227], v[68:71]
    s_cselect_b32 s10, 0, s10
    v_mfma_f32_16x16x32_bf16 v[72:75], v[168:171], v[216:219], v[72:75]
    v_mfma_f32_16x16x32_bf16 v[72:75], v[192:195], v[228:231], v[72:75]
    s_cselect_b32 s33, 0, s33
    v_mfma_f32_16x16x32_bf16 v[88:91], v[172:175], v[208:211], v[88:91]
    v_mfma_f32_16x16x32_bf16 v[88:91], v[196:199], v[220:223], v[88:91]
    s_add_u32 s45, s33, 3072
    v_mfma_f32_16x16x32_bf16 v[92:95], v[172:175], v[212:215], v[92:95]
    v_mfma_f32_16x16x32_bf16 v[92:95], v[196:199], v[224:227], v[92:95]
    s_add_u32 s39, s39, 24576
    v_mfma_f32_16x16x32_bf16 v[96:99], v[172:175], v[216:219], v[96:99]
    v_mfma_f32_16x16x32_bf16 v[96:99], v[196:199], v[228:231], v[96:99]
    s_cmp_eq_u32 s39, 73728
    v_mfma_f32_16x16x32_bf16 v[112:115], v[176:179], v[208:211], v[112:115]
    v_mfma_f32_16x16x32_bf16 v[112:115], v[200:203], v[220:223], v[112:115]
    s_cselect_b32 s39, 0, s39
    v_mfma_f32_16x16x32_bf16 v[116:119], v[176:179], v[212:215], v[116:119]
    v_mfma_f32_16x16x32_bf16 v[116:119], v[200:203], v[224:227], v[116:119]
    v_add_u32 v4, s39, v9
    v_mfma_f32_16x16x32_bf16 v[120:123], v[176:179], v[216:219], v[120:123]
    v_mfma_f32_16x16x32_bf16 v[120:123], v[200:203], v[228:231], v[120:123]
    v_mfma_f32_16x16x32_bf16 v[136:139], v[180:183], v[208:211], v[136:139]
    v_mfma_f32_16x16x32_bf16 v[136:139], v[204:207], v[220:223], v[136:139]
    v_mfma_f32_16x16x32_bf16 v[140:143], v[180:183], v[212:215], v[140:143]
    v_mfma_f32_16x16x32_bf16 v[140:143], v[204:207], v[224:227], v[140:143]
    v_mfma_f32_16x16x32_bf16 v[144:147], v[180:183], v[216:219], v[144:147]
    v_mfma_f32_16x16x32_bf16 v[144:147], v[204:207], v[228:231], v[144:147]
    s_setprio 0
    s_mov_b32 m0, s48
    ds_read_b128 v[208:211], v4 offset:0
    buffer_load_dwordx4 v254, s[20:23], s47 offen offset:0 lds
    ds_read_b128 v[212:215], v4 offset:1024
    buffer_load_dwordx4 v254, s[20:23], s47 offen offset:1024 lds
    ds_read_b128 v[216:219], v4 offset:2048
    ds_read_b128 v[220:223], v4 offset:3072
    ds_read_b128 v[224:227], v4 offset:4096
    ds_read_b128 v[228:231], v4 offset:5120
    s_waitcnt vmcnt(8)
    s_waitcnt lgkmcnt(0)
    s_setprio 2
    s_barrier
    v_mfma_f32_16x16x32_bf16 v[28:31], v[160:163], v[208:211], v[28:31]
    v_mfma_f32_16x16x32_bf16 v[28:31], v[184:187], v[220:223], v[28:31]
    s_add_u32 s48, s48, 24576
    v_mfma_f32_16x16x32_bf16 v[32:35], v[160:163], v[212:215], v[32:35]
    v_mfma_f32_16x16x32_bf16 v[32:35], v[184:187], v[224:227], v[32:35]
    s_cmp_eq_u32 s48, s50
    v_mfma_f32_16x16x32_bf16 v[36:39], v[160:163], v[216:219], v[36:39]
    v_mfma_f32_16x16x32_bf16 v[36:39], v[184:187], v[228:231], v[36:39]
    s_cselect_b32 s48, s49, s48
    v_mfma_f32_16x16x32_bf16 v[52:55], v[164:167], v[208:211], v[52:55]
    v_mfma_f32_16x16x32_bf16 v[52:55], v[188:191], v[220:223], v[52:55]
    s_sub_u32 s47, s47, 24576
    v_mfma_f32_16x16x32_bf16 v[56:59], v[164:167], v[212:215], v[56:59]
    v_mfma_f32_16x16x32_bf16 v[56:59], v[188:191], v[224:227], v[56:59]
    s_cselect_b32 s44, 1179648, 0
    v_mfma_f32_16x16x32_bf16 v[60:63], v[164:167], v[216:219], v[60:63]
    v_mfma_f32_16x16x32_bf16 v[60:63], v[188:191], v[228:231], v[60:63]
    s_add_u32 s47, s47, s44
    v_mfma_f32_16x16x32_bf16 v[76:79], v[168:171], v[208:211], v[76:79]
    v_mfma_f32_16x16x32_bf16 v[76:79], v[192:195], v[220:223], v[76:79]
    s_add_u32 s39, s39, 24576
    v_mfma_f32_16x16x32_bf16 v[80:83], v[168:171], v[212:215], v[80:83]
    v_mfma_f32_16x16x32_bf16 v[80:83], v[192:195], v[224:227], v[80:83]
    s_cmp_eq_u32 s39, 73728
    v_mfma_f32_16x16x32_bf16 v[84:87], v[168:171], v[216:219], v[84:87]
    v_mfma_f32_16x16x32_bf16 v[84:87], v[192:195], v[228:231], v[84:87]
    s_cselect_b32 s39, 0, s39
    v_mfma_f32_16x16x32_bf16 v[100:103], v[172:175], v[208:211], v[100:103]
    v_mfma_f32_16x16x32_bf16 v[100:103], v[196:199], v[220:223], v[100:103]
    v_add_u32 v4, s39, v9
    v_mfma_f32_16x16x32_bf16 v[104:107], v[172:175], v[212:215], v[104:107]
    v_mfma_f32_16x16x32_bf16 v[104:107], v[196:199], v[224:227], v[104:107]
    s_add_u32 s40, s40, 24576
    v_mfma_f32_16x16x32_bf16 v[108:111], v[172:175], v[216:219], v[108:111]
    v_mfma_f32_16x16x32_bf16 v[108:111], v[196:199], v[228:231], v[108:111]
    s_cmp_eq_u32 s40, 73728
    v_mfma_f32_16x16x32_bf16 v[124:127], v[176:179], v[208:211], v[124:127]
    v_mfma_f32_16x16x32_bf16 v[124:127], v[200:203], v[220:223], v[124:127]
    s_cselect_b32 s40, 0, s40
    v_mfma_f32_16x16x32_bf16 v[128:131], v[176:179], v[212:215], v[128:131]
    v_mfma_f32_16x16x32_bf16 v[128:131], v[200:203], v[224:227], v[128:131]
    v_add_u32 v5, s40, v10
    v_mfma_f32_16x16x32_bf16 v[132:135], v[176:179], v[216:219], v[132:135]
    v_mfma_f32_16x16x32_bf16 v[132:135], v[200:203], v[228:231], v[132:135]
    v_add_u32 v6, s40, v11
    v_mfma_f32_16x16x32_bf16 v[148:151], v[180:183], v[208:211], v[148:151]
    v_mfma_f32_16x16x32_bf16 v[148:151], v[204:207], v[220:223], v[148:151]
    v_mfma_f32_16x16x32_bf16 v[152:155], v[180:183], v[212:215], v[152:155]
    v_mfma_f32_16x16x32_bf16 v[152:155], v[204:207], v[224:227], v[152:155]
    v_mfma_f32_16x16x32_bf16 v[156:159], v[180:183], v[216:219], v[156:159]
    v_mfma_f32_16x16x32_bf16 v[156:159], v[204:207], v[228:231], v[156:159]
    s_setprio 0
    s_mov_b32 m0, s48
    ds_read_b128 v[208:211], v4 offset:0
    ds_read_b128 v[212:215], v4 offset:1024
    ds_read_b128 v[216:219], v4 offset:2048
    ds_read_b128 v[220:223], v4 offset:3072
    ds_read_b128 v[224:227], v4 offset:4096
    ds_read_b128 v[228:231], v4 offset:5120
    ds_read_b64_tr_b16 v[160:161], v5 offset:0
    ds_read_b64_tr_b16 v[162:163], v6 offset:0
    ds_read_b64_tr_b16 v[184:185], v5 offset:12288
    ds_read_b64_tr_b16 v[186:187], v6 offset:12288
    ds_read_b64_tr_b16 v[164:165], v5 offset:1024
    ds_read_b64_tr_b16 v[166:167], v6 offset:1024
    ds_read_b64_tr_b16 v[188:189], v5 offset:13312
    ds_read_b64_tr_b16 v[190:191], v6 offset:13312
    ds_read_b64_tr_b16 v[168:169], v5 offset:2048
    buffer_load_dwordx4 v254, s[20:23], s47 offen offset:0 lds
    ds_read_b64_tr_b16 v[170:171], v6 offset:2048
    ds_read_b64_tr_b16 v[192:193], v5 offset:14336
    ds_read_b64_tr_b16 v[194:195], v6 offset:14336
    ds_read_b64_tr_b16 v[172:173], v5 offset:3072
    ds_read_b64_tr_b16 v[174:175], v6 offset:3072
    ds_read_b64_tr_b16 v[196:197], v5 offset:15360
    ds_read_b64_tr_b16 v[198:199], v6 offset:15360
    ds_read_b64_tr_b16 v[176:177], v5 offset:4096
    ds_read_b64_tr_b16 v[178:179], v6 offset:4096
    ds_read_b64_tr_b16 v[200:201], v5 offset:16384
    ds_read_b64_tr_b16 v[202:203], v6 offset:16384
    ds_read_b64_tr_b16 v[180:181], v5 offset:5120
    ds_read_b64_tr_b16 v[182:183], v6 offset:5120
    ds_read_b64_tr_b16 v[204:205], v5 offset:17408
    ds_read_b64_tr_b16 v[206:207], v6 offset:17408
    buffer_load_dwordx4 v254, s[20:23], s47 offen offset:1024 lds
    s_waitcnt vmcnt(2)
    s_waitcnt lgkmcnt(0)
    s_setprio 2
    s_barrier
    v_mfma_f32_16x16x32_bf16 v[16:19], v[160:163], v[208:211], v[16:19]
    v_mfma_f32_16x16x32_bf16 v[16:19], v[184:187], v[220:223], v[16:19]
    s_add_u32 s48, s48, 24576
    v_mfma_f32_16x16x32_bf16 v[20:23], v[160:163], v[212:215], v[20:23]
    v_mfma_f32_16x16x32_bf16 v[20:23], v[184:187], v[224:227], v[20:23]
    s_cmp_eq_u32 s48, s50
    v_mfma_f32_16x16x32_bf16 v[24:27], v[160:163], v[216:219], v[24:27]
    v_mfma_f32_16x16x32_bf16 v[24:27], v[184:187], v[228:231], v[24:27]
    s_cselect_b32 s48, s49, s48
    v_mfma_f32_16x16x32_bf16 v[40:43], v[164:167], v[208:211], v[40:43]
    v_mfma_f32_16x16x32_bf16 v[40:43], v[188:191], v[220:223], v[40:43]
    s_sub_u32 s47, s47, 24576
    v_mfma_f32_16x16x32_bf16 v[44:47], v[164:167], v[212:215], v[44:47]
    v_mfma_f32_16x16x32_bf16 v[44:47], v[188:191], v[224:227], v[44:47]
    s_cselect_b32 s44, 1179648, 0
    v_mfma_f32_16x16x32_bf16 v[48:51], v[164:167], v[216:219], v[48:51]
    v_mfma_f32_16x16x32_bf16 v[48:51], v[188:191], v[228:231], v[48:51]
    s_add_u32 s47, s47, s44
    v_mfma_f32_16x16x32_bf16 v[64:67], v[168:171], v[208:211], v[64:67]
    v_mfma_f32_16x16x32_bf16 v[64:67], v[192:195], v[220:223], v[64:67]
    s_add_u32 s39, s39, 24576
    v_mfma_f32_16x16x32_bf16 v[68:71], v[168:171], v[212:215], v[68:71]
    v_mfma_f32_16x16x32_bf16 v[68:71], v[192:195], v[224:227], v[68:71]
    s_cmp_eq_u32 s39, 73728
    v_mfma_f32_16x16x32_bf16 v[72:75], v[168:171], v[216:219], v[72:75]
    v_mfma_f32_16x16x32_bf16 v[72:75], v[192:195], v[228:231], v[72:75]
    s_cselect_b32 s39, 0, s39
    v_mfma_f32_16x16x32_bf16 v[88:91], v[172:175], v[208:211], v[88:91]
    v_mfma_f32_16x16x32_bf16 v[88:91], v[196:199], v[220:223], v[88:91]
    v_add_u32 v4, s39, v9
    v_mfma_f32_16x16x32_bf16 v[92:95], v[172:175], v[212:215], v[92:95]
    v_mfma_f32_16x16x32_bf16 v[92:95], v[196:199], v[224:227], v[92:95]
    s_sub_u32 s37, s43, 6
    v_mfma_f32_16x16x32_bf16 v[96:99], v[172:175], v[216:219], v[96:99]
    v_mfma_f32_16x16x32_bf16 v[96:99], v[196:199], v[228:231], v[96:99]
    s_sub_u32 s43, s43, 1
    v_mfma_f32_16x16x32_bf16 v[112:115], v[176:179], v[208:211], v[112:115]
    v_mfma_f32_16x16x32_bf16 v[112:115], v[200:203], v[220:223], v[112:115]
    v_mfma_f32_16x16x32_bf16 v[116:119], v[176:179], v[212:215], v[116:119]
    v_mfma_f32_16x16x32_bf16 v[116:119], v[200:203], v[224:227], v[116:119]
    v_mfma_f32_16x16x32_bf16 v[120:123], v[176:179], v[216:219], v[120:123]
    v_mfma_f32_16x16x32_bf16 v[120:123], v[200:203], v[228:231], v[120:123]
    v_mfma_f32_16x16x32_bf16 v[136:139], v[180:183], v[208:211], v[136:139]
    v_mfma_f32_16x16x32_bf16 v[136:139], v[204:207], v[220:223], v[136:139]
    v_mfma_f32_16x16x32_bf16 v[140:143], v[180:183], v[212:215], v[140:143]
    v_mfma_f32_16x16x32_bf16 v[140:143], v[204:207], v[224:227], v[140:143]
    v_mfma_f32_16x16x32_bf16 v[144:147], v[180:183], v[216:219], v[144:147]
    v_mfma_f32_16x16x32_bf16 v[144:147], v[204:207], v[228:231], v[144:147]
    s_setprio 0
    s_cmp_lt_u32 s37, 6
    s_cbranch_scc0 K3_xl3_xr
    ds_read2_b32 v[240:241], v7 offset0:0 offset1:3
    ds_read2_b32 v[242:243], v7 offset0:6 offset1:9
    ds_read2_b32 v[244:245], v7 offset0:1 offset1:4
    ds_read2_b32 v[246:247], v7 offset0:7 offset1:10
    ds_read2_b32 v[248:249], v7 offset0:2 offset1:5
    ds_read2_b32 v[250:251], v7 offset0:8 offset1:11
K3_xl3_xr:
    s_mov_b32 m0, s48
    ds_read_b128 v[208:211], v4 offset:0
    buffer_load_dwordx4 v254, s[20:23], s47 offen offset:0 lds
    ds_read_b128 v[212:215], v4 offset:1024
    buffer_load_dwordx4 v254, s[20:23], s47 offen offset:1024 lds
    ds_read_b128 v[216:219], v4 offset:2048
    ds_read_b128 v[220:223], v4 offset:3072
    ds_read_b128 v[224:227], v4 offset:4096
    ds_read_b128 v[228:231], v4 offset:5120
    s_cmp_lt_u32 s37, 6
    s_cbranch_scc0 K3_xl3_xn
    s_cmp_lg_u32 s37, 0
    s_cbranch_scc1 K3_xl3_x1
    s_waitcnt vmcnt(2)
    s_waitcnt lgkmcnt(0)
    s_setprio 2
    s_barrier
    v_mfma_f32_16x16x32_bf16 v[16:19], v[240:243], v[232:235], v[16:19]
    v_mfma_f32_16x16x32_bf16 v[20:23], v[240:243], v[236:239], v[20:23]
    v_mfma_f32_16x16x32_bf16 v[24:27], v[244:247], v[232:235], v[24:27]
    v_mfma_f32_16x16x32_bf16 v[28:31], v[244:247], v[236:239], v[28:31]
    v_mfma_f32_16x16x32_bf16 v[32:35], v[248:251], v[232:235], v[32:35]
    v_mfma_f32_16x16x32_bf16 v[36:39], v[248:251], v[236:239], v[36:39]
    s_branch K3_xl3_xd
K3_xl3_x1:
    s_cmp_lg_u32 s37, 1
    s_cbranch_scc1 K3_xl3_x2
    s_waitcnt vmcnt(2)
    s_waitcnt lgkmcnt(0)
    s_setprio 2
    s_barrier
    v_mfma_f32_16x16x32_bf16 v[40:43], v[240:243], v[232:235], v[40:43]
    v_mfma_f32_16x16x32_bf16 v[44:47], v[240:243], v[236:239], v[44:47]
    v_mfma_f32_16x16x32_bf16 v[48:51], v[244:247], v[232:235], v[48:51]
    v_mfma_f32_16x16x32_bf16 v[52:55], v[244:247], v[236:239], v[52:55]
    v_mfma_f32_16x16x32_bf16 v[56:59], v[248:251], v[232:235], v[56:59]
    v_mfma_f32_16x16x32_bf16 v[60:63], v[248:251], v[236:239], v[60:63]
    s_branch K3_xl3_xd
K3_xl3_x2:
    s_cmp_lg_u32 s37, 2
    s_cbranch_scc1 K3_xl3_x3
    s_waitcnt vmcnt(2)
    s_waitcnt lgkmcnt(0)
    s_setprio 2
    s_barrier
    v_mfma_f32_16x16x32_bf16 v[64:67], v[240:243], v[232:235], v[64:67]
    v_mfma_f32_16x16x32_bf16 v[68:71], v[240:243], v[236:239], v[68:71]
    v_mfma_f32_16x16x32_bf16 v[72:75], v[244:247], v[232:235], v[72:75]
    v_mfma_f32_16x16x32_bf16 v[76:79], v[244:247], v[236:239], v[76:79]
    v_mfma_f32_16x16x32_bf16 v[80:83], v[248:251], v[232:235], v[80:83]
    v_mfma_f32_16x16x32_bf16 v[84:87], v[248:251], v[236:239], v[84:87]
    s_branch K3_xl3_xd
K3_xl3_x3:
    s_cmp_lg_u32 s37, 3
    s_cbranch_scc1 K3_xl3_x4
    s_waitcnt vmcnt(2)
    s_waitcnt lgkmcnt(0)
    s_setprio 2
    s_barrier
    v_mfma_f32_16x16x32_bf16 v[88:91], v[240:243], v[232:235], v[88:91]
    v_mfma_f32_16x16x32_bf16 v[92:95], v[240:243], v[236:239], v[92:95]
    v_mfma_f32_16x16x32_bf16 v[96:99], v[244:247], v[232:235], v[96:99]
    v_mfma_f32_16x16x32_bf16 v[100:103], v[244:247], v[236:239], v[100:103]
    v_mfma_f32_16x16x32_bf16 v[104:107], v[248:251], v[232:235], v[104:107]
    v_mfma_f32_16x16x32_bf16 v[108:111], v[248:251], v[236:239], v[108:111]
    s_branch K3_xl3_xd
K3_xl3_x4:
    s_cmp_lg_u32 s37, 4
    s_cbranch_scc1 K3_xl3_x5
    s_waitcnt vmcnt(2)
    s_waitcnt lgkmcnt(0)
    s_setprio 2
    s_barrier
    v_mfma_f32_16x16x32_bf16 v[112:115], v[240:243], v[232:235], v[112:115]
    v_mfma_f32_16x16x32_bf16 v[116:119], v[240:243], v[236:239], v[116:119]
    v_mfma_f32_16x16x32_bf16 v[120:123], v[244:247], v[232:235], v[120:123]
    v_mfma_f32_16x16x32_bf16 v[124:127], v[244:247], v[236:239], v[124:127]
    v_mfma_f32_16x16x32_bf16 v[128:131], v[248:251], v[232:235], v[128:131]
    v_mfma_f32_16x16x32_bf16 v[132:135], v[248:251], v[236:239], v[132:135]
    s_branch K3_xl3_xd
K3_xl3_x5:
    s_waitcnt vmcnt(2)
    s_waitcnt lgkmcnt(0)
    s_setprio 2
    s_barrier
    v_mfma_f32_16x16x32_bf16 v[136:139], v[240:243], v[232:235], v[136:139]
    v_mfma_f32_16x16x32_bf16 v[140:143], v[240:243], v[236:239], v[140:143]
    v_mfma_f32_16x16x32_bf16 v[144:147], v[244:247], v[232:235], v[144:147]
    v_mfma_f32_16x16x32_bf16 v[148:151], v[244:247], v[236:239], v[148:151]
    v_mfma_f32_16x16x32_bf16 v[152:155], v[248:251], v[232:235], v[152:155]
    v_mfma_f32_16x16x32_bf16 v[156:159], v[248:251], v[236:239], v[156:159]
    s_branch K3_xl3_xd
K3_xl3_xn:
    s_waitcnt vmcnt(2)
    s_waitcnt lgkmcnt(0)
    s_setprio 2
    s_barrier
K3_xl3_xd:
    v_mfma_f32_16x16x32_bf16 v[28:31], v[160:163], v[208:211], v[28:31]
    v_mfma_f32_16x16x32_bf16 v[28:31], v[184:187], v[220:223], v[28:31]
    s_add_u32 s48, s48, 24576
    v_mfma_f32_16x16x32_bf16 v[32:35], v[160:163], v[212:215], v[32:35]
    v_mfma_f32_16x16x32_bf16 v[32:35], v[184:187], v[224:227], v[32:35]
    s_cmp_eq_u32 s48, s50
    v_mfma_f32_16x16x32_bf16 v[36:39], v[160:163], v[216:219], v[36:39]
    v_mfma_f32_16x16x32_bf16 v[36:39], v[184:187], v[228:231], v[36:39]
    s_cselect_b32 s48, s49, s48
    v_mfma_f32_16x16x32_bf16 v[52:55], v[164:167], v[208:211], v[52:55]
    v_mfma_f32_16x16x32_bf16 v[52:55], v[188:191], v[220:223], v[52:55]
    s_sub_u32 s47, s47, 24576
    v_mfma_f32_16x16x32_bf16 v[56:59], v[164:167], v[212:215], v[56:59]
    v_mfma_f32_16x16x32_bf16 v[56:59], v[188:191], v[224:227], v[56:59]
    s_cselect_b32 s44, 1179648, 0
    v_mfma_f32_16x16x32_bf16 v[60:63], v[164:167], v[216:219], v[60:63]
    v_mfma_f32_16x16x32_bf16 v[60:63], v[188:191], v[228:231], v[60:63]
    s_add_u32 s47, s47, s44
    v_mfma_f32_16x16x32_bf16 v[76:79], v[168:171], v[208:211], v[76:79]
    v_mfma_f32_16x16x32_bf16 v[76:79], v[192:195], v[220:223], v[76:79]
    s_add_u32 s39, s39, 24576
    v_mfma_f32_16x16x32_bf16 v[80:83], v[168:171], v[212:215], v[80:83]
    v_mfma_f32_16x16x32_bf16 v[80:83], v[192:195], v[224:227], v[80:83]
    s_cmp_eq_u32 s39, 73728
    v_mfma_f32_16x16x32_bf16 v[84:87], v[168:171], v[216:219], v[84:87]
    v_mfma_f32_16x16x32_bf16 v[84:87], v[192:195], v[228:231], v[84:87]
    s_cselect_b32 s39, 0, s39
    v_mfma_f32_16x16x32_bf16 v[100:103], v[172:175], v[208:211], v[100:103]
    v_mfma_f32_16x16x32_bf16 v[100:103], v[196:199], v[220:223], v[100:103]
    v_add_u32 v4, s39, v9
    v_mfma_f32_16x16x32_bf16 v[104:107], v[172:175], v[212:215], v[104:107]
    v_mfma_f32_16x16x32_bf16 v[104:107], v[196:199], v[224:227], v[104:107]
    s_add_u32 s40, s40, 24576
    v_mfma_f32_16x16x32_bf16 v[108:111], v[172:175], v[216:219], v[108:111]
    v_mfma_f32_16x16x32_bf16 v[108:111], v[196:199], v[228:231], v[108:111]
    s_cmp_eq_u32 s40, 73728
    v_mfma_f32_16x16x32_bf16 v[124:127], v[176:179], v[208:211], v[124:127]
    v_mfma_f32_16x16x32_bf16 v[124:127], v[200:203], v[220:223], v[124:127]
    s_cselect_b32 s40, 0, s40
    v_mfma_f32_16x16x32_bf16 v[128:131], v[176:179], v[212:215], v[128:131]
    v_mfma_f32_16x16x32_bf16 v[128:131], v[200:203], v[224:227], v[128:131]
    v_add_u32 v5, s40, v10
    v_mfma_f32_16x16x32_bf16 v[132:135], v[176:179], v[216:219], v[132:135]
    v_mfma_f32_16x16x32_bf16 v[132:135], v[200:203], v[228:231], v[132:135]
    v_add_u32 v6, s40, v11
    v_mfma_f32_16x16x32_bf16 v[148:151], v[180:183], v[208:211], v[148:151]
    v_mfma_f32_16x16x32_bf16 v[148:151], v[204:207], v[220:223], v[148:151]
    v_mfma_f32_16x16x32_bf16 v[152:155], v[180:183], v[212:215], v[152:155]
    v_mfma_f32_16x16x32_bf16 v[152:155], v[204:207], v[224:227], v[152:155]
    v_mfma_f32_16x16x32_bf16 v[156:159], v[180:183], v[216:219], v[156:159]
    v_mfma_f32_16x16x32_bf16 v[156:159], v[204:207], v[228:231], v[156:159]
    s_setprio 0
    s_cmp_lg_u32 s43, -1
    s_cbranch_scc1 K3_x_loop
    s_add_u32 s41, s41, 48
    s_cmp_lg_u32 s41, 144
    s_cbranch_scc1 K3_x_tile
K3_fin:
    s_nop 7
    s_mov_b32 s38, s42
    s_nop 0
    v_cvt_pk_bf16_f32 v240, v16, v20
    v_cvt_pk_bf16_f32 v241, v24, v28
    v_cvt_pk_bf16_f32 v242, v32, v36
    buffer_store_dwordx3 v[240:242], v8, s[12:15], s38 offen offset:0
    v_cvt_pk_bf16_f32 v244, v17, v21
    v_cvt_pk_bf16_f32 v245, v25, v29
    v_cvt_pk_bf16_f32 v246, v33, v37
    buffer_store_dwordx3 v[244:246], v8, s[12:15], s38 offen offset:768
    v_cvt_pk_bf16_f32 v248, v18, v22
    v_cvt_pk_bf16_f32 v249, v26, v30
    v_cvt_pk_bf16_f32 v250, v34, v38
    buffer_store_dwordx3 v[248:250], v8, s[12:15], s38 offen offset:1536
    v_cvt_pk_bf16_f32 v240, v19, v23
    v_cvt_pk_bf16_f32 v241, v27, v31
    v_cvt_pk_bf16_f32 v242, v35, v39
    buffer_store_dwordx3 v[240:242], v8, s[12:15], s38 offen offset:2304
    s_add_u32 s38, s38, 12288
    v_cvt_pk_bf16_f32 v244, v40, v44
    v_cvt_pk_bf16_f32 v245, v48, v52
    v_cvt_pk_bf16_f32 v246, v56, v60
    buffer_store_dwordx3 v[244:246], v8, s[12:15], s38 offen offset:0
    v_cvt_pk_bf16_f32 v248, v41, v45
    v_cvt_pk_bf16_f32 v249, v49, v53
    v_cvt_pk_bf16_f32 v250, v57, v61
    buffer_store_dwordx3 v[248:250], v8, s[12:15], s38 offen offset:768
    v_cvt_pk_bf16_f32 v240, v42, v46
    v_cvt_pk_bf16_f32 v241, v50, v54
    v_cvt_pk_bf16_f32 v242, v58, v62
    buffer_store_dwordx3 v[240:242], v8, s[12:15], s38 offen offset:1536
    v_cvt_pk_bf16_f32 v244, v43, v47
    v_cvt_pk_bf16_f32 v245, v51, v55
    v_cvt_pk_bf16_f32 v246, v59, v63
    buffer_store_dwordx3 v[244:246], v8, s[12:15], s38 offen offset:2304
    s_add_u32 s38, s38, 12288
    v_cvt_pk_bf16_f32 v248, v64, v68
    v_cvt_pk_bf16_f32 v249, v72, v76
    v_cvt_pk_bf16_f32 v250, v80, v84
    buffer_store_dwordx3 v[248:250], v8, s[12:15], s38 offen offset:0
    v_cvt_pk_bf16_f32 v240, v65, v69
    v_cvt_pk_bf16_f32 v241, v73, v77
    v_cvt_pk_bf16_f32 v242, v81, v85
    buffer_store_dwordx3 v[240:242], v8, s[12:15], s38 offen offset:768
    v_cvt_pk_bf16_f32 v244, v66, v70
    v_cvt_pk_bf16_f32 v245, v74, v78
    v_cvt_pk_bf16_f32 v246, v82, v86
    buffer_store_dwordx3 v[244:246], v8, s[12:15], s38 offen offset:1536
    v_cvt_pk_bf16_f32 v248, v67, v71
    v_cvt_pk_bf16_f32 v249, v75, v79
    v_cvt_pk_bf16_f32 v250, v83, v87
    buffer_store_dwordx3 v[248:250], v8, s[12:15], s38 offen offset:2304
    s_add_u32 s38, s38, 12288
    v_cvt_pk_bf16_f32 v240, v88, v92
    v_cvt_pk_bf16_f32 v241, v96, v100
    v_cvt_pk_bf16_f32 v242, v104, v108
    buffer_store_dwordx3 v[240:242], v8, s[12:15], s38 offen offset:0
    v_cvt_pk_bf16_f32 v244, v89, v93
    v_cvt_pk_bf16_f32 v245, v97, v101
    v_cvt_pk_bf16_f32 v246, v105, v109
    buffer_store_dwordx3 v[244:246], v8, s[12:15], s38 offen offset:768
    v_cvt_pk_bf16_f32 v248, v90, v94
    v_cvt_pk_bf16_f32 v249, v98, v102
    v_cvt_pk_bf16_f32 v250, v106, v110
    buffer_store_dwordx3 v[248:250], v8, s[12:15], s38 offen offset:1536
    v_cvt_pk_bf16_f32 v240, v91, v95
    v_cvt_pk_bf16_f32 v241, v99, v103
    v_cvt_pk_bf16_f32 v242, v107, v111
    buffer_store_dwordx3 v[240:242], v8, s[12:15], s38 offen offset:2304
    s_add_u32 s38, s38, 12288
    v_cvt_pk_bf16_f32 v244, v112, v116
    v_cvt_pk_bf16_f32 v245, v120, v124
    v_cvt_pk_bf16_f32 v246, v128, v132
    buffer_store_dwordx3 v[244:246], v8, s[12:15], s38 offen offset:0
    v_cvt_pk_bf16_f32 v248, v113, v117
    v_cvt_pk_bf16_f32 v249, v121, v125
    v_cvt_pk_bf16_f32 v250, v129, v133
    buffer_store_dwordx3 v[248:250], v8, s[12:15], s38 offen offset:768
    v_cvt_pk_bf16_f32 v240, v114, v118
    v_cvt_pk_bf16_f32 v241, v122, v126
    v_cvt_pk_bf16_f32 v242, v130, v134
    buffer_store_dwordx3 v[240:242], v8, s[12:15], s38 offen offset:1536
    v_cvt_pk_bf16_f32 v244, v115, v119
    v_cvt_pk_bf16_f32 v245, v123, v127
    v_cvt_pk_bf16_f32 v246, v131, v135
    buffer_store_dwordx3 v[244:246], v8, s[12:15], s38 offen offset:2304
    s_add_u32 s38, s38, 12288
    v_cvt_pk_bf16_f32 v248, v136, v140
    v_cvt_pk_bf16_f32 v249, v144, v148
    v_cvt_pk_bf16_f32 v250, v152, v156
    buffer_store_dwordx3 v[248:250], v8, s[12:15], s38 offen offset:0
    v_cvt_pk_bf16_f32 v240, v137, v141
    v_cvt_pk_bf16_f32 v241, v145, v149
    v_cvt_pk_bf16_f32 v242, v153, v157
    buffer_store_dwordx3 v[240:242], v8, s[12:15], s38 offen offset:768
    v_cvt_pk_bf16_f32 v244, v138, v142
    v_cvt_pk_bf16_f32 v245, v146, v150
    v_cvt_pk_bf16_f32 v246, v154, v158
    buffer_store_dwordx3 v[244:246], v8, s[12:15], s38 offen offset:1536
    v_cvt_pk_bf16_f32 v248, v139, v143
    v_cvt_pk_bf16_f32 v249, v147, v151
    v_cvt_pk_bf16_f32 v250, v155, v159
    buffer_store_dwordx3 v[248:250], v8, s[12:15], s38 offen offset:2304
    s_sub_u32 s42, s42, 147456
K3_end:
    s_endpgm
.section .rodata,"a"
.p2align 6
.amdhsa_kernel gemm1_kernel
  .amdhsa_next_free_vgpr 256
  .amdhsa_next_free_sgpr 100
  .amdhsa_accum_offset 256
  .amdhsa_group_segment_fixed_size 0
  .amdhsa_kernarg_size 72
  .amdhsa_user_sgpr_count 2
  .amdhsa_user_sgpr_kernarg_segment_ptr 1
  .amdhsa_system_sgpr_workgroup_id_x 1
  .amdhsa_float_denorm_mode_32 3
.end_amdhsa_kernel
.p2align 6
.amdhsa_kernel gemm2_kernel
  .amdhsa_next_free_vgpr 256
  .amdhsa_next_free_sgpr 100
  .amdhsa_accum_offset 256
  .amdhsa_group_segment_fixed_size 0
  .amdhsa_kernarg_size 72
  .amdhsa_user_sgpr_count 2
  .amdhsa_user_sgpr_kernarg_segment_ptr 1
  .amdhsa_system_sgpr_workgroup_id_x 1
  .amdhsa_float_denorm_mode_32 3
.end_amdhsa_kernel
```
